```python
import torch

def _softmax(x, axis=-1):
    return torch.softmax(x, dim=axis)
def _gelu(x):
    return torch.nn.functional.gelu(x, approximate="tanh")
def _silu(x):
    return torch.nn.functional.silu(x)
def _sigmoid(x):
    return torch.sigmoid(x)
def _layernorm(x, axis=-1, eps=1e-5):
    m = x.mean(dim=axis, keepdim=True)
    v = x.var(dim=axis, keepdim=True, unbiased=False)
    return (x - m) / torch.sqrt(v + eps)
def _scatter_add(tgt, idx, src, axis=0):
    return tgt.clone().index_add_(axis, idx, src)
def _segment_sum(src, seg, n):
    out = torch.zeros((n,) + src.shape[1:], dtype=src.dtype)
    return out.index_add_(0, seg, src)
def _pad(x, pw):
    flat = tuple(v for pair in reversed(pw) for v in pair)
    return torch.nn.functional.pad(x, flat)

kernel_name = 'recurrent_scan__mha_block__glu_gated_reglu__prompt'

def setup_inputs():

    _w = (lambda a: (lambda t: t.to(torch.bfloat16) if t.is_floating_point() else t)(torch.as_tensor(a)))
    def _A_setup():
        B, S, D, H = 1, 2048, 576, 32
        return {
            "x": _w((lambda *s: torch.randn(*s, dtype=torch.bfloat16) * 0.05)(B, S, D)),
            "wqkv": _w((lambda *s: torch.randn(*s, dtype=torch.bfloat16) * 0.2)(D, 3 * D)),
            "wo": _w((lambda *s: torch.randn(*s, dtype=torch.bfloat16) * 0.2)(D, D)),
        }
    _A_in = _A_setup()

    def _B_setup():
        B, S, D, F = 1, 2048, 576, 4608
        return {
            "x": _w((lambda *s: torch.randn(*s, dtype=torch.bfloat16) * 0.05)(B, S, D)),
            "W_gate": _w((lambda *s: torch.randn(*s, dtype=torch.bfloat16) * 0.1)(D, F) * (2.0 / D) ** 0.5),
            "W_up": _w((lambda *s: torch.randn(*s, dtype=torch.bfloat16) * 0.1)(D, F) * (2.0 / D) ** 0.5),
            "W_down": _w((lambda *s: torch.randn(*s, dtype=torch.bfloat16) * 0.1)(F, D) * (1.0 / F) ** 0.5),
        }
    _B_in = _B_setup()

    return {
        "A_x": _A_in["x"],
        "A_wqkv": _A_in["wqkv"],
        "A_wo": _A_in["wo"],
        "B_x": _B_in["x"],
        "B_W_gate": _B_in["W_gate"],
        "B_W_up": _B_in["W_up"],
        "B_W_down": _B_in["W_down"],
    }

def reference(A_x, A_wqkv, A_wo, B_x, B_W_gate, B_W_up, B_W_down):
    def _A_ref(x, wqkv, wo):
        B, S, D = x.shape
        H = 32
        Dh = D // H
        qkv = (lambda x, *d: x.permute(*d))((x @ wqkv).reshape(B, S, 3, H, Dh), 2, 0, 3, 1, 4)
        q, k, v = qkv[0], qkv[1], qkv[2]
        scores = torch.einsum("bhqd,bhkd->bhqk", q, k) * (Dh ** -0.5)
        p = _softmax(scores, axis=-1)
        o = torch.einsum("bhqk,bhkd->bhqd", p, v)
        return (lambda x, *d: x.permute(*d))(o, 0, 2, 1, 3).reshape(B, S, D) @ wo

    def _B_ref(x, W_gate, W_up, W_down):
        gate = torch.einsum("bsd,df->bsf", x, W_gate)
        up = torch.einsum("bsd,df->bsf", x, W_up)
        gate = gate * (lambda x, dt: x.to(dt))(gate > 0, gate.dtype)
        h = gate * up
        return torch.einsum("bsf,fd->bsd", h, W_down)

    x = A_x
    xn = _layernorm(x, axis=-1)
    s = _A_ref(xn, A_wqkv, A_wo)
    g = _silu(_B_ref(xn, B_W_gate, B_W_up, B_W_down))
    return x + s * g
```

```asm
; @launch grid=(256,1,1) block=(256,1,1) lds=163840
.amdgcn_target "amdgcn-amd-amdhsa--gfx950"
.text
.globl recurrent_scan__mha_block__glu_gated_reglu__prompt_kernel
.p2align 12
.p2align 8
.type recurrent_scan__mha_block__glu_gated_reglu__prompt_kernel,@function
recurrent_scan__mha_block__glu_gated_reglu__prompt_kernel:
s_load_dwordx2 s[4:5], s[0:1], 0
s_cmp_ge_u32 s2, 0x100
s_cbranch_scc1 L_exit
v_lshrrev_b32 v1, 6, v0
v_and_b32 v0, 63, v0
s_and_b32 s60, s2, 7
s_lshr_b32 s45, s2, 3
s_getpc_b64 s[100:101]
L_pc:
s_lshl_b32 s46, s45, 2
v_add_u32 v5, s46, v1
v_lshl_add_u32 v5, v0, 7, v5
v_lshlrev_b32 v5, 7, v5
v_min_u32 v5, L_codeend-L_pc-4, v5
v_add_co_u32 v6, vcc, s100, v5
v_mov_b32 v7, s101
s_mov_b64 exec, 63
v_addc_co_u32 v7, vcc, 0, v7, vcc
global_load_dword a255, v[6:7], off
s_mov_b64 exec, -1
v_readfirstlane_b32 s40, v1
s_lshr_b32 s61, s45, 2
s_lshr_b32 s42, s45, 2
s_lshl_b32 s42, s42, 1
s_and_b32 s62, s60, 1
s_add_u32 s42, s42, s62
s_and_b32 s82, s45, 3
s_lshl_b32 s47, s82, 3
s_bitcmp1_b32 s45, 2
s_cselect_b32 s83, 0, 0x10103840
s_cselect_b32 s46, 0x16100800, 0
s_add_u32 s46, s46, 0x1000000
s_lshr_b32 s83, s83, s47
s_and_b32 s83, s83, 0xff
s_sub_u32 s83, 0x48, s83
s_lshr_b32 s47, s46, s47
s_and_b32 s47, s47, 0xff
s_min_u32 s82, s82, 2
s_lshl_b32 s46, s40, 3
s_add_u32 s46, s46, 32
s_cmp_eq_u32 s40, 3
s_cselect_b32 s83, s83, s46
s_cselect_b32 s82, s47, s82
s_load_dwordx2 s[80:81], s[0:1], s83
s_lshl_b32 s82, s82, 21
s_lshl_b32 s46, s2, 7
s_add_u32 s82, s82, s46
s_mul_i32 s58, s40, 0x4800
s_lshl_b32 s62, s42, 2
s_add_u32 s62, s62, s40
s_lshl_b32 s62, s62, 5
v_lshrrev_b32 v3, 3, v0
v_lshrrev_b32 v4, 4, v0
v_and_b32 v168, 7, v0
v_xor_b32 v168, v168, v4
v_xor_b32 v169, 4, v168
v_add_u32 v4, s62, v3
v_mul_u32_u24 v4, 0x480, v4
v_lshl_add_u32 v170, v168, 4, v4
v_lshl_add_u32 v171, v169, 4, v4
v_add_u32 v171, 0x2000, v171
v_add_u32 v168, 0x780, v170
v_add_u32 v169, 0x780, v171
s_lshr_b32 s43, s60, 1
s_lshl_b32 s43, s43, 2
s_and_b32 s63, s45, 3
s_add_u32 s43, s43, s63
s_and_b32 s59, s43, 1
s_mul_i32 s49, s59, 0x4800
s_waitcnt lgkmcnt(0)
s_sub_u32 s98, s4, 0x780
s_subb_u32 s99, s5, 0
s_add_u32 s96, s98, s49
s_addc_u32 s97, s99, 0
s_add_u32 m0, s58, 0
s_nop 0
global_load_lds_dwordx4 v168, s[96:97]
global_load_lds_dwordx4 v169, s[96:97] offset:1024
global_load_lds_dwordx4 v170, s[96:97] offset:2048
global_load_lds_dwordx4 v171, s[96:97] offset:3072
s_load_dwordx2 s[16:17], s[0:1], 32
s_load_dwordx2 s[20:21], s[0:1], 40
s_load_dwordx2 s[8:9], s[0:1], 8
s_load_dwordx2 s[12:13], s[0:1], 16
s_load_dwordx2 s[24:25], s[0:1], 48
s_load_dwordx2 s[28:29], s[0:1], 56
s_load_dwordx2 s[32:33], s[0:1], 64
s_load_dwordx2 s[36:37], s[0:1], 72
s_load_dword s83, s[80:81], s82
s_sub_u32 s49, 0x4800, s49
s_add_u32 s98, s98, s49
s_addc_u32 s99, s99, 0
s_mul_i32 s92, s59, 0x48000
s_sub_u32 s93, 0x48000, s92
s_lshl_b32 s44, s60, 2
s_and_b32 s63, s45, 3
s_add_u32 s44, s44, s63
s_lshl_b32 s41, s40, 10
s_mul_i32 s53, s40, 0x1c00
s_mul_i32 s54, s40, 0x1400
s_mov_b32 s6, 0x240000
s_mov_b32 s7, 0x20000
s_mov_b32 s10, 0x1e6000
s_mov_b32 s11, 0x20000
s_mov_b32 s14, 0xa2000
s_mov_b32 s15, 0x20000
s_mov_b32 s18, 0x510000
s_mov_b32 s19, 0x20000
s_mov_b32 s22, 0x510000
s_mov_b32 s23, 0x20000
s_mov_b32 s26, 0x510000
s_mov_b32 s27, 0x20000
s_mov_b32 s30, 0x240000
s_mov_b32 s31, 0x20000
s_mov_b32 s34, 0x100
s_mov_b32 s35, 0x20000
s_mov_b32 s38, 0x10000000
s_mov_b32 s39, 0x20000
s_mov_b32 s50, 0x3f80
s_mov_b32 s51, 0x3f800000
s_mov_b32 s52, 0x3f803f80
v_and_b32 v3, 15, v0
v_lshrrev_b32 v4, 1, v3
v_lshlrev_b32 v3, 7, v3
v_add_u32 v3, s58, v3
v_lshrrev_b32 v11, 4, v0
v_xor_b32 v11, v11, v4
v_xor_b32 v10, 4, v11
v_lshl_add_u32 v11, v11, 4, v3
v_lshl_add_u32 v10, v10, 4, v3
v_mov_b32 v176, s52
v_mov_b32 v177, s52
v_mov_b32 v178, s52
v_mov_b32 v179, s52
v_and_b32 v3, 1, v0
v_lshlrev_b32 v3, 4, v3
v_lshlrev_b32 v3, v3, s50
v_bfe_u32 v4, v0, 1, 1
v_mul_lo_u32 v4, v4, v3
v_sub_u32 v3, v3, v4
v_accvgpr_write_b32 a208, v3
v_accvgpr_write_b32 a209, v4
s_lshl_b32 s3, s59, 7
s_lshl_b32 s94, s59, 9
s_sub_u32 s94, 0x200, s94
s_lshl_b32 s46, s42, 2
s_add_u32 s46, s46, s40
s_mul_i32 s46, s46, 0x14400
s_mul_i32 s47, s43, 0x240
s_and_b32 s47, s47, 0xffffff80
s_add_u32 s46, s46, s47
v_mul_u32_u24 v4, 0x2400, v0
v_add_u32 v4, s46, v4
v_cmp_gt_u32 vcc, 9, v0
v_mov_b32 v3, 0x80000000
s_nop 0
v_cndmask_b32 v51, v3, v4, vcc
v_mul_u32_u24 v4, 0x1c72, v0
v_lshrrev_b32 v4, 16, v4
v_mul_u32_u24 v3, 9, v4
v_sub_u32 v3, v0, v3
v_mul_u32_u24 v3, 0xd80, v3
v_lshl_add_u32 v3, v4, 7, v3
s_lshl_b32 s46, s42, 2
s_add_u32 s46, s46, s40
s_mul_i32 s46, s46, 0x7980
s_mul_i32 s47, s43, 0xd8
s_and_b32 s47, s47, 0xffffff80
s_add_u32 s46, s46, s47
v_add_u32 v3, s46, v3
v_cmp_gt_u32 vcc, 27, v0
v_mov_b32 v4, 0x80000000
s_nop 0
v_cndmask_b32 v53, v4, v3, vcc
v_lshrrev_b32 v3, 3, v0
v_and_b32 v5, 6, v3
v_and_b32 v4, 7, v0
v_xor_b32 v4, v4, v5
s_and_b32 s46, s40, 1
s_lshl_b32 s46, s46, 4
s_lshr_b32 s47, s40, 1
s_lshl_b32 s47, s47, 2
s_add_u32 s46, s46, s47
v_and_b32 v5, 4, v3
v_add_u32 v7, v3, v5
v_add_u32 v7, s46, v7
s_mul_i32 s47, s43, 0x120
s_lshl_b32 s62, s59, 5
s_add_u32 s62, s62, s47
s_lshl_b32 s63, s59, 8
s_sub_u32 s63, 0x100, s63
s_add_u32 s63, s63, s47
s_lshl_b32 s46, s62, 1
v_mul_u32_u24 v5, 0x2400, v7
v_lshl_add_u32 v5, v4, 4, v5
v_add_u32 v14, s46, v5
s_add_u32 m0, s58, 0xf00
s_nop 0
global_load_lds_dwordx4 v168, s[96:97] offset:256
global_load_lds_dwordx4 v169, s[96:97] offset:1280
global_load_lds_dwordx4 v170, s[96:97] offset:2304
global_load_lds_dwordx4 v171, s[96:97] offset:3328
s_lshl_b32 s46, s63, 1
v_lshrrev_b32 v5, 2, v4
v_lshl_add_u32 v5, v5, 5, v7
v_mul_u32_u24 v5, 0x2400, v5
v_and_b32 v6, 3, v4
v_lshl_add_u32 v5, v6, 4, v5
v_add_u32 v15, s46, v5
s_lshl_b32 s46, s40, 3
v_add_u32 v5, s46, v3
v_add_u32 v6, s62, v5
v_mul_u32_u24 v6, 0x480, v6
v_lshl_add_u32 v16, v4, 4, v6
v_add_u32 v6, s63, v5
v_mul_u32_u24 v6, 0x480, v6
v_lshl_add_u32 v17, v4, 4, v6
v_bfe_u32 v4, v0, 2, 3
v_and_b32 v7, 3, v0
v_lshrrev_b32 v3, 5, v0
v_lshlrev_b32 v8, 10, v3
v_lshl_add_u32 v8, v4, 7, v8
v_lshl_add_u32 v8, v7, 3, v8
v_lshrrev_b32 v5, 1, v4
v_xor_b32 v6, 0, v5
v_lshl_add_u32 v18, v6, 5, v8
v_add_u32 v19, 0x10000, v18
v_add_u32 v20, 0x20000, v18
v_xor_b32 v6, 1, v5
v_lshl_add_u32 v21, v6, 5, v8
v_add_u32 v22, 0x10000, v21
v_add_u32 v23, 0x20000, v21
v_xor_b32 v6, 2, v5
v_lshl_add_u32 v24, v6, 5, v8
v_add_u32 v25, 0x10000, v24
v_add_u32 v26, 0x20000, v24
v_xor_b32 v6, 3, v5
v_lshl_add_u32 v27, v6, 5, v8
v_add_u32 v28, 0x10000, v27
v_add_u32 v29, 0x20000, v27
s_mul_i32 s46, s43, 0xd8
s_and_b32 s46, s46, -16
s_mul_i32 s47, s40, 0x1b000
s_add_u32 s46, s46, s47
v_add_u32 v3, 0, v0
v_mul_u32_u24 v4, 0x124a, v3
v_lshrrev_b32 v4, 16, v4
v_mul_u32_u24 v5, 14, v4
v_sub_u32 v3, v3, v5
v_and_b32 v5, 12, v4
v_and_b32 v7, 3, v4
v_lshl_add_u32 v7, v5, 1, v7
v_lshrrev_b32 v5, 4, v4
v_lshl_add_u32 v7, v5, 2, v7
v_mul_u32_u24 v7, 0xd80, v7
v_lshl_add_u32 v7, v3, 4, v7
v_add_u32 v30, s46, v7
v_add_u32 v3, 64, v0
v_mul_u32_u24 v4, 0x124a, v3
v_lshrrev_b32 v4, 16, v4
v_mul_u32_u24 v5, 14, v4
v_sub_u32 v3, v3, v5
v_and_b32 v5, 12, v4
v_and_b32 v7, 3, v4
v_lshl_add_u32 v7, v5, 1, v7
v_lshrrev_b32 v5, 4, v4
v_lshl_add_u32 v7, v5, 2, v7
v_mul_u32_u24 v7, 0xd80, v7
v_lshl_add_u32 v7, v3, 4, v7
v_add_u32 v31, s46, v7
v_subrev_u32 v31, 0x400, v31
v_add_u32 v3, 0x80, v0
s_add_u32 m0, s58, 0x1e00
s_nop 0
global_load_lds_dwordx4 v168, s[96:97] offset:512
global_load_lds_dwordx4 v169, s[96:97] offset:1536
s_mov_b64 exec, 0
s_cmp_eq_u32 s40, 0
s_cbranch_scc1 L_pg0
s_cmp_eq_u32 s40, 1
s_cbranch_scc1 L_pg1
s_cmp_eq_u32 s40, 2
s_cbranch_scc1 L_pg2
s_branch L_pg3
L_tr0:
s_mov_b64 exec, -1
s_waitcnt lgkmcnt(0)
s_waitcnt vmcnt(8)
ds_read_b128 a[0:3], v11
ds_read_b128 a[4:7], v10
global_load_lds_dwordx4 v170, s[96:97] offset:2560
global_load_lds_dwordx4 v171, s[96:97] offset:3584
v_mul_u32_u24 v4, 0x124a, v3
v_lshrrev_b32 v4, 16, v4
v_mul_u32_u24 v5, 14, v4
v_sub_u32 v3, v3, v5
v_and_b32 v5, 12, v4
v_and_b32 v7, 3, v4
v_lshl_add_u32 v7, v5, 1, v7
v_lshrrev_b32 v5, 4, v4
v_lshl_add_u32 v7, v5, 2, v7
v_mul_u32_u24 v7, 0xd80, v7
s_waitcnt vmcnt(8)
ds_read_b128 a[8:11], v11 offset:2048
ds_read_b128 a[12:15], v10 offset:2048
v_lshl_add_u32 v7, v3, 4, v7
v_add_u32 v32, s46, v7
v_subrev_u32 v32, 0x800, v32
v_add_u32 v3, 0xc0, v0
v_mul_u32_u24 v4, 0x124a, v3
v_lshrrev_b32 v4, 16, v4
v_mul_u32_u24 v5, 14, v4
v_sub_u32 v3, v3, v5
v_and_b32 v5, 12, v4
v_and_b32 v7, 3, v4
s_waitcnt lgkmcnt(2)
v_mfma_f32_16x16x32_bf16 v[172:175], v[176:179], a[0:3], 0
s_add_u32 m0, s58, 0x2d00
v_mfma_f32_16x16x32_bf16 v[38:41], a[0:3], a[0:3], 0
global_load_lds_dwordx4 v168, s[96:97] offset:768
global_load_lds_dwordx4 v169, s[96:97] offset:1792
v_mfma_f32_16x16x32_bf16 v[172:175], v[176:179], a[4:7], v[172:175]
v_lshl_add_u32 v7, v5, 1, v7
v_lshrrev_b32 v5, 4, v4
v_mfma_f32_16x16x32_bf16 v[38:41], a[4:7], a[4:7], v[38:41]
v_lshl_add_u32 v7, v5, 2, v7
v_mul_u32_u24 v7, 0xd80, v7
s_mov_b64 exec, 0
s_cmp_eq_u32 s40, 0
s_cbranch_scc1 L_pg4
s_cmp_eq_u32 s40, 1
s_cbranch_scc1 L_pg5
s_cmp_eq_u32 s40, 2
s_cbranch_scc1 L_pg6
s_branch L_pg7
L_tr1:
s_mov_b64 exec, -1
s_waitcnt vmcnt(8)
ds_read_b128 a[16:19], v11 offset:4096
ds_read_b128 a[20:23], v10 offset:4096
v_lshl_add_u32 v7, v3, 4, v7
v_add_u32 v33, s46, v7
v_subrev_u32 v33, 0xc00, v33
v_add_u32 v3, 0x100, v0
v_mul_u32_u24 v4, 0x124a, v3
v_lshrrev_b32 v4, 16, v4
v_mul_u32_u24 v5, 14, v4
v_sub_u32 v3, v3, v5
v_and_b32 v5, 12, v4
v_and_b32 v7, 3, v4
s_waitcnt lgkmcnt(2)
v_mfma_f32_16x16x32_bf16 v[172:175], v[176:179], a[8:11], v[172:175]
v_lshl_add_u32 v7, v5, 1, v7
v_lshrrev_b32 v5, 4, v4
v_mfma_f32_16x16x32_bf16 v[38:41], a[8:11], a[8:11], v[38:41]
global_load_lds_dwordx4 v170, s[96:97] offset:2816
global_load_lds_dwordx4 v171, s[96:97] offset:3840
v_mfma_f32_16x16x32_bf16 v[172:175], v[176:179], a[12:15], v[172:175]
v_lshl_add_u32 v7, v5, 2, v7
v_mul_u32_u24 v7, 0xd80, v7
v_mfma_f32_16x16x32_bf16 v[38:41], a[12:15], a[12:15], v[38:41]
v_lshl_add_u32 v7, v3, 4, v7
v_add_u32 v34, s46, v7
s_waitcnt vmcnt(8)
ds_read_b128 a[24:27], v11 offset:6144
ds_read_b128 a[28:31], v10 offset:6144
v_add_u32 v3, 0x140, v0
v_mul_u32_u24 v4, 0x124a, v3
v_lshrrev_b32 v4, 16, v4
v_mul_u32_u24 v5, 14, v4
v_sub_u32 v3, v3, v5
v_and_b32 v5, 12, v4
v_and_b32 v7, 3, v4
v_lshl_add_u32 v7, v5, 1, v7
v_lshrrev_b32 v5, 4, v4
v_lshl_add_u32 v7, v5, 2, v7
s_waitcnt lgkmcnt(2)
v_mfma_f32_16x16x32_bf16 v[172:175], v[176:179], a[16:19], v[172:175]
s_add_u32 m0, s58, 0x3c00
v_mfma_f32_16x16x32_bf16 v[38:41], a[16:19], a[16:19], v[38:41]
global_load_lds_dwordx4 v168, s[96:97] offset:1024
global_load_lds_dwordx4 v169, s[96:97] offset:2048
v_mfma_f32_16x16x32_bf16 v[172:175], v[176:179], a[20:23], v[172:175]
v_mul_u32_u24 v7, 0xd80, v7
v_lshl_add_u32 v7, v3, 4, v7
v_mfma_f32_16x16x32_bf16 v[38:41], a[20:23], a[20:23], v[38:41]
v_add_u32 v35, s46, v7
v_subrev_u32 v35, 0x400, v35
s_mov_b64 exec, 0
s_cmp_eq_u32 s40, 0
s_cbranch_scc1 L_pg8
s_cmp_eq_u32 s40, 1
s_cbranch_scc1 L_pg9
s_cmp_eq_u32 s40, 2
s_cbranch_scc1 L_pg10
s_branch L_pg11
L_tr2:
s_mov_b64 exec, -1
s_waitcnt vmcnt(8)
ds_read_b128 a[32:35], v11 offset:8192
ds_read_b128 a[36:39], v10 offset:8192
v_add_u32 v3, 0x180, v0
v_mul_u32_u24 v4, 0x124a, v3
v_lshrrev_b32 v4, 16, v4
v_mul_u32_u24 v5, 14, v4
v_sub_u32 v3, v3, v5
v_and_b32 v5, 12, v4
v_and_b32 v7, 3, v4
v_lshl_add_u32 v7, v5, 1, v7
v_lshrrev_b32 v5, 4, v4
v_lshl_add_u32 v7, v5, 2, v7
s_waitcnt lgkmcnt(2)
v_mfma_f32_16x16x32_bf16 v[172:175], v[176:179], a[24:27], v[172:175]
s_add_u32 m0, s58, 0x12000
v_mfma_f32_16x16x32_bf16 v[38:41], a[24:27], a[24:27], v[38:41]
global_load_lds_dwordx4 v168, s[98:99]
global_load_lds_dwordx4 v169, s[98:99] offset:1024
v_mfma_f32_16x16x32_bf16 v[172:175], v[176:179], a[28:31], v[172:175]
v_mul_u32_u24 v7, 0xd80, v7
v_lshl_add_u32 v7, v3, 4, v7
v_mfma_f32_16x16x32_bf16 v[38:41], a[28:31], a[28:31], v[38:41]
v_add_u32 v36, s46, v7
v_subrev_u32 v36, 0x800, v36
s_waitcnt vmcnt(8)
ds_read_b128 a[40:43], v11 offset:10240
ds_read_b128 a[44:47], v10 offset:10240
v_mov_b32 v50, 1
s_waitcnt lgkmcnt(2)
v_mfma_f32_16x16x32_bf16 v[172:175], v[176:179], a[32:35], v[172:175]
v_mfma_f32_16x16x32_bf16 v[38:41], a[32:35], a[32:35], v[38:41]
global_load_lds_dwordx4 v170, s[98:99] offset:2048
global_load_lds_dwordx4 v171, s[98:99] offset:3072
v_mfma_f32_16x16x32_bf16 v[172:175], v[176:179], a[36:39], v[172:175]
v_mfma_f32_16x16x32_bf16 v[38:41], a[36:39], a[36:39], v[38:41]
s_mov_b64 exec, 0
s_cmp_eq_u32 s40, 0
s_cbranch_scc1 L_pg12
s_cmp_eq_u32 s40, 1
s_cbranch_scc1 L_pg13
s_cmp_eq_u32 s40, 2
s_cbranch_scc1 L_pg14
s_branch L_pg15
L_tr3:
s_mov_b64 exec, -1
s_waitcnt vmcnt(8)
ds_read_b128 a[48:51], v11 offset:12288
ds_read_b128 a[52:55], v10 offset:12288
s_waitcnt lgkmcnt(2)
v_mfma_f32_16x16x32_bf16 v[172:175], v[176:179], a[40:43], v[172:175]
s_add_u32 m0, s58, 0x12f00
v_mfma_f32_16x16x32_bf16 v[38:41], a[40:43], a[40:43], v[38:41]
global_load_lds_dwordx4 v168, s[98:99] offset:256
global_load_lds_dwordx4 v169, s[98:99] offset:1280
v_mfma_f32_16x16x32_bf16 v[172:175], v[176:179], a[44:47], v[172:175]
v_mfma_f32_16x16x32_bf16 v[38:41], a[44:47], a[44:47], v[38:41]
s_waitcnt vmcnt(8)
ds_read_b128 a[56:59], v11 offset:14336
ds_read_b128 a[60:63], v10 offset:14336
s_waitcnt lgkmcnt(2)
v_mfma_f32_16x16x32_bf16 v[172:175], v[176:179], a[48:51], v[172:175]
v_mfma_f32_16x16x32_bf16 v[38:41], a[48:51], a[48:51], v[38:41]
global_load_lds_dwordx4 v170, s[98:99] offset:2304
global_load_lds_dwordx4 v171, s[98:99] offset:3328
v_mfma_f32_16x16x32_bf16 v[172:175], v[176:179], a[52:55], v[172:175]
v_mfma_f32_16x16x32_bf16 v[38:41], a[52:55], a[52:55], v[38:41]
s_waitcnt vmcnt(8)
ds_read_b128 a[64:67], v11 offset:16384
ds_read_b128 a[68:71], v10 offset:16384
s_waitcnt lgkmcnt(2)
v_mfma_f32_16x16x32_bf16 v[172:175], v[176:179], a[56:59], v[172:175]
s_add_u32 m0, s58, 0x13e00
v_mfma_f32_16x16x32_bf16 v[38:41], a[56:59], a[56:59], v[38:41]
global_load_lds_dwordx4 v168, s[98:99] offset:512
global_load_lds_dwordx4 v169, s[98:99] offset:1536
v_mfma_f32_16x16x32_bf16 v[172:175], v[176:179], a[60:63], v[172:175]
v_mfma_f32_16x16x32_bf16 v[38:41], a[60:63], a[60:63], v[38:41]
s_branch L_main
L_exit:
s_endpgm
.p2align 12
L_main:
L_pg0:
s_cbranch_execz L_tr0
s_waitcnt lgkmcnt(0)
v_mfma_f32_16x16x32_bf16 v[172:175], v[176:179], a[64:67], v[172:175]
v_mfma_f32_16x16x32_bf16 v[38:41], a[64:67], a[64:67], v[38:41]
global_load_lds_dwordx4 v170, s[98:99] offset:2560
global_load_lds_dwordx4 v171, s[98:99] offset:3584
v_mfma_f32_16x16x32_bf16 v[172:175], v[176:179], a[68:71], v[172:175]
v_mfma_f32_16x16x32_bf16 v[38:41], a[68:71], a[68:71], v[38:41]
v_add_u32 v11, 0x12000, v11
v_add_u32 v10, 0x12000, v10
s_waitcnt vmcnt(10)
ds_read_b128 v[56:59], v11
ds_read_b128 v[60:63], v10
s_nop 1
v_mul_f32 v46, 0x3ae38e39, v172
v_cvt_pk_bf16_f32 v3, v46, v46
v_lshlrev_b32 v3, 16, v3
v_xor_b32 v164, 0x80000000, v3
v_xor_b32 v165, 0x80000000, v3
v_xor_b32 v166, 0x80000000, v3
v_xor_b32 v167, 0x80000000, v3
s_nop 1
v_mfma_f32_4x4x4_16b_bf16 v[140:143], a[208:209], a[0:1], v[164:167]
v_mfma_f32_4x4x4_16b_bf16 v[144:147], a[208:209], a[2:3], v[164:167]
v_mfma_f32_4x4x4_16b_bf16 v[148:151], a[208:209], a[4:5], v[164:167]
v_mfma_f32_4x4x4_16b_bf16 v[152:155], a[208:209], a[6:7], v[164:167]
s_nop 1
v_cvt_pk_bf16_f32 v192, v140, v141
v_cvt_pk_bf16_f32 v193, v142, v143
s_waitcnt vmcnt(8)
ds_read_b128 v[64:67], v11 offset:2048
ds_read_b128 v[68:71], v10 offset:2048
s_waitcnt lgkmcnt(2)
v_mfma_f32_16x16x32_bf16 v[172:175], v[176:179], v[56:59], 0
s_add_u32 m0, s58, 0x14d00
v_mfma_f32_16x16x32_bf16 v[42:45], v[56:59], v[56:59], 0
global_load_lds_dwordx4 v168, s[98:99] offset:768
global_load_lds_dwordx4 v169, s[98:99] offset:1792
v_mfma_f32_16x16x32_bf16 v[172:175], v[176:179], v[60:63], v[172:175]
v_cvt_pk_bf16_f32 v194, v144, v145
v_cvt_pk_bf16_f32 v195, v146, v147
v_mfma_f32_16x16x32_bf16 v[42:45], v[60:63], v[60:63], v[42:45]
v_cvt_pk_bf16_f32 v196, v148, v149
v_cvt_pk_bf16_f32 v197, v150, v151
v_mfma_f32_4x4x4_16b_bf16 v[156:159], a[208:209], a[8:9], v[164:167]
v_cvt_pk_bf16_f32 v198, v152, v153
v_cvt_pk_bf16_f32 v199, v154, v155
v_mfma_f32_4x4x4_16b_bf16 v[160:163], a[208:209], a[10:11], v[164:167]
v_mfma_f32_4x4x4_16b_bf16 v[180:183], a[208:209], a[12:13], v[164:167]
v_mfma_f32_4x4x4_16b_bf16 v[184:187], a[208:209], a[14:15], v[164:167]
v_cvt_pk_bf16_f32 v200, v156, v157
v_cvt_pk_bf16_f32 v201, v158, v159
s_waitcnt vmcnt(8)
ds_read_b128 v[72:75], v11 offset:4096
ds_read_b128 v[76:79], v10 offset:4096
s_waitcnt lgkmcnt(2)
v_mfma_f32_16x16x32_bf16 v[172:175], v[176:179], v[64:67], v[172:175]
v_cvt_pk_bf16_f32 v202, v160, v161
v_cvt_pk_bf16_f32 v203, v162, v163
v_mfma_f32_16x16x32_bf16 v[42:45], v[64:67], v[64:67], v[42:45]
global_load_lds_dwordx4 v170, s[98:99] offset:2816
global_load_lds_dwordx4 v171, s[98:99] offset:3840
v_mfma_f32_16x16x32_bf16 v[172:175], v[176:179], v[68:71], v[172:175]
v_cvt_pk_bf16_f32 v204, v180, v181
v_cvt_pk_bf16_f32 v205, v182, v183
v_mfma_f32_16x16x32_bf16 v[42:45], v[68:71], v[68:71], v[42:45]
v_cvt_pk_bf16_f32 v206, v184, v185
v_cvt_pk_bf16_f32 v207, v186, v187
v_mfma_f32_4x4x4_16b_bf16 v[140:143], a[208:209], a[16:17], v[164:167]
v_mfma_f32_4x4x4_16b_bf16 v[144:147], a[208:209], a[18:19], v[164:167]
v_mfma_f32_4x4x4_16b_bf16 v[148:151], a[208:209], a[20:21], v[164:167]
v_mfma_f32_4x4x4_16b_bf16 v[152:155], a[208:209], a[22:23], v[164:167]
s_nop 1
v_cvt_pk_bf16_f32 v208, v140, v141
v_cvt_pk_bf16_f32 v209, v142, v143
s_waitcnt vmcnt(8)
ds_read_b128 v[80:83], v11 offset:6144
ds_read_b128 v[84:87], v10 offset:6144
s_waitcnt lgkmcnt(2)
v_mfma_f32_16x16x32_bf16 v[172:175], v[176:179], v[72:75], v[172:175]
s_add_u32 m0, s58, 0x15c00
v_mfma_f32_16x16x32_bf16 v[42:45], v[72:75], v[72:75], v[42:45]
global_load_lds_dwordx4 v168, s[98:99] offset:1024
global_load_lds_dwordx4 v169, s[98:99] offset:2048
v_mfma_f32_16x16x32_bf16 v[172:175], v[176:179], v[76:79], v[172:175]
v_cvt_pk_bf16_f32 v210, v144, v145
v_cvt_pk_bf16_f32 v211, v146, v147
v_mfma_f32_16x16x32_bf16 v[42:45], v[76:79], v[76:79], v[42:45]
v_cvt_pk_bf16_f32 v212, v148, v149
v_cvt_pk_bf16_f32 v213, v150, v151
v_mfma_f32_4x4x4_16b_bf16 v[156:159], a[208:209], a[24:25], v[164:167]
v_cvt_pk_bf16_f32 v214, v152, v153
v_cvt_pk_bf16_f32 v215, v154, v155
v_mfma_f32_4x4x4_16b_bf16 v[160:163], a[208:209], a[26:27], v[164:167]
v_mfma_f32_4x4x4_16b_bf16 v[180:183], a[208:209], a[28:29], v[164:167]
v_mfma_f32_4x4x4_16b_bf16 v[184:187], a[208:209], a[30:31], v[164:167]
v_cvt_pk_bf16_f32 v216, v156, v157
v_cvt_pk_bf16_f32 v217, v158, v159
s_waitcnt vmcnt(8)
ds_read_b128 v[88:91], v11 offset:8192
ds_read_b128 v[92:95], v10 offset:8192
s_waitcnt lgkmcnt(2)
v_mfma_f32_16x16x32_bf16 v[172:175], v[176:179], v[80:83], v[172:175]
s_add_u32 m0, s41, 0x24000
s_add_u32 s96, s20, 0
s_addc_u32 s97, s21, 0
v_mfma_f32_16x16x32_bf16 v[42:45], v[80:83], v[80:83], v[42:45]
global_load_lds_dwordx4 v14, s[96:97]
v_mfma_f32_16x16x32_bf16 v[172:175], v[176:179], v[84:87], v[172:175]
v_cvt_pk_bf16_f32 v218, v160, v161
v_cvt_pk_bf16_f32 v219, v162, v163
v_mfma_f32_16x16x32_bf16 v[42:45], v[84:87], v[84:87], v[42:45]
v_cvt_pk_bf16_f32 v220, v180, v181
v_cvt_pk_bf16_f32 v221, v182, v183
v_mfma_f32_4x4x4_16b_bf16 v[140:143], a[208:209], a[32:33], v[164:167]
v_cvt_pk_bf16_f32 v222, v184, v185
v_cvt_pk_bf16_f32 v223, v186, v187
v_mfma_f32_4x4x4_16b_bf16 v[144:147], a[208:209], a[34:35], v[164:167]
v_mfma_f32_4x4x4_16b_bf16 v[148:151], a[208:209], a[36:37], v[164:167]
v_mfma_f32_4x4x4_16b_bf16 v[152:155], a[208:209], a[38:39], v[164:167]
v_cvt_pk_bf16_f32 v224, v140, v141
v_cvt_pk_bf16_f32 v225, v142, v143
s_waitcnt vmcnt(7)
ds_read_b128 v[96:99], v11 offset:10240
ds_read_b128 v[100:103], v10 offset:10240
s_barrier
s_waitcnt lgkmcnt(2)
v_mfma_f32_16x16x32_bf16 v[172:175], v[176:179], v[88:91], v[172:175]
s_add_u32 m0, s41, 0x25000
s_add_u32 s96, s20, 0x48000
s_addc_u32 s97, s21, 0
v_mfma_f32_16x16x32_bf16 v[42:45], v[88:91], v[88:91], v[42:45]
global_load_lds_dwordx4 v14, s[96:97]
v_mfma_f32_16x16x32_bf16 v[172:175], v[176:179], v[92:95], v[172:175]
s_add_u32 m0, s41, 0x26000
s_add_u32 s96, s20, 0x90000
s_addc_u32 s97, s21, 0
v_mfma_f32_16x16x32_bf16 v[42:45], v[92:95], v[92:95], v[42:45]
global_load_lds_dwordx4 v14, s[96:97]
v_mfma_f32_4x4x4_16b_bf16 v[156:159], a[208:209], a[40:41], v[164:167]
v_cvt_pk_bf16_f32 v226, v144, v145
v_cvt_pk_bf16_f32 v227, v146, v147
v_mfma_f32_4x4x4_16b_bf16 v[160:163], a[208:209], a[42:43], v[164:167]
v_cvt_pk_bf16_f32 v228, v148, v149
v_cvt_pk_bf16_f32 v229, v150, v151
v_mfma_f32_4x4x4_16b_bf16 v[180:183], a[208:209], a[44:45], v[164:167]
v_cvt_pk_bf16_f32 v230, v152, v153
v_cvt_pk_bf16_f32 v231, v154, v155
v_mfma_f32_4x4x4_16b_bf16 v[184:187], a[208:209], a[46:47], v[164:167]
v_cvt_pk_bf16_f32 v232, v156, v157
v_cvt_pk_bf16_f32 v233, v158, v159
s_waitcnt vmcnt(7)
ds_read_b128 v[104:107], v11 offset:12288
ds_read_b128 v[108:111], v10 offset:12288
s_waitcnt lgkmcnt(2)
v_mfma_f32_16x16x32_bf16 v[172:175], v[176:179], v[96:99], v[172:175]
s_add_u32 m0, s41, 0x27000
s_add_u32 s96, s16, 0
s_addc_u32 s97, s17, 0
v_mfma_f32_16x16x32_bf16 v[42:45], v[96:99], v[96:99], v[42:45]
global_load_lds_dwordx4 v14, s[96:97]
v_mfma_f32_16x16x32_bf16 v[172:175], v[176:179], v[100:103], v[172:175]
s_add_u32 m0, s41, 0
s_add_u32 s96, s16, 0x48000
s_addc_u32 s97, s17, 0
v_mfma_f32_16x16x32_bf16 v[42:45], v[100:103], v[100:103], v[42:45]
global_load_lds_dwordx4 v14, s[96:97]
v_mfma_f32_4x4x4_16b_bf16 v[140:143], a[208:209], a[48:49], v[164:167]
v_cvt_pk_bf16_f32 v234, v160, v161
v_cvt_pk_bf16_f32 v235, v162, v163
v_mfma_f32_4x4x4_16b_bf16 v[144:147], a[208:209], a[50:51], v[164:167]
v_cvt_pk_bf16_f32 v236, v180, v181
v_cvt_pk_bf16_f32 v237, v182, v183
v_mfma_f32_4x4x4_16b_bf16 v[148:151], a[208:209], a[52:53], v[164:167]
v_cvt_pk_bf16_f32 v238, v184, v185
v_cvt_pk_bf16_f32 v239, v186, v187
v_mfma_f32_4x4x4_16b_bf16 v[152:155], a[208:209], a[54:55], v[164:167]
v_cvt_pk_bf16_f32 v240, v140, v141
v_cvt_pk_bf16_f32 v241, v142, v143
s_waitcnt vmcnt(7)
ds_read_b128 v[112:115], v11 offset:14336
ds_read_b128 v[116:119], v10 offset:14336
s_waitcnt lgkmcnt(2)
v_mfma_f32_16x16x32_bf16 v[172:175], v[176:179], v[104:107], v[172:175]
s_add_u32 m0, s41, 0x1000
s_add_u32 s96, s16, 0x90000
s_addc_u32 s97, s17, 0
v_mfma_f32_16x16x32_bf16 v[42:45], v[104:107], v[104:107], v[42:45]
global_load_lds_dwordx4 v14, s[96:97]
v_mfma_f32_16x16x32_bf16 v[172:175], v[176:179], v[108:111], v[172:175]
v_cvt_pk_bf16_f32 v242, v144, v145
v_cvt_pk_bf16_f32 v243, v146, v147
v_mfma_f32_16x16x32_bf16 v[42:45], v[108:111], v[108:111], v[42:45]
buffer_load_dword a255, v51, s[16:19], s3 offen
buffer_load_dword a255, v51, s[20:23], s3 offen
v_mfma_f32_4x4x4_16b_bf16 v[156:159], a[208:209], a[56:57], v[164:167]
v_cvt_pk_bf16_f32 v244, v148, v149
v_cvt_pk_bf16_f32 v245, v150, v151
v_mfma_f32_4x4x4_16b_bf16 v[160:163], a[208:209], a[58:59], v[164:167]
v_cvt_pk_bf16_f32 v246, v152, v153
v_cvt_pk_bf16_f32 v247, v154, v155
v_mfma_f32_4x4x4_16b_bf16 v[180:183], a[208:209], a[60:61], v[164:167]
v_mfma_f32_4x4x4_16b_bf16 v[184:187], a[208:209], a[62:63], v[164:167]
v_cvt_pk_bf16_f32 v248, v156, v157
v_cvt_pk_bf16_f32 v249, v158, v159
s_waitcnt vmcnt(8)
ds_read_b128 v[120:123], v11 offset:16384
ds_read_b128 v[124:127], v10 offset:16384
s_waitcnt lgkmcnt(2)
v_mfma_f32_16x16x32_bf16 v[172:175], v[176:179], v[112:115], v[172:175]
s_add_u32 m0, s41, 0x2000
s_add_u32 s96, s16, 0xd8000
s_addc_u32 s97, s17, 0
v_mfma_f32_16x16x32_bf16 v[42:45], v[112:115], v[112:115], v[42:45]
global_load_lds_dwordx4 v14, s[96:97]
v_mfma_f32_16x16x32_bf16 v[172:175], v[176:179], v[116:119], v[172:175]
s_add_u32 m0, s41, 0x3000
s_add_u32 s96, s16, 0x120000
s_addc_u32 s97, s17, 0
v_mfma_f32_16x16x32_bf16 v[42:45], v[116:119], v[116:119], v[42:45]
global_load_lds_dwordx4 v14, s[96:97]
v_mfma_f32_4x4x4_16b_bf16 v[140:143], a[208:209], a[64:65], v[164:167]
v_cvt_pk_bf16_f32 v250, v160, v161
v_cvt_pk_bf16_f32 v251, v162, v163
v_mfma_f32_4x4x4_16b_bf16 v[144:147], a[208:209], a[66:67], v[164:167]
v_cvt_pk_bf16_f32 v128, v180, v181
v_cvt_pk_bf16_f32 v129, v182, v183
v_mfma_f32_4x4x4_16b_bf16 v[148:151], a[208:209], a[68:69], v[164:167]
v_cvt_pk_bf16_f32 v130, v184, v185
v_cvt_pk_bf16_f32 v131, v186, v187
v_mfma_f32_4x4x4_16b_bf16 v[152:155], a[208:209], a[70:71], v[164:167]
v_accvgpr_write_b32 a60, v128
v_accvgpr_write_b32 a61, v129
s_waitcnt lgkmcnt(0)
v_mfma_f32_16x16x32_bf16 v[172:175], v[176:179], v[120:123], v[172:175]
s_add_u32 m0, s41, 0x4000
s_add_u32 s96, s16, 0x168000
s_addc_u32 s97, s17, 0
v_mfma_f32_16x16x32_bf16 v[42:45], v[120:123], v[120:123], v[42:45]
global_load_lds_dwordx4 v14, s[96:97]
v_mfma_f32_16x16x32_bf16 v[172:175], v[176:179], v[124:127], v[172:175]
s_add_u32 m0, s41, 0x5000
s_add_u32 s96, s20, 0xd8000
s_addc_u32 s97, s21, 0
v_mfma_f32_16x16x32_bf16 v[42:45], v[124:127], v[124:127], v[42:45]
global_load_lds_dwordx4 v14, s[96:97]
v_accvgpr_write_b32 a62, v130
v_accvgpr_write_b32 a63, v131
v_cvt_pk_bf16_f32 v132, v140, v141
v_cvt_pk_bf16_f32 v133, v142, v143
v_cvt_pk_bf16_f32 v134, v144, v145
v_cvt_pk_bf16_f32 v135, v146, v147
v_accvgpr_write_b32 a64, v132
v_accvgpr_write_b32 a65, v133
v_accvgpr_write_b32 a66, v134
v_accvgpr_write_b32 a67, v135
v_cvt_pk_bf16_f32 v136, v148, v149
v_cvt_pk_bf16_f32 v137, v150, v151
v_cvt_pk_bf16_f32 v138, v152, v153
v_cvt_pk_bf16_f32 v139, v154, v155
v_accvgpr_write_b32 a68, v136
v_accvgpr_write_b32 a69, v137
v_accvgpr_write_b32 a70, v138
v_accvgpr_write_b32 a71, v139
v_mul_f32 v47, 0x3ae38e39, v172
v_cvt_pk_bf16_f32 v12, v47, v47
v_lshlrev_b32 v12, 16, v12
v_xor_b32 v164, 0x80000000, v12
v_xor_b32 v165, 0x80000000, v12
v_xor_b32 v166, 0x80000000, v12
v_xor_b32 v167, 0x80000000, v12
s_nop 1
v_mfma_f32_4x4x4_16b_bf16 v[156:159], a[208:209], v[56:57], v[164:167]
v_mfma_f32_4x4x4_16b_bf16 v[160:163], a[208:209], v[58:59], v[164:167]
v_mfma_f32_4x4x4_16b_bf16 v[180:183], a[208:209], v[60:61], v[164:167]
v_mfma_f32_4x4x4_16b_bf16 v[184:187], a[208:209], v[62:63], v[164:167]
s_nop 1
v_cvt_pk_bf16_f32 v56, v156, v157
v_cvt_pk_bf16_f32 v57, v158, v159
v_mfma_f32_4x4x4_16b_bf16 v[140:143], a[208:209], v[64:65], v[164:167]
v_cvt_pk_bf16_f32 v58, v160, v161
v_cvt_pk_bf16_f32 v59, v162, v163
v_mfma_f32_4x4x4_16b_bf16 v[144:147], a[208:209], v[66:67], v[164:167]
v_cvt_pk_bf16_f32 v60, v180, v181
v_cvt_pk_bf16_f32 v61, v182, v183
v_mfma_f32_4x4x4_16b_bf16 v[148:151], a[208:209], v[68:69], v[164:167]
v_cvt_pk_bf16_f32 v62, v184, v185
v_cvt_pk_bf16_f32 v63, v186, v187
v_mfma_f32_4x4x4_16b_bf16 v[152:155], a[208:209], v[70:71], v[164:167]
v_cvt_pk_bf16_f32 v64, v140, v141
v_cvt_pk_bf16_f32 v65, v142, v143
v_mfma_f32_4x4x4_16b_bf16 v[156:159], a[208:209], v[72:73], v[164:167]
v_cvt_pk_bf16_f32 v66, v144, v145
v_cvt_pk_bf16_f32 v67, v146, v147
v_mfma_f32_4x4x4_16b_bf16 v[160:163], a[208:209], v[74:75], v[164:167]
v_cvt_pk_bf16_f32 v68, v148, v149
v_cvt_pk_bf16_f32 v69, v150, v151
v_mfma_f32_4x4x4_16b_bf16 v[180:183], a[208:209], v[76:77], v[164:167]
v_cvt_pk_bf16_f32 v70, v152, v153
v_cvt_pk_bf16_f32 v71, v154, v155
v_mfma_f32_4x4x4_16b_bf16 v[184:187], a[208:209], v[78:79], v[164:167]
v_cvt_pk_bf16_f32 v72, v156, v157
v_cvt_pk_bf16_f32 v73, v158, v159
v_mfma_f32_4x4x4_16b_bf16 v[140:143], a[208:209], v[80:81], v[164:167]
s_waitcnt vmcnt(9)
s_barrier
v_mfma_f32_4x4x4_16b_bf16 v[144:147], a[208:209], v[82:83], v[164:167]
v_cvt_pk_bf16_f32 v74, v160, v161
v_cvt_pk_bf16_f32 v75, v162, v163
v_mfma_f32_4x4x4_16b_bf16 v[148:151], a[208:209], v[84:85], v[164:167]
ds_read_b64_tr_b16 a[144:145], v29 offset:16384
v_cvt_pk_bf16_f32 v76, v180, v181
v_cvt_pk_bf16_f32 v77, v182, v183
v_mfma_f32_4x4x4_16b_bf16 v[152:155], a[208:209], v[86:87], v[164:167]
ds_read_b64_tr_b16 a[146:147], v29 offset:18432
v_cvt_pk_bf16_f32 v78, v184, v185
v_cvt_pk_bf16_f32 v79, v186, v187
v_mfma_f32_4x4x4_16b_bf16 v[156:159], a[208:209], v[88:89], v[164:167]
ds_read_b64_tr_b16 a[148:149], v29 offset:20480
v_cvt_pk_bf16_f32 v80, v140, v141
v_cvt_pk_bf16_f32 v81, v142, v143
v_mfma_f32_4x4x4_16b_bf16 v[160:163], a[208:209], v[90:91], v[164:167]
ds_read_b64_tr_b16 a[150:151], v29 offset:22528
v_cvt_pk_bf16_f32 v82, v144, v145
v_cvt_pk_bf16_f32 v83, v146, v147
v_mfma_f32_4x4x4_16b_bf16 v[180:183], a[208:209], v[92:93], v[164:167]
ds_read_b64_tr_b16 a[152:153], v29 offset:24576
v_cvt_pk_bf16_f32 v84, v148, v149
v_cvt_pk_bf16_f32 v85, v150, v151
v_mfma_f32_4x4x4_16b_bf16 v[184:187], a[208:209], v[94:95], v[164:167]
ds_read_b64_tr_b16 a[154:155], v29 offset:26624
v_cvt_pk_bf16_f32 v86, v152, v153
v_cvt_pk_bf16_f32 v87, v154, v155
v_mfma_f32_4x4x4_16b_bf16 v[140:143], a[208:209], v[96:97], v[164:167]
ds_read_b64_tr_b16 a[156:157], v26 offset:16384
v_cvt_pk_bf16_f32 v88, v156, v157
v_cvt_pk_bf16_f32 v89, v158, v159
v_mfma_f32_4x4x4_16b_bf16 v[144:147], a[208:209], v[98:99], v[164:167]
ds_read_b64_tr_b16 a[158:159], v26 offset:18432
v_cvt_pk_bf16_f32 v90, v160, v161
v_cvt_pk_bf16_f32 v91, v162, v163
v_mfma_f32_4x4x4_16b_bf16 v[148:151], a[208:209], v[100:101], v[164:167]
ds_read_b64_tr_b16 a[160:161], v26 offset:20480
v_cvt_pk_bf16_f32 v92, v180, v181
v_cvt_pk_bf16_f32 v93, v182, v183
v_mfma_f32_4x4x4_16b_bf16 v[152:155], a[208:209], v[102:103], v[164:167]
ds_read_b64_tr_b16 a[162:163], v26 offset:22528
v_cvt_pk_bf16_f32 v94, v184, v185
v_cvt_pk_bf16_f32 v95, v186, v187
v_mfma_f32_4x4x4_16b_bf16 v[156:159], a[208:209], v[104:105], v[164:167]
ds_read_b64_tr_b16 a[164:165], v26 offset:24576
v_cvt_pk_bf16_f32 v96, v140, v141
v_cvt_pk_bf16_f32 v97, v142, v143
v_mfma_f32_4x4x4_16b_bf16 v[160:163], a[208:209], v[106:107], v[164:167]
ds_read_b64_tr_b16 a[166:167], v26 offset:26624
v_cvt_pk_bf16_f32 v98, v144, v145
v_cvt_pk_bf16_f32 v99, v146, v147
v_mfma_f32_4x4x4_16b_bf16 v[180:183], a[208:209], v[108:109], v[164:167]
ds_read_b64_tr_b16 a[168:169], v23 offset:16384
v_cvt_pk_bf16_f32 v100, v148, v149
v_cvt_pk_bf16_f32 v101, v150, v151
v_mfma_f32_4x4x4_16b_bf16 v[184:187], a[208:209], v[110:111], v[164:167]
ds_read_b64_tr_b16 a[170:171], v23 offset:18432
v_cvt_pk_bf16_f32 v102, v152, v153
v_cvt_pk_bf16_f32 v103, v154, v155
v_cvt_pk_bf16_f32 v104, v156, v157
v_cvt_pk_bf16_f32 v105, v158, v159
v_cvt_pk_bf16_f32 v106, v160, v161
v_cvt_pk_bf16_f32 v107, v162, v163
v_cvt_pk_bf16_f32 v108, v180, v181
v_cvt_pk_bf16_f32 v109, v182, v183
v_cvt_pk_bf16_f32 v110, v184, v185
v_cvt_pk_bf16_f32 v111, v186, v187
s_waitcnt lgkmcnt(8)
v_mfma_f32_16x16x32_bf16 v[184:187], a[144:147], v[192:195], 0
s_add_u32 m0, s41, 0x6000
ds_read_b64_tr_b16 a[172:173], v23 offset:20480
v_lshlrev_b32 v252, 16, v112
v_mfma_f32_16x16x32_bf16 v[184:187], a[148:151], v[196:199], v[184:187]
s_add_u32 s96, s20, 0x120000
ds_read_b64_tr_b16 a[174:175], v23 offset:22528
v_and_b32 v112, 0xffff0000, v112
v_mfma_f32_16x16x32_bf16 v[184:187], a[152:155], v[200:203], v[184:187]
s_addc_u32 s97, s21, 0
ds_read_b64_tr_b16 a[176:177], v23 offset:24576
ds_read_b64_tr_b16 a[178:179], v23 offset:26624
v_mfma_f32_16x16x32_bf16 v[188:191], a[152:155], v[64:67], 0
global_load_lds_dwordx4 v14, s[96:97]
v_mfma_f32_16x16x32_bf16 v[188:191], a[148:151], v[60:63], v[188:191]
s_add_u32 m0, s41, 0x7000
ds_read_b64_tr_b16 a[180:181], v20 offset:16384
v_sub_f32 v252, v252, v12
v_mfma_f32_16x16x32_bf16 v[188:191], a[144:147], v[56:59], v[188:191]
s_waitcnt lgkmcnt(7)
ds_read_b64_tr_b16 a[182:183], v20 offset:18432
v_sub_f32 v112, v112, v12
v_mfma_f32_16x16x32_bf16 v[172:175], a[156:159], v[56:59], 0
s_add_u32 s96, s20, 0x168000
ds_read_b64_tr_b16 a[184:185], v20 offset:20480
v_cvt_pk_bf16_f32 v112, v252, v112
v_mfma_f32_16x16x32_bf16 v[172:175], a[160:163], v[60:63], v[172:175]
s_addc_u32 s97, s21, 0
ds_read_b64_tr_b16 a[186:187], v20 offset:22528
v_lshlrev_b32 v252, 16, v113
v_mfma_f32_16x16x32_bf16 v[172:175], a[164:167], v[64:67], v[172:175]
s_waitcnt vmcnt(7)
ds_read_b64_tr_b16 a[188:189], v20 offset:24576
ds_read_b64_tr_b16 a[190:191], v20 offset:26624
v_mfma_f32_16x16x32_bf16 v[168:171], a[164:167], v[200:203], 0
s_barrier
v_mfma_f32_16x16x32_bf16 v[168:171], a[160:163], v[196:199], v[168:171]
ds_read_b64_tr_b16 a[192:193], v29 offset:28672
v_and_b32 v113, 0xffff0000, v113
v_mfma_f32_16x16x32_bf16 v[168:171], a[156:159], v[192:195], v[168:171]
s_waitcnt lgkmcnt(7)
ds_read_b64_tr_b16 a[194:195], v29 offset:30720
ds_read_b64_tr_b16 a[196:197], v27
v_mfma_f32_16x16x32_bf16 v[152:155], a[168:171], v[192:195], 0
global_load_lds_dwordx4 v14, s[96:97]
v_mfma_f32_16x16x32_bf16 v[152:155], a[172:175], v[196:199], v[152:155]
s_add_u32 m0, s41, 0x8000
ds_read_b64_tr_b16 a[198:199], v27 offset:2048
v_sub_f32 v252, v252, v12
v_mfma_f32_16x16x32_bf16 v[152:155], a[176:179], v[200:203], v[152:155]
s_add_u32 s96, s20, 0x1b0000
ds_read_b64_tr_b16 a[200:201], v27 offset:4096
v_sub_f32 v113, v113, v12
v_mfma_f32_16x16x32_bf16 v[156:159], a[176:179], v[64:67], 0
s_addc_u32 s97, s21, 0
ds_read_b64_tr_b16 a[202:203], v27 offset:6144
ds_read_b64_tr_b16 a[204:205], v26 offset:28672
v_mfma_f32_16x16x32_bf16 v[156:159], a[172:175], v[60:63], v[156:159]
global_load_lds_dwordx4 v14, s[96:97]
v_mfma_f32_16x16x32_bf16 v[156:159], a[168:171], v[56:59], v[156:159]
s_waitcnt lgkmcnt(7)
ds_read_b64_tr_b16 a[206:207], v26 offset:30720
v_cvt_pk_bf16_f32 v113, v252, v113
v_mfma_f32_16x16x32_bf16 v[140:143], a[180:183], v[56:59], 0
s_add_u32 m0, s41, 0x9000
ds_read_b64_tr_b16 a[144:145], v24
v_lshlrev_b32 v252, 16, v114
v_mfma_f32_16x16x32_bf16 v[140:143], a[184:187], v[60:63], v[140:143]
s_add_u32 s96, s20, 0x1f8000
ds_read_b64_tr_b16 a[146:147], v24 offset:2048
v_and_b32 v114, 0xffff0000, v114
v_mfma_f32_16x16x32_bf16 v[140:143], a[188:191], v[64:67], v[140:143]
s_addc_u32 s97, s21, 0
ds_read_b64_tr_b16 a[148:149], v24 offset:4096
ds_read_b64_tr_b16 a[150:151], v24 offset:6144
v_mfma_f32_16x16x32_bf16 v[136:139], a[188:191], v[200:203], 0
global_load_lds_dwordx4 v14, s[96:97]
v_mfma_f32_16x16x32_bf16 v[136:139], a[184:187], v[196:199], v[136:139]
s_add_u32 m0, s41, 0xa000
ds_read_b64_tr_b16 a[152:153], v23 offset:28672
v_sub_f32 v252, v252, v12
v_mfma_f32_16x16x32_bf16 v[136:139], a[180:183], v[192:195], v[136:139]
s_waitcnt lgkmcnt(7)
ds_read_b64_tr_b16 a[154:155], v23 offset:30720
v_sub_f32 v114, v114, v12
v_mfma_f32_16x16x32_bf16 v[176:179], a[192:195], v[192:195], 0
s_add_u32 s96, s20, 0x240000
ds_read_b64_tr_b16 a[156:157], v21
v_cvt_pk_bf16_f32 v114, v252, v114
v_mfma_f32_16x16x32_bf16 v[176:179], a[196:199], v[196:199], v[176:179]
s_addc_u32 s97, s21, 0
ds_read_b64_tr_b16 a[158:159], v21 offset:2048
ds_read_b64_tr_b16 a[160:161], v21 offset:4096
v_mfma_f32_16x16x32_bf16 v[176:179], a[200:203], v[200:203], v[176:179]
global_load_lds_dwordx4 v14, s[96:97]
v_mfma_f32_16x16x32_bf16 v[180:183], a[200:203], v[64:67], 0
s_add_u32 m0, s41, 0xb000
ds_read_b64_tr_b16 a[162:163], v21 offset:6144
v_lshlrev_b32 v252, 16, v115
v_mfma_f32_16x16x32_bf16 v[180:183], a[196:199], v[60:63], v[180:183]
s_add_u32 s96, s16, 0x1b0000
ds_read_b64_tr_b16 a[164:165], v20 offset:28672
v_and_b32 v115, 0xffff0000, v115
v_mfma_f32_16x16x32_bf16 v[180:183], a[192:195], v[56:59], v[180:183]
s_waitcnt lgkmcnt(7)
ds_read_b64_tr_b16 a[166:167], v20 offset:30720
v_sub_f32 v252, v252, v12
v_mfma_f32_16x16x32_bf16 v[164:167], a[204:207], v[56:59], 0
s_addc_u32 s97, s17, 0
ds_read_b64_tr_b16 a[168:169], v18
ds_read_b64_tr_b16 a[170:171], v18 offset:2048
v_mfma_f32_16x16x32_bf16 v[164:167], a[144:147], v[60:63], v[164:167]
global_load_lds_dwordx4 v14, s[96:97]
v_mfma_f32_16x16x32_bf16 v[164:167], a[148:151], v[64:67], v[164:167]
s_waitcnt vmcnt(7)
ds_read_b64_tr_b16 a[172:173], v18 offset:4096
ds_read_b64_tr_b16 a[174:175], v18 offset:6144
v_mfma_f32_16x16x32_bf16 v[160:163], a[148:151], v[200:203], 0
s_barrier
v_mfma_f32_16x16x32_bf16 v[160:163], a[144:147], v[196:199], v[160:163]
s_add_u32 m0, s41, 0xc000
ds_read_b64_tr_b16 a[176:177], v18 offset:8192
v_sub_f32 v115, v115, v12
v_mfma_f32_16x16x32_bf16 v[160:163], a[204:207], v[192:195], v[160:163]
s_waitcnt lgkmcnt(7)
ds_read_b64_tr_b16 a[178:179], v18 offset:10240
v_cvt_pk_bf16_f32 v115, v252, v115
v_mfma_f32_16x16x32_bf16 v[144:147], a[152:155], v[192:195], 0
s_add_u32 s96, s16, 0x1f8000
ds_read_b64_tr_b16 a[180:181], v18 offset:12288
v_lshlrev_b32 v252, 16, v116
v_mfma_f32_16x16x32_bf16 v[144:147], a[156:159], v[196:199], v[144:147]
s_addc_u32 s97, s17, 0
ds_read_b64_tr_b16 a[182:183], v18 offset:14336
ds_read_b64_tr_b16 a[184:185], v18 offset:16384
v_mfma_f32_16x16x32_bf16 v[144:147], a[160:163], v[200:203], v[144:147]
global_load_lds_dwordx4 v14, s[96:97]
v_mfma_f32_16x16x32_bf16 v[148:151], a[160:163], v[64:67], 0
s_add_u32 m0, s41, 0xd000
ds_read_b64_tr_b16 a[186:187], v18 offset:18432
v_and_b32 v116, 0xffff0000, v116
v_mfma_f32_16x16x32_bf16 v[148:151], a[156:159], v[60:63], v[148:151]
s_add_u32 s96, s16, 0x240000
ds_read_b64_tr_b16 a[188:189], v21 offset:8192
v_sub_f32 v252, v252, v12
v_mfma_f32_16x16x32_bf16 v[148:151], a[152:155], v[56:59], v[148:151]
s_waitcnt lgkmcnt(7)
ds_read_b64_tr_b16 a[190:191], v21 offset:10240
v_sub_f32 v116, v116, v12
v_mfma_f32_16x16x32_bf16 v[132:135], a[164:167], v[56:59], 0
s_addc_u32 s97, s17, 0
ds_read_b64_tr_b16 a[192:193], v21 offset:12288
ds_read_b64_tr_b16 a[194:195], v21 offset:14336
v_mfma_f32_16x16x32_bf16 v[132:135], a[168:171], v[60:63], v[132:135]
global_load_lds_dwordx4 v14, s[96:97]
v_mfma_f32_16x16x32_bf16 v[132:135], a[172:175], v[64:67], v[132:135]
s_add_u32 m0, s41, 0xe000
ds_read_b64_tr_b16 a[196:197], v21 offset:16384
v_cvt_pk_bf16_f32 v116, v252, v116
v_mfma_f32_16x16x32_bf16 v[128:131], a[172:175], v[200:203], 0
s_add_u32 s96, s16, 0x288000
ds_read_b64_tr_b16 a[198:199], v21 offset:18432
v_lshlrev_b32 v252, 16, v117
v_mfma_f32_16x16x32_bf16 v[128:131], a[168:171], v[196:199], v[128:131]
s_addc_u32 s97, s17, 0
ds_read_b64_tr_b16 a[200:201], v24 offset:8192
v_and_b32 v117, 0xffff0000, v117
v_mfma_f32_16x16x32_bf16 v[128:131], a[164:167], v[192:195], v[128:131]
s_waitcnt lgkmcnt(7)
ds_read_b64_tr_b16 a[202:203], v24 offset:10240
ds_read_b64_tr_b16 a[204:205], v24 offset:12288
v_mfma_f32_16x16x32_bf16 v[128:131], a[176:179], v[204:207], v[128:131]
global_load_lds_dwordx4 v14, s[96:97]
v_mfma_f32_16x16x32_bf16 v[128:131], a[180:183], v[208:211], v[128:131]
s_add_u32 m0, s41, 0xf000
ds_read_b64_tr_b16 a[206:207], v24 offset:14336
v_sub_f32 v252, v252, v12
v_mfma_f32_16x16x32_bf16 v[128:131], a[184:187], v[212:215], v[128:131]
s_add_u32 s96, s16, 0x2d0000
ds_read_b64_tr_b16 a[144:145], v24 offset:16384
v_sub_f32 v117, v117, v12
v_mfma_f32_16x16x32_bf16 v[132:135], a[184:187], v[76:79], v[132:135]
s_addc_u32 s97, s17, 0
ds_read_b64_tr_b16 a[146:147], v24 offset:18432
ds_read_b64_tr_b16 a[148:149], v27 offset:8192
v_mfma_f32_16x16x32_bf16 v[132:135], a[180:183], v[72:75], v[132:135]
L_pg1:
s_cbranch_execz L_tr0
global_load_lds_dwordx4 v14, s[96:97]
v_mfma_f32_16x16x32_bf16 v[132:135], a[176:179], v[68:71], v[132:135]
s_waitcnt lgkmcnt(7)
ds_read_b64_tr_b16 a[150:151], v27 offset:10240
v_cvt_pk_bf16_f32 v117, v252, v117
v_mfma_f32_16x16x32_bf16 v[148:151], a[188:191], v[68:71], v[148:151]
s_add_u32 m0, s41, 0x10000
ds_read_b64_tr_b16 a[152:153], v27 offset:12288
v_lshlrev_b32 v252, 16, v118
v_mfma_f32_16x16x32_bf16 v[148:151], a[192:195], v[72:75], v[148:151]
s_add_u32 s96, s16, 0x318000
ds_read_b64_tr_b16 a[154:155], v27 offset:14336
v_and_b32 v118, 0xffff0000, v118
v_mfma_f32_16x16x32_bf16 v[148:151], a[196:199], v[76:79], v[148:151]
s_waitcnt vmcnt(8)
ds_read_b64_tr_b16 a[156:157], v27 offset:16384
ds_read_b64_tr_b16 a[158:159], v27 offset:18432
v_mfma_f32_16x16x32_bf16 v[144:147], a[196:199], v[212:215], v[144:147]
s_barrier
v_mfma_f32_16x16x32_bf16 v[144:147], a[192:195], v[208:211], v[144:147]
s_addc_u32 s97, s17, 0
ds_read_b64_tr_b16 a[160:161], v18 offset:20480
v_sub_f32 v252, v252, v12
v_mfma_f32_16x16x32_bf16 v[144:147], a[188:191], v[204:207], v[144:147]
s_waitcnt lgkmcnt(7)
ds_read_b64_tr_b16 a[162:163], v18 offset:22528
ds_read_b64_tr_b16 a[164:165], v18 offset:24576
v_mfma_f32_16x16x32_bf16 v[160:163], a[200:203], v[204:207], v[160:163]
global_load_lds_dwordx4 v14, s[96:97]
v_mfma_f32_16x16x32_bf16 v[160:163], a[204:207], v[208:211], v[160:163]
s_add_u32 m0, s41, 0x11000
ds_read_b64_tr_b16 a[166:167], v18 offset:26624
v_sub_f32 v118, v118, v12
v_mfma_f32_16x16x32_bf16 v[160:163], a[144:147], v[212:215], v[160:163]
s_add_u32 s96, s20, 0x288000
ds_read_b64_tr_b16 a[168:169], v18 offset:28672
v_cvt_pk_bf16_f32 v118, v252, v118
v_mfma_f32_16x16x32_bf16 v[164:167], a[144:147], v[76:79], v[164:167]
s_addc_u32 s97, s21, 0
ds_read_b64_tr_b16 a[170:171], v18 offset:30720
ds_read_b64_tr_b16 a[172:173], v21 offset:20480
v_mfma_f32_16x16x32_bf16 v[164:167], a[204:207], v[72:75], v[164:167]
global_load_lds_dwordx4 v14, s[96:97]
v_mfma_f32_16x16x32_bf16 v[164:167], a[200:203], v[68:71], v[164:167]
s_waitcnt lgkmcnt(7)
ds_read_b64_tr_b16 a[174:175], v21 offset:22528
v_lshlrev_b32 v252, 16, v119
v_mfma_f32_16x16x32_bf16 v[180:183], a[148:151], v[68:71], v[180:183]
s_add_u32 m0, s41, 0x12000
ds_read_b64_tr_b16 a[176:177], v21 offset:24576
v_and_b32 v119, 0xffff0000, v119
v_mfma_f32_16x16x32_bf16 v[180:183], a[152:155], v[72:75], v[180:183]
s_add_u32 s96, s20, 0x2d0000
ds_read_b64_tr_b16 a[178:179], v21 offset:26624
v_sub_f32 v252, v252, v12
v_mfma_f32_16x16x32_bf16 v[180:183], a[156:159], v[76:79], v[180:183]
s_addc_u32 s97, s21, 0
ds_read_b64_tr_b16 a[180:181], v21 offset:28672
ds_read_b64_tr_b16 a[182:183], v21 offset:30720
v_mfma_f32_16x16x32_bf16 v[176:179], a[156:159], v[212:215], v[176:179]
global_load_lds_dwordx4 v14, s[96:97]
v_mfma_f32_16x16x32_bf16 v[176:179], a[152:155], v[208:211], v[176:179]
s_add_u32 m0, s41, 0x13000
ds_read_b64_tr_b16 a[184:185], v24 offset:20480
v_sub_f32 v119, v119, v12
v_mfma_f32_16x16x32_bf16 v[176:179], a[148:151], v[204:207], v[176:179]
s_waitcnt lgkmcnt(7)
ds_read_b64_tr_b16 a[186:187], v24 offset:22528
v_cvt_pk_bf16_f32 v119, v252, v119
v_mfma_f32_16x16x32_bf16 v[136:139], a[160:163], v[204:207], v[136:139]
s_add_u32 s96, s20, 0x318000
ds_read_b64_tr_b16 a[188:189], v24 offset:24576
v_lshlrev_b32 v252, 16, v120
v_mfma_f32_16x16x32_bf16 v[136:139], a[164:167], v[208:211], v[136:139]
s_addc_u32 s97, s21, 0
ds_read_b64_tr_b16 a[190:191], v24 offset:26624
ds_read_b64_tr_b16 a[192:193], v24 offset:28672
v_mfma_f32_16x16x32_bf16 v[136:139], a[168:171], v[212:215], v[136:139]
global_load_lds_dwordx4 v14, s[96:97]
v_mfma_f32_16x16x32_bf16 v[140:143], a[168:171], v[76:79], v[140:143]
s_add_u32 m0, s41, 0x14000
ds_read_b64_tr_b16 a[194:195], v24 offset:30720
v_and_b32 v120, 0xffff0000, v120
v_mfma_f32_16x16x32_bf16 v[140:143], a[164:167], v[72:75], v[140:143]
s_add_u32 s96, s20, 0x360000
ds_read_b64_tr_b16 a[196:197], v27 offset:20480
v_sub_f32 v252, v252, v12
v_mfma_f32_16x16x32_bf16 v[140:143], a[160:163], v[68:71], v[140:143]
s_waitcnt lgkmcnt(7)
ds_read_b64_tr_b16 a[198:199], v27 offset:22528
v_sub_f32 v120, v120, v12
v_mfma_f32_16x16x32_bf16 v[156:159], a[172:175], v[68:71], v[156:159]
s_addc_u32 s97, s21, 0
ds_read_b64_tr_b16 a[200:201], v27 offset:24576
ds_read_b64_tr_b16 a[202:203], v27 offset:26624
v_mfma_f32_16x16x32_bf16 v[156:159], a[176:179], v[72:75], v[156:159]
global_load_lds_dwordx4 v14, s[96:97]
v_mfma_f32_16x16x32_bf16 v[156:159], a[180:183], v[76:79], v[156:159]
s_waitcnt vmcnt(7)
ds_read_b64_tr_b16 a[204:205], v27 offset:28672
ds_read_b64_tr_b16 a[206:207], v27 offset:30720
v_mfma_f32_16x16x32_bf16 v[152:155], a[180:183], v[212:215], v[152:155]
s_barrier
v_mfma_f32_16x16x32_bf16 v[152:155], a[176:179], v[208:211], v[152:155]
s_add_u32 m0, s41, 0x15000
ds_read_b64_tr_b16 a[144:145], v27 offset:32768
v_cvt_pk_bf16_f32 v120, v252, v120
v_mfma_f32_16x16x32_bf16 v[152:155], a[172:175], v[204:207], v[152:155]
s_waitcnt lgkmcnt(7)
ds_read_b64_tr_b16 a[146:147], v27 offset:34816
v_lshlrev_b32 v252, 16, v121
v_mfma_f32_16x16x32_bf16 v[168:171], a[184:187], v[204:207], v[168:171]
s_add_u32 s96, s20, 0x3a8000
ds_read_b64_tr_b16 a[148:149], v27 offset:36864
v_and_b32 v121, 0xffff0000, v121
v_mfma_f32_16x16x32_bf16 v[168:171], a[188:191], v[208:211], v[168:171]
s_addc_u32 s97, s21, 0
ds_read_b64_tr_b16 a[150:151], v27 offset:38912
ds_read_b64_tr_b16 a[152:153], v27 offset:40960
v_mfma_f32_16x16x32_bf16 v[168:171], a[192:195], v[212:215], v[168:171]
global_load_lds_dwordx4 v14, s[96:97]
v_mfma_f32_16x16x32_bf16 v[172:175], a[192:195], v[76:79], v[172:175]
s_add_u32 m0, s41, 0x16000
ds_read_b64_tr_b16 a[154:155], v27 offset:43008
v_sub_f32 v252, v252, v12
v_mfma_f32_16x16x32_bf16 v[172:175], a[188:191], v[72:75], v[172:175]
s_add_u32 s96, s20, 0x3f0000
ds_read_b64_tr_b16 a[156:157], v24 offset:32768
v_sub_f32 v121, v121, v12
v_mfma_f32_16x16x32_bf16 v[172:175], a[184:187], v[68:71], v[172:175]
s_waitcnt lgkmcnt(7)
ds_read_b64_tr_b16 a[158:159], v24 offset:34816
v_cvt_pk_bf16_f32 v121, v252, v121
v_mfma_f32_16x16x32_bf16 v[188:191], a[196:199], v[68:71], v[188:191]
s_addc_u32 s97, s21, 0
ds_read_b64_tr_b16 a[160:161], v24 offset:36864
ds_read_b64_tr_b16 a[162:163], v24 offset:38912
v_mfma_f32_16x16x32_bf16 v[188:191], a[200:203], v[72:75], v[188:191]
global_load_lds_dwordx4 v14, s[96:97]
v_mfma_f32_16x16x32_bf16 v[188:191], a[204:207], v[76:79], v[188:191]
s_add_u32 m0, s41, 0x17000
ds_read_b64_tr_b16 a[164:165], v24 offset:40960
v_lshlrev_b32 v252, 16, v122
v_mfma_f32_16x16x32_bf16 v[184:187], a[204:207], v[212:215], v[184:187]
s_add_u32 s96, s16, 0x360000
ds_read_b64_tr_b16 a[166:167], v24 offset:43008
v_and_b32 v122, 0xffff0000, v122
v_mfma_f32_16x16x32_bf16 v[184:187], a[200:203], v[208:211], v[184:187]
s_addc_u32 s97, s17, 0
ds_read_b64_tr_b16 a[168:169], v21 offset:32768
v_sub_f32 v252, v252, v12
v_mfma_f32_16x16x32_bf16 v[184:187], a[196:199], v[204:207], v[184:187]
s_waitcnt lgkmcnt(7)
ds_read_b64_tr_b16 a[170:171], v21 offset:34816
ds_read_b64_tr_b16 a[172:173], v21 offset:36864
v_mfma_f32_16x16x32_bf16 v[184:187], a[144:147], v[216:219], v[184:187]
global_load_lds_dwordx4 v14, s[96:97]
v_mfma_f32_16x16x32_bf16 v[184:187], a[148:151], v[220:223], v[184:187]
s_add_u32 m0, s41, 0x18000
ds_read_b64_tr_b16 a[174:175], v21 offset:38912
v_sub_f32 v122, v122, v12
v_mfma_f32_16x16x32_bf16 v[184:187], a[152:155], v[224:227], v[184:187]
s_add_u32 s96, s16, 0x3a8000
ds_read_b64_tr_b16 a[176:177], v21 offset:40960
v_cvt_pk_bf16_f32 v122, v252, v122
v_mfma_f32_16x16x32_bf16 v[188:191], a[152:155], v[88:91], v[188:191]
s_addc_u32 s97, s17, 0
ds_read_b64_tr_b16 a[178:179], v21 offset:43008
ds_read_b64_tr_b16 a[180:181], v18 offset:32768
v_mfma_f32_16x16x32_bf16 v[188:191], a[148:151], v[84:87], v[188:191]
buffer_load_dword a255, v51, s[16:19], s3 offen offset:128
v_mfma_f32_16x16x32_bf16 v[188:191], a[144:147], v[80:83], v[188:191]
s_waitcnt lgkmcnt(7)
ds_read_b64_tr_b16 a[182:183], v18 offset:34816
v_lshlrev_b32 v252, 16, v123
v_mfma_f32_16x16x32_bf16 v[172:175], a[156:159], v[80:83], v[172:175]
ds_read_b64_tr_b16 a[184:185], v18 offset:36864
ds_read_b64_tr_b16 a[186:187], v18 offset:38912
v_mfma_f32_16x16x32_bf16 v[172:175], a[160:163], v[84:87], v[172:175]
buffer_load_dword a255, v51, s[20:23], s3 offen offset:128
v_mfma_f32_16x16x32_bf16 v[172:175], a[164:167], v[88:91], v[172:175]
ds_read_b64_tr_b16 a[188:189], v18 offset:40960
v_and_b32 v123, 0xffff0000, v123
v_mfma_f32_16x16x32_bf16 v[168:171], a[164:167], v[224:227], v[168:171]
ds_read_b64_tr_b16 a[190:191], v18 offset:43008
v_sub_f32 v252, v252, v12
v_mfma_f32_16x16x32_bf16 v[168:171], a[160:163], v[220:223], v[168:171]
ds_read_b64_tr_b16 a[192:193], v27 offset:45056
v_sub_f32 v123, v123, v12
v_mfma_f32_16x16x32_bf16 v[168:171], a[156:159], v[216:219], v[168:171]
s_waitcnt lgkmcnt(7)
ds_read_b64_tr_b16 a[194:195], v27 offset:47104
v_cvt_pk_bf16_f32 v123, v252, v123
v_mfma_f32_16x16x32_bf16 v[152:155], a[168:171], v[216:219], v[152:155]
ds_read_b64_tr_b16 a[196:197], v27 offset:49152
v_lshlrev_b32 v252, 16, v124
v_mfma_f32_16x16x32_bf16 v[152:155], a[172:175], v[220:223], v[152:155]
ds_read_b64_tr_b16 a[198:199], v27 offset:51200
v_and_b32 v124, 0xffff0000, v124
v_mfma_f32_16x16x32_bf16 v[152:155], a[176:179], v[224:227], v[152:155]
ds_read_b64_tr_b16 a[200:201], v27 offset:53248
v_sub_f32 v252, v252, v12
v_mfma_f32_16x16x32_bf16 v[156:159], a[176:179], v[88:91], v[156:159]
ds_read_b64_tr_b16 a[202:203], v27 offset:55296
v_sub_f32 v124, v124, v12
v_mfma_f32_16x16x32_bf16 v[156:159], a[172:175], v[84:87], v[156:159]
ds_read_b64_tr_b16 a[204:205], v24 offset:45056
v_cvt_pk_bf16_f32 v124, v252, v124
v_mfma_f32_16x16x32_bf16 v[156:159], a[168:171], v[80:83], v[156:159]
s_waitcnt lgkmcnt(7)
ds_read_b64_tr_b16 a[206:207], v24 offset:47104
v_lshlrev_b32 v252, 16, v125
v_mfma_f32_16x16x32_bf16 v[140:143], a[180:183], v[80:83], v[140:143]
ds_read_b64_tr_b16 a[144:145], v24 offset:49152
v_and_b32 v125, 0xffff0000, v125
v_mfma_f32_16x16x32_bf16 v[140:143], a[184:187], v[84:87], v[140:143]
ds_read_b64_tr_b16 a[146:147], v24 offset:51200
v_sub_f32 v252, v252, v12
v_mfma_f32_16x16x32_bf16 v[140:143], a[188:191], v[88:91], v[140:143]
ds_read_b64_tr_b16 a[148:149], v24 offset:53248
v_sub_f32 v125, v125, v12
v_mfma_f32_16x16x32_bf16 v[136:139], a[188:191], v[224:227], v[136:139]
ds_read_b64_tr_b16 a[150:151], v24 offset:55296
v_cvt_pk_bf16_f32 v125, v252, v125
v_mfma_f32_16x16x32_bf16 v[136:139], a[184:187], v[220:223], v[136:139]
ds_read_b64_tr_b16 a[152:153], v21 offset:45056
v_lshlrev_b32 v252, 16, v126
v_mfma_f32_16x16x32_bf16 v[136:139], a[180:183], v[216:219], v[136:139]
s_waitcnt lgkmcnt(7)
ds_read_b64_tr_b16 a[154:155], v21 offset:47104
v_and_b32 v126, 0xffff0000, v126
v_mfma_f32_16x16x32_bf16 v[176:179], a[192:195], v[216:219], v[176:179]
ds_read_b64_tr_b16 a[156:157], v21 offset:49152
v_sub_f32 v252, v252, v12
v_mfma_f32_16x16x32_bf16 v[176:179], a[196:199], v[220:223], v[176:179]
ds_read_b64_tr_b16 a[158:159], v21 offset:51200
v_sub_f32 v126, v126, v12
v_mfma_f32_16x16x32_bf16 v[176:179], a[200:203], v[224:227], v[176:179]
ds_read_b64_tr_b16 a[160:161], v21 offset:53248
v_cvt_pk_bf16_f32 v126, v252, v126
v_mfma_f32_16x16x32_bf16 v[180:183], a[200:203], v[88:91], v[180:183]
ds_read_b64_tr_b16 a[162:163], v21 offset:55296
v_lshlrev_b32 v252, 16, v127
v_mfma_f32_16x16x32_bf16 v[180:183], a[196:199], v[84:87], v[180:183]
ds_read_b64_tr_b16 a[164:165], v18 offset:45056
v_and_b32 v127, 0xffff0000, v127
v_mfma_f32_16x16x32_bf16 v[180:183], a[192:195], v[80:83], v[180:183]
s_waitcnt lgkmcnt(7)
ds_read_b64_tr_b16 a[166:167], v18 offset:47104
ds_read_b64_tr_b16 a[168:169], v18 offset:49152
v_mfma_f32_16x16x32_bf16 v[164:167], a[204:207], v[80:83], v[164:167]
global_load_lds_dwordx4 v14, s[96:97]
v_mfma_f32_16x16x32_bf16 v[164:167], a[144:147], v[84:87], v[164:167]
s_add_u32 m0, s41, 0x19000
ds_read_b64_tr_b16 a[170:171], v18 offset:51200
v_sub_f32 v252, v252, v12
v_mfma_f32_16x16x32_bf16 v[164:167], a[148:151], v[88:91], v[164:167]
s_waitcnt vmcnt(7)
ds_read_b64_tr_b16 a[172:173], v18 offset:53248
ds_read_b64_tr_b16 a[174:175], v18 offset:55296
v_mfma_f32_16x16x32_bf16 v[160:163], a[148:151], v[224:227], v[160:163]
s_barrier
v_mfma_f32_16x16x32_bf16 v[160:163], a[144:147], v[220:223], v[160:163]
s_add_u32 s96, s16, 0x3f0000
ds_read_b64_tr_b16 a[176:177], v18 offset:57344
v_sub_f32 v127, v127, v12
v_mfma_f32_16x16x32_bf16 v[160:163], a[204:207], v[216:219], v[160:163]
s_waitcnt lgkmcnt(7)
ds_read_b64_tr_b16 a[178:179], v18 offset:59392
v_cvt_pk_bf16_f32 v127, v252, v127
v_mfma_f32_16x16x32_bf16 v[144:147], a[152:155], v[216:219], v[144:147]
s_addc_u32 s97, s17, 0
ds_read_b64_tr_b16 a[180:181], v18 offset:61440
ds_read_b64_tr_b16 a[182:183], v18 offset:63488
v_mfma_f32_16x16x32_bf16 v[144:147], a[156:159], v[220:223], v[144:147]
global_load_lds_dwordx4 v14, s[96:97]
v_mfma_f32_16x16x32_bf16 v[144:147], a[160:163], v[224:227], v[144:147]
s_add_u32 m0, s41, 0x1a000
ds_read_b64_tr_b16 a[184:185], v19
v_accvgpr_write_b32 a0, v192
v_mfma_f32_16x16x32_bf16 v[148:151], a[160:163], v[88:91], v[148:151]
s_add_u32 s96, s16, 0x438000
ds_read_b64_tr_b16 a[186:187], v19 offset:2048
v_accvgpr_write_b32 a1, v193
v_mfma_f32_16x16x32_bf16 v[148:151], a[156:159], v[84:87], v[148:151]
s_addc_u32 s97, s17, 0
ds_read_b64_tr_b16 a[188:189], v21 offset:57344
v_accvgpr_write_b32 a2, v194
v_mfma_f32_16x16x32_bf16 v[148:151], a[152:155], v[80:83], v[148:151]
s_waitcnt lgkmcnt(7)
ds_read_b64_tr_b16 a[190:191], v21 offset:59392
ds_read_b64_tr_b16 a[192:193], v21 offset:61440
v_mfma_f32_16x16x32_bf16 v[132:135], a[164:167], v[80:83], v[132:135]
global_load_lds_dwordx4 v14, s[96:97]
v_mfma_f32_16x16x32_bf16 v[132:135], a[168:171], v[84:87], v[132:135]
s_add_u32 m0, s41, 0x1b000
ds_read_b64_tr_b16 a[194:195], v21 offset:63488
v_accvgpr_write_b32 a3, v195
v_mfma_f32_16x16x32_bf16 v[132:135], a[172:175], v[88:91], v[132:135]
s_add_u32 s96, s16, 0x480000
ds_read_b64_tr_b16 a[196:197], v22
v_accvgpr_write_b32 a4, v196
v_mfma_f32_16x16x32_bf16 v[128:131], a[172:175], v[224:227], v[128:131]
s_addc_u32 s97, s17, 0
ds_read_b64_tr_b16 a[198:199], v22 offset:2048
ds_read_b64_tr_b16 a[200:201], v24 offset:57344
v_mfma_f32_16x16x32_bf16 v[128:131], a[168:171], v[220:223], v[128:131]
global_load_lds_dwordx4 v14, s[96:97]
v_mfma_f32_16x16x32_bf16 v[128:131], a[164:167], v[216:219], v[128:131]
s_waitcnt lgkmcnt(7)
ds_read_b64_tr_b16 a[202:203], v24 offset:59392
v_accvgpr_write_b32 a5, v197
v_mfma_f32_16x16x32_bf16 v[128:131], a[176:179], v[228:231], v[128:131]
s_add_u32 m0, s41, 0x1c000
ds_read_b64_tr_b16 a[204:205], v24 offset:61440
v_accvgpr_write_b32 a6, v198
v_mfma_f32_16x16x32_bf16 v[128:131], a[180:183], v[232:235], v[128:131]
s_add_u32 s96, s16, 0x4c8000
ds_read_b64_tr_b16 a[206:207], v24 offset:63488
v_accvgpr_write_b32 a7, v199
v_mfma_f32_16x16x32_bf16 v[128:131], a[184:187], v[236:239], v[128:131]
s_addc_u32 s97, s17, 0
ds_read_b64_tr_b16 a[144:145], v25
ds_read_b64_tr_b16 a[146:147], v25 offset:2048
v_mfma_f32_16x16x32_bf16 v[132:135], a[184:187], v[100:103], v[132:135]
global_load_lds_dwordx4 v14, s[96:97]
v_mfma_f32_16x16x32_bf16 v[132:135], a[180:183], v[96:99], v[132:135]
s_add_u32 m0, s41, 0x1d000
ds_read_b64_tr_b16 a[148:149], v27 offset:57344
v_accvgpr_write_b32 a8, v200
v_mfma_f32_16x16x32_bf16 v[132:135], a[176:179], v[92:95], v[132:135]
s_waitcnt lgkmcnt(7)
ds_read_b64_tr_b16 a[150:151], v27 offset:59392
v_accvgpr_write_b32 a9, v201
v_mfma_f32_16x16x32_bf16 v[148:151], a[188:191], v[92:95], v[148:151]
s_add_u32 s96, s20, 0x438000
ds_read_b64_tr_b16 a[152:153], v27 offset:61440
v_accvgpr_write_b32 a10, v202
v_mfma_f32_16x16x32_bf16 v[148:151], a[192:195], v[96:99], v[148:151]
s_addc_u32 s97, s21, 0
ds_read_b64_tr_b16 a[154:155], v27 offset:63488
ds_read_b64_tr_b16 a[156:157], v28
v_mfma_f32_16x16x32_bf16 v[148:151], a[196:199], v[100:103], v[148:151]
global_load_lds_dwordx4 v14, s[96:97]
v_mfma_f32_16x16x32_bf16 v[144:147], a[196:199], v[236:239], v[144:147]
s_add_u32 m0, s41, 0x1e000
ds_read_b64_tr_b16 a[158:159], v28 offset:2048
v_accvgpr_write_b32 a11, v203
v_mfma_f32_16x16x32_bf16 v[144:147], a[192:195], v[232:235], v[144:147]
s_add_u32 s96, s20, 0x480000
ds_read_b64_tr_b16 a[160:161], v19 offset:4096
v_accvgpr_write_b32 a12, v204
v_mfma_f32_16x16x32_bf16 v[144:147], a[188:191], v[228:231], v[144:147]
s_waitcnt lgkmcnt(7)
ds_read_b64_tr_b16 a[162:163], v19 offset:6144
v_accvgpr_write_b32 a13, v205
v_mfma_f32_16x16x32_bf16 v[160:163], a[200:203], v[228:231], v[160:163]
s_addc_u32 s97, s21, 0
ds_read_b64_tr_b16 a[164:165], v19 offset:8192
ds_read_b64_tr_b16 a[166:167], v19 offset:10240
v_mfma_f32_16x16x32_bf16 v[160:163], a[204:207], v[232:235], v[160:163]
global_load_lds_dwordx4 v14, s[96:97]
v_mfma_f32_16x16x32_bf16 v[160:163], a[144:147], v[236:239], v[160:163]
s_add_u32 m0, s41, 0x1f000
ds_read_b64_tr_b16 a[168:169], v19 offset:12288
v_accvgpr_write_b32 a14, v206
v_mfma_f32_16x16x32_bf16 v[164:167], a[144:147], v[100:103], v[164:167]
s_add_u32 s96, s20, 0x4c8000
ds_read_b64_tr_b16 a[170:171], v19 offset:14336
v_accvgpr_write_b32 a15, v207
v_mfma_f32_16x16x32_bf16 v[164:167], a[204:207], v[96:99], v[164:167]
s_addc_u32 s97, s21, 0
ds_read_b64_tr_b16 a[172:173], v22 offset:4096
v_accvgpr_write_b32 a16, v208
v_mfma_f32_16x16x32_bf16 v[164:167], a[200:203], v[92:95], v[164:167]
s_waitcnt lgkmcnt(7)
ds_read_b64_tr_b16 a[174:175], v22 offset:6144
ds_read_b64_tr_b16 a[176:177], v22 offset:8192
v_mfma_f32_16x16x32_bf16 v[180:183], a[148:151], v[92:95], v[180:183]
global_load_lds_dwordx4 v14, s[96:97]
v_mfma_f32_16x16x32_bf16 v[180:183], a[152:155], v[96:99], v[180:183]
s_add_u32 m0, s41, 0x20000
ds_read_b64_tr_b16 a[178:179], v22 offset:10240
v_accvgpr_write_b32 a17, v209
v_mfma_f32_16x16x32_bf16 v[180:183], a[156:159], v[100:103], v[180:183]
s_add_u32 s96, s16, 0x80
ds_read_b64_tr_b16 a[180:181], v22 offset:12288
v_accvgpr_write_b32 a18, v210
v_mfma_f32_16x16x32_bf16 v[176:179], a[156:159], v[236:239], v[176:179]
s_addc_u32 s97, s17, 0
ds_read_b64_tr_b16 a[182:183], v22 offset:14336
ds_read_b64_tr_b16 a[184:185], v25 offset:4096
v_mfma_f32_16x16x32_bf16 v[176:179], a[152:155], v[232:235], v[176:179]
global_load_lds_dwordx4 v14, s[96:97]
v_mfma_f32_16x16x32_bf16 v[176:179], a[148:151], v[228:231], v[176:179]
s_waitcnt lgkmcnt(7)
ds_read_b64_tr_b16 a[186:187], v25 offset:6144
v_accvgpr_write_b32 a19, v211
v_mfma_f32_16x16x32_bf16 v[136:139], a[160:163], v[228:231], v[136:139]
s_add_u32 m0, s41, 0x21000
ds_read_b64_tr_b16 a[188:189], v25 offset:8192
v_accvgpr_write_b32 a20, v212
v_mfma_f32_16x16x32_bf16 v[136:139], a[164:167], v[232:235], v[136:139]
s_add_u32 s96, s16, 0x48080
ds_read_b64_tr_b16 a[190:191], v25 offset:10240
v_accvgpr_write_b32 a21, v213
v_mfma_f32_16x16x32_bf16 v[136:139], a[168:171], v[236:239], v[136:139]
s_addc_u32 s97, s17, 0
ds_read_b64_tr_b16 a[192:193], v25 offset:12288
ds_read_b64_tr_b16 a[194:195], v25 offset:14336
v_mfma_f32_16x16x32_bf16 v[140:143], a[168:171], v[100:103], v[140:143]
global_load_lds_dwordx4 v14, s[96:97]
v_mfma_f32_16x16x32_bf16 v[140:143], a[164:167], v[96:99], v[140:143]
s_add_u32 m0, s41, 0x22000
ds_read_b64_tr_b16 a[196:197], v28 offset:4096
v_accvgpr_write_b32 a22, v214
v_mfma_f32_16x16x32_bf16 v[140:143], a[160:163], v[92:95], v[140:143]
s_waitcnt lgkmcnt(7)
ds_read_b64_tr_b16 a[198:199], v28 offset:6144
v_accvgpr_write_b32 a23, v215
v_mfma_f32_16x16x32_bf16 v[156:159], a[172:175], v[92:95], v[156:159]
s_add_u32 s96, s16, 0x90080
ds_read_b64_tr_b16 a[200:201], v28 offset:8192
v_accvgpr_write_b32 a24, v216
v_mfma_f32_16x16x32_bf16 v[156:159], a[176:179], v[96:99], v[156:159]
s_addc_u32 s97, s17, 0
ds_read_b64_tr_b16 a[202:203], v28 offset:10240
v_accvgpr_write_b32 a25, v217
v_mfma_f32_16x16x32_bf16 v[156:159], a[180:183], v[100:103], v[156:159]
s_waitcnt vmcnt(8)
ds_read_b64_tr_b16 a[204:205], v28 offset:12288
ds_read_b64_tr_b16 a[206:207], v28 offset:14336
v_mfma_f32_16x16x32_bf16 v[152:155], a[180:183], v[236:239], v[152:155]
s_barrier
v_mfma_f32_16x16x32_bf16 v[152:155], a[176:179], v[232:235], v[152:155]
ds_read_b64_tr_b16 a[144:145], v28 offset:16384
v_accvgpr_write_b32 a26, v218
v_mfma_f32_16x16x32_bf16 v[152:155], a[172:175], v[228:231], v[152:155]
s_waitcnt lgkmcnt(7)
ds_read_b64_tr_b16 a[146:147], v28 offset:18432
ds_read_b64_tr_b16 a[148:149], v28 offset:20480
v_mfma_f32_16x16x32_bf16 v[168:171], a[184:187], v[228:231], v[168:171]
global_load_lds_dwordx4 v14, s[96:97]
v_mfma_f32_16x16x32_bf16 v[168:171], a[188:191], v[232:235], v[168:171]
s_add_u32 m0, s41, 0x23000
ds_read_b64_tr_b16 a[150:151], v28 offset:22528
v_accvgpr_write_b32 a27, v219
v_mfma_f32_16x16x32_bf16 v[168:171], a[192:195], v[236:239], v[168:171]
s_add_u32 s96, s16, 0xd8080
ds_read_b64_tr_b16 a[152:153], v28 offset:24576
v_accvgpr_write_b32 a28, v220
v_mfma_f32_16x16x32_bf16 v[172:175], a[192:195], v[100:103], v[172:175]
s_addc_u32 s97, s17, 0
ds_read_b64_tr_b16 a[154:155], v28 offset:26624
ds_read_b64_tr_b16 a[156:157], v25 offset:16384
v_mfma_f32_16x16x32_bf16 v[172:175], a[188:191], v[96:99], v[172:175]
global_load_lds_dwordx4 v14, s[96:97]
v_mfma_f32_16x16x32_bf16 v[172:175], a[184:187], v[92:95], v[172:175]
s_waitcnt lgkmcnt(7)
ds_read_b64_tr_b16 a[158:159], v25 offset:18432
v_accvgpr_write_b32 a29, v221
v_mfma_f32_16x16x32_bf16 v[188:191], a[196:199], v[92:95], v[188:191]
s_add_u32 m0, s41, 0x24000
ds_read_b64_tr_b16 a[160:161], v25 offset:20480
v_accvgpr_write_b32 a30, v222
v_mfma_f32_16x16x32_bf16 v[188:191], a[200:203], v[96:99], v[188:191]
s_add_u32 s96, s16, 0x120080
ds_read_b64_tr_b16 a[162:163], v25 offset:22528
v_accvgpr_write_b32 a31, v223
v_mfma_f32_16x16x32_bf16 v[188:191], a[204:207], v[100:103], v[188:191]
s_addc_u32 s97, s17, 0
ds_read_b64_tr_b16 a[164:165], v25 offset:24576
ds_read_b64_tr_b16 a[166:167], v25 offset:26624
v_mfma_f32_16x16x32_bf16 v[184:187], a[204:207], v[236:239], v[184:187]
global_load_lds_dwordx4 v14, s[96:97]
v_mfma_f32_16x16x32_bf16 v[184:187], a[200:203], v[232:235], v[184:187]
s_add_u32 m0, s41, 0x25000
ds_read_b64_tr_b16 a[168:169], v22 offset:16384
v_accvgpr_write_b32 a32, v224
v_mfma_f32_16x16x32_bf16 v[184:187], a[196:199], v[228:231], v[184:187]
s_waitcnt lgkmcnt(7)
ds_read_b64_tr_b16 a[170:171], v22 offset:18432
ds_read_b64_tr_b16 a[172:173], v22 offset:20480
v_mfma_f32_16x16x32_bf16 v[184:187], a[144:147], v[240:243], v[184:187]
buffer_load_dword a255, v53, s[8:11], 0 offen
v_mfma_f32_16x16x32_bf16 v[184:187], a[148:151], v[244:247], v[184:187]
s_add_u32 s96, s16, 0x168080
ds_read_b64_tr_b16 a[174:175], v22 offset:22528
v_accvgpr_write_b32 a33, v225
v_mfma_f32_16x16x32_bf16 v[184:187], a[152:155], v[248:251], v[184:187]
s_addc_u32 s97, s17, 0
ds_read_b64_tr_b16 a[176:177], v22 offset:24576
v_accvgpr_write_b32 a34, v226
v_mfma_f32_16x16x32_bf16 v[188:191], a[152:155], v[112:115], v[188:191]
ds_read_b64_tr_b16 a[178:179], v22 offset:26624
v_accvgpr_write_b32 a35, v227
v_mfma_f32_16x16x32_bf16 v[188:191], a[148:151], v[108:111], v[188:191]
ds_read_b64_tr_b16 a[180:181], v19 offset:16384
v_accvgpr_write_b32 a36, v228
v_mfma_f32_16x16x32_bf16 v[188:191], a[144:147], v[104:107], v[188:191]
s_waitcnt lgkmcnt(7)
ds_read_b64_tr_b16 a[182:183], v19 offset:18432
v_accvgpr_write_b32 a37, v229
v_mfma_f32_16x16x32_bf16 v[172:175], a[156:159], v[104:107], v[172:175]
ds_read_b64_tr_b16 a[184:185], v19 offset:20480
v_accvgpr_write_b32 a38, v230
v_mfma_f32_16x16x32_bf16 v[172:175], a[160:163], v[108:111], v[172:175]
ds_read_b64_tr_b16 a[186:187], v19 offset:22528
v_accvgpr_write_b32 a39, v231
v_mfma_f32_16x16x32_bf16 v[172:175], a[164:167], v[112:115], v[172:175]
ds_read_b64_tr_b16 a[188:189], v19 offset:24576
v_accvgpr_write_b32 a40, v232
v_mfma_f32_16x16x32_bf16 v[168:171], a[164:167], v[248:251], v[168:171]
ds_read_b64_tr_b16 a[190:191], v19 offset:26624
v_accvgpr_write_b32 a41, v233
v_mfma_f32_16x16x32_bf16 v[168:171], a[160:163], v[244:247], v[168:171]
ds_read_b64_tr_b16 a[192:193], v28 offset:28672
v_accvgpr_write_b32 a42, v234
v_mfma_f32_16x16x32_bf16 v[168:171], a[156:159], v[240:243], v[168:171]
s_waitcnt lgkmcnt(7)
ds_read_b64_tr_b16 a[194:195], v28 offset:30720
v_accvgpr_write_b32 a43, v235
v_mfma_f32_16x16x32_bf16 v[152:155], a[168:171], v[240:243], v[152:155]
ds_read_b64_tr_b16 a[196:197], v28 offset:32768
v_accvgpr_write_b32 a44, v236
v_mfma_f32_16x16x32_bf16 v[152:155], a[172:175], v[244:247], v[152:155]
ds_read_b64_tr_b16 a[198:199], v28 offset:34816
v_accvgpr_write_b32 a45, v237
v_mfma_f32_16x16x32_bf16 v[152:155], a[176:179], v[248:251], v[152:155]
ds_read_b64_tr_b16 a[200:201], v28 offset:36864
v_accvgpr_write_b32 a46, v238
v_mfma_f32_16x16x32_bf16 v[156:159], a[176:179], v[112:115], v[156:159]
ds_read_b64_tr_b16 a[202:203], v28 offset:38912
v_accvgpr_write_b32 a47, v239
v_mfma_f32_16x16x32_bf16 v[156:159], a[172:175], v[108:111], v[156:159]
ds_read_b64_tr_b16 a[204:205], v25 offset:28672
v_accvgpr_write_b32 a48, v240
v_mfma_f32_16x16x32_bf16 v[156:159], a[168:171], v[104:107], v[156:159]
s_waitcnt lgkmcnt(7)
ds_read_b64_tr_b16 a[206:207], v25 offset:30720
v_accvgpr_write_b32 a49, v241
v_mfma_f32_16x16x32_bf16 v[140:143], a[180:183], v[104:107], v[140:143]
ds_read_b64_tr_b16 a[144:145], v25 offset:32768
v_accvgpr_write_b32 a50, v242
v_mfma_f32_16x16x32_bf16 v[140:143], a[184:187], v[108:111], v[140:143]
ds_read_b64_tr_b16 a[146:147], v25 offset:34816
v_accvgpr_write_b32 a51, v243
v_mfma_f32_16x16x32_bf16 v[140:143], a[188:191], v[112:115], v[140:143]
ds_read_b64_tr_b16 a[148:149], v25 offset:36864
v_accvgpr_write_b32 a52, v244
v_mfma_f32_16x16x32_bf16 v[136:139], a[188:191], v[248:251], v[136:139]
L_pg2:
s_cbranch_execz L_tr0
ds_read_b64_tr_b16 a[150:151], v25 offset:38912
v_accvgpr_write_b32 a53, v245
v_mfma_f32_16x16x32_bf16 v[136:139], a[184:187], v[244:247], v[136:139]
ds_read_b64_tr_b16 a[152:153], v22 offset:28672
v_accvgpr_write_b32 a54, v246
v_mfma_f32_16x16x32_bf16 v[136:139], a[180:183], v[240:243], v[136:139]
s_waitcnt lgkmcnt(7)
ds_read_b64_tr_b16 a[154:155], v22 offset:30720
v_accvgpr_write_b32 a55, v247
v_mfma_f32_16x16x32_bf16 v[176:179], a[192:195], v[240:243], v[176:179]
ds_read_b64_tr_b16 a[156:157], v22 offset:32768
v_accvgpr_write_b32 a56, v248
v_mfma_f32_16x16x32_bf16 v[176:179], a[196:199], v[244:247], v[176:179]
ds_read_b64_tr_b16 a[158:159], v22 offset:34816
v_accvgpr_write_b32 a57, v249
v_mfma_f32_16x16x32_bf16 v[176:179], a[200:203], v[248:251], v[176:179]
ds_read_b64_tr_b16 a[160:161], v22 offset:36864
v_accvgpr_write_b32 a58, v250
v_mfma_f32_16x16x32_bf16 v[180:183], a[200:203], v[112:115], v[180:183]
ds_read_b64_tr_b16 a[162:163], v22 offset:38912
v_accvgpr_write_b32 a59, v251
v_mfma_f32_16x16x32_bf16 v[180:183], a[196:199], v[108:111], v[180:183]
ds_read_b64_tr_b16 a[164:165], v19 offset:28672
v_and_b32 v5, 1, v0
v_mfma_f32_16x16x32_bf16 v[180:183], a[192:195], v[104:107], v[180:183]
s_waitcnt lgkmcnt(7)
ds_read_b64_tr_b16 a[166:167], v19 offset:30720
v_cmp_eq_u32 vcc, 0, v5
v_mfma_f32_16x16x32_bf16 v[164:167], a[204:207], v[104:107], v[164:167]
ds_read_b64_tr_b16 a[168:169], v19 offset:32768
v_and_b32 v5, 2, v0
v_mfma_f32_16x16x32_bf16 v[164:167], a[144:147], v[108:111], v[164:167]
ds_read_b64_tr_b16 a[170:171], v19 offset:34816
v_cndmask_b32 v38, v39, v38, vcc
v_mfma_f32_16x16x32_bf16 v[164:167], a[148:151], v[112:115], v[164:167]
s_waitcnt vmcnt(6)
ds_read_b64_tr_b16 a[172:173], v19 offset:36864
ds_read_b64_tr_b16 a[174:175], v19 offset:38912
v_mfma_f32_16x16x32_bf16 v[160:163], a[148:151], v[248:251], v[160:163]
s_barrier
v_mfma_f32_16x16x32_bf16 v[160:163], a[144:147], v[244:247], v[160:163]
ds_read_b64_tr_b16 a[176:177], v19 offset:40960
v_cndmask_b32 v40, v41, v40, vcc
v_mfma_f32_16x16x32_bf16 v[160:163], a[204:207], v[240:243], v[160:163]
s_waitcnt lgkmcnt(7)
ds_read_b64_tr_b16 a[178:179], v19 offset:43008
ds_read_b64_tr_b16 a[180:181], v19 offset:45056
v_mfma_f32_16x16x32_bf16 v[144:147], a[152:155], v[240:243], v[144:147]
global_load_lds_dwordx4 v14, s[96:97]
v_mfma_f32_16x16x32_bf16 v[144:147], a[156:159], v[244:247], v[144:147]
s_add_u32 m0, s41, 0x26000
ds_read_b64_tr_b16 a[182:183], v19 offset:47104
v_cmp_eq_u32 vcc, 0, v5
v_mfma_f32_16x16x32_bf16 v[144:147], a[160:163], v[248:251], v[144:147]
ds_read_b64_tr_b16 a[184:185], v19 offset:49152
v_bfe_u32 v5, v0, 2, 2
v_mfma_f32_16x16x32_bf16 v[148:151], a[160:163], v[112:115], v[148:151]
s_add_u32 s96, s20, 0x80
ds_read_b64_tr_b16 a[186:187], v19 offset:51200
v_cndmask_b32 v38, v40, v38, vcc
v_mfma_f32_16x16x32_bf16 v[148:151], a[156:159], v[108:111], v[148:151]
s_addc_u32 s97, s21, 0
ds_read_b64_tr_b16 a[188:189], v22 offset:40960
v_lshrrev_b32 v39, 4, v0
v_mfma_f32_16x16x32_bf16 v[148:151], a[152:155], v[104:107], v[148:151]
s_waitcnt lgkmcnt(7)
ds_read_b64_tr_b16 a[190:191], v22 offset:43008
ds_read_b64_tr_b16 a[192:193], v22 offset:45056
v_mfma_f32_16x16x32_bf16 v[132:135], a[164:167], v[104:107], v[132:135]
global_load_lds_dwordx4 v14, s[96:97]
v_mfma_f32_16x16x32_bf16 v[132:135], a[168:171], v[108:111], v[132:135]
s_add_u32 m0, s41, 0x27000
ds_read_b64_tr_b16 a[194:195], v22 offset:47104
v_cmp_eq_u32 vcc, v5, v39
v_mfma_f32_16x16x32_bf16 v[132:135], a[172:175], v[112:115], v[132:135]
ds_read_b64_tr_b16 a[196:197], v22 offset:49152
v_cndmask_b32 v38, 0, v38, vcc
v_mfma_f32_16x16x32_bf16 v[128:131], a[172:175], v[248:251], v[128:131]
s_add_u32 s96, s20, 0x48080
ds_read_b64_tr_b16 a[198:199], v22 offset:51200
v_mov_b32 v39, v38
v_mfma_f32_16x16x32_bf16 v[128:131], a[168:171], v[244:247], v[128:131]
s_addc_u32 s97, s21, 0
ds_read_b64_tr_b16 a[200:201], v25 offset:40960
v_permlane16_swap_b32 v38, v39
v_mfma_f32_16x16x32_bf16 v[128:131], a[164:167], v[240:243], v[128:131]
s_waitcnt lgkmcnt(7)
ds_read_b64_tr_b16 a[202:203], v25 offset:43008
ds_read_b64_tr_b16 a[204:205], v25 offset:45056
v_mfma_f32_16x16x32_bf16 v[128:131], a[176:179], a[60:63], v[128:131]
global_load_lds_dwordx4 v14, s[96:97]
v_mfma_f32_16x16x32_bf16 v[128:131], a[180:183], a[64:67], v[128:131]
s_add_u32 m0, s41, 0
ds_read_b64_tr_b16 a[206:207], v25 offset:47104
v_add_f32 v38, v38, v39
v_mfma_f32_16x16x32_bf16 v[128:131], a[184:187], a[68:71], v[128:131]
s_add_u32 s96, s20, 0x90080
ds_read_b64_tr_b16 a[144:145], v25 offset:49152
v_mov_b32 v39, v38
v_mfma_f32_16x16x32_bf16 v[132:135], a[184:187], v[124:127], v[132:135]
s_addc_u32 s97, s21, 0
ds_read_b64_tr_b16 a[146:147], v25 offset:51200
ds_read_b64_tr_b16 a[148:149], v28 offset:40960
v_mfma_f32_16x16x32_bf16 v[132:135], a[180:183], v[120:123], v[132:135]
global_load_lds_dwordx4 v14, s[96:97]
v_mfma_f32_16x16x32_bf16 v[132:135], a[176:179], v[116:119], v[132:135]
s_waitcnt lgkmcnt(7)
ds_read_b64_tr_b16 a[150:151], v28 offset:43008
v_permlane32_swap_b32 v38, v39
v_mfma_f32_16x16x32_bf16 v[148:151], a[188:191], v[116:119], v[148:151]
s_add_u32 m0, s41, 0x1000
ds_read_b64_tr_b16 a[152:153], v28 offset:45056
v_add_f32 v38, v38, v39
v_mfma_f32_16x16x32_bf16 v[148:151], a[192:195], v[120:123], v[148:151]
s_add_u32 s96, s20, 0xd8080
ds_read_b64_tr_b16 a[154:155], v28 offset:47104
v_mul_f32 v38, 0x3ae38e39, v38
v_mfma_f32_16x16x32_bf16 v[148:151], a[196:199], v[124:127], v[148:151]
s_addc_u32 s97, s21, 0
ds_read_b64_tr_b16 a[156:157], v28 offset:49152
ds_read_b64_tr_b16 a[158:159], v28 offset:51200
v_mfma_f32_16x16x32_bf16 v[144:147], a[196:199], a[68:71], v[144:147]
global_load_lds_dwordx4 v14, s[96:97]
v_mfma_f32_16x16x32_bf16 v[144:147], a[192:195], a[64:67], v[144:147]
s_add_u32 m0, s41, 0x2000
ds_read_b64_tr_b16 a[160:161], v19 offset:53248
v_fma_f32 v38, -v46, v46, v38
v_mfma_f32_16x16x32_bf16 v[144:147], a[188:191], a[60:63], v[144:147]
s_waitcnt lgkmcnt(7)
ds_read_b64_tr_b16 a[162:163], v19 offset:55296
v_max_f32 v38, 0, v38
v_mfma_f32_16x16x32_bf16 v[160:163], a[200:203], a[60:63], v[160:163]
s_add_u32 s96, s20, 0x120080
ds_read_b64_tr_b16 a[164:165], v19 offset:57344
v_cvt_pk_bf16_f32 v38, v38, v38
v_mfma_f32_16x16x32_bf16 v[160:163], a[204:207], a[64:67], v[160:163]
s_addc_u32 s97, s21, 0
ds_read_b64_tr_b16 a[166:167], v19 offset:59392
ds_read_b64_tr_b16 a[168:169], v19 offset:61440
v_mfma_f32_16x16x32_bf16 v[160:163], a[144:147], a[68:71], v[160:163]
global_load_lds_dwordx4 v14, s[96:97]
v_mfma_f32_16x16x32_bf16 v[164:167], a[144:147], v[124:127], v[164:167]
s_add_u32 m0, s41, 0x3000
ds_read_b64_tr_b16 a[170:171], v19 offset:63488
v_lshlrev_b32 v38, 16, v38
v_mfma_f32_16x16x32_bf16 v[164:167], a[204:207], v[120:123], v[164:167]
s_add_u32 s96, s20, 0x168080
ds_read_b64_tr_b16 a[172:173], v22 offset:53248
v_add_f32 v38, 0x3727c5ac, v38
v_mfma_f32_16x16x32_bf16 v[164:167], a[200:203], v[116:119], v[164:167]
s_waitcnt lgkmcnt(7)
ds_read_b64_tr_b16 a[174:175], v22 offset:55296
v_cvt_pk_bf16_f32 v38, v38, v38
v_mfma_f32_16x16x32_bf16 v[180:183], a[148:151], v[116:119], v[180:183]
s_addc_u32 s97, s21, 0
ds_read_b64_tr_b16 a[176:177], v22 offset:57344
ds_read_b64_tr_b16 a[178:179], v22 offset:59392
v_mfma_f32_16x16x32_bf16 v[180:183], a[152:155], v[120:123], v[180:183]
global_load_lds_dwordx4 v14, s[96:97]
v_mfma_f32_16x16x32_bf16 v[180:183], a[156:159], v[124:127], v[180:183]
s_add_u32 m0, s41, 0x4000
ds_read_b64_tr_b16 a[180:181], v22 offset:61440
v_lshlrev_b32 v38, 16, v38
v_mfma_f32_16x16x32_bf16 v[176:179], a[156:159], a[68:71], v[176:179]
s_add_u32 s96, s20, 0x1b0080
ds_read_b64_tr_b16 a[182:183], v22 offset:63488
v_sqrt_f32 v38, v38
v_mfma_f32_16x16x32_bf16 v[176:179], a[152:155], a[64:67], v[176:179]
s_addc_u32 s97, s21, 0
ds_read_b64_tr_b16 a[184:185], v25 offset:53248
v_cvt_pk_bf16_f32 v38, v38, v38
v_mfma_f32_16x16x32_bf16 v[176:179], a[148:151], a[60:63], v[176:179]
s_waitcnt lgkmcnt(7)
ds_read_b64_tr_b16 a[186:187], v25 offset:55296
ds_read_b64_tr_b16 a[188:189], v25 offset:57344
v_mfma_f32_16x16x32_bf16 v[136:139], a[160:163], a[60:63], v[136:139]
global_load_lds_dwordx4 v14, s[96:97]
v_mfma_f32_16x16x32_bf16 v[136:139], a[164:167], a[64:67], v[136:139]
s_add_u32 m0, s41, 0x5000
ds_read_b64_tr_b16 a[190:191], v25 offset:59392
v_lshlrev_b32 v38, 16, v38
v_mfma_f32_16x16x32_bf16 v[136:139], a[168:171], a[68:71], v[136:139]
s_add_u32 s96, s20, 0x1f8080
ds_read_b64_tr_b16 a[192:193], v25 offset:61440
v_rcp_f32 v9, v38
v_mfma_f32_16x16x32_bf16 v[140:143], a[168:171], v[124:127], v[140:143]
s_addc_u32 s97, s21, 0
ds_read_b64_tr_b16 a[194:195], v25 offset:63488
ds_read_b64_tr_b16 a[196:197], v28 offset:53248
v_mfma_f32_16x16x32_bf16 v[140:143], a[164:167], v[120:123], v[140:143]
global_load_lds_dwordx4 v14, s[96:97]
v_mfma_f32_16x16x32_bf16 v[140:143], a[160:163], v[116:119], v[140:143]
s_waitcnt lgkmcnt(7)
ds_read_b64_tr_b16 a[198:199], v28 offset:55296
v_and_b32 v5, 1, v0
v_mfma_f32_16x16x32_bf16 v[156:159], a[172:175], v[116:119], v[156:159]
s_add_u32 m0, s41, 0x6000
ds_read_b64_tr_b16 a[200:201], v28 offset:57344
v_cmp_eq_u32 vcc, 0, v5
v_mfma_f32_16x16x32_bf16 v[156:159], a[176:179], v[120:123], v[156:159]
ds_read_b64_tr_b16 a[202:203], v28 offset:59392
v_and_b32 v5, 2, v0
v_mfma_f32_16x16x32_bf16 v[156:159], a[180:183], v[124:127], v[156:159]
s_waitcnt vmcnt(8)
ds_read_b64_tr_b16 a[204:205], v28 offset:61440
ds_read_b64_tr_b16 a[206:207], v28 offset:63488
v_mfma_f32_16x16x32_bf16 v[152:155], a[180:183], a[68:71], v[152:155]
s_barrier
v_mfma_f32_16x16x32_bf16 v[152:155], a[176:179], a[64:67], v[152:155]
s_add_u32 s96, s20, 0x240080
ds_read_b64_tr_b16 a[144:145], v20
v_cndmask_b32 v42, v43, v42, vcc
v_mfma_f32_16x16x32_bf16 v[152:155], a[172:175], a[60:63], v[152:155]
s_waitcnt lgkmcnt(7)
ds_read_b64_tr_b16 a[146:147], v20 offset:2048
v_cndmask_b32 v44, v45, v44, vcc
v_mfma_f32_16x16x32_bf16 v[168:171], a[184:187], a[60:63], v[168:171]
s_addc_u32 s97, s21, 0
ds_read_b64_tr_b16 a[148:149], v20 offset:4096
ds_read_b64_tr_b16 a[150:151], v20 offset:6144
v_mfma_f32_16x16x32_bf16 v[168:171], a[188:191], a[64:67], v[168:171]
global_load_lds_dwordx4 v14, s[96:97]
v_mfma_f32_16x16x32_bf16 v[168:171], a[192:195], a[68:71], v[168:171]
s_add_u32 m0, s41, 0x7000
ds_read_b64_tr_b16 a[152:153], v20 offset:8192
v_max_f32 v128, 0, v128
v_mfma_f32_16x16x32_bf16 v[172:175], a[192:195], v[124:127], v[172:175]
s_add_u32 s96, s20, 0x288080
ds_read_b64_tr_b16 a[154:155], v20 offset:10240
ds_read_b64_tr_b16 a[156:157], v20 offset:12288
v_mfma_f32_16x16x32_bf16 v[172:175], a[188:191], v[120:123], v[172:175]
buffer_load_dword a255, v51, s[16:19], s3 offen offset:256
v_mfma_f32_16x16x32_bf16 v[172:175], a[184:187], v[116:119], v[172:175]
s_waitcnt lgkmcnt(7)
ds_read_b64_tr_b16 a[158:159], v20 offset:14336
v_max_f32 v129, 0, v129
v_mfma_f32_16x16x32_bf16 v[188:191], a[196:199], v[116:119], v[188:191]
s_addc_u32 s97, s21, 0
ds_read_b64_tr_b16 a[160:161], v20 offset:16384
ds_read_b64_tr_b16 a[162:163], v20 offset:18432
v_mfma_f32_16x16x32_bf16 v[188:191], a[200:203], v[120:123], v[188:191]
buffer_load_dword a255, v51, s[20:23], s3 offen offset:256
v_mfma_f32_16x16x32_bf16 v[188:191], a[204:207], v[124:127], v[188:191]
ds_read_b64_tr_b16 a[164:165], v20 offset:20480
v_max_f32 v130, 0, v130
v_mfma_f32_16x16x32_bf16 v[184:187], a[204:207], a[68:71], v[184:187]
ds_read_b64_tr_b16 a[166:167], v20 offset:22528
v_max_f32 v131, 0, v131
v_mfma_f32_16x16x32_bf16 v[184:187], a[200:203], a[64:67], v[184:187]
ds_read_b64_tr_b16 a[168:169], v23
v_max_f32 v132, 0, v132
v_mfma_f32_16x16x32_bf16 v[184:187], a[196:199], a[60:63], v[184:187]
s_waitcnt lgkmcnt(7)
ds_read_b64_tr_b16 a[170:171], v23 offset:2048
v_max_f32 v133, 0, v133
v_mfma_f32_16x16x32_bf16 v[192:195], a[144:147], a[0:3], 0
ds_read_b64_tr_b16 a[172:173], v23 offset:4096
v_max_f32 v134, 0, v134
v_mfma_f32_16x16x32_bf16 v[192:195], a[148:151], a[4:7], v[192:195]
ds_read_b64_tr_b16 a[174:175], v23 offset:6144
v_max_f32 v135, 0, v135
v_mfma_f32_16x16x32_bf16 v[192:195], a[152:155], a[8:11], v[192:195]
s_waitcnt lgkmcnt(4)
ds_read_b64_tr_b16 a[176:177], v23 offset:8192
v_mul_f32 v136, v128, v136
v_mfma_f32_16x16x32_bf16 v[192:195], a[156:159], a[12:15], v[192:195]
ds_read_b64_tr_b16 a[178:179], v23 offset:10240
v_mul_f32 v137, v129, v137
v_mfma_f32_16x16x32_bf16 v[192:195], a[160:163], a[16:19], v[192:195]
ds_read_b64_tr_b16 a[180:181], v23 offset:12288
v_mul_f32 v138, v130, v138
v_mfma_f32_16x16x32_bf16 v[192:195], a[164:167], a[20:23], v[192:195]
ds_read_b64_tr_b16 a[182:183], v23 offset:14336
v_mul_f32 v139, v131, v139
v_mfma_f32_16x16x32_bf16 v[196:199], a[164:167], v[76:79], 0
ds_read_b64_tr_b16 a[184:185], v23 offset:16384
v_cvt_pk_bf16_f32 v128, v136, v137
v_mfma_f32_16x16x32_bf16 v[196:199], a[160:163], v[72:75], v[196:199]
ds_read_b64_tr_b16 a[186:187], v23 offset:18432
v_cvt_pk_bf16_f32 v129, v138, v139
v_mfma_f32_16x16x32_bf16 v[196:199], a[156:159], v[68:71], v[196:199]
ds_read_b64_tr_b16 a[188:189], v23 offset:20480
v_accvgpr_write_b32 a72, v128
v_mfma_f32_16x16x32_bf16 v[196:199], a[152:155], v[64:67], v[196:199]
ds_read_b64_tr_b16 a[190:191], v23 offset:22528
v_accvgpr_write_b32 a73, v129
v_mfma_f32_16x16x32_bf16 v[196:199], a[148:151], v[60:63], v[196:199]
ds_read_b64_tr_b16 a[192:193], v26
v_mul_f32 v140, v132, v140
v_mfma_f32_16x16x32_bf16 v[196:199], a[144:147], v[56:59], v[196:199]
s_waitcnt lgkmcnt(7)
ds_read_b64_tr_b16 a[194:195], v26 offset:2048
v_mul_f32 v141, v133, v141
v_mfma_f32_16x16x32_bf16 v[212:215], a[168:171], v[56:59], 0
ds_read_b64_tr_b16 a[196:197], v26 offset:4096
v_mul_f32 v142, v134, v142
v_mfma_f32_16x16x32_bf16 v[212:215], a[172:175], v[60:63], v[212:215]
ds_read_b64_tr_b16 a[198:199], v26 offset:6144
v_mul_f32 v143, v135, v143
v_mfma_f32_16x16x32_bf16 v[212:215], a[176:179], v[64:67], v[212:215]
s_waitcnt lgkmcnt(4)
ds_read_b64_tr_b16 a[200:201], v26 offset:8192
v_cvt_pk_bf16_f32 v132, v140, v141
v_mfma_f32_16x16x32_bf16 v[212:215], a[180:183], v[68:71], v[212:215]
ds_read_b64_tr_b16 a[202:203], v26 offset:10240
v_cvt_pk_bf16_f32 v133, v142, v143
v_mfma_f32_16x16x32_bf16 v[212:215], a[184:187], v[72:75], v[212:215]
ds_read_b64_tr_b16 a[204:205], v26 offset:12288
v_accvgpr_write_b32 a76, v132
v_mfma_f32_16x16x32_bf16 v[212:215], a[188:191], v[76:79], v[212:215]
ds_read_b64_tr_b16 a[206:207], v26 offset:14336
v_accvgpr_write_b32 a77, v133
v_mfma_f32_16x16x32_bf16 v[208:211], a[188:191], a[20:23], 0
ds_read_b64_tr_b16 a[144:145], v26 offset:16384
ds_read_b64_tr_b16 a[146:147], v26 offset:18432
v_mfma_f32_16x16x32_bf16 v[208:211], a[184:187], a[16:19], v[208:211]
global_load_lds_dwordx4 v14, s[96:97]
v_mfma_f32_16x16x32_bf16 v[208:211], a[180:183], a[12:15], v[208:211]
s_add_u32 m0, s41, 0x8000
ds_read_b64_tr_b16 a[148:149], v26 offset:20480
v_max_f32 v144, 0, v144
v_mfma_f32_16x16x32_bf16 v[208:211], a[176:179], a[8:11], v[208:211]
s_add_u32 s96, s20, 0x2d0080
ds_read_b64_tr_b16 a[150:151], v26 offset:22528
v_max_f32 v145, 0, v145
v_mfma_f32_16x16x32_bf16 v[208:211], a[172:175], a[4:7], v[208:211]
s_addc_u32 s97, s21, 0
ds_read_b64_tr_b16 a[152:153], v29
v_max_f32 v146, 0, v146
v_mfma_f32_16x16x32_bf16 v[208:211], a[168:171], a[0:3], v[208:211]
s_waitcnt lgkmcnt(7)
ds_read_b64_tr_b16 a[154:155], v29 offset:2048
ds_read_b64_tr_b16 a[156:157], v29 offset:4096
v_mfma_f32_16x16x32_bf16 v[224:227], a[192:195], a[0:3], 0
global_load_lds_dwordx4 v14, s[96:97]
v_mfma_f32_16x16x32_bf16 v[224:227], a[196:199], a[4:7], v[224:227]
s_add_u32 m0, s41, 0x9000
ds_read_b64_tr_b16 a[158:159], v29 offset:6144
v_max_f32 v147, 0, v147
v_mfma_f32_16x16x32_bf16 v[224:227], a[200:203], a[8:11], v[224:227]
s_waitcnt lgkmcnt(4)
ds_read_b64_tr_b16 a[160:161], v29 offset:8192
v_max_f32 v148, 0, v148
v_mfma_f32_16x16x32_bf16 v[224:227], a[204:207], a[12:15], v[224:227]
s_add_u32 s96, s20, 0x318080
ds_read_b64_tr_b16 a[162:163], v29 offset:10240
v_max_f32 v149, 0, v149
v_mfma_f32_16x16x32_bf16 v[224:227], a[144:147], a[16:19], v[224:227]
s_addc_u32 s97, s21, 0
ds_read_b64_tr_b16 a[164:165], v29 offset:12288
ds_read_b64_tr_b16 a[166:167], v29 offset:14336
v_mfma_f32_16x16x32_bf16 v[224:227], a[148:151], a[20:23], v[224:227]
global_load_lds_dwordx4 v14, s[96:97]
v_mfma_f32_16x16x32_bf16 v[228:231], a[148:151], v[76:79], 0
s_add_u32 m0, s41, 0xa000
ds_read_b64_tr_b16 a[168:169], v29 offset:16384
v_max_f32 v150, 0, v150
v_mfma_f32_16x16x32_bf16 v[228:231], a[144:147], v[72:75], v[228:231]
s_add_u32 s96, s16, 0x1b0080
ds_read_b64_tr_b16 a[170:171], v29 offset:18432
v_max_f32 v151, 0, v151
v_mfma_f32_16x16x32_bf16 v[228:231], a[204:207], v[68:71], v[228:231]
s_waitcnt vmcnt(8)
ds_read_b64_tr_b16 a[172:173], v29 offset:20480
ds_read_b64_tr_b16 a[174:175], v29 offset:22528
v_mfma_f32_16x16x32_bf16 v[228:231], a[200:203], v[64:67], v[228:231]
s_barrier
v_mfma_f32_16x16x32_bf16 v[228:231], a[196:199], v[60:63], v[228:231]
s_addc_u32 s97, s17, 0
ds_read_b64_tr_b16 a[176:177], v20 offset:24576
v_mul_f32 v152, v144, v152
v_mfma_f32_16x16x32_bf16 v[228:231], a[192:195], v[56:59], v[228:231]
s_waitcnt lgkmcnt(7)
ds_read_b64_tr_b16 a[178:179], v20 offset:26624
ds_read_b64_tr_b16 a[180:181], v20 offset:28672
v_mfma_f32_16x16x32_bf16 v[244:247], a[152:155], v[56:59], 0
global_load_lds_dwordx4 v14, s[96:97]
v_mfma_f32_16x16x32_bf16 v[244:247], a[156:159], v[60:63], v[244:247]
s_add_u32 m0, s41, 0xb000
ds_read_b64_tr_b16 a[182:183], v20 offset:30720
v_mul_f32 v153, v145, v153
v_mfma_f32_16x16x32_bf16 v[244:247], a[160:163], v[64:67], v[244:247]
s_waitcnt lgkmcnt(4)
ds_read_b64_tr_b16 a[184:185], v18
v_mul_f32 v154, v146, v154
v_mfma_f32_16x16x32_bf16 v[244:247], a[164:167], v[68:71], v[244:247]
s_add_u32 s96, s16, 0x1f8080
ds_read_b64_tr_b16 a[186:187], v18 offset:2048
v_mul_f32 v155, v147, v155
v_mfma_f32_16x16x32_bf16 v[244:247], a[168:171], v[72:75], v[244:247]
s_addc_u32 s97, s17, 0
ds_read_b64_tr_b16 a[188:189], v18 offset:4096
ds_read_b64_tr_b16 a[190:191], v18 offset:6144
v_mfma_f32_16x16x32_bf16 v[244:247], a[172:175], v[76:79], v[244:247]
global_load_lds_dwordx4 v14, s[96:97]
v_mfma_f32_16x16x32_bf16 v[240:243], a[172:175], a[20:23], 0
s_add_u32 m0, s41, 0xc000
ds_read_b64_tr_b16 a[192:193], v18 offset:8192
v_cvt_pk_bf16_f32 v144, v152, v153
v_mfma_f32_16x16x32_bf16 v[240:243], a[168:171], a[16:19], v[240:243]
s_add_u32 s96, s16, 0x240080
ds_read_b64_tr_b16 a[194:195], v18 offset:10240
v_cvt_pk_bf16_f32 v145, v154, v155
v_mfma_f32_16x16x32_bf16 v[240:243], a[164:167], a[12:15], v[240:243]
s_addc_u32 s97, s17, 0
ds_read_b64_tr_b16 a[196:197], v18 offset:12288
ds_read_b64_tr_b16 a[198:199], v18 offset:14336
v_mfma_f32_16x16x32_bf16 v[240:243], a[160:163], a[8:11], v[240:243]
global_load_lds_dwordx4 v14, s[96:97]
v_mfma_f32_16x16x32_bf16 v[240:243], a[156:159], a[4:7], v[240:243]
s_add_u32 m0, s41, 0xd000
ds_read_b64_tr_b16 a[200:201], v23 offset:24576
v_accvgpr_write_b32 a74, v144
v_mfma_f32_16x16x32_bf16 v[240:243], a[152:155], a[0:3], v[240:243]
s_waitcnt lgkmcnt(7)
ds_read_b64_tr_b16 a[202:203], v23 offset:26624
v_accvgpr_write_b32 a75, v145
v_mfma_f32_16x16x32_bf16 v[200:203], a[176:179], a[0:3], 0
s_add_u32 s96, s16, 0x288080
ds_read_b64_tr_b16 a[204:205], v23 offset:28672
v_mul_f32 v156, v148, v156
v_mfma_f32_16x16x32_bf16 v[200:203], a[180:183], a[4:7], v[200:203]
s_addc_u32 s97, s17, 0
ds_read_b64_tr_b16 a[206:207], v23 offset:30720
v_mul_f32 v157, v149, v157
v_mfma_f32_16x16x32_bf16 v[200:203], a[184:187], a[8:11], v[200:203]
s_waitcnt lgkmcnt(4)
ds_read_b64_tr_b16 a[144:145], v21
ds_read_b64_tr_b16 a[146:147], v21 offset:2048
v_mfma_f32_16x16x32_bf16 v[200:203], a[188:191], a[12:15], v[200:203]
global_load_lds_dwordx4 v14, s[96:97]
v_mfma_f32_16x16x32_bf16 v[200:203], a[192:195], a[16:19], v[200:203]
s_add_u32 m0, s41, 0xe000
ds_read_b64_tr_b16 a[148:149], v21 offset:4096
v_mul_f32 v158, v150, v158
v_mfma_f32_16x16x32_bf16 v[200:203], a[196:199], a[20:23], v[200:203]
s_add_u32 s96, s16, 0x2d0080
ds_read_b64_tr_b16 a[150:151], v21 offset:6144
v_mul_f32 v159, v151, v159
v_mfma_f32_16x16x32_bf16 v[204:207], a[196:199], v[76:79], 0
s_addc_u32 s97, s17, 0
ds_read_b64_tr_b16 a[152:153], v21 offset:8192
ds_read_b64_tr_b16 a[154:155], v21 offset:10240
v_mfma_f32_16x16x32_bf16 v[204:207], a[192:195], v[72:75], v[204:207]
global_load_lds_dwordx4 v14, s[96:97]
v_mfma_f32_16x16x32_bf16 v[204:207], a[188:191], v[68:71], v[204:207]
s_add_u32 m0, s41, 0xf000
ds_read_b64_tr_b16 a[156:157], v21 offset:12288
v_cvt_pk_bf16_f32 v148, v156, v157
v_mfma_f32_16x16x32_bf16 v[204:207], a[184:187], v[64:67], v[204:207]
s_add_u32 s96, s16, 0x318080
ds_read_b64_tr_b16 a[158:159], v21 offset:14336
v_cvt_pk_bf16_f32 v149, v158, v159
v_mfma_f32_16x16x32_bf16 v[204:207], a[180:183], v[60:63], v[204:207]
s_addc_u32 s97, s17, 0
ds_read_b64_tr_b16 a[160:161], v26 offset:24576
v_accvgpr_write_b32 a78, v148
v_mfma_f32_16x16x32_bf16 v[204:207], a[176:179], v[56:59], v[204:207]
s_waitcnt lgkmcnt(7)
ds_read_b64_tr_b16 a[162:163], v26 offset:26624
ds_read_b64_tr_b16 a[164:165], v26 offset:28672
v_mfma_f32_16x16x32_bf16 v[220:223], a[200:203], v[56:59], 0
global_load_lds_dwordx4 v14, s[96:97]
v_mfma_f32_16x16x32_bf16 v[220:223], a[204:207], v[60:63], v[220:223]
s_add_u32 m0, s41, 0x10000
ds_read_b64_tr_b16 a[166:167], v26 offset:30720
v_accvgpr_write_b32 a79, v149
v_mfma_f32_16x16x32_bf16 v[220:223], a[144:147], v[64:67], v[220:223]
s_waitcnt lgkmcnt(4)
ds_read_b64_tr_b16 a[168:169], v24
v_max_f32 v160, 0, v160
v_mfma_f32_16x16x32_bf16 v[220:223], a[148:151], v[68:71], v[220:223]
s_add_u32 s96, s16, 0x360080
ds_read_b64_tr_b16 a[170:171], v24 offset:2048
v_max_f32 v161, 0, v161
v_mfma_f32_16x16x32_bf16 v[220:223], a[152:155], v[72:75], v[220:223]
s_addc_u32 s97, s17, 0
ds_read_b64_tr_b16 a[172:173], v24 offset:4096
ds_read_b64_tr_b16 a[174:175], v24 offset:6144
v_mfma_f32_16x16x32_bf16 v[220:223], a[156:159], v[76:79], v[220:223]
global_load_lds_dwordx4 v14, s[96:97]
v_mfma_f32_16x16x32_bf16 v[216:219], a[156:159], a[20:23], 0
s_add_u32 m0, s41, 0x11000
ds_read_b64_tr_b16 a[176:177], v24 offset:8192
v_max_f32 v162, 0, v162
v_mfma_f32_16x16x32_bf16 v[216:219], a[152:155], a[16:19], v[216:219]
s_add_u32 s96, s16, 0x3a8080
ds_read_b64_tr_b16 a[178:179], v24 offset:10240
v_max_f32 v163, 0, v163
v_mfma_f32_16x16x32_bf16 v[216:219], a[148:151], a[12:15], v[216:219]
s_addc_u32 s97, s17, 0
ds_read_b64_tr_b16 a[180:181], v24 offset:12288
ds_read_b64_tr_b16 a[182:183], v24 offset:14336
v_mfma_f32_16x16x32_bf16 v[216:219], a[144:147], a[8:11], v[216:219]
global_load_lds_dwordx4 v14, s[96:97]
v_mfma_f32_16x16x32_bf16 v[216:219], a[204:207], a[4:7], v[216:219]
s_add_u32 m0, s41, 0x12000
ds_read_b64_tr_b16 a[184:185], v29 offset:24576
v_max_f32 v164, 0, v164
v_mfma_f32_16x16x32_bf16 v[216:219], a[200:203], a[0:3], v[216:219]
s_waitcnt lgkmcnt(7)
ds_read_b64_tr_b16 a[186:187], v29 offset:26624
v_max_f32 v165, 0, v165
v_mfma_f32_16x16x32_bf16 v[232:235], a[160:163], a[0:3], 0
s_add_u32 s96, s16, 0x3f0080
ds_read_b64_tr_b16 a[188:189], v29 offset:28672
v_max_f32 v166, 0, v166
v_mfma_f32_16x16x32_bf16 v[232:235], a[164:167], a[4:7], v[232:235]
s_addc_u32 s97, s17, 0
ds_read_b64_tr_b16 a[190:191], v29 offset:30720
v_max_f32 v167, 0, v167
v_mfma_f32_16x16x32_bf16 v[232:235], a[168:171], a[8:11], v[232:235]
s_waitcnt lgkmcnt(4)
ds_read_b64_tr_b16 a[192:193], v27
ds_read_b64_tr_b16 a[194:195], v27 offset:2048
v_mfma_f32_16x16x32_bf16 v[232:235], a[172:175], a[12:15], v[232:235]
global_load_lds_dwordx4 v14, s[96:97]
v_mfma_f32_16x16x32_bf16 v[232:235], a[176:179], a[16:19], v[232:235]
s_add_u32 m0, s41, 0x13000
ds_read_b64_tr_b16 a[196:197], v27 offset:4096
v_mul_f32 v168, v160, v168
v_mfma_f32_16x16x32_bf16 v[232:235], a[180:183], a[20:23], v[232:235]
s_add_u32 s96, s16, 0x438080
ds_read_b64_tr_b16 a[198:199], v27 offset:6144
v_mul_f32 v169, v161, v169
v_mfma_f32_16x16x32_bf16 v[236:239], a[180:183], v[76:79], 0
s_addc_u32 s97, s17, 0
ds_read_b64_tr_b16 a[200:201], v27 offset:8192
ds_read_b64_tr_b16 a[202:203], v27 offset:10240
v_mfma_f32_16x16x32_bf16 v[236:239], a[176:179], v[72:75], v[236:239]
global_load_lds_dwordx4 v14, s[96:97]
v_mfma_f32_16x16x32_bf16 v[236:239], a[172:175], v[68:71], v[236:239]
s_waitcnt vmcnt(10)
ds_read_b64_tr_b16 a[204:205], v27 offset:12288
ds_read_b64_tr_b16 a[206:207], v27 offset:14336
v_mfma_f32_16x16x32_bf16 v[236:239], a[168:171], v[64:67], v[236:239]
s_barrier
v_mfma_f32_16x16x32_bf16 v[236:239], a[164:167], v[60:63], v[236:239]
s_add_u32 m0, s41, 0x14000
ds_read_b64_tr_b16 a[144:145], v27 offset:16384
v_mul_f32 v170, v162, v170
v_mfma_f32_16x16x32_bf16 v[236:239], a[160:163], v[56:59], v[236:239]
s_waitcnt lgkmcnt(7)
ds_read_b64_tr_b16 a[146:147], v27 offset:18432
v_mul_f32 v171, v163, v171
v_mfma_f32_16x16x32_bf16 v[252:255], a[184:187], v[56:59], 0
s_add_u32 s96, s16, 0x480080
ds_read_b64_tr_b16 a[148:149], v27 offset:20480
v_cvt_pk_bf16_f32 v160, v168, v169
v_mfma_f32_16x16x32_bf16 v[252:255], a[188:191], v[60:63], v[252:255]
s_addc_u32 s97, s17, 0
ds_read_b64_tr_b16 a[150:151], v27 offset:22528
v_cvt_pk_bf16_f32 v161, v170, v171
v_mfma_f32_16x16x32_bf16 v[252:255], a[192:195], v[64:67], v[252:255]
s_waitcnt lgkmcnt(4)
ds_read_b64_tr_b16 a[152:153], v27 offset:24576
ds_read_b64_tr_b16 a[154:155], v27 offset:26624
v_mfma_f32_16x16x32_bf16 v[252:255], a[196:199], v[68:71], v[252:255]
global_load_lds_dwordx4 v14, s[96:97]
v_mfma_f32_16x16x32_bf16 v[252:255], a[200:203], v[72:75], v[252:255]
s_add_u32 m0, s41, 0x15000
ds_read_b64_tr_b16 a[156:157], v27 offset:28672
v_accvgpr_write_b32 a80, v160
v_mfma_f32_16x16x32_bf16 v[252:255], a[204:207], v[76:79], v[252:255]
s_add_u32 s96, s16, 0x4c8080
ds_read_b64_tr_b16 a[158:159], v27 offset:30720
v_accvgpr_write_b32 a81, v161
v_mfma_f32_16x16x32_bf16 v[248:251], a[204:207], a[20:23], 0
s_addc_u32 s97, s17, 0
ds_read_b64_tr_b16 a[160:161], v27 offset:32768
ds_read_b64_tr_b16 a[162:163], v27 offset:34816
v_mfma_f32_16x16x32_bf16 v[248:251], a[200:203], a[16:19], v[248:251]
global_load_lds_dwordx4 v14, s[96:97]
v_mfma_f32_16x16x32_bf16 v[248:251], a[196:199], a[12:15], v[248:251]
s_add_u32 m0, s41, 0x16000
ds_read_b64_tr_b16 a[164:165], v27 offset:36864
v_mul_f32 v172, v164, v172
v_mfma_f32_16x16x32_bf16 v[248:251], a[192:195], a[8:11], v[248:251]
s_add_u32 s96, s20, 0x360080
ds_read_b64_tr_b16 a[166:167], v27 offset:38912
v_mul_f32 v173, v165, v173
v_mfma_f32_16x16x32_bf16 v[248:251], a[188:191], a[4:7], v[248:251]
L_pg3:
s_cbranch_execz L_tr0
s_addc_u32 s97, s21, 0
ds_read_b64_tr_b16 a[168:169], v24 offset:16384
v_mul_f32 v174, v166, v174
v_mfma_f32_16x16x32_bf16 v[248:251], a[184:187], a[0:3], v[248:251]
s_waitcnt lgkmcnt(7)
ds_read_b64_tr_b16 a[170:171], v24 offset:18432
ds_read_b64_tr_b16 a[172:173], v24 offset:20480
v_mfma_f32_16x16x32_bf16 v[248:251], a[144:147], a[24:27], v[248:251]
global_load_lds_dwordx4 v14, s[96:97]
v_mfma_f32_16x16x32_bf16 v[248:251], a[148:151], a[28:31], v[248:251]
s_add_u32 m0, s41, 0x17000
ds_read_b64_tr_b16 a[174:175], v24 offset:22528
v_mul_f32 v175, v167, v175
v_mfma_f32_16x16x32_bf16 v[248:251], a[152:155], a[32:35], v[248:251]
s_waitcnt lgkmcnt(4)
ds_read_b64_tr_b16 a[176:177], v24 offset:24576
v_cvt_pk_bf16_f32 v164, v172, v173
v_mfma_f32_16x16x32_bf16 v[248:251], a[156:159], a[36:39], v[248:251]
s_add_u32 s96, s20, 0x3a8080
ds_read_b64_tr_b16 a[178:179], v24 offset:26624
v_cvt_pk_bf16_f32 v165, v174, v175
v_mfma_f32_16x16x32_bf16 v[248:251], a[160:163], a[40:43], v[248:251]
s_addc_u32 s97, s21, 0
ds_read_b64_tr_b16 a[180:181], v24 offset:28672
ds_read_b64_tr_b16 a[182:183], v24 offset:30720
v_mfma_f32_16x16x32_bf16 v[248:251], a[164:167], a[44:47], v[248:251]
global_load_lds_dwordx4 v14, s[96:97]
v_mfma_f32_16x16x32_bf16 v[252:255], a[164:167], v[100:103], v[252:255]
s_add_u32 m0, s41, 0x18000
ds_read_b64_tr_b16 a[184:185], v24 offset:32768
v_accvgpr_write_b32 a84, v164
v_mfma_f32_16x16x32_bf16 v[252:255], a[160:163], v[96:99], v[252:255]
s_add_u32 s96, s20, 0x3f0080
ds_read_b64_tr_b16 a[186:187], v24 offset:34816
v_accvgpr_write_b32 a85, v165
v_mfma_f32_16x16x32_bf16 v[252:255], a[156:159], v[92:95], v[252:255]
s_addc_u32 s97, s21, 0
ds_read_b64_tr_b16 a[188:189], v24 offset:36864
ds_read_b64_tr_b16 a[190:191], v24 offset:38912
v_mfma_f32_16x16x32_bf16 v[252:255], a[152:155], v[88:91], v[252:255]
global_load_lds_dwordx4 v14, s[96:97]
v_mfma_f32_16x16x32_bf16 v[252:255], a[148:151], v[84:87], v[252:255]
s_add_u32 m0, s41, 0x19000
ds_read_b64_tr_b16 a[192:193], v21 offset:16384
v_max_f32 v176, 0, v176
v_mfma_f32_16x16x32_bf16 v[252:255], a[144:147], v[80:83], v[252:255]
s_waitcnt lgkmcnt(7)
ds_read_b64_tr_b16 a[194:195], v21 offset:18432
v_max_f32 v177, 0, v177
v_mfma_f32_16x16x32_bf16 v[236:239], a[168:171], v[80:83], v[236:239]
s_add_u32 s96, s20, 0x438080
ds_read_b64_tr_b16 a[196:197], v21 offset:20480
v_max_f32 v178, 0, v178
v_mfma_f32_16x16x32_bf16 v[236:239], a[172:175], v[84:87], v[236:239]
s_addc_u32 s97, s21, 0
ds_read_b64_tr_b16 a[198:199], v21 offset:22528
v_max_f32 v179, 0, v179
v_mfma_f32_16x16x32_bf16 v[236:239], a[176:179], v[88:91], v[236:239]
s_waitcnt lgkmcnt(4)
ds_read_b64_tr_b16 a[200:201], v21 offset:24576
ds_read_b64_tr_b16 a[202:203], v21 offset:26624
v_mfma_f32_16x16x32_bf16 v[236:239], a[180:183], v[92:95], v[236:239]
global_load_lds_dwordx4 v14, s[96:97]
v_mfma_f32_16x16x32_bf16 v[236:239], a[184:187], v[96:99], v[236:239]
s_add_u32 m0, s41, 0x1a000
ds_read_b64_tr_b16 a[204:205], v21 offset:28672
v_max_f32 v180, 0, v180
v_mfma_f32_16x16x32_bf16 v[236:239], a[188:191], v[100:103], v[236:239]
s_add_u32 s96, s20, 0x480080
ds_read_b64_tr_b16 a[206:207], v21 offset:30720
v_max_f32 v181, 0, v181
v_mfma_f32_16x16x32_bf16 v[232:235], a[188:191], a[44:47], v[232:235]
s_addc_u32 s97, s21, 0
ds_read_b64_tr_b16 a[144:145], v21 offset:32768
ds_read_b64_tr_b16 a[146:147], v21 offset:34816
v_mfma_f32_16x16x32_bf16 v[232:235], a[184:187], a[40:43], v[232:235]
global_load_lds_dwordx4 v14, s[96:97]
v_mfma_f32_16x16x32_bf16 v[232:235], a[180:183], a[36:39], v[232:235]
s_add_u32 m0, s41, 0x1b000
ds_read_b64_tr_b16 a[148:149], v21 offset:36864
v_max_f32 v182, 0, v182
v_mfma_f32_16x16x32_bf16 v[232:235], a[176:179], a[32:35], v[232:235]
s_add_u32 s96, s20, 0x4c8080
ds_read_b64_tr_b16 a[150:151], v21 offset:38912
v_max_f32 v183, 0, v183
v_mfma_f32_16x16x32_bf16 v[232:235], a[172:175], a[28:31], v[232:235]
s_addc_u32 s97, s21, 0
ds_read_b64_tr_b16 a[152:153], v18 offset:16384
v_mul_f32 v184, v176, v184
v_mfma_f32_16x16x32_bf16 v[232:235], a[168:171], a[24:27], v[232:235]
s_waitcnt lgkmcnt(7)
ds_read_b64_tr_b16 a[154:155], v18 offset:18432
ds_read_b64_tr_b16 a[156:157], v18 offset:20480
v_mfma_f32_16x16x32_bf16 v[216:219], a[192:195], a[24:27], v[216:219]
global_load_lds_dwordx4 v14, s[96:97]
v_mfma_f32_16x16x32_bf16 v[216:219], a[196:199], a[28:31], v[216:219]
s_add_u32 s96, s8, 0
ds_read_b64_tr_b16 a[158:159], v18 offset:22528
v_mul_f32 v185, v177, v185
v_mfma_f32_16x16x32_bf16 v[216:219], a[200:203], a[32:35], v[216:219]
s_waitcnt lgkmcnt(4)
ds_read_b64_tr_b16 a[160:161], v18 offset:24576
v_mul_f32 v186, v178, v186
v_mfma_f32_16x16x32_bf16 v[216:219], a[204:207], a[36:39], v[216:219]
s_addc_u32 s97, s9, 0
ds_read_b64_tr_b16 a[162:163], v18 offset:26624
v_mul_f32 v187, v179, v187
v_mfma_f32_16x16x32_bf16 v[216:219], a[144:147], a[40:43], v[216:219]
s_add_u32 m0, s53, 0x1c000
ds_read_b64_tr_b16 a[164:165], v18 offset:28672
ds_read_b64_tr_b16 a[166:167], v18 offset:30720
v_mfma_f32_16x16x32_bf16 v[216:219], a[148:151], a[44:47], v[216:219]
global_load_lds_dwordx4 v30, s[96:97]
v_mfma_f32_16x16x32_bf16 v[220:223], a[148:151], v[100:103], v[220:223]
ds_read_b64_tr_b16 a[168:169], v18 offset:32768
v_cvt_pk_bf16_f32 v176, v184, v185
v_mfma_f32_16x16x32_bf16 v[220:223], a[144:147], v[96:99], v[220:223]
ds_read_b64_tr_b16 a[170:171], v18 offset:34816
v_cvt_pk_bf16_f32 v177, v186, v187
v_mfma_f32_16x16x32_bf16 v[220:223], a[204:207], v[92:95], v[220:223]
s_waitcnt vmcnt(13)
ds_read_b64_tr_b16 a[172:173], v18 offset:36864
ds_read_b64_tr_b16 a[174:175], v18 offset:38912
v_mfma_f32_16x16x32_bf16 v[220:223], a[200:203], v[88:91], v[220:223]
s_barrier
v_mfma_f32_16x16x32_bf16 v[220:223], a[196:199], v[84:87], v[220:223]
ds_read_b64_tr_b16 a[176:177], v27 offset:40960
v_accvgpr_write_b32 a82, v176
v_mfma_f32_16x16x32_bf16 v[220:223], a[192:195], v[80:83], v[220:223]
s_waitcnt lgkmcnt(7)
ds_read_b64_tr_b16 a[178:179], v27 offset:43008
ds_read_b64_tr_b16 a[180:181], v27 offset:45056
v_mfma_f32_16x16x32_bf16 v[204:207], a[152:155], v[80:83], v[204:207]
global_load_lds_dwordx4 v31, s[96:97] offset:1024
v_mfma_f32_16x16x32_bf16 v[204:207], a[156:159], v[84:87], v[204:207]
ds_read_b64_tr_b16 a[182:183], v27 offset:47104
v_accvgpr_write_b32 a83, v177
v_mfma_f32_16x16x32_bf16 v[204:207], a[160:163], v[88:91], v[204:207]
s_waitcnt lgkmcnt(4)
ds_read_b64_tr_b16 a[184:185], v27 offset:49152
v_mul_f32 v188, v180, v188
v_mfma_f32_16x16x32_bf16 v[204:207], a[164:167], v[92:95], v[204:207]
ds_read_b64_tr_b16 a[186:187], v27 offset:51200
v_mul_f32 v189, v181, v189
v_mfma_f32_16x16x32_bf16 v[204:207], a[168:171], v[96:99], v[204:207]
ds_read_b64_tr_b16 a[188:189], v27 offset:53248
v_mul_f32 v190, v182, v190
v_mfma_f32_16x16x32_bf16 v[204:207], a[172:175], v[100:103], v[204:207]
ds_read_b64_tr_b16 a[190:191], v27 offset:55296
v_mul_f32 v191, v183, v191
v_mfma_f32_16x16x32_bf16 v[200:203], a[172:175], a[44:47], v[200:203]
ds_read_b64_tr_b16 a[192:193], v27 offset:57344
ds_read_b64_tr_b16 a[194:195], v27 offset:59392
v_mfma_f32_16x16x32_bf16 v[200:203], a[168:171], a[40:43], v[200:203]
global_load_lds_dwordx4 v32, s[96:97] offset:2048
v_mfma_f32_16x16x32_bf16 v[200:203], a[164:167], a[36:39], v[200:203]
ds_read_b64_tr_b16 a[196:197], v27 offset:61440
v_cvt_pk_bf16_f32 v180, v188, v189
v_mfma_f32_16x16x32_bf16 v[200:203], a[160:163], a[32:35], v[200:203]
ds_read_b64_tr_b16 a[198:199], v27 offset:63488
v_cvt_pk_bf16_f32 v181, v190, v191
v_mfma_f32_16x16x32_bf16 v[200:203], a[156:159], a[28:31], v[200:203]
ds_read_b64_tr_b16 a[200:201], v24 offset:40960
v_accvgpr_write_b32 a86, v180
v_mfma_f32_16x16x32_bf16 v[200:203], a[152:155], a[24:27], v[200:203]
s_waitcnt lgkmcnt(7)
ds_read_b64_tr_b16 a[202:203], v24 offset:43008
v_accvgpr_write_b32 a87, v181
v_mfma_f32_16x16x32_bf16 v[240:243], a[176:179], a[24:27], v[240:243]
ds_read_b64_tr_b16 a[204:205], v24 offset:45056
v_cmp_eq_u32 vcc, 0, v5
v_mfma_f32_16x16x32_bf16 v[240:243], a[180:183], a[28:31], v[240:243]
ds_read_b64_tr_b16 a[206:207], v24 offset:47104
v_bfe_u32 v5, v0, 2, 2
v_mfma_f32_16x16x32_bf16 v[240:243], a[184:187], a[32:35], v[240:243]
s_waitcnt lgkmcnt(4)
ds_read_b64_tr_b16 a[144:145], v24 offset:49152
ds_read_b64_tr_b16 a[146:147], v24 offset:51200
v_mfma_f32_16x16x32_bf16 v[240:243], a[188:191], a[36:39], v[240:243]
global_load_lds_dwordx4 v33, s[96:97] offset:3072
v_mfma_f32_16x16x32_bf16 v[240:243], a[192:195], a[40:43], v[240:243]
s_add_u32 m0, s53, 0x1d000
ds_read_b64_tr_b16 a[148:149], v24 offset:53248
v_cndmask_b32 v42, v44, v42, vcc
v_mfma_f32_16x16x32_bf16 v[240:243], a[196:199], a[44:47], v[240:243]
ds_read_b64_tr_b16 a[150:151], v24 offset:55296
v_lshrrev_b32 v43, 4, v0
v_mfma_f32_16x16x32_bf16 v[244:247], a[196:199], v[100:103], v[244:247]
ds_read_b64_tr_b16 a[152:153], v24 offset:57344
v_cmp_eq_u32 vcc, v5, v43
v_mfma_f32_16x16x32_bf16 v[244:247], a[192:195], v[96:99], v[244:247]
ds_read_b64_tr_b16 a[154:155], v24 offset:59392
v_cndmask_b32 v42, 0, v42, vcc
v_mfma_f32_16x16x32_bf16 v[244:247], a[188:191], v[92:95], v[244:247]
ds_read_b64_tr_b16 a[156:157], v24 offset:61440
v_mov_b32 v43, v42
v_mfma_f32_16x16x32_bf16 v[244:247], a[184:187], v[88:91], v[244:247]
ds_read_b64_tr_b16 a[158:159], v24 offset:63488
ds_read_b64_tr_b16 a[160:161], v21 offset:40960
v_mfma_f32_16x16x32_bf16 v[244:247], a[180:183], v[84:87], v[244:247]
global_load_lds_dwordx4 v34, s[96:97]
v_mfma_f32_16x16x32_bf16 v[244:247], a[176:179], v[80:83], v[244:247]
s_waitcnt lgkmcnt(7)
ds_read_b64_tr_b16 a[162:163], v21 offset:43008
v_permlane16_swap_b32 v42, v43
v_mfma_f32_16x16x32_bf16 v[228:231], a[200:203], v[80:83], v[228:231]
ds_read_b64_tr_b16 a[164:165], v21 offset:45056
v_add_f32 v42, v42, v43
v_mfma_f32_16x16x32_bf16 v[228:231], a[204:207], v[84:87], v[228:231]
ds_read_b64_tr_b16 a[166:167], v21 offset:47104
v_mov_b32 v43, v42
v_mfma_f32_16x16x32_bf16 v[228:231], a[144:147], v[88:91], v[228:231]
s_waitcnt lgkmcnt(4)
ds_read_b64_tr_b16 a[168:169], v21 offset:49152
v_permlane32_swap_b32 v42, v43
v_mfma_f32_16x16x32_bf16 v[228:231], a[148:151], v[92:95], v[228:231]
ds_read_b64_tr_b16 a[170:171], v21 offset:51200
v_add_f32 v42, v42, v43
v_mfma_f32_16x16x32_bf16 v[228:231], a[152:155], v[96:99], v[228:231]
ds_read_b64_tr_b16 a[172:173], v21 offset:53248
v_mul_f32 v42, 0x3ae38e39, v42
v_mfma_f32_16x16x32_bf16 v[228:231], a[156:159], v[100:103], v[228:231]
ds_read_b64_tr_b16 a[174:175], v21 offset:55296
ds_read_b64_tr_b16 a[176:177], v21 offset:57344
v_mfma_f32_16x16x32_bf16 v[224:227], a[156:159], a[44:47], v[224:227]
global_load_lds_dwordx4 v35, s[96:97] offset:1024
v_mfma_f32_16x16x32_bf16 v[224:227], a[152:155], a[40:43], v[224:227]
ds_read_b64_tr_b16 a[178:179], v21 offset:59392
v_fma_f32 v42, -v47, v47, v42
v_mfma_f32_16x16x32_bf16 v[224:227], a[148:151], a[36:39], v[224:227]
ds_read_b64_tr_b16 a[180:181], v21 offset:61440
v_max_f32 v42, 0, v42
v_mfma_f32_16x16x32_bf16 v[224:227], a[144:147], a[32:35], v[224:227]
ds_read_b64_tr_b16 a[182:183], v21 offset:63488
v_cvt_pk_bf16_f32 v42, v42, v42
v_mfma_f32_16x16x32_bf16 v[224:227], a[204:207], a[28:31], v[224:227]
ds_read_b64_tr_b16 a[184:185], v18 offset:40960
v_lshlrev_b32 v42, 16, v42
v_mfma_f32_16x16x32_bf16 v[224:227], a[200:203], a[24:27], v[224:227]
s_waitcnt lgkmcnt(7)
ds_read_b64_tr_b16 a[186:187], v18 offset:43008
v_add_f32 v42, 0x3727c5ac, v42
v_mfma_f32_16x16x32_bf16 v[208:211], a[160:163], a[24:27], v[208:211]
ds_read_b64_tr_b16 a[188:189], v18 offset:45056
ds_read_b64_tr_b16 a[190:191], v18 offset:47104
v_mfma_f32_16x16x32_bf16 v[208:211], a[164:167], a[28:31], v[208:211]
global_load_lds_dwordx4 v36, s[96:97] offset:2048
v_mfma_f32_16x16x32_bf16 v[208:211], a[168:171], a[32:35], v[208:211]
s_waitcnt lgkmcnt(4)
ds_read_b64_tr_b16 a[192:193], v18 offset:49152
v_cvt_pk_bf16_f32 v42, v42, v42
v_mfma_f32_16x16x32_bf16 v[208:211], a[172:175], a[36:39], v[208:211]
ds_read_b64_tr_b16 a[194:195], v18 offset:51200
v_lshlrev_b32 v42, 16, v42
v_mfma_f32_16x16x32_bf16 v[208:211], a[176:179], a[40:43], v[208:211]
ds_read_b64_tr_b16 a[196:197], v18 offset:53248
v_sqrt_f32 v42, v42
v_mfma_f32_16x16x32_bf16 v[208:211], a[180:183], a[44:47], v[208:211]
ds_read_b64_tr_b16 a[198:199], v18 offset:55296
v_cvt_pk_bf16_f32 v42, v42, v42
v_mfma_f32_16x16x32_bf16 v[212:215], a[180:183], v[100:103], v[212:215]
ds_read_b64_tr_b16 a[200:201], v18 offset:57344
v_lshlrev_b32 v42, 16, v42
v_mfma_f32_16x16x32_bf16 v[212:215], a[176:179], v[96:99], v[212:215]
ds_read_b64_tr_b16 a[202:203], v18 offset:59392
v_rcp_f32 v10, v42
v_mfma_f32_16x16x32_bf16 v[212:215], a[172:175], v[92:95], v[212:215]
s_waitcnt vmcnt(13)
ds_read_b64_tr_b16 a[204:205], v18 offset:61440
ds_read_b64_tr_b16 a[206:207], v18 offset:63488
v_mfma_f32_16x16x32_bf16 v[212:215], a[168:171], v[88:91], v[212:215]
s_barrier
v_mfma_f32_16x16x32_bf16 v[212:215], a[164:167], v[84:87], v[212:215]
s_add_u32 s96, s8, 0x6c000
ds_read_b64_tr_b16 a[144:145], v19
v_and_b32 v7, 3, v0
v_mfma_f32_16x16x32_bf16 v[212:215], a[160:163], v[80:83], v[212:215]
s_waitcnt lgkmcnt(7)
ds_read_b64_tr_b16 a[146:147], v19 offset:2048
s_addc_u32 s97, s9, 0
v_mfma_f32_16x16x32_bf16 v[196:199], a[184:187], v[80:83], v[196:199]
s_add_u32 m0, s53, 0
ds_read_b64_tr_b16 a[148:149], v19 offset:4096
ds_read_b64_tr_b16 a[150:151], v19 offset:6144
v_mfma_f32_16x16x32_bf16 v[196:199], a[188:191], v[84:87], v[196:199]
global_load_lds_dwordx4 v30, s[96:97]
v_mfma_f32_16x16x32_bf16 v[196:199], a[192:195], v[88:91], v[196:199]
s_waitcnt lgkmcnt(4)
ds_read_b64_tr_b16 a[152:153], v19 offset:8192
s_lshl_b32 s46, s59, 3
v_mfma_f32_16x16x32_bf16 v[196:199], a[196:199], v[92:95], v[196:199]
ds_read_b64_tr_b16 a[154:155], v19 offset:10240
ds_read_b64_tr_b16 a[156:157], v19 offset:12288
v_mfma_f32_16x16x32_bf16 v[196:199], a[200:203], v[96:99], v[196:199]
global_load_lds_dwordx4 v31, s[96:97] offset:1024
v_mfma_f32_16x16x32_bf16 v[196:199], a[204:207], v[100:103], v[196:199]
ds_read_b64_tr_b16 a[158:159], v19 offset:14336
v_lshrrev_b32 v5, 2, v0
v_mfma_f32_16x16x32_bf16 v[192:195], a[204:207], a[44:47], v[192:195]
ds_read_b64_tr_b16 a[160:161], v19 offset:16384
v_mul_u32_u24 v5, 0xe0, v5
v_mfma_f32_16x16x32_bf16 v[192:195], a[200:203], a[40:43], v[192:195]
ds_read_b64_tr_b16 a[162:163], v19 offset:18432
v_add_u32 v5, s46, v5
v_mfma_f32_16x16x32_bf16 v[192:195], a[196:199], a[36:39], v[192:195]
ds_read_b64_tr_b16 a[164:165], v19 offset:20480
v_lshl_add_u32 v37, v7, 3, v5
v_mfma_f32_16x16x32_bf16 v[192:195], a[192:195], a[32:35], v[192:195]
ds_read_b64_tr_b16 a[166:167], v19 offset:22528
v_mul_u32_u24 v6, 0x48, v7
v_mfma_f32_16x16x32_bf16 v[192:195], a[188:191], a[28:31], v[192:195]
ds_read_b64_tr_b16 a[168:169], v22
v_add3_u32 v40, v5, v6, 32
v_mfma_f32_16x16x32_bf16 v[192:195], a[184:187], a[24:27], v[192:195]
s_waitcnt lgkmcnt(7)
ds_read_b64_tr_b16 a[170:171], v22 offset:2048
ds_read_b64_tr_b16 a[172:173], v22 offset:4096
v_mfma_f32_16x16x32_bf16 v[192:195], a[144:147], a[48:51], v[192:195]
global_load_lds_dwordx4 v32, s[96:97] offset:2048
v_mfma_f32_16x16x32_bf16 v[192:195], a[148:151], a[52:55], v[192:195]
ds_read_b64_tr_b16 a[174:175], v22 offset:6144
v_add_u32 v38, 0x10000, v37
v_mfma_f32_16x16x32_bf16 v[192:195], a[152:155], a[56:59], v[192:195]
s_waitcnt lgkmcnt(4)
ds_read_b64_tr_b16 a[176:177], v22 offset:8192
v_add_u32 v41, 0x10000, v40
v_mfma_f32_16x16x32_bf16 v[192:195], a[156:159], a[60:63], v[192:195]
ds_read_b64_tr_b16 a[178:179], v22 offset:10240
v_add_u32 v39, 0x20000, v37
v_mfma_f32_16x16x32_bf16 v[192:195], a[160:163], a[64:67], v[192:195]
ds_read_b64_tr_b16 a[180:181], v22 offset:12288
v_add_u32 v42, 0x20000, v40
v_mfma_f32_16x16x32_bf16 v[192:195], a[164:167], a[68:71], v[192:195]
s_lshl_b32 s46, s42, 2
ds_read_b64_tr_b16 a[182:183], v22 offset:14336
s_add_u32 s46, s46, s40
v_mfma_f32_16x16x32_bf16 v[196:199], a[164:167], v[124:127], v[196:199]
s_mul_i32 s46, s46, 0x500
ds_read_b64_tr_b16 a[184:185], v22 offset:16384
ds_read_b64_tr_b16 a[186:187], v22 offset:18432
v_mfma_f32_16x16x32_bf16 v[196:199], a[160:163], v[120:123], v[196:199]
global_load_lds_dwordx4 v33, s[96:97] offset:3072
v_mfma_f32_16x16x32_bf16 v[196:199], a[156:159], v[116:119], v[196:199]
s_add_u32 m0, s53, 0x1000
ds_read_b64_tr_b16 a[188:189], v22 offset:20480
s_mul_i32 s47, s43, 0x78000
v_mfma_f32_16x16x32_bf16 v[196:199], a[152:155], v[112:115], v[196:199]
s_add_u32 s46, s46, s47
ds_read_b64_tr_b16 a[190:191], v22 offset:22528
s_mul_i32 s47, s59, 16
v_mfma_f32_16x16x32_bf16 v[196:199], a[148:151], v[108:111], v[196:199]
ds_read_b64_tr_b16 a[192:193], v25
v_xor_b32 v6, s47, v0
v_mfma_f32_16x16x32_bf16 v[196:199], a[144:147], v[104:107], v[196:199]
s_waitcnt lgkmcnt(7)
ds_read_b64_tr_b16 a[194:195], v25 offset:2048
v_and_b32 v3, 31, v6
v_mfma_f32_16x16x32_bf16 v[212:215], a[168:171], v[104:107], v[212:215]
ds_read_b64_tr_b16 a[196:197], v25 offset:4096
v_lshrrev_b32 v4, 5, v0
v_mfma_f32_16x16x32_bf16 v[212:215], a[172:175], v[108:111], v[212:215]
ds_read_b64_tr_b16 a[198:199], v25 offset:6144
v_lshlrev_b32 v5, 2, v4
v_mfma_f32_16x16x32_bf16 v[212:215], a[176:179], v[112:115], v[212:215]
s_waitcnt lgkmcnt(4)
ds_read_b64_tr_b16 a[200:201], v25 offset:8192
ds_read_b64_tr_b16 a[202:203], v25 offset:10240
v_mfma_f32_16x16x32_bf16 v[212:215], a[180:183], v[116:119], v[212:215]
global_load_lds_dwordx4 v34, s[96:97]
v_mfma_f32_16x16x32_bf16 v[212:215], a[184:187], v[120:123], v[212:215]
ds_read_b64_tr_b16 a[204:205], v25 offset:12288
v_xor_b32 v5, v5, v6
v_mfma_f32_16x16x32_bf16 v[212:215], a[188:191], v[124:127], v[212:215]
ds_read_b64_tr_b16 a[206:207], v25 offset:14336
v_lshlrev_b32 v5, 4, v5
v_mfma_f32_16x16x32_bf16 v[208:211], a[188:191], a[68:71], v[208:211]
ds_read_b64_tr_b16 a[144:145], v25 offset:16384
v_add_u32 v43, s46, v5
v_mfma_f32_16x16x32_bf16 v[208:211], a[184:187], a[64:67], v[208:211]
ds_read_b64_tr_b16 a[146:147], v25 offset:18432
v_and_b32 v6, 7, v3
v_mfma_f32_16x16x32_bf16 v[208:211], a[180:183], a[60:63], v[208:211]
ds_read_b64_tr_b16 a[148:149], v25 offset:20480
v_bfe_u32 v5, v3, 4, 1
v_mfma_f32_16x16x32_bf16 v[208:211], a[176:179], a[56:59], v[208:211]
ds_read_b64_tr_b16 a[150:151], v25 offset:22528
ds_read_b64_tr_b16 a[152:153], v28
v_mfma_f32_16x16x32_bf16 v[208:211], a[172:175], a[52:55], v[208:211]
global_load_lds_dwordx4 v35, s[96:97] offset:1024
v_mfma_f32_16x16x32_bf16 v[208:211], a[168:171], a[48:51], v[208:211]
s_waitcnt lgkmcnt(7)
ds_read_b64_tr_b16 a[154:155], v28 offset:2048
v_lshl_add_u32 v6, v5, 3, v6
v_mfma_f32_16x16x32_bf16 v[224:227], a[192:195], a[48:51], v[224:227]
ds_read_b64_tr_b16 a[156:157], v28 offset:4096
v_bfe_u32 v5, v3, 3, 1
v_mfma_f32_16x16x32_bf16 v[224:227], a[196:199], a[52:55], v[224:227]
ds_read_b64_tr_b16 a[158:159], v28 offset:6144
v_xor_b32 v5, 1, v5
v_mfma_f32_16x16x32_bf16 v[224:227], a[200:203], a[56:59], v[224:227]
s_waitcnt lgkmcnt(4)
ds_read_b64_tr_b16 a[160:161], v28 offset:8192
v_lshl_add_u32 v6, v5, 4, v6
v_mfma_f32_16x16x32_bf16 v[224:227], a[204:207], a[60:63], v[224:227]
ds_read_b64_tr_b16 a[162:163], v28 offset:10240
v_lshlrev_b32 v6, 3, v6
v_mfma_f32_16x16x32_bf16 v[224:227], a[144:147], a[64:67], v[224:227]
ds_read_b64_tr_b16 a[164:165], v28 offset:12288
v_add_u32 v6, s46, v6
v_mfma_f32_16x16x32_bf16 v[224:227], a[148:151], a[68:71], v[224:227]
ds_read_b64_tr_b16 a[166:167], v28 offset:14336
ds_read_b64_tr_b16 a[168:169], v28 offset:16384
v_mfma_f32_16x16x32_bf16 v[228:231], a[148:151], v[124:127], v[228:231]
global_load_lds_dwordx4 v36, s[96:97] offset:2048
v_mfma_f32_16x16x32_bf16 v[228:231], a[144:147], v[120:123], v[228:231]
ds_read_b64_tr_b16 a[170:171], v28 offset:18432
v_add_u32 v6, 0x400, v6
v_mfma_f32_16x16x32_bf16 v[228:231], a[204:207], v[116:119], v[228:231]
s_waitcnt vmcnt(14)
ds_read_b64_tr_b16 a[172:173], v28 offset:20480
ds_read_b64_tr_b16 a[174:175], v28 offset:22528
v_mfma_f32_16x16x32_bf16 v[228:231], a[200:203], v[112:115], v[228:231]
s_barrier
v_mfma_f32_16x16x32_bf16 v[228:231], a[196:199], v[108:111], v[228:231]
s_add_u32 s96, s8, 0xd8000
ds_read_b64_tr_b16 a[176:177], v19 offset:24576
v_mul_u32_u24 v5, 0x50000, v4
v_mfma_f32_16x16x32_bf16 v[228:231], a[192:195], v[104:107], v[228:231]
s_waitcnt lgkmcnt(7)
ds_read_b64_tr_b16 a[178:179], v19 offset:26624
v_add_u32 v44, v6, v5
v_mfma_f32_16x16x32_bf16 v[244:247], a[152:155], v[104:107], v[244:247]
s_addc_u32 s97, s9, 0
ds_read_b64_tr_b16 a[180:181], v19 offset:28672
v_lshl_add_u32 v45, v4, 31, v6
v_mfma_f32_16x16x32_bf16 v[244:247], a[156:159], v[108:111], v[244:247]
s_add_u32 m0, s53, 0x7000
ds_read_b64_tr_b16 a[182:183], v19 offset:30720
s_mul_i32 s46, s43, 6
v_mfma_f32_16x16x32_bf16 v[244:247], a[160:163], v[112:115], v[244:247]
s_waitcnt lgkmcnt(4)
ds_read_b64_tr_b16 a[184:185], v19 offset:32768
ds_read_b64_tr_b16 a[186:187], v19 offset:34816
v_mfma_f32_16x16x32_bf16 v[244:247], a[164:167], v[116:119], v[244:247]
global_load_lds_dwordx4 v30, s[96:97]
v_mfma_f32_16x16x32_bf16 v[244:247], a[168:171], v[120:123], v[244:247]
ds_read_b64_tr_b16 a[188:189], v19 offset:36864
v_lshrrev_b32 v5, 4, v0
v_mfma_f32_16x16x32_bf16 v[244:247], a[172:175], v[124:127], v[244:247]
ds_read_b64_tr_b16 a[190:191], v19 offset:38912
v_lshl_add_u32 v5, v5, 1, s46
v_mfma_f32_16x16x32_bf16 v[240:243], a[172:175], a[68:71], v[240:243]
ds_read_b64_tr_b16 a[192:193], v19 offset:40960
v_mov_b32 v6, 0x3eae1a93
v_mfma_f32_16x16x32_bf16 v[240:243], a[168:171], a[64:67], v[240:243]
ds_read_b64_tr_b16 a[194:195], v19 offset:43008
v_cmp_gt_u32 vcc, 32, v5
v_mfma_f32_16x16x32_bf16 v[240:243], a[164:167], a[60:63], v[240:243]
ds_read_b64_tr_b16 a[196:197], v19 offset:45056
ds_read_b64_tr_b16 a[198:199], v19 offset:47104
v_mfma_f32_16x16x32_bf16 v[240:243], a[160:163], a[56:59], v[240:243]
global_load_lds_dwordx4 v31, s[96:97] offset:1024
v_mfma_f32_16x16x32_bf16 v[240:243], a[156:159], a[52:55], v[240:243]
ds_read_b64_tr_b16 a[200:201], v22 offset:24576
v_cndmask_b32 v46, 1.0, v6, vcc
v_mfma_f32_16x16x32_bf16 v[240:243], a[152:155], a[48:51], v[240:243]
s_waitcnt lgkmcnt(7)
ds_read_b64_tr_b16 a[202:203], v22 offset:26624
v_readlane_b32 s55, v46, 0
v_mfma_f32_16x16x32_bf16 v[200:203], a[176:179], a[48:51], v[200:203]
ds_read_b64_tr_b16 a[204:205], v22 offset:28672
v_readlane_b32 s56, v46, 16
v_mfma_f32_16x16x32_bf16 v[200:203], a[180:183], a[52:55], v[200:203]
ds_read_b64_tr_b16 a[206:207], v22 offset:30720
v_readlane_b32 s57, v46, 32
v_mfma_f32_16x16x32_bf16 v[200:203], a[184:187], a[56:59], v[200:203]
s_waitcnt lgkmcnt(4)
ds_read_b64_tr_b16 a[144:145], v22 offset:32768
v_mfma_f32_16x16x32_bf16 v[200:203], a[188:191], a[60:63], v[200:203]
s_lshl_b32 s46, s42, 2
ds_read_b64_tr_b16 a[146:147], v22 offset:34816
ds_read_b64_tr_b16 a[148:149], v22 offset:36864
v_mfma_f32_16x16x32_bf16 v[200:203], a[192:195], a[64:67], v[200:203]
global_load_lds_dwordx4 v32, s[96:97] offset:2048
v_mfma_f32_16x16x32_bf16 v[200:203], a[196:199], a[68:71], v[200:203]
s_add_u32 s46, s46, s40
ds_read_b64_tr_b16 a[150:151], v22 offset:38912
s_mul_i32 s62, s46, 0x90000
v_mfma_f32_16x16x32_bf16 v[204:207], a[196:199], v[124:127], v[204:207]
s_lshl_b32 s47, s43, 10
ds_read_b64_tr_b16 a[152:153], v22 offset:40960
s_add_u32 s47, s47, s62
v_mfma_f32_16x16x32_bf16 v[204:207], a[192:195], v[120:123], v[204:207]
ds_read_b64_tr_b16 a[154:155], v22 offset:43008
v_lshl_add_u32 v47, v0, 4, s47
v_mfma_f32_16x16x32_bf16 v[204:207], a[188:191], v[116:119], v[204:207]
s_lshl_b32 s47, s43, 9
ds_read_b64_tr_b16 a[156:157], v22 offset:45056
s_add_u32 s47, s47, s62
v_mfma_f32_16x16x32_bf16 v[204:207], a[184:187], v[112:115], v[204:207]
ds_read_b64_tr_b16 a[158:159], v22 offset:47104
v_lshl_add_u32 v48, v0, 3, s47
v_mfma_f32_16x16x32_bf16 v[204:207], a[180:183], v[108:111], v[204:207]
s_lshl_b32 s47, s46, 11
ds_read_b64_tr_b16 a[160:161], v25 offset:24576
s_add_u32 s47, s47, 0x2ed0000
v_mfma_f32_16x16x32_bf16 v[204:207], a[176:179], v[104:107], v[204:207]
s_waitcnt lgkmcnt(7)
ds_read_b64_tr_b16 a[162:163], v25 offset:26624
ds_read_b64_tr_b16 a[164:165], v25 offset:28672
v_mfma_f32_16x16x32_bf16 v[220:223], a[200:203], v[104:107], v[220:223]
global_load_lds_dwordx4 v33, s[96:97] offset:3072
v_mfma_f32_16x16x32_bf16 v[220:223], a[204:207], v[108:111], v[220:223]
s_add_u32 m0, s53, 0x8000
ds_read_b64_tr_b16 a[166:167], v25 offset:30720
v_lshl_add_u32 v5, v0, 9, s47
v_mfma_f32_16x16x32_bf16 v[220:223], a[144:147], v[112:115], v[220:223]
s_waitcnt lgkmcnt(4)
ds_read_b64_tr_b16 a[168:169], v25 offset:32768
s_and_b32 s63, s43, 3
v_mfma_f32_16x16x32_bf16 v[220:223], a[148:151], v[116:119], v[220:223]
s_lshl_b32 s63, s63, 9
ds_read_b64_tr_b16 a[170:171], v25 offset:34816
v_max_f32 v192, 0, v192
v_mfma_f32_16x16x32_bf16 v[220:223], a[152:155], v[120:123], v[220:223]
s_add_u32 s63, s63, s47
ds_read_b64_tr_b16 a[172:173], v25 offset:36864
v_max_f32 v193, 0, v193
v_mfma_f32_16x16x32_bf16 v[220:223], a[156:159], v[124:127], v[220:223]
ds_read_b64_tr_b16 a[174:175], v25 offset:38912
v_max_f32 v194, 0, v194
v_mfma_f32_16x16x32_bf16 v[216:219], a[156:159], a[68:71], v[216:219]
ds_read_b64_tr_b16 a[176:177], v25 offset:40960
ds_read_b64_tr_b16 a[178:179], v25 offset:43008
v_mfma_f32_16x16x32_bf16 v[216:219], a[152:155], a[64:67], v[216:219]
global_load_lds_dwordx4 v34, s[96:97]
v_mfma_f32_16x16x32_bf16 v[216:219], a[148:151], a[60:63], v[216:219]
ds_read_b64_tr_b16 a[180:181], v25 offset:45056
v_max_f32 v195, 0, v195
v_mfma_f32_16x16x32_bf16 v[216:219], a[144:147], a[56:59], v[216:219]
ds_read_b64_tr_b16 a[182:183], v25 offset:47104
v_max_f32 v196, 0, v196
v_mfma_f32_16x16x32_bf16 v[216:219], a[204:207], a[52:55], v[216:219]
ds_read_b64_tr_b16 a[184:185], v28 offset:24576
v_max_f32 v197, 0, v197
v_mfma_f32_16x16x32_bf16 v[216:219], a[200:203], a[48:51], v[216:219]
s_waitcnt lgkmcnt(7)
ds_read_b64_tr_b16 a[186:187], v28 offset:26624
v_max_f32 v198, 0, v198
v_mfma_f32_16x16x32_bf16 v[232:235], a[160:163], a[48:51], v[232:235]
ds_read_b64_tr_b16 a[188:189], v28 offset:28672
v_max_f32 v199, 0, v199
v_mfma_f32_16x16x32_bf16 v[232:235], a[164:167], a[52:55], v[232:235]
ds_read_b64_tr_b16 a[190:191], v28 offset:30720
v_mul_f32 v200, v192, v200
v_mfma_f32_16x16x32_bf16 v[232:235], a[168:171], a[56:59], v[232:235]
s_waitcnt lgkmcnt(4)
ds_read_b64_tr_b16 a[192:193], v28 offset:32768
ds_read_b64_tr_b16 a[194:195], v28 offset:34816
v_mfma_f32_16x16x32_bf16 v[232:235], a[172:175], a[60:63], v[232:235]
global_load_lds_dwordx4 v35, s[96:97] offset:1024
v_mfma_f32_16x16x32_bf16 v[232:235], a[176:179], a[64:67], v[232:235]
ds_read_b64_tr_b16 a[196:197], v28 offset:36864
v_mul_f32 v201, v193, v201
v_mfma_f32_16x16x32_bf16 v[232:235], a[180:183], a[68:71], v[232:235]
ds_read_b64_tr_b16 a[198:199], v28 offset:38912
v_mul_f32 v202, v194, v202
v_mfma_f32_16x16x32_bf16 v[236:239], a[180:183], v[124:127], v[236:239]
ds_read_b64_tr_b16 a[200:201], v28 offset:40960
v_mul_f32 v203, v195, v203
v_mfma_f32_16x16x32_bf16 v[236:239], a[176:179], v[120:123], v[236:239]
L_pg4:
s_cbranch_execz L_tr1
ds_read_b64_tr_b16 a[202:203], v28 offset:43008
v_cvt_pk_bf16_f32 v192, v200, v201
v_mfma_f32_16x16x32_bf16 v[236:239], a[172:175], v[116:119], v[236:239]
s_waitcnt vmcnt(13)
ds_read_b64_tr_b16 a[204:205], v28 offset:45056
ds_read_b64_tr_b16 a[206:207], v28 offset:47104
v_mfma_f32_16x16x32_bf16 v[236:239], a[168:171], v[112:115], v[236:239]
s_barrier
v_mfma_f32_16x16x32_bf16 v[236:239], a[164:167], v[108:111], v[236:239]
ds_read_b64_tr_b16 a[144:145], v38 offset:49152
v_cvt_pk_bf16_f32 v193, v202, v203
v_mfma_f32_16x16x32_bf16 v[236:239], a[160:163], v[104:107], v[236:239]
s_waitcnt lgkmcnt(7)
ds_read_b64_tr_b16 a[146:147], v38 offset:52736
ds_read_b64_tr_b16 a[148:149], v38 offset:56320
v_mfma_f32_16x16x32_bf16 v[252:255], a[184:187], v[104:107], v[252:255]
global_load_lds_dwordx4 v36, s[96:97] offset:2048
v_mfma_f32_16x16x32_bf16 v[252:255], a[188:191], v[108:111], v[252:255]
s_add_u32 s96, s8, 0x144000
ds_read_b64_tr_b16 a[150:151], v38 offset:59904
v_accvgpr_write_b32 a88, v192
v_mfma_f32_16x16x32_bf16 v[252:255], a[192:195], v[112:115], v[252:255]
s_waitcnt lgkmcnt(4)
ds_read_b64_tr_b16 a[152:153], v38 offset:63488
v_accvgpr_write_b32 a89, v193
v_mfma_f32_16x16x32_bf16 v[252:255], a[196:199], v[116:119], v[252:255]
s_addc_u32 s97, s9, 0
ds_read_b64_tr_b16 a[154:155], v39 offset:1536
v_mul_f32 v204, v196, v204
v_mfma_f32_16x16x32_bf16 v[252:255], a[200:203], v[120:123], v[252:255]
s_add_u32 m0, s53, 0xe000
ds_read_b64_tr_b16 a[156:157], v39 offset:5120
v_mul_f32 v205, v197, v205
v_mfma_f32_16x16x32_bf16 v[252:255], a[204:207], v[124:127], v[252:255]
ds_read_b64_tr_b16 a[158:159], v39 offset:8704
ds_read_b64_tr_b16 a[160:161], v38 offset:49192
v_mfma_f32_16x16x32_bf16 v[248:251], a[204:207], a[68:71], v[248:251]
global_load_lds_dwordx4 v30, s[96:97]
v_mfma_f32_16x16x32_bf16 v[248:251], a[200:203], a[64:67], v[248:251]
ds_read_b64_tr_b16 a[162:163], v38 offset:52776
v_mul_f32 v206, v198, v206
v_mfma_f32_16x16x32_bf16 v[248:251], a[196:199], a[60:63], v[248:251]
ds_read_b64_tr_b16 a[164:165], v38 offset:56360
v_mul_f32 v207, v199, v207
v_mfma_f32_16x16x32_bf16 v[248:251], a[192:195], a[56:59], v[248:251]
ds_read_b64_tr_b16 a[166:167], v38 offset:59944
v_cvt_pk_bf16_f32 v196, v204, v205
v_mfma_f32_16x16x32_bf16 v[248:251], a[188:191], a[52:55], v[248:251]
ds_read_b64_tr_b16 a[168:169], v38 offset:63528
v_cvt_pk_bf16_f32 v197, v206, v207
v_mfma_f32_16x16x32_bf16 v[248:251], a[184:187], a[48:51], v[248:251]
s_waitcnt lgkmcnt(7)
ds_read_b64_tr_b16 a[170:171], v39 offset:1576
v_accvgpr_write_b32 a92, v196
v_mfma_f32_16x16x32_bf16 v[128:131], a[144:147], a[0:3], 0
ds_read_b64_tr_b16 a[172:173], v39 offset:5160
ds_read_b64_tr_b16 a[174:175], v39 offset:8744
v_mfma_f32_16x16x32_bf16 v[128:131], a[148:151], a[4:7], v[128:131]
global_load_lds_dwordx4 v31, s[96:97] offset:1024
v_mfma_f32_16x16x32_bf16 v[128:131], a[152:155], a[8:11], v[128:131]
s_waitcnt lgkmcnt(8)
ds_read_b64_tr_b16 a[176:177], v38 offset:49224
v_accvgpr_write_b32 a93, v197
v_mfma_f32_16x16x32_bf16 v[128:131], a[156:159], a[12:15], v[128:131]
ds_read_b64_tr_b16 a[178:179], v38 offset:52808
v_max_f32 v208, 0, v208
v_mfma_f32_16x16x32_bf16 v[132:135], a[156:159], v[68:71], 0
ds_read_b64_tr_b16 a[180:181], v38 offset:56392
v_max_f32 v209, 0, v209
v_mfma_f32_16x16x32_bf16 v[132:135], a[152:155], v[64:67], v[132:135]
ds_read_b64_tr_b16 a[182:183], v38 offset:59976
v_max_f32 v210, 0, v210
v_mfma_f32_16x16x32_bf16 v[132:135], a[148:151], v[60:63], v[132:135]
ds_read_b64_tr_b16 a[184:185], v38 offset:63560
v_max_f32 v211, 0, v211
v_mfma_f32_16x16x32_bf16 v[132:135], a[144:147], v[56:59], v[132:135]
s_waitcnt lgkmcnt(7)
ds_read_b64_tr_b16 a[186:187], v39 offset:1608
v_max_f32 v212, 0, v212
v_mfma_f32_16x16x32_bf16 v[140:143], a[160:163], v[56:59], 0
ds_read_b64_tr_b16 a[188:189], v39 offset:5192
ds_read_b64_tr_b16 a[190:191], v39 offset:8776
v_mfma_f32_16x16x32_bf16 v[140:143], a[164:167], v[60:63], v[140:143]
global_load_lds_dwordx4 v32, s[96:97] offset:2048
v_mfma_f32_16x16x32_bf16 v[140:143], a[168:171], v[64:67], v[140:143]
s_waitcnt lgkmcnt(8)
ds_read_b64_tr_b16 a[192:193], v38 offset:49264
v_max_f32 v213, 0, v213
v_mfma_f32_16x16x32_bf16 v[140:143], a[172:175], v[68:71], v[140:143]
ds_read_b64_tr_b16 a[194:195], v38 offset:52848
v_max_f32 v214, 0, v214
v_mfma_f32_16x16x32_bf16 v[136:139], a[172:175], a[12:15], 0
ds_read_b64_tr_b16 a[196:197], v38 offset:56432
v_max_f32 v215, 0, v215
v_mfma_f32_16x16x32_bf16 v[136:139], a[168:171], a[8:11], v[136:139]
ds_read_b64_tr_b16 a[198:199], v38 offset:60016
v_mul_f32 v216, v208, v216
v_mfma_f32_16x16x32_bf16 v[136:139], a[164:167], a[4:7], v[136:139]
ds_read_b64_tr_b16 a[200:201], v38 offset:63600
v_mul_f32 v217, v209, v217
v_mfma_f32_16x16x32_bf16 v[136:139], a[160:163], a[0:3], v[136:139]
s_waitcnt lgkmcnt(7)
ds_read_b64_tr_b16 a[202:203], v39 offset:1648
ds_read_b64_tr_b16 a[204:205], v39 offset:5232
v_mfma_f32_16x16x32_bf16 v[144:147], a[176:179], a[0:3], 0
global_load_lds_dwordx4 v33, s[96:97] offset:3072
v_mfma_f32_16x16x32_bf16 v[144:147], a[180:183], a[4:7], v[144:147]
s_add_u32 m0, s53, 0xf000
ds_read_b64_tr_b16 a[206:207], v39 offset:8816
v_mul_f32 v218, v210, v218
v_mfma_f32_16x16x32_bf16 v[144:147], a[184:187], a[8:11], v[144:147]
s_waitcnt lgkmcnt(8)
ds_read_b64_tr_b16 a[144:145], v38 offset:49296
v_mul_f32 v219, v211, v219
v_mfma_f32_16x16x32_bf16 v[144:147], a[188:191], a[12:15], v[144:147]
ds_read_b64_tr_b16 a[146:147], v38 offset:52880
v_cvt_pk_bf16_f32 v208, v216, v217
v_mfma_f32_16x16x32_bf16 v[148:151], a[188:191], v[68:71], 0
ds_read_b64_tr_b16 a[148:149], v38 offset:56464
v_cvt_pk_bf16_f32 v209, v218, v219
v_mfma_f32_16x16x32_bf16 v[148:151], a[184:187], v[64:67], v[148:151]
ds_read_b64_tr_b16 a[150:151], v38 offset:60048
v_accvgpr_write_b32 a90, v208
v_mfma_f32_16x16x32_bf16 v[148:151], a[180:183], v[60:63], v[148:151]
ds_read_b64_tr_b16 a[152:153], v38 offset:63632
v_accvgpr_write_b32 a91, v209
v_mfma_f32_16x16x32_bf16 v[148:151], a[176:179], v[56:59], v[148:151]
s_waitcnt lgkmcnt(7)
ds_read_b64_tr_b16 a[154:155], v39 offset:1680
ds_read_b64_tr_b16 a[156:157], v39 offset:5264
v_mfma_f32_16x16x32_bf16 v[156:159], a[192:195], v[56:59], 0
global_load_lds_dwordx4 v34, s[96:97]
v_mfma_f32_16x16x32_bf16 v[156:159], a[196:199], v[60:63], v[156:159]
ds_read_b64_tr_b16 a[158:159], v39 offset:8848
v_mul_f32 v220, v212, v220
v_mfma_f32_16x16x32_bf16 v[156:159], a[200:203], v[64:67], v[156:159]
s_waitcnt lgkmcnt(8)
ds_read_b64_tr_b16 a[160:161], v38 offset:49336
v_mul_f32 v221, v213, v221
v_mfma_f32_16x16x32_bf16 v[156:159], a[204:207], v[68:71], v[156:159]
ds_read_b64_tr_b16 a[162:163], v38 offset:52920
v_mul_f32 v222, v214, v222
v_mfma_f32_16x16x32_bf16 v[152:155], a[204:207], a[12:15], 0
ds_read_b64_tr_b16 a[164:165], v38 offset:56504
v_mul_f32 v223, v215, v223
v_mfma_f32_16x16x32_bf16 v[152:155], a[200:203], a[8:11], v[152:155]
ds_read_b64_tr_b16 a[166:167], v38 offset:60088
v_cvt_pk_bf16_f32 v212, v220, v221
v_mfma_f32_16x16x32_bf16 v[152:155], a[196:199], a[4:7], v[152:155]
ds_read_b64_tr_b16 a[168:169], v38 offset:63672
v_cvt_pk_bf16_f32 v213, v222, v223
v_mfma_f32_16x16x32_bf16 v[152:155], a[192:195], a[0:3], v[152:155]
s_waitcnt lgkmcnt(7)
ds_read_b64_tr_b16 a[170:171], v39 offset:1720
ds_read_b64_tr_b16 a[172:173], v39 offset:5304
v_mfma_f32_16x16x32_bf16 v[160:163], a[144:147], a[0:3], 0
global_load_lds_dwordx4 v35, s[96:97] offset:1024
v_mfma_f32_16x16x32_bf16 v[160:163], a[148:151], a[4:7], v[160:163]
ds_read_b64_tr_b16 a[174:175], v39 offset:8888
v_accvgpr_write_b32 a94, v212
v_mfma_f32_16x16x32_bf16 v[160:163], a[152:155], a[8:11], v[160:163]
s_waitcnt lgkmcnt(8)
ds_read_b64_tr_b16 a[176:177], v41 offset:49152
v_accvgpr_write_b32 a95, v213
v_mfma_f32_16x16x32_bf16 v[160:163], a[156:159], a[12:15], v[160:163]
ds_read_b64_tr_b16 a[178:179], v41 offset:52736
v_max_f32 v224, 0, v224
v_mfma_f32_16x16x32_bf16 v[164:167], a[156:159], v[68:71], 0
ds_read_b64_tr_b16 a[180:181], v41 offset:56320
v_max_f32 v225, 0, v225
v_mfma_f32_16x16x32_bf16 v[164:167], a[152:155], v[64:67], v[164:167]
ds_read_b64_tr_b16 a[182:183], v41 offset:59904
v_max_f32 v226, 0, v226
v_mfma_f32_16x16x32_bf16 v[164:167], a[148:151], v[60:63], v[164:167]
ds_read_b64_tr_b16 a[184:185], v41 offset:63488
v_max_f32 v227, 0, v227
v_mfma_f32_16x16x32_bf16 v[164:167], a[144:147], v[56:59], v[164:167]
s_waitcnt lgkmcnt(7)
ds_read_b64_tr_b16 a[186:187], v42 offset:1536
v_max_f32 v228, 0, v228
v_mfma_f32_16x16x32_bf16 v[172:175], a[160:163], v[56:59], 0
s_waitcnt vmcnt(13)
ds_read_b64_tr_b16 a[188:189], v42 offset:5120
ds_read_b64_tr_b16 a[190:191], v42 offset:8704
v_mfma_f32_16x16x32_bf16 v[172:175], a[164:167], v[60:63], v[172:175]
s_barrier
v_mfma_f32_16x16x32_bf16 v[172:175], a[168:171], v[64:67], v[172:175]
s_waitcnt lgkmcnt(8)
ds_read_b64_tr_b16 a[192:193], v40
ds_read_b64_tr_b16 a[194:195], v40 offset:3584
v_mfma_f32_16x16x32_bf16 v[172:175], a[172:175], v[68:71], v[172:175]
global_load_lds_dwordx4 v36, s[96:97] offset:2048
v_mfma_f32_16x16x32_bf16 v[168:171], a[172:175], a[12:15], 0
s_mov_b32 s48, 0x1b0000
ds_read_b64_tr_b16 a[196:197], v40 offset:7168
v_max_f32 v229, 0, v229
v_mfma_f32_16x16x32_bf16 v[168:171], a[168:171], a[8:11], v[168:171]
s_add_u32 m0, s53, 0x15000
ds_read_b64_tr_b16 a[198:199], v40 offset:10752
ds_read_b64_tr_b16 a[200:201], v40 offset:14336
v_mfma_f32_16x16x32_bf16 v[168:171], a[164:167], a[4:7], v[168:171]
buffer_load_dwordx4 v30, s[8:11], s48 offen lds
v_mfma_f32_16x16x32_bf16 v[168:171], a[160:163], a[0:3], v[168:171]
s_waitcnt lgkmcnt(7)
ds_read_b64_tr_b16 a[202:203], v40 offset:17920
v_max_f32 v230, 0, v230
v_mfma_f32_16x16x32_bf16 v[176:179], a[176:179], a[0:3], 0
ds_read_b64_tr_b16 a[204:205], v40 offset:21504
v_max_f32 v231, 0, v231
v_mfma_f32_16x16x32_bf16 v[176:179], a[180:183], a[4:7], v[176:179]
ds_read_b64_tr_b16 a[206:207], v40 offset:25088
v_mul_f32 v232, v224, v232
v_mfma_f32_16x16x32_bf16 v[176:179], a[184:187], a[8:11], v[176:179]
s_waitcnt lgkmcnt(8)
ds_read_b64_tr_b16 a[144:145], v37 offset:184
ds_read_b64_tr_b16 a[146:147], v37 offset:3768
v_mfma_f32_16x16x32_bf16 v[176:179], a[188:191], a[12:15], v[176:179]
buffer_load_dwordx4 v31, s[8:11], s48 offen offset:1024 lds
v_mfma_f32_16x16x32_bf16 v[180:183], a[188:191], v[68:71], 0
ds_read_b64_tr_b16 a[148:149], v37 offset:7352
v_mul_f32 v233, v225, v233
v_mfma_f32_16x16x32_bf16 v[180:183], a[184:187], v[64:67], v[180:183]
ds_read_b64_tr_b16 a[150:151], v37 offset:10936
v_mul_f32 v234, v226, v234
v_mfma_f32_16x16x32_bf16 v[180:183], a[180:183], v[60:63], v[180:183]
ds_read_b64_tr_b16 a[152:153], v37 offset:14520
v_mul_f32 v235, v227, v235
v_mfma_f32_16x16x32_bf16 v[180:183], a[176:179], v[56:59], v[180:183]
s_waitcnt lgkmcnt(7)
ds_read_b64_tr_b16 a[154:155], v37 offset:18104
ds_read_b64_tr_b16 a[156:157], v37 offset:21688
v_mfma_f32_16x16x32_bf16 v[180:183], a[192:195], v[72:75], v[180:183]
buffer_load_dwordx4 v32, s[8:11], s48 offen offset:2048 lds
v_mfma_f32_16x16x32_bf16 v[180:183], a[196:199], v[76:79], v[180:183]
ds_read_b64_tr_b16 a[158:159], v37 offset:25272
v_cvt_pk_bf16_f32 v224, v232, v233
v_mfma_f32_16x16x32_bf16 v[180:183], a[200:203], v[80:83], v[180:183]
s_waitcnt lgkmcnt(8)
ds_read_b64_tr_b16 a[160:161], v37 offset:144
v_cvt_pk_bf16_f32 v225, v234, v235
v_mfma_f32_16x16x32_bf16 v[180:183], a[204:207], v[84:87], v[180:183]
ds_read_b64_tr_b16 a[162:163], v37 offset:3728
v_accvgpr_write_b32 a96, v224
v_mfma_f32_16x16x32_bf16 v[176:179], a[204:207], a[28:31], v[176:179]
ds_read_b64_tr_b16 a[164:165], v37 offset:7312
ds_read_b64_tr_b16 a[166:167], v37 offset:10896
v_mfma_f32_16x16x32_bf16 v[176:179], a[200:203], a[24:27], v[176:179]
buffer_load_dwordx4 v33, s[8:11], s48 offen offset:3072 lds
v_mfma_f32_16x16x32_bf16 v[176:179], a[196:199], a[20:23], v[176:179]
s_add_u32 m0, s53, 0x16000
ds_read_b64_tr_b16 a[168:169], v37 offset:14480
v_accvgpr_write_b32 a97, v225
v_mfma_f32_16x16x32_bf16 v[176:179], a[192:195], a[16:19], v[176:179]
s_waitcnt lgkmcnt(7)
ds_read_b64_tr_b16 a[170:171], v37 offset:18064
v_mul_f32 v236, v228, v236
v_mfma_f32_16x16x32_bf16 v[168:171], a[144:147], a[16:19], v[168:171]
ds_read_b64_tr_b16 a[172:173], v37 offset:21648
v_mul_f32 v237, v229, v237
v_mfma_f32_16x16x32_bf16 v[168:171], a[148:151], a[20:23], v[168:171]
ds_read_b64_tr_b16 a[174:175], v37 offset:25232
v_mul_f32 v238, v230, v238
v_mfma_f32_16x16x32_bf16 v[168:171], a[152:155], a[24:27], v[168:171]
s_waitcnt lgkmcnt(8)
ds_read_b64_tr_b16 a[176:177], v37 offset:112
ds_read_b64_tr_b16 a[178:179], v37 offset:3696
v_mfma_f32_16x16x32_bf16 v[168:171], a[156:159], a[28:31], v[168:171]
buffer_load_dwordx4 v34, s[8:11], s48 offen lds
v_mfma_f32_16x16x32_bf16 v[172:175], a[156:159], v[84:87], v[172:175]
ds_read_b64_tr_b16 a[180:181], v37 offset:7280
v_mul_f32 v239, v231, v239
v_mfma_f32_16x16x32_bf16 v[172:175], a[152:155], v[80:83], v[172:175]
ds_read_b64_tr_b16 a[182:183], v37 offset:10864
v_cvt_pk_bf16_f32 v228, v236, v237
v_mfma_f32_16x16x32_bf16 v[172:175], a[148:151], v[76:79], v[172:175]
ds_read_b64_tr_b16 a[184:185], v37 offset:14448
v_cvt_pk_bf16_f32 v229, v238, v239
v_mfma_f32_16x16x32_bf16 v[172:175], a[144:147], v[72:75], v[172:175]
s_waitcnt lgkmcnt(7)
ds_read_b64_tr_b16 a[186:187], v37 offset:18032
ds_read_b64_tr_b16 a[188:189], v37 offset:21616
v_mfma_f32_16x16x32_bf16 v[164:167], a[160:163], v[72:75], v[164:167]
buffer_load_dwordx4 v35, s[8:11], s48 offen offset:1024 lds
v_mfma_f32_16x16x32_bf16 v[164:167], a[164:167], v[76:79], v[164:167]
ds_read_b64_tr_b16 a[190:191], v37 offset:25200
v_accvgpr_write_b32 a100, v228
v_mfma_f32_16x16x32_bf16 v[164:167], a[168:171], v[80:83], v[164:167]
s_waitcnt lgkmcnt(8)
ds_read_b64_tr_b16 a[192:193], v37 offset:72
v_accvgpr_write_b32 a101, v229
v_mfma_f32_16x16x32_bf16 v[164:167], a[172:175], v[84:87], v[164:167]
ds_read_b64_tr_b16 a[194:195], v37 offset:3656
ds_read_b64_tr_b16 a[196:197], v37 offset:7240
v_mfma_f32_16x16x32_bf16 v[160:163], a[172:175], a[28:31], v[160:163]
buffer_load_dwordx4 v36, s[8:11], s48 offen offset:2048 lds
v_mfma_f32_16x16x32_bf16 v[160:163], a[168:171], a[24:27], v[160:163]
ds_read_b64_tr_b16 a[198:199], v37 offset:10824
v_max_f32 v240, 0, v240
v_mfma_f32_16x16x32_bf16 v[160:163], a[164:167], a[20:23], v[160:163]
ds_read_b64_tr_b16 a[200:201], v37 offset:14408
v_max_f32 v241, 0, v241
v_mfma_f32_16x16x32_bf16 v[160:163], a[160:163], a[16:19], v[160:163]
s_waitcnt lgkmcnt(7)
ds_read_b64_tr_b16 a[202:203], v37 offset:17992
v_max_f32 v242, 0, v242
v_mfma_f32_16x16x32_bf16 v[152:155], a[176:179], a[16:19], v[152:155]
ds_read_b64_tr_b16 a[204:205], v37 offset:21576
v_max_f32 v243, 0, v243
v_mfma_f32_16x16x32_bf16 v[152:155], a[180:183], a[20:23], v[152:155]
ds_read_b64_tr_b16 a[206:207], v37 offset:25160
v_max_f32 v244, 0, v244
v_mfma_f32_16x16x32_bf16 v[152:155], a[184:187], a[24:27], v[152:155]
s_waitcnt lgkmcnt(8)
ds_read_b64_tr_b16 a[144:145], v37 offset:40
v_max_f32 v245, 0, v245
v_mfma_f32_16x16x32_bf16 v[152:155], a[188:191], a[28:31], v[152:155]
ds_read_b64_tr_b16 a[146:147], v37 offset:3624
v_max_f32 v246, 0, v246
v_mfma_f32_16x16x32_bf16 v[156:159], a[188:191], v[84:87], v[156:159]
ds_read_b64_tr_b16 a[148:149], v37 offset:7208
v_max_f32 v247, 0, v247
v_mfma_f32_16x16x32_bf16 v[156:159], a[184:187], v[80:83], v[156:159]
ds_read_b64_tr_b16 a[150:151], v37 offset:10792
v_mul_f32 v248, v240, v248
v_mfma_f32_16x16x32_bf16 v[156:159], a[180:183], v[76:79], v[156:159]
ds_read_b64_tr_b16 a[152:153], v37 offset:14376
v_mul_f32 v249, v241, v249
v_mfma_f32_16x16x32_bf16 v[156:159], a[176:179], v[72:75], v[156:159]
s_waitcnt lgkmcnt(7)
ds_read_b64_tr_b16 a[154:155], v37 offset:17960
v_mul_f32 v250, v242, v250
v_mfma_f32_16x16x32_bf16 v[148:151], a[192:195], v[72:75], v[148:151]
ds_read_b64_tr_b16 a[156:157], v37 offset:21544
v_mul_f32 v251, v243, v251
v_mfma_f32_16x16x32_bf16 v[148:151], a[196:199], v[76:79], v[148:151]
ds_read_b64_tr_b16 a[158:159], v37 offset:25128
v_cvt_pk_bf16_f32 v240, v248, v249
v_mfma_f32_16x16x32_bf16 v[148:151], a[200:203], v[80:83], v[148:151]
s_waitcnt lgkmcnt(8)
ds_read_b64_tr_b16 a[160:161], v37
v_cvt_pk_bf16_f32 v241, v250, v251
v_mfma_f32_16x16x32_bf16 v[148:151], a[204:207], v[84:87], v[148:151]
ds_read_b64_tr_b16 a[162:163], v37 offset:3584
v_accvgpr_write_b32 a98, v240
v_mfma_f32_16x16x32_bf16 v[144:147], a[204:207], a[28:31], v[144:147]
ds_read_b64_tr_b16 a[164:165], v37 offset:7168
v_accvgpr_write_b32 a99, v241
v_mfma_f32_16x16x32_bf16 v[144:147], a[200:203], a[24:27], v[144:147]
ds_read_b64_tr_b16 a[166:167], v37 offset:10752
v_mul_f32 v252, v244, v252
v_mfma_f32_16x16x32_bf16 v[144:147], a[196:199], a[20:23], v[144:147]
ds_read_b64_tr_b16 a[168:169], v37 offset:14336
v_mul_f32 v253, v245, v253
v_mfma_f32_16x16x32_bf16 v[144:147], a[192:195], a[16:19], v[144:147]
s_waitcnt lgkmcnt(7)
ds_read_b64_tr_b16 a[170:171], v37 offset:17920
v_mul_f32 v254, v246, v254
v_mfma_f32_16x16x32_bf16 v[136:139], a[144:147], a[16:19], v[136:139]
s_waitcnt vmcnt(14)
ds_read_b64_tr_b16 a[172:173], v37 offset:21504
ds_read_b64_tr_b16 a[174:175], v37 offset:25088
v_mfma_f32_16x16x32_bf16 v[136:139], a[148:151], a[20:23], v[136:139]
s_barrier
v_mfma_f32_16x16x32_bf16 v[136:139], a[152:155], a[24:27], v[136:139]
s_waitcnt lgkmcnt(8)
ds_read_b64_tr_b16 a[176:177], v37 offset:28672
v_mul_f32 v255, v247, v255
v_mfma_f32_16x16x32_bf16 v[136:139], a[156:159], a[28:31], v[136:139]
s_add_u32 m0, s41, 0x1c000
ds_read_b64_tr_b16 a[178:179], v37 offset:32256
v_cvt_pk_bf16_f32 v244, v252, v253
v_mfma_f32_16x16x32_bf16 v[140:143], a[156:159], v[84:87], v[140:143]
s_add_u32 s96, s16, 0x100
ds_read_b64_tr_b16 a[180:181], v37 offset:35840
v_cvt_pk_bf16_f32 v245, v254, v255
v_mfma_f32_16x16x32_bf16 v[140:143], a[152:155], v[80:83], v[140:143]
s_addc_u32 s97, s17, 0
ds_read_b64_tr_b16 a[182:183], v37 offset:39424
ds_read_b64_tr_b16 a[184:185], v37 offset:43008
v_mfma_f32_16x16x32_bf16 v[140:143], a[148:151], v[76:79], v[140:143]
global_load_lds_dwordx4 v14, s[96:97]
v_mfma_f32_16x16x32_bf16 v[140:143], a[144:147], v[72:75], v[140:143]
s_waitcnt lgkmcnt(7)
ds_read_b64_tr_b16 a[186:187], v37 offset:46592
v_accvgpr_write_b32 a102, v244
v_mfma_f32_16x16x32_bf16 v[132:135], a[160:163], v[72:75], v[132:135]
s_add_u32 m0, s41, 0x1d000
ds_read_b64_tr_b16 a[188:189], v37 offset:50176
v_accvgpr_write_b32 a103, v245
v_mfma_f32_16x16x32_bf16 v[132:135], a[164:167], v[76:79], v[132:135]
s_add_u32 s96, s16, 0x48100
ds_read_b64_tr_b16 a[190:191], v37 offset:53760
v_cmp_gt_u32 vcc, 4, v0
v_mfma_f32_16x16x32_bf16 v[132:135], a[168:171], v[80:83], v[132:135]
s_waitcnt lgkmcnt(8)
ds_read_b64_tr_b16 a[192:193], v37 offset:28712
v_mov_b32 v6, 0x80000000
v_mfma_f32_16x16x32_bf16 v[132:135], a[172:175], v[84:87], v[132:135]
s_addc_u32 s97, s17, 0
ds_read_b64_tr_b16 a[194:195], v37 offset:32296
ds_read_b64_tr_b16 a[196:197], v37 offset:35880
v_mfma_f32_16x16x32_bf16 v[128:131], a[172:175], a[28:31], v[128:131]
global_load_lds_dwordx4 v14, s[96:97]
v_mfma_f32_16x16x32_bf16 v[128:131], a[168:171], a[24:27], v[128:131]
s_add_u32 m0, s41, 0x1e000
ds_read_b64_tr_b16 a[198:199], v37 offset:39464
v_cndmask_b32 v49, v6, v5, vcc
v_mfma_f32_16x16x32_bf16 v[128:131], a[164:167], a[20:23], v[128:131]
s_add_u32 s96, s16, 0x90100
ds_read_b64_tr_b16 a[200:201], v37 offset:43048
s_addc_u32 s97, s17, 0
v_mfma_f32_16x16x32_bf16 v[128:131], a[160:163], a[16:19], v[128:131]
s_waitcnt lgkmcnt(7)
ds_read_b64_tr_b16 a[202:203], v37 offset:46632
ds_read_b64_tr_b16 a[204:205], v37 offset:50216
v_mfma_f32_16x16x32_bf16 v[128:131], a[176:179], a[32:35], v[128:131]
global_load_lds_dwordx4 v14, s[96:97]
v_mfma_f32_16x16x32_bf16 v[128:131], a[180:183], a[36:39], v[128:131]
s_add_u32 m0, s41, 0x1f000
ds_read_b64_tr_b16 a[206:207], v37 offset:53800
s_add_u32 s96, s16, 0xd8100
v_mfma_f32_16x16x32_bf16 v[128:131], a[184:187], a[40:43], v[128:131]
s_waitcnt lgkmcnt(8)
ds_read_b64_tr_b16 a[144:145], v37 offset:28744
s_addc_u32 s97, s17, 0
v_mfma_f32_16x16x32_bf16 v[128:131], a[188:191], a[44:47], v[128:131]
s_lshl_b32 s47, s61, 2
ds_read_b64_tr_b16 a[146:147], v37 offset:32328
ds_read_b64_tr_b16 a[148:149], v37 offset:35912
v_mfma_f32_16x16x32_bf16 v[132:135], a[188:191], v[100:103], v[132:135]
global_load_lds_dwordx4 v14, s[96:97]
v_mfma_f32_16x16x32_bf16 v[132:135], a[184:187], v[96:99], v[132:135]
s_add_u32 m0, s41, 0x20000
ds_read_b64_tr_b16 a[150:151], v37 offset:39496
s_add_u32 s96, s16, 0x120100
v_mfma_f32_16x16x32_bf16 v[132:135], a[180:183], v[92:95], v[132:135]
s_addc_u32 s97, s17, 0
ds_read_b64_tr_b16 a[152:153], v37 offset:43080
s_add_u32 s47, s47, s40
v_mfma_f32_16x16x32_bf16 v[132:135], a[176:179], v[88:91], v[132:135]
s_waitcnt lgkmcnt(7)
ds_read_b64_tr_b16 a[154:155], v37 offset:46664
ds_read_b64_tr_b16 a[156:157], v37 offset:50248
v_mfma_f32_16x16x32_bf16 v[140:143], a[192:195], v[88:91], v[140:143]
global_load_lds_dwordx4 v14, s[96:97]
v_mfma_f32_16x16x32_bf16 v[140:143], a[196:199], v[92:95], v[140:143]
s_add_u32 m0, s41, 0x21000
ds_read_b64_tr_b16 a[158:159], v37 offset:53832
s_add_u32 s96, s16, 0x168100
v_mfma_f32_16x16x32_bf16 v[140:143], a[200:203], v[96:99], v[140:143]
s_waitcnt lgkmcnt(8)
ds_read_b64_tr_b16 a[160:161], v37 offset:28784
s_addc_u32 s97, s17, 0
v_mfma_f32_16x16x32_bf16 v[140:143], a[204:207], v[100:103], v[140:143]
s_lshl_b32 s47, s47, 12
ds_read_b64_tr_b16 a[162:163], v37 offset:32368
ds_read_b64_tr_b16 a[164:165], v37 offset:35952
v_mfma_f32_16x16x32_bf16 v[136:139], a[204:207], a[44:47], v[136:139]
buffer_load_dword a255, v51, s[16:19], s3 offen offset:384
v_mfma_f32_16x16x32_bf16 v[136:139], a[200:203], a[40:43], v[136:139]
s_add_u32 s47, s47, 0x2ea0000
ds_read_b64_tr_b16 a[166:167], v37 offset:39536
v_lshl_add_u32 v5, v0, 9, s47
v_mfma_f32_16x16x32_bf16 v[136:139], a[196:199], a[36:39], v[136:139]
ds_read_b64_tr_b16 a[168:169], v37 offset:43120
v_cmp_gt_u32 vcc, 8, v0
v_mfma_f32_16x16x32_bf16 v[136:139], a[192:195], a[32:35], v[136:139]
s_waitcnt lgkmcnt(7)
ds_read_b64_tr_b16 a[170:171], v37 offset:46704
v_mov_b32 v6, 0x80000000
v_mfma_f32_16x16x32_bf16 v[144:147], a[144:147], a[32:35], v[144:147]
ds_read_b64_tr_b16 a[172:173], v37 offset:50288
ds_read_b64_tr_b16 a[174:175], v37 offset:53872
v_mfma_f32_16x16x32_bf16 v[144:147], a[148:151], a[36:39], v[144:147]
buffer_load_dword a255, v51, s[20:23], s3 offen offset:384
v_mfma_f32_16x16x32_bf16 v[144:147], a[152:155], a[40:43], v[144:147]
s_waitcnt lgkmcnt(8)
ds_read_b64_tr_b16 a[176:177], v37 offset:28816
v_cndmask_b32 v52, v6, v5, vcc
v_mfma_f32_16x16x32_bf16 v[144:147], a[156:159], a[44:47], v[144:147]
s_lshl_b32 s47, s60, 2
ds_read_b64_tr_b16 a[178:179], v37 offset:32400
s_lshr_b32 s62, s45, 3
v_mfma_f32_16x16x32_bf16 v[148:151], a[156:159], v[100:103], v[148:151]
s_add_u32 s47, s47, s62
ds_read_b64_tr_b16 a[180:181], v37 offset:35984
s_lshl_b32 s47, s47, 1
v_mfma_f32_16x16x32_bf16 v[148:151], a[152:155], v[96:99], v[148:151]
s_and_b32 s62, s45, 1
ds_read_b64_tr_b16 a[182:183], v37 offset:39568
s_add_u32 s47, s47, s62
v_mfma_f32_16x16x32_bf16 v[148:151], a[148:151], v[92:95], v[148:151]
s_lshl_b32 s47, s47, 2
ds_read_b64_tr_b16 a[184:185], v37 offset:43152
s_add_u32 s47, s47, s40
v_mfma_f32_16x16x32_bf16 v[148:151], a[144:147], v[88:91], v[148:151]
s_waitcnt lgkmcnt(7)
ds_read_b64_tr_b16 a[186:187], v37 offset:46736
s_lshl_b32 s47, s47, 9
v_mfma_f32_16x16x32_bf16 v[156:159], a[160:163], v[88:91], v[156:159]
s_add_u32 s79, s47, 0x2ea0000
ds_read_b64_tr_b16 a[188:189], v37 offset:50320
v_writelane_b32 v6, s63, 0
v_mfma_f32_16x16x32_bf16 v[156:159], a[164:167], v[92:95], v[156:159]
ds_read_b64_tr_b16 a[190:191], v37 offset:53904
v_writelane_b32 v6, s79, 1
v_mfma_f32_16x16x32_bf16 v[156:159], a[168:171], v[96:99], v[156:159]
s_waitcnt lgkmcnt(8)
ds_read_b64_tr_b16 a[192:193], v37 offset:28856
v_sub_u32 v5, 1, v0
v_mfma_f32_16x16x32_bf16 v[156:159], a[172:175], v[100:103], v[156:159]
ds_read_b64_tr_b16 a[194:195], v37 offset:32440
v_lshlrev_b32 v5, 4, v5
v_mfma_f32_16x16x32_bf16 v[152:155], a[172:175], a[44:47], v[152:155]
ds_read_b64_tr_b16 a[196:197], v37 offset:36024
v_mfma_f32_16x16x32_bf16 v[152:155], a[168:171], a[40:43], v[152:155]
ds_read_b64_tr_b16 a[198:199], v37 offset:39608
v_mfma_f32_16x16x32_bf16 v[152:155], a[164:167], a[36:39], v[152:155]
ds_read_b64_tr_b16 a[200:201], v37 offset:43192
v_mfma_f32_16x16x32_bf16 v[152:155], a[160:163], a[32:35], v[152:155]
s_waitcnt lgkmcnt(7)
ds_read_b64_tr_b16 a[202:203], v37 offset:46776
v_mfma_f32_16x16x32_bf16 v[160:163], a[176:179], a[32:35], v[160:163]
ds_read_b64_tr_b16 a[204:205], v37 offset:50360
v_mfma_f32_16x16x32_bf16 v[160:163], a[180:183], a[36:39], v[160:163]
ds_read_b64_tr_b16 a[206:207], v37 offset:53944
v_mfma_f32_16x16x32_bf16 v[160:163], a[184:187], a[40:43], v[160:163]
s_waitcnt lgkmcnt(8)
ds_read_b64_tr_b16 a[144:145], v40 offset:28672
v_mfma_f32_16x16x32_bf16 v[160:163], a[188:191], a[44:47], v[160:163]
ds_read_b64_tr_b16 a[146:147], v40 offset:32256
v_mfma_f32_16x16x32_bf16 v[164:167], a[188:191], v[100:103], v[164:167]
ds_read_b64_tr_b16 a[148:149], v40 offset:35840
v_mfma_f32_16x16x32_bf16 v[164:167], a[184:187], v[96:99], v[164:167]
ds_read_b64_tr_b16 a[150:151], v40 offset:39424
v_mfma_f32_16x16x32_bf16 v[164:167], a[180:183], v[92:95], v[164:167]
ds_read_b64_tr_b16 a[152:153], v40 offset:43008
v_mfma_f32_16x16x32_bf16 v[164:167], a[176:179], v[88:91], v[164:167]
s_waitcnt lgkmcnt(7)
ds_read_b64_tr_b16 a[154:155], v40 offset:46592
v_mfma_f32_16x16x32_bf16 v[172:175], a[192:195], v[88:91], v[172:175]
s_waitcnt vmcnt(14)
ds_read_b64_tr_b16 a[156:157], v40 offset:50176
ds_read_b64_tr_b16 a[158:159], v40 offset:53760
v_mfma_f32_16x16x32_bf16 v[172:175], a[196:199], v[92:95], v[172:175]
s_barrier
v_mfma_f32_16x16x32_bf16 v[172:175], a[200:203], v[96:99], v[172:175]
s_waitcnt lgkmcnt(8)
ds_read_b64_tr_b16 a[160:161], v40 offset:57344
ds_read_b64_tr_b16 a[162:163], v40 offset:60928
v_mfma_f32_16x16x32_bf16 v[172:175], a[204:207], v[100:103], v[172:175]
buffer_store_dword v5, v6, s[36:39], 0 offen sc1
v_mfma_f32_16x16x32_bf16 v[168:171], a[204:207], a[44:47], v[168:171]
ds_read_b64_tr_b16 a[164:165], v40 offset:64512
v_and_b32 v3, 16, v0
v_mfma_f32_16x16x32_bf16 v[168:171], a[200:203], a[40:43], v[168:171]
ds_read_b64_tr_b16 a[166:167], v41 offset:2560
ds_read_b64_tr_b16 a[168:169], v41 offset:6144
v_mfma_f32_16x16x32_bf16 v[168:171], a[196:199], a[36:39], v[168:171]
global_load_lds_dwordx4 v14, s[96:97]
v_mfma_f32_16x16x32_bf16 v[168:171], a[192:195], a[32:35], v[168:171]
s_waitcnt lgkmcnt(7)
ds_read_b64_tr_b16 a[170:171], v41 offset:9728
v_cmp_eq_u32 vcc, 0, v3
v_mfma_f32_16x16x32_bf16 v[176:179], a[144:147], a[32:35], v[176:179]
ds_read_b64_tr_b16 a[172:173], v41 offset:13312
v_cndmask_b32 v4, v10, v9, vcc
v_mfma_f32_16x16x32_bf16 v[176:179], a[148:151], a[36:39], v[176:179]
s_add_u32 m0, s41, 0x22000
ds_read_b64_tr_b16 a[174:175], v41 offset:16896
v_mul_f32 v4, v4, v4
v_mfma_f32_16x16x32_bf16 v[176:179], a[152:155], a[40:43], v[176:179]
s_waitcnt lgkmcnt(8)
ds_read_b64_tr_b16 a[176:177], v37 offset:57528
s_add_u32 s96, s20, 0x100
v_mfma_f32_16x16x32_bf16 v[176:179], a[156:159], a[44:47], v[176:179]
s_addc_u32 s97, s21, 0
ds_read_b64_tr_b16 a[178:179], v37 offset:61112
ds_read_b64_tr_b16 a[180:181], v37 offset:64696
v_mfma_f32_16x16x32_bf16 v[180:183], a[156:159], v[100:103], v[180:183]
global_load_lds_dwordx4 v14, s[96:97]
v_mfma_f32_16x16x32_bf16 v[180:183], a[152:155], v[96:99], v[180:183]
s_add_u32 m0, s41, 0x23000
L_pg5:
s_cbranch_execz L_tr1
ds_read_b64_tr_b16 a[182:183], v38 offset:2744
s_add_u32 s96, s20, 0x48100
v_mfma_f32_16x16x32_bf16 v[180:183], a[148:151], v[92:95], v[180:183]
s_addc_u32 s97, s21, 0
ds_read_b64_tr_b16 a[184:185], v38 offset:6328
s_lshl_b32 s46, s46, 7
v_mfma_f32_16x16x32_bf16 v[180:183], a[144:147], v[88:91], v[180:183]
s_waitcnt lgkmcnt(7)
ds_read_b64_tr_b16 a[186:187], v38 offset:9912
ds_read_b64_tr_b16 a[188:189], v38 offset:13496
v_mfma_f32_16x16x32_bf16 v[180:183], a[160:163], v[104:107], v[180:183]
global_load_lds_dwordx4 v14, s[96:97]
v_mfma_f32_16x16x32_bf16 v[180:183], a[164:167], v[108:111], v[180:183]
s_add_u32 m0, s41, 0x24000
ds_read_b64_tr_b16 a[190:191], v38 offset:17080
s_add_u32 s96, s20, 0x90100
v_mfma_f32_16x16x32_bf16 v[180:183], a[168:171], v[112:115], v[180:183]
s_waitcnt lgkmcnt(8)
ds_read_b64_tr_b16 a[192:193], v37 offset:57488
s_addc_u32 s97, s21, 0
v_mfma_f32_16x16x32_bf16 v[180:183], a[172:175], v[116:119], v[180:183]
s_add_u32 s46, s46, 0x2ec0000
ds_read_b64_tr_b16 a[194:195], v37 offset:61072
ds_read_b64_tr_b16 a[196:197], v37 offset:64656
v_mfma_f32_16x16x32_bf16 v[176:179], a[172:175], a[60:63], v[176:179]
global_load_lds_dwordx4 v14, s[96:97]
v_mfma_f32_16x16x32_bf16 v[176:179], a[168:171], a[56:59], v[176:179]
s_add_u32 m0, s41, 0x25000
ds_read_b64_tr_b16 a[198:199], v38 offset:2704
v_lshl_add_u32 v3, v0, 2, s46
v_mfma_f32_16x16x32_bf16 v[176:179], a[164:167], a[52:55], v[176:179]
s_add_u32 s96, s20, 0xd8100
ds_read_b64_tr_b16 a[200:201], v38 offset:6288
s_addc_u32 s97, s21, 0
v_mfma_f32_16x16x32_bf16 v[176:179], a[160:163], a[48:51], v[176:179]
s_waitcnt lgkmcnt(7)
ds_read_b64_tr_b16 a[202:203], v38 offset:9872
ds_read_b64_tr_b16 a[204:205], v38 offset:13456
v_mfma_f32_16x16x32_bf16 v[168:171], a[176:179], a[48:51], v[168:171]
global_load_lds_dwordx4 v14, s[96:97]
v_mfma_f32_16x16x32_bf16 v[168:171], a[180:183], a[52:55], v[168:171]
s_add_u32 m0, s41, 0x26000
ds_read_b64_tr_b16 a[206:207], v38 offset:17040
s_add_u32 s96, s20, 0x120100
v_mfma_f32_16x16x32_bf16 v[168:171], a[184:187], a[56:59], v[168:171]
s_waitcnt lgkmcnt(8)
ds_read_b64_tr_b16 a[144:145], v37 offset:57456
s_addc_u32 s97, s21, 0
v_mfma_f32_16x16x32_bf16 v[168:171], a[188:191], a[60:63], v[168:171]
s_lshl_b32 s47, s43, 6
ds_read_b64_tr_b16 a[146:147], v37 offset:61040
ds_read_b64_tr_b16 a[148:149], v37 offset:64624
v_mfma_f32_16x16x32_bf16 v[172:175], a[188:191], v[116:119], v[172:175]
global_load_lds_dwordx4 v14, s[96:97]
v_mfma_f32_16x16x32_bf16 v[172:175], a[184:187], v[112:115], v[172:175]
s_add_u32 m0, s41, 0x27000
ds_read_b64_tr_b16 a[150:151], v38 offset:2672
v_add_u32 v5, s47, v0
v_mfma_f32_16x16x32_bf16 v[172:175], a[180:183], v[108:111], v[172:175]
s_add_u32 s96, s20, 0x168100
ds_read_b64_tr_b16 a[152:153], v38 offset:6256
v_cmp_gt_u32 vcc, 32, v5
v_mfma_f32_16x16x32_bf16 v[172:175], a[176:179], v[104:107], v[172:175]
s_waitcnt lgkmcnt(7)
ds_read_b64_tr_b16 a[154:155], v38 offset:9840
v_mov_b32 v6, 0x80000000
v_mfma_f32_16x16x32_bf16 v[164:167], a[192:195], v[104:107], v[164:167]
s_addc_u32 s97, s21, 0
ds_read_b64_tr_b16 a[156:157], v38 offset:13424
ds_read_b64_tr_b16 a[158:159], v38 offset:17008
v_mfma_f32_16x16x32_bf16 v[164:167], a[196:199], v[108:111], v[164:167]
global_load_lds_dwordx4 v14, s[96:97]
v_mfma_f32_16x16x32_bf16 v[164:167], a[200:203], v[112:115], v[164:167]
s_waitcnt lgkmcnt(8)
ds_read_b64_tr_b16 a[160:161], v37 offset:57416
v_cndmask_b32 v3, v6, v3, vcc
v_mfma_f32_16x16x32_bf16 v[164:167], a[204:207], v[116:119], v[164:167]
s_add_u32 m0, s41, 0
ds_read_b64_tr_b16 a[162:163], v37 offset:61000
s_add_u32 s96, s20, 0x1b0100
v_mfma_f32_16x16x32_bf16 v[160:163], a[204:207], a[60:63], v[160:163]
s_addc_u32 s97, s21, 0
ds_read_b64_tr_b16 a[164:165], v37 offset:64584
v_mfma_f32_16x16x32_bf16 v[160:163], a[200:203], a[56:59], v[160:163]
ds_read_b64_tr_b16 a[166:167], v38 offset:2632
ds_read_b64_tr_b16 a[168:169], v38 offset:6216
v_mfma_f32_16x16x32_bf16 v[160:163], a[196:199], a[52:55], v[160:163]
buffer_store_dword v4, v3, s[36:39], 0 offen sc1
v_mfma_f32_16x16x32_bf16 v[160:163], a[192:195], a[48:51], v[160:163]
s_waitcnt lgkmcnt(7)
ds_read_b64_tr_b16 a[170:171], v38 offset:9800
s_lshl_b32 s46, s42, 2
v_mfma_f32_16x16x32_bf16 v[152:155], a[144:147], a[48:51], v[152:155]
s_add_u32 s46, s46, s40
ds_read_b64_tr_b16 a[172:173], v38 offset:13384
s_mul_i32 s46, s46, 0x1440
v_mfma_f32_16x16x32_bf16 v[152:155], a[148:151], a[52:55], v[152:155]
s_and_b32 s46, s46, 0xffffff80
ds_read_b64_tr_b16 a[174:175], v38 offset:16968
s_mul_i32 s47, s43, 0x51000
v_mfma_f32_16x16x32_bf16 v[152:155], a[152:155], a[56:59], v[152:155]
s_waitcnt lgkmcnt(8)
ds_read_b64_tr_b16 a[176:177], v37 offset:57384
ds_read_b64_tr_b16 a[178:179], v37 offset:60968
v_mfma_f32_16x16x32_bf16 v[152:155], a[156:159], a[60:63], v[152:155]
global_load_lds_dwordx4 v14, s[96:97]
v_mfma_f32_16x16x32_bf16 v[156:159], a[156:159], v[116:119], v[156:159]
s_add_u32 m0, s41, 0x1000
ds_read_b64_tr_b16 a[180:181], v37 offset:64552
s_add_u32 s96, s20, 0x1f8100
v_mfma_f32_16x16x32_bf16 v[156:159], a[152:155], v[112:115], v[156:159]
s_addc_u32 s97, s21, 0
ds_read_b64_tr_b16 a[182:183], v38 offset:2600
s_add_u32 s46, s46, s47
v_mfma_f32_16x16x32_bf16 v[156:159], a[148:151], v[108:111], v[156:159]
ds_read_b64_tr_b16 a[184:185], v38 offset:6184
v_mul_u32_u24 v53, 0x180, v0
v_mfma_f32_16x16x32_bf16 v[156:159], a[144:147], v[104:107], v[156:159]
s_waitcnt lgkmcnt(7)
ds_read_b64_tr_b16 a[186:187], v38 offset:9768
ds_read_b64_tr_b16 a[188:189], v38 offset:13352
v_mfma_f32_16x16x32_bf16 v[148:151], a[160:163], v[104:107], v[148:151]
global_load_lds_dwordx4 v14, s[96:97]
v_mfma_f32_16x16x32_bf16 v[148:151], a[164:167], v[108:111], v[148:151]
s_add_u32 m0, s41, 0x2000
ds_read_b64_tr_b16 a[190:191], v38 offset:16936
v_add_u32 v53, s46, v53
v_mfma_f32_16x16x32_bf16 v[148:151], a[168:171], v[112:115], v[148:151]
s_waitcnt lgkmcnt(8)
ds_read_b64_tr_b16 a[192:193], v37 offset:57344
v_cmp_gt_u32 vcc, 14, v0
v_mfma_f32_16x16x32_bf16 v[148:151], a[172:175], v[116:119], v[148:151]
ds_read_b64_tr_b16 a[194:195], v37 offset:60928
v_mov_b32 v8, 0x80000000
v_mfma_f32_16x16x32_bf16 v[144:147], a[172:175], a[60:63], v[144:147]
s_add_u32 s96, s20, 0x240100
ds_read_b64_tr_b16 a[196:197], v37 offset:64512
v_cndmask_b32 v53, v8, v53, vcc
v_mfma_f32_16x16x32_bf16 v[144:147], a[168:171], a[56:59], v[144:147]
s_addc_u32 s97, s21, 0
ds_read_b64_tr_b16 a[198:199], v38 offset:2560
ds_read_b64_tr_b16 a[200:201], v38 offset:6144
v_mfma_f32_16x16x32_bf16 v[144:147], a[164:167], a[52:55], v[144:147]
global_load_lds_dwordx4 v14, s[96:97]
v_mfma_f32_16x16x32_bf16 v[144:147], a[160:163], a[48:51], v[144:147]
s_waitcnt lgkmcnt(7)
ds_read_b64_tr_b16 a[202:203], v38 offset:9728
s_add_u32 m0, s41, 0x3000
v_mfma_f32_16x16x32_bf16 v[136:139], a[176:179], a[48:51], v[136:139]
s_waitcnt vmcnt(19)
ds_read_b64_tr_b16 a[204:205], v38 offset:13312
ds_read_b64_tr_b16 a[206:207], v38 offset:16896
v_mfma_f32_16x16x32_bf16 v[136:139], a[180:183], a[52:55], v[136:139]
s_barrier
v_mfma_f32_16x16x32_bf16 v[136:139], a[184:187], a[56:59], v[136:139]
s_waitcnt lgkmcnt(8)
ds_read_b64_tr_b16 a[144:145], v38 offset:20480
s_add_u32 s96, s20, 0x288100
v_mfma_f32_16x16x32_bf16 v[136:139], a[188:191], a[60:63], v[136:139]
s_addc_u32 s97, s21, 0
ds_read_b64_tr_b16 a[146:147], v38 offset:24064
ds_read_b64_tr_b16 a[148:149], v38 offset:27648
v_mfma_f32_16x16x32_bf16 v[140:143], a[188:191], v[116:119], v[140:143]
global_load_lds_dwordx4 v14, s[96:97]
v_mfma_f32_16x16x32_bf16 v[140:143], a[184:187], v[112:115], v[140:143]
s_add_u32 m0, s41, 0x4000
ds_read_b64_tr_b16 a[150:151], v38 offset:31232
s_add_u32 s96, s20, 0x2d0100
v_mfma_f32_16x16x32_bf16 v[140:143], a[180:183], v[108:111], v[140:143]
s_addc_u32 s97, s21, 0
ds_read_b64_tr_b16 a[152:153], v38 offset:20520
v_mfma_f32_16x16x32_bf16 v[140:143], a[176:179], v[104:107], v[140:143]
s_waitcnt lgkmcnt(7)
ds_read_b64_tr_b16 a[154:155], v38 offset:24104
ds_read_b64_tr_b16 a[156:157], v38 offset:27688
v_mfma_f32_16x16x32_bf16 v[132:135], a[192:195], v[104:107], v[132:135]
global_load_lds_dwordx4 v14, s[96:97]
v_mfma_f32_16x16x32_bf16 v[132:135], a[196:199], v[108:111], v[132:135]
s_add_u32 m0, s41, 0x5000
ds_read_b64_tr_b16 a[158:159], v38 offset:31272
s_add_u32 s96, s20, 0x318100
v_mfma_f32_16x16x32_bf16 v[132:135], a[200:203], v[112:115], v[132:135]
s_waitcnt lgkmcnt(8)
ds_read_b64_tr_b16 a[160:161], v38 offset:20552
s_addc_u32 s97, s21, 0
v_mfma_f32_16x16x32_bf16 v[132:135], a[204:207], v[116:119], v[132:135]
ds_read_b64_tr_b16 a[162:163], v38 offset:24136
ds_read_b64_tr_b16 a[164:165], v38 offset:27720
v_mfma_f32_16x16x32_bf16 v[128:131], a[204:207], a[60:63], v[128:131]
global_load_lds_dwordx4 v14, s[96:97]
v_mfma_f32_16x16x32_bf16 v[128:131], a[200:203], a[56:59], v[128:131]
s_add_u32 m0, s41, 0x6000
ds_read_b64_tr_b16 a[166:167], v38 offset:31304
s_add_u32 s96, s16, 0x1b0100
v_mfma_f32_16x16x32_bf16 v[128:131], a[196:199], a[52:55], v[128:131]
s_addc_u32 s97, s17, 0
ds_read_b64_tr_b16 a[168:169], v38 offset:20592
v_mfma_f32_16x16x32_bf16 v[128:131], a[192:195], a[48:51], v[128:131]
s_waitcnt lgkmcnt(9)
ds_read_b64_tr_b16 a[170:171], v38 offset:24176
v_mfma_f32_16x16x32_bf16 v[128:131], a[144:147], a[64:67], v[128:131]
ds_read_b64_tr_b16 a[172:173], v38 offset:27760
ds_read_b64_tr_b16 a[174:175], v38 offset:31344
v_mfma_f32_16x16x32_bf16 v[128:131], a[148:151], a[68:71], v[128:131]
buffer_load_dword a255, v51, s[16:19], s94 offen
v_mfma_f32_16x16x32_bf16 v[132:135], a[148:151], v[124:127], v[132:135]
ds_read_b64_tr_b16 a[176:177], v38 offset:20624
v_mfma_f32_16x16x32_bf16 v[132:135], a[144:147], v[120:123], v[132:135]
s_waitcnt lgkmcnt(9)
ds_read_b64_tr_b16 a[178:179], v38 offset:24208
v_mfma_f32_16x16x32_bf16 v[140:143], a[152:155], v[120:123], v[140:143]
ds_read_b64_tr_b16 a[180:181], v38 offset:27792
v_mfma_f32_16x16x32_bf16 v[140:143], a[156:159], v[124:127], v[140:143]
ds_read_b64_tr_b16 a[182:183], v38 offset:31376
v_mfma_f32_16x16x32_bf16 v[136:139], a[156:159], a[68:71], v[136:139]
ds_read_b64_tr_b16 a[184:185], v38 offset:20664
v_mfma_f32_16x16x32_bf16 v[136:139], a[152:155], a[64:67], v[136:139]
s_waitcnt lgkmcnt(9)
ds_read_b64_tr_b16 a[186:187], v38 offset:24248
ds_read_b64_tr_b16 a[188:189], v38 offset:27832
v_mfma_f32_16x16x32_bf16 v[144:147], a[160:163], a[64:67], v[144:147]
buffer_load_dword a255, v51, s[20:23], s94 offen
v_mfma_f32_16x16x32_bf16 v[144:147], a[164:167], a[68:71], v[144:147]
s_mov_b32 s49, 0
ds_read_b64_tr_b16 a[190:191], v38 offset:31416
v_mul_f32 v184, s55, v9
v_mfma_f32_16x16x32_bf16 v[148:151], a[164:167], v[124:127], v[148:151]
ds_read_b64_tr_b16 a[192:193], v41 offset:20480
v_mul_f32 v185, s55, v10
v_mfma_f32_16x16x32_bf16 v[148:151], a[160:163], v[120:123], v[148:151]
s_waitcnt lgkmcnt(9)
ds_read_b64_tr_b16 a[194:195], v41 offset:24064
v_mul_f32 v128, v184, v128
v_mfma_f32_16x16x32_bf16 v[156:159], a[168:171], v[120:123], v[156:159]
s_waitcnt vmcnt(9)
ds_read_b64_tr_b16 a[196:197], v41 offset:27648
ds_read_b64_tr_b16 a[198:199], v41 offset:31232
v_mfma_f32_16x16x32_bf16 v[156:159], a[172:175], v[124:127], v[156:159]
s_barrier
v_mfma_f32_16x16x32_bf16 v[152:155], a[172:175], a[68:71], v[152:155]
ds_read_b64_tr_b16 a[200:201], v19 offset:49152
v_mul_f32 v129, v184, v129
v_mfma_f32_16x16x32_bf16 v[152:155], a[168:171], a[64:67], v[152:155]
s_waitcnt lgkmcnt(9)
ds_read_b64_tr_b16 a[202:203], v19 offset:51200
v_mul_f32 v130, v184, v130
v_mfma_f32_16x16x32_bf16 v[160:163], a[176:179], a[64:67], v[160:163]
ds_read_b64_tr_b16 a[204:205], v19 offset:53248
v_mul_f32 v131, v184, v131
v_mfma_f32_16x16x32_bf16 v[160:163], a[180:183], a[68:71], v[160:163]
ds_read_b64_tr_b16 a[206:207], v19 offset:55296
v_mul_f32 v132, v185, v132
v_mfma_f32_16x16x32_bf16 v[164:167], a[180:183], v[124:127], v[164:167]
ds_read_b64_tr_b16 a[144:145], v19 offset:57344
v_mul_f32 v133, v185, v133
v_mfma_f32_16x16x32_bf16 v[164:167], a[176:179], v[120:123], v[164:167]
s_waitcnt lgkmcnt(9)
ds_read_b64_tr_b16 a[146:147], v19 offset:59392
v_mul_f32 v134, v185, v134
v_mfma_f32_16x16x32_bf16 v[172:175], a[184:187], v[120:123], v[172:175]
ds_read_b64_tr_b16 a[148:149], v19 offset:61440
v_mul_f32 v135, v185, v135
v_mfma_f32_16x16x32_bf16 v[172:175], a[188:191], v[124:127], v[172:175]
ds_read_b64_tr_b16 a[150:151], v19 offset:63488
v_cvt_pk_bf16_f32 v128, v128, v129
v_mfma_f32_16x16x32_bf16 v[168:171], a[188:191], a[68:71], v[168:171]
ds_read_b64_tr_b16 a[152:153], v20
v_cvt_pk_bf16_f32 v129, v130, v131
v_mfma_f32_16x16x32_bf16 v[168:171], a[184:187], a[64:67], v[168:171]
s_waitcnt lgkmcnt(9)
ds_read_b64_tr_b16 a[154:155], v20 offset:2048
v_cvt_pk_bf16_f32 v130, v132, v133
v_mfma_f32_16x16x32_bf16 v[176:179], a[192:195], a[64:67], v[176:179]
ds_read_b64_tr_b16 a[156:157], v20 offset:4096
v_cvt_pk_bf16_f32 v131, v134, v135
v_mfma_f32_16x16x32_bf16 v[176:179], a[196:199], a[68:71], v[176:179]
ds_read_b64_tr_b16 a[158:159], v20 offset:6144
v_permlane16_swap_b32 v128, v130
v_mfma_f32_16x16x32_bf16 v[180:183], a[196:199], v[124:127], v[180:183]
ds_read_b64_tr_b16 a[160:161], v22 offset:49152
v_permlane16_swap_b32 v129, v131
v_mfma_f32_16x16x32_bf16 v[180:183], a[192:195], v[120:123], v[180:183]
s_waitcnt lgkmcnt(7)
ds_read_b64_tr_b16 a[162:163], v22 offset:51200
v_mul_f32 v136, v184, v136
v_mfma_f32_16x16x32_bf16 v[196:199], a[200:203], v[56:59], 0
ds_read_b64_tr_b16 a[164:165], v22 offset:53248
v_mul_f32 v137, v184, v137
v_mfma_f32_16x16x32_bf16 v[196:199], a[204:207], v[60:63], v[196:199]
ds_read_b64_tr_b16 a[166:167], v22 offset:55296
v_mul_f32 v138, v184, v138
v_mfma_f32_16x16x32_bf16 v[196:199], a[144:147], v[64:67], v[196:199]
s_waitcnt lgkmcnt(4)
ds_read_b64_tr_b16 a[168:169], v22 offset:57344
ds_read_b64_tr_b16 a[170:171], v22 offset:59392
v_mfma_f32_16x16x32_bf16 v[196:199], a[148:151], v[68:71], v[196:199]
buffer_store_dwordx4 v[128:131], v43, s[36:39], s49 offen sc1
v_mfma_f32_16x16x32_bf16 v[196:199], a[152:155], v[72:75], v[196:199]
s_mov_b32 s49, 0x14000
ds_read_b64_tr_b16 a[172:173], v22 offset:61440
v_mul_f32 v139, v184, v139
v_mfma_f32_16x16x32_bf16 v[196:199], a[156:159], v[76:79], v[196:199]
ds_read_b64_tr_b16 a[174:175], v22 offset:63488
v_mul_f32 v140, v185, v140
v_mfma_f32_16x16x32_bf16 v[192:195], a[156:159], a[20:23], 0
ds_read_b64_tr_b16 a[176:177], v23
v_mul_f32 v141, v185, v141
v_mfma_f32_16x16x32_bf16 v[192:195], a[152:155], a[16:19], v[192:195]
ds_read_b64_tr_b16 a[178:179], v23 offset:2048
ds_read_b64_tr_b16 a[180:181], v23 offset:4096
v_mfma_f32_16x16x32_bf16 v[192:195], a[148:151], a[12:15], v[192:195]
global_load_lds_dwordx4 v14, s[96:97]
v_mfma_f32_16x16x32_bf16 v[192:195], a[144:147], a[8:11], v[192:195]
s_add_u32 m0, s41, 0x7000
ds_read_b64_tr_b16 a[182:183], v23 offset:6144
v_mul_f32 v142, v185, v142
v_mfma_f32_16x16x32_bf16 v[192:195], a[204:207], a[4:7], v[192:195]
s_add_u32 s96, s16, 0x1f8100
ds_read_b64_tr_b16 a[184:185], v25 offset:49152
v_mul_f32 v143, v185, v143
v_mfma_f32_16x16x32_bf16 v[192:195], a[200:203], a[0:3], v[192:195]
s_waitcnt lgkmcnt(7)
ds_read_b64_tr_b16 a[186:187], v25 offset:51200
v_cvt_pk_bf16_f32 v136, v136, v137
v_mfma_f32_16x16x32_bf16 v[208:211], a[160:163], a[0:3], 0
s_addc_u32 s97, s17, 0
ds_read_b64_tr_b16 a[188:189], v25 offset:53248
ds_read_b64_tr_b16 a[190:191], v25 offset:55296
v_mfma_f32_16x16x32_bf16 v[208:211], a[164:167], a[4:7], v[208:211]
global_load_lds_dwordx4 v14, s[96:97]
v_mfma_f32_16x16x32_bf16 v[208:211], a[168:171], a[8:11], v[208:211]
s_waitcnt lgkmcnt(4)
ds_read_b64_tr_b16 a[192:193], v25 offset:57344
v_cvt_pk_bf16_f32 v137, v138, v139
v_mfma_f32_16x16x32_bf16 v[208:211], a[172:175], a[12:15], v[208:211]
s_add_u32 m0, s41, 0x8000
ds_read_b64_tr_b16 a[194:195], v25 offset:59392
v_cvt_pk_bf16_f32 v138, v140, v141
v_mfma_f32_16x16x32_bf16 v[208:211], a[176:179], a[16:19], v[208:211]
s_add_u32 s96, s16, 0x240100
ds_read_b64_tr_b16 a[196:197], v25 offset:61440
v_cvt_pk_bf16_f32 v139, v142, v143
v_mfma_f32_16x16x32_bf16 v[208:211], a[180:183], a[20:23], v[208:211]
s_addc_u32 s97, s17, 0
ds_read_b64_tr_b16 a[198:199], v25 offset:63488
ds_read_b64_tr_b16 a[200:201], v26
v_mfma_f32_16x16x32_bf16 v[212:215], a[180:183], v[76:79], 0
global_load_lds_dwordx4 v14, s[96:97]
v_mfma_f32_16x16x32_bf16 v[212:215], a[176:179], v[72:75], v[212:215]
s_add_u32 m0, s41, 0x9000
ds_read_b64_tr_b16 a[202:203], v26 offset:2048
v_permlane16_swap_b32 v136, v138
v_mfma_f32_16x16x32_bf16 v[212:215], a[172:175], v[68:71], v[212:215]
s_add_u32 s96, s16, 0x288100
ds_read_b64_tr_b16 a[204:205], v26 offset:4096
v_permlane16_swap_b32 v137, v139
v_mfma_f32_16x16x32_bf16 v[212:215], a[168:171], v[64:67], v[212:215]
s_addc_u32 s97, s17, 0
ds_read_b64_tr_b16 a[206:207], v26 offset:6144
v_mul_f32 v184, s56, v9
v_mfma_f32_16x16x32_bf16 v[212:215], a[164:167], v[60:63], v[212:215]
ds_read_b64_tr_b16 a[144:145], v28 offset:49152
v_mul_f32 v185, s56, v10
v_mfma_f32_16x16x32_bf16 v[212:215], a[160:163], v[56:59], v[212:215]
s_waitcnt lgkmcnt(7)
ds_read_b64_tr_b16 a[146:147], v28 offset:51200
ds_read_b64_tr_b16 a[148:149], v28 offset:53248
v_mfma_f32_16x16x32_bf16 v[228:231], a[184:187], v[56:59], 0
buffer_store_dwordx4 v[136:139], v43, s[36:39], s49 offen sc1
v_mfma_f32_16x16x32_bf16 v[228:231], a[188:191], v[60:63], v[228:231]
s_mov_b32 s49, 0x28000
ds_read_b64_tr_b16 a[150:151], v28 offset:55296
v_mul_f32 v144, v184, v144
v_mfma_f32_16x16x32_bf16 v[228:231], a[192:195], v[64:67], v[228:231]
s_waitcnt lgkmcnt(4)
ds_read_b64_tr_b16 a[152:153], v28 offset:57344
v_mul_f32 v145, v184, v145
v_mfma_f32_16x16x32_bf16 v[228:231], a[196:199], v[68:71], v[228:231]
ds_read_b64_tr_b16 a[154:155], v28 offset:59392
ds_read_b64_tr_b16 a[156:157], v28 offset:61440
v_mfma_f32_16x16x32_bf16 v[228:231], a[200:203], v[72:75], v[228:231]
global_load_lds_dwordx4 v14, s[96:97]
v_mfma_f32_16x16x32_bf16 v[228:231], a[204:207], v[76:79], v[228:231]
s_add_u32 m0, s41, 0xa000
ds_read_b64_tr_b16 a[158:159], v28 offset:63488
v_mul_f32 v146, v184, v146
v_mfma_f32_16x16x32_bf16 v[224:227], a[204:207], a[20:23], 0
s_add_u32 s96, s16, 0x2d0100
ds_read_b64_tr_b16 a[160:161], v29
v_mul_f32 v147, v184, v147
v_mfma_f32_16x16x32_bf16 v[224:227], a[200:203], a[16:19], v[224:227]
s_addc_u32 s97, s17, 0
ds_read_b64_tr_b16 a[162:163], v29 offset:2048
v_mul_f32 v148, v185, v148
v_mfma_f32_16x16x32_bf16 v[224:227], a[196:199], a[12:15], v[224:227]
ds_read_b64_tr_b16 a[164:165], v29 offset:4096
ds_read_b64_tr_b16 a[166:167], v29 offset:6144
v_mfma_f32_16x16x32_bf16 v[224:227], a[192:195], a[8:11], v[224:227]
global_load_lds_dwordx4 v14, s[96:97]
v_mfma_f32_16x16x32_bf16 v[224:227], a[188:191], a[4:7], v[224:227]
s_add_u32 m0, s41, 0xb000
ds_read_b64_tr_b16 a[168:169], v20 offset:8192
v_mul_f32 v149, v185, v149
v_mfma_f32_16x16x32_bf16 v[224:227], a[184:187], a[0:3], v[224:227]
s_waitcnt lgkmcnt(7)
ds_read_b64_tr_b16 a[170:171], v20 offset:10240
v_mul_f32 v150, v185, v150
v_mfma_f32_16x16x32_bf16 v[240:243], a[144:147], a[0:3], 0
s_add_u32 s96, s16, 0x318100
ds_read_b64_tr_b16 a[172:173], v20 offset:12288
v_mul_f32 v151, v185, v151
v_mfma_f32_16x16x32_bf16 v[240:243], a[148:151], a[4:7], v[240:243]
s_addc_u32 s97, s17, 0
ds_read_b64_tr_b16 a[174:175], v20 offset:14336
v_cvt_pk_bf16_f32 v144, v144, v145
v_mfma_f32_16x16x32_bf16 v[240:243], a[152:155], a[8:11], v[240:243]
s_waitcnt lgkmcnt(4)
ds_read_b64_tr_b16 a[176:177], v20 offset:16384
ds_read_b64_tr_b16 a[178:179], v20 offset:18432
v_mfma_f32_16x16x32_bf16 v[240:243], a[156:159], a[12:15], v[240:243]
global_load_lds_dwordx4 v14, s[96:97]
v_mfma_f32_16x16x32_bf16 v[240:243], a[160:163], a[16:19], v[240:243]
s_add_u32 m0, s41, 0xc000
ds_read_b64_tr_b16 a[180:181], v20 offset:20480
v_cvt_pk_bf16_f32 v145, v146, v147
v_mfma_f32_16x16x32_bf16 v[240:243], a[164:167], a[20:23], v[240:243]
s_add_u32 s96, s16, 0x360100
ds_read_b64_tr_b16 a[182:183], v20 offset:22528
v_cvt_pk_bf16_f32 v146, v148, v149
v_mfma_f32_16x16x32_bf16 v[244:247], a[164:167], v[76:79], 0
s_addc_u32 s97, s17, 0
ds_read_b64_tr_b16 a[184:185], v20 offset:24576
ds_read_b64_tr_b16 a[186:187], v20 offset:26624
v_mfma_f32_16x16x32_bf16 v[244:247], a[160:163], v[72:75], v[244:247]
global_load_lds_dwordx4 v14, s[96:97]
v_mfma_f32_16x16x32_bf16 v[244:247], a[156:159], v[68:71], v[244:247]
s_add_u32 m0, s41, 0xd000
ds_read_b64_tr_b16 a[188:189], v20 offset:28672
v_cvt_pk_bf16_f32 v147, v150, v151
v_mfma_f32_16x16x32_bf16 v[244:247], a[152:155], v[64:67], v[244:247]
s_add_u32 s96, s16, 0x3a8100
ds_read_b64_tr_b16 a[190:191], v20 offset:30720
v_permlane16_swap_b32 v144, v146
v_mfma_f32_16x16x32_bf16 v[244:247], a[148:151], v[60:63], v[244:247]
s_addc_u32 s97, s17, 0
ds_read_b64_tr_b16 a[192:193], v23 offset:8192
v_permlane16_swap_b32 v145, v147
v_mfma_f32_16x16x32_bf16 v[244:247], a[144:147], v[56:59], v[244:247]
s_waitcnt lgkmcnt(7)
ds_read_b64_tr_b16 a[194:195], v23 offset:10240
ds_read_b64_tr_b16 a[196:197], v23 offset:12288
v_mfma_f32_16x16x32_bf16 v[204:207], a[168:171], v[56:59], 0
buffer_store_dwordx4 v[144:147], v43, s[36:39], s49 offen sc1
v_mfma_f32_16x16x32_bf16 v[204:207], a[172:175], v[60:63], v[204:207]
s_mov_b32 s49, 0x3c000
ds_read_b64_tr_b16 a[198:199], v23 offset:14336
v_mul_f32 v152, v184, v152
v_mfma_f32_16x16x32_bf16 v[204:207], a[176:179], v[64:67], v[204:207]
s_waitcnt lgkmcnt(4)
ds_read_b64_tr_b16 a[200:201], v23 offset:16384
v_mul_f32 v153, v184, v153
v_mfma_f32_16x16x32_bf16 v[204:207], a[180:183], v[68:71], v[204:207]
ds_read_b64_tr_b16 a[202:203], v23 offset:18432
v_mul_f32 v154, v184, v154
v_mfma_f32_16x16x32_bf16 v[204:207], a[184:187], v[72:75], v[204:207]
ds_read_b64_tr_b16 a[204:205], v23 offset:20480
ds_read_b64_tr_b16 a[206:207], v23 offset:22528
v_mfma_f32_16x16x32_bf16 v[204:207], a[188:191], v[76:79], v[204:207]
global_load_lds_dwordx4 v14, s[96:97]
v_mfma_f32_16x16x32_bf16 v[200:203], a[188:191], a[20:23], 0
s_add_u32 m0, s41, 0xe000
ds_read_b64_tr_b16 a[144:145], v23 offset:24576
v_mul_f32 v155, v184, v155
v_mfma_f32_16x16x32_bf16 v[200:203], a[184:187], a[16:19], v[200:203]
s_add_u32 s96, s16, 0x3f0100
ds_read_b64_tr_b16 a[146:147], v23 offset:26624
v_mul_f32 v156, v185, v156
v_mfma_f32_16x16x32_bf16 v[200:203], a[180:183], a[12:15], v[200:203]
s_addc_u32 s97, s17, 0
ds_read_b64_tr_b16 a[148:149], v23 offset:28672
v_mul_f32 v157, v185, v157
v_mfma_f32_16x16x32_bf16 v[200:203], a[176:179], a[8:11], v[200:203]
ds_read_b64_tr_b16 a[150:151], v23 offset:30720
ds_read_b64_tr_b16 a[152:153], v26 offset:8192
v_mfma_f32_16x16x32_bf16 v[200:203], a[172:175], a[4:7], v[200:203]
global_load_lds_dwordx4 v14, s[96:97]
v_mfma_f32_16x16x32_bf16 v[200:203], a[168:171], a[0:3], v[200:203]
s_waitcnt lgkmcnt(7)
ds_read_b64_tr_b16 a[154:155], v26 offset:10240
v_mul_f32 v158, v185, v158
v_mfma_f32_16x16x32_bf16 v[216:219], a[192:195], a[0:3], 0
s_add_u32 m0, s41, 0xf000
ds_read_b64_tr_b16 a[156:157], v26 offset:12288
v_mul_f32 v159, v185, v159
v_mfma_f32_16x16x32_bf16 v[216:219], a[196:199], a[4:7], v[216:219]
s_add_u32 s96, s16, 0x438100
ds_read_b64_tr_b16 a[158:159], v26 offset:14336
v_cvt_pk_bf16_f32 v152, v152, v153
v_mfma_f32_16x16x32_bf16 v[216:219], a[200:203], a[8:11], v[216:219]
s_waitcnt lgkmcnt(4)
ds_read_b64_tr_b16 a[160:161], v26 offset:16384
v_cvt_pk_bf16_f32 v153, v154, v155
v_mfma_f32_16x16x32_bf16 v[216:219], a[204:207], a[12:15], v[216:219]
s_addc_u32 s97, s17, 0
ds_read_b64_tr_b16 a[162:163], v26 offset:18432
ds_read_b64_tr_b16 a[164:165], v26 offset:20480
v_mfma_f32_16x16x32_bf16 v[216:219], a[144:147], a[16:19], v[216:219]
global_load_lds_dwordx4 v14, s[96:97]
v_mfma_f32_16x16x32_bf16 v[216:219], a[148:151], a[20:23], v[216:219]
s_add_u32 m0, s41, 0x10000
ds_read_b64_tr_b16 a[166:167], v26 offset:22528
v_cvt_pk_bf16_f32 v154, v156, v157
v_mfma_f32_16x16x32_bf16 v[220:223], a[148:151], v[76:79], 0
s_add_u32 s96, s16, 0x480100
ds_read_b64_tr_b16 a[168:169], v26 offset:24576
v_cvt_pk_bf16_f32 v155, v158, v159
v_mfma_f32_16x16x32_bf16 v[220:223], a[144:147], v[72:75], v[220:223]
s_addc_u32 s97, s17, 0
ds_read_b64_tr_b16 a[170:171], v26 offset:26624
ds_read_b64_tr_b16 a[172:173], v26 offset:28672
v_mfma_f32_16x16x32_bf16 v[220:223], a[204:207], v[68:71], v[220:223]
global_load_lds_dwordx4 v14, s[96:97]
v_mfma_f32_16x16x32_bf16 v[220:223], a[200:203], v[64:67], v[220:223]
s_add_u32 m0, s41, 0x11000
ds_read_b64_tr_b16 a[174:175], v26 offset:30720
v_permlane16_swap_b32 v152, v154
v_mfma_f32_16x16x32_bf16 v[220:223], a[196:199], v[60:63], v[220:223]
s_add_u32 s96, s16, 0x4c8100
ds_read_b64_tr_b16 a[176:177], v29 offset:8192
v_permlane16_swap_b32 v153, v155
v_mfma_f32_16x16x32_bf16 v[220:223], a[192:195], v[56:59], v[220:223]
s_waitcnt lgkmcnt(7)
ds_read_b64_tr_b16 a[178:179], v29 offset:10240
v_mul_f32 v184, s57, v9
v_mfma_f32_16x16x32_bf16 v[236:239], a[152:155], v[56:59], 0
s_addc_u32 s97, s17, 0
ds_read_b64_tr_b16 a[180:181], v29 offset:12288
ds_read_b64_tr_b16 a[182:183], v29 offset:14336
v_mfma_f32_16x16x32_bf16 v[236:239], a[156:159], v[60:63], v[236:239]
buffer_store_dwordx4 v[152:155], v43, s[36:39], s49 offen sc1
v_mfma_f32_16x16x32_bf16 v[236:239], a[160:163], v[64:67], v[236:239]
s_waitcnt lgkmcnt(4)
ds_read_b64_tr_b16 a[184:185], v29 offset:16384
v_mul_f32 v185, s57, v10
v_mfma_f32_16x16x32_bf16 v[236:239], a[164:167], v[68:71], v[236:239]
s_mov_b32 s49, 0x50000
ds_read_b64_tr_b16 a[186:187], v29 offset:18432
v_mul_f32 v160, v184, v160
v_mfma_f32_16x16x32_bf16 v[236:239], a[168:171], v[72:75], v[236:239]
ds_read_b64_tr_b16 a[188:189], v29 offset:20480
v_mul_f32 v161, v184, v161
v_mfma_f32_16x16x32_bf16 v[236:239], a[172:175], v[76:79], v[236:239]
ds_read_b64_tr_b16 a[190:191], v29 offset:22528
ds_read_b64_tr_b16 a[192:193], v29 offset:24576
v_mfma_f32_16x16x32_bf16 v[232:235], a[172:175], a[20:23], 0
global_load_lds_dwordx4 v14, s[96:97]
v_mfma_f32_16x16x32_bf16 v[232:235], a[168:171], a[16:19], v[232:235]
s_add_u32 m0, s41, 0x12000
ds_read_b64_tr_b16 a[194:195], v29 offset:26624
v_mul_f32 v162, v184, v162
v_mfma_f32_16x16x32_bf16 v[232:235], a[164:167], a[12:15], v[232:235]
s_waitcnt vmcnt(8)
ds_read_b64_tr_b16 a[196:197], v29 offset:28672
ds_read_b64_tr_b16 a[198:199], v29 offset:30720
v_mfma_f32_16x16x32_bf16 v[232:235], a[160:163], a[8:11], v[232:235]
s_barrier
v_mfma_f32_16x16x32_bf16 v[232:235], a[156:159], a[4:7], v[232:235]
s_add_u32 s96, s20, 0x360100
ds_read_b64_tr_b16 a[200:201], v27
v_mul_f32 v163, v184, v163
v_mfma_f32_16x16x32_bf16 v[232:235], a[152:155], a[0:3], v[232:235]
s_waitcnt lgkmcnt(7)
ds_read_b64_tr_b16 a[202:203], v27 offset:2048
v_mul_f32 v164, v185, v164
v_mfma_f32_16x16x32_bf16 v[248:251], a[176:179], a[0:3], 0
s_addc_u32 s97, s21, 0
ds_read_b64_tr_b16 a[204:205], v27 offset:4096
L_pg6:
s_cbranch_execz L_tr1
ds_read_b64_tr_b16 a[206:207], v27 offset:6144
v_mfma_f32_16x16x32_bf16 v[248:251], a[180:183], a[4:7], v[248:251]
global_load_lds_dwordx4 v14, s[96:97]
v_mfma_f32_16x16x32_bf16 v[248:251], a[184:187], a[8:11], v[248:251]
s_waitcnt lgkmcnt(4)
ds_read_b64_tr_b16 a[144:145], v27 offset:8192
v_mul_f32 v165, v185, v165
v_mfma_f32_16x16x32_bf16 v[248:251], a[188:191], a[12:15], v[248:251]
s_add_u32 m0, s41, 0x13000
ds_read_b64_tr_b16 a[146:147], v27 offset:10240
v_mul_f32 v166, v185, v166
v_mfma_f32_16x16x32_bf16 v[248:251], a[192:195], a[16:19], v[248:251]
s_add_u32 s96, s20, 0x3a8100
ds_read_b64_tr_b16 a[148:149], v27 offset:12288
v_mul_f32 v167, v185, v167
v_mfma_f32_16x16x32_bf16 v[248:251], a[196:199], a[20:23], v[248:251]
s_addc_u32 s97, s21, 0
ds_read_b64_tr_b16 a[150:151], v27 offset:14336
ds_read_b64_tr_b16 a[152:153], v27 offset:16384
v_mfma_f32_16x16x32_bf16 v[252:255], a[196:199], v[76:79], 0
global_load_lds_dwordx4 v14, s[96:97]
v_mfma_f32_16x16x32_bf16 v[252:255], a[192:195], v[72:75], v[252:255]
s_add_u32 m0, s41, 0x14000
ds_read_b64_tr_b16 a[154:155], v27 offset:18432
v_cvt_pk_bf16_f32 v160, v160, v161
v_mfma_f32_16x16x32_bf16 v[252:255], a[188:191], v[68:71], v[252:255]
s_add_u32 s96, s20, 0x3f0100
ds_read_b64_tr_b16 a[156:157], v27 offset:20480
v_cvt_pk_bf16_f32 v161, v162, v163
v_mfma_f32_16x16x32_bf16 v[252:255], a[184:187], v[64:67], v[252:255]
s_addc_u32 s97, s21, 0
ds_read_b64_tr_b16 a[158:159], v27 offset:22528
ds_read_b64_tr_b16 a[160:161], v24
v_mfma_f32_16x16x32_bf16 v[252:255], a[180:183], v[60:63], v[252:255]
global_load_lds_dwordx4 v14, s[96:97]
v_mfma_f32_16x16x32_bf16 v[252:255], a[176:179], v[56:59], v[252:255]
s_waitcnt lgkmcnt(7)
ds_read_b64_tr_b16 a[162:163], v24 offset:2048
v_cvt_pk_bf16_f32 v162, v164, v165
v_mfma_f32_16x16x32_bf16 v[252:255], a[200:203], v[80:83], v[252:255]
s_add_u32 m0, s41, 0x15000
ds_read_b64_tr_b16 a[164:165], v24 offset:4096
v_cvt_pk_bf16_f32 v163, v166, v167
v_mfma_f32_16x16x32_bf16 v[252:255], a[204:207], v[84:87], v[252:255]
s_add_u32 s96, s20, 0x438100
ds_read_b64_tr_b16 a[166:167], v24 offset:6144
v_permlane16_swap_b32 v160, v162
v_mfma_f32_16x16x32_bf16 v[252:255], a[144:147], v[88:91], v[252:255]
s_waitcnt lgkmcnt(4)
ds_read_b64_tr_b16 a[168:169], v24 offset:8192
v_permlane16_swap_b32 v161, v163
v_mfma_f32_16x16x32_bf16 v[252:255], a[148:151], v[92:95], v[252:255]
s_addc_u32 s97, s21, 0
ds_read_b64_tr_b16 a[170:171], v24 offset:10240
ds_read_b64_tr_b16 a[172:173], v24 offset:12288
v_mfma_f32_16x16x32_bf16 v[252:255], a[152:155], v[96:99], v[252:255]
global_load_lds_dwordx4 v14, s[96:97]
v_mfma_f32_16x16x32_bf16 v[252:255], a[156:159], v[100:103], v[252:255]
s_add_u32 m0, s41, 0x16000
ds_read_b64_tr_b16 a[174:175], v24 offset:14336
v_mul_f32 v168, v184, v168
v_mfma_f32_16x16x32_bf16 v[248:251], a[156:159], a[44:47], v[248:251]
s_add_u32 s96, s20, 0x480100
ds_read_b64_tr_b16 a[176:177], v24 offset:16384
v_mul_f32 v169, v184, v169
v_mfma_f32_16x16x32_bf16 v[248:251], a[152:155], a[40:43], v[248:251]
s_addc_u32 s97, s21, 0
ds_read_b64_tr_b16 a[178:179], v24 offset:18432
ds_read_b64_tr_b16 a[180:181], v24 offset:20480
v_mfma_f32_16x16x32_bf16 v[248:251], a[148:151], a[36:39], v[248:251]
global_load_lds_dwordx4 v14, s[96:97]
v_mfma_f32_16x16x32_bf16 v[248:251], a[144:147], a[32:35], v[248:251]
s_add_u32 m0, s41, 0x17000
ds_read_b64_tr_b16 a[182:183], v24 offset:22528
v_mul_f32 v170, v184, v170
v_mfma_f32_16x16x32_bf16 v[248:251], a[204:207], a[28:31], v[248:251]
s_add_u32 s96, s20, 0x4c8100
ds_read_b64_tr_b16 a[184:185], v21
v_mul_f32 v171, v184, v171
v_mfma_f32_16x16x32_bf16 v[248:251], a[200:203], a[24:27], v[248:251]
s_waitcnt lgkmcnt(7)
ds_read_b64_tr_b16 a[186:187], v21 offset:2048
v_mul_f32 v172, v185, v172
v_mfma_f32_16x16x32_bf16 v[232:235], a[160:163], a[24:27], v[232:235]
s_addc_u32 s97, s21, 0
ds_read_b64_tr_b16 a[188:189], v21 offset:4096
ds_read_b64_tr_b16 a[190:191], v21 offset:6144
v_mfma_f32_16x16x32_bf16 v[232:235], a[164:167], a[28:31], v[232:235]
global_load_lds_dwordx4 v14, s[96:97]
v_mfma_f32_16x16x32_bf16 v[232:235], a[168:171], a[32:35], v[232:235]
s_waitcnt lgkmcnt(4)
ds_read_b64_tr_b16 a[192:193], v21 offset:8192
v_mul_f32 v173, v185, v173
v_mfma_f32_16x16x32_bf16 v[232:235], a[172:175], a[36:39], v[232:235]
s_add_u32 m0, s41, 0x18000
ds_read_b64_tr_b16 a[194:195], v21 offset:10240
v_mul_f32 v174, v185, v174
v_mfma_f32_16x16x32_bf16 v[232:235], a[176:179], a[40:43], v[232:235]
s_add_u32 s96, s16, 0x180
ds_read_b64_tr_b16 a[196:197], v21 offset:12288
v_mul_f32 v175, v185, v175
v_mfma_f32_16x16x32_bf16 v[232:235], a[180:183], a[44:47], v[232:235]
s_addc_u32 s97, s17, 0
ds_read_b64_tr_b16 a[198:199], v21 offset:14336
ds_read_b64_tr_b16 a[200:201], v21 offset:16384
v_mfma_f32_16x16x32_bf16 v[236:239], a[180:183], v[100:103], v[236:239]
global_load_lds_dwordx4 v14, s[96:97]
v_mfma_f32_16x16x32_bf16 v[236:239], a[176:179], v[96:99], v[236:239]
s_add_u32 m0, s41, 0x19000
ds_read_b64_tr_b16 a[202:203], v21 offset:18432
v_cvt_pk_bf16_f32 v168, v168, v169
v_mfma_f32_16x16x32_bf16 v[236:239], a[172:175], v[92:95], v[236:239]
s_add_u32 s96, s16, 0x48180
ds_read_b64_tr_b16 a[204:205], v21 offset:20480
v_cvt_pk_bf16_f32 v169, v170, v171
v_mfma_f32_16x16x32_bf16 v[236:239], a[168:171], v[88:91], v[236:239]
s_addc_u32 s97, s17, 0
ds_read_b64_tr_b16 a[206:207], v21 offset:22528
ds_read_b64_tr_b16 a[144:145], v18
v_mfma_f32_16x16x32_bf16 v[236:239], a[164:167], v[84:87], v[236:239]
global_load_lds_dwordx4 v14, s[96:97]
v_mfma_f32_16x16x32_bf16 v[236:239], a[160:163], v[80:83], v[236:239]
s_waitcnt lgkmcnt(7)
ds_read_b64_tr_b16 a[146:147], v18 offset:2048
v_cvt_pk_bf16_f32 v170, v172, v173
v_mfma_f32_16x16x32_bf16 v[220:223], a[184:187], v[80:83], v[220:223]
s_add_u32 m0, s41, 0x1a000
ds_read_b64_tr_b16 a[148:149], v18 offset:4096
v_cvt_pk_bf16_f32 v171, v174, v175
v_mfma_f32_16x16x32_bf16 v[220:223], a[188:191], v[84:87], v[220:223]
s_add_u32 s96, s16, 0x90180
ds_read_b64_tr_b16 a[150:151], v18 offset:6144
v_permlane16_swap_b32 v168, v170
v_mfma_f32_16x16x32_bf16 v[220:223], a[192:195], v[88:91], v[220:223]
s_waitcnt lgkmcnt(4)
ds_read_b64_tr_b16 a[152:153], v18 offset:8192
v_permlane16_swap_b32 v169, v171
v_mfma_f32_16x16x32_bf16 v[220:223], a[196:199], v[92:95], v[220:223]
s_addc_u32 s97, s17, 0
ds_read_b64_tr_b16 a[154:155], v18 offset:10240
ds_read_b64_tr_b16 a[156:157], v18 offset:12288
v_mfma_f32_16x16x32_bf16 v[220:223], a[200:203], v[96:99], v[220:223]
global_load_lds_dwordx4 v14, s[96:97]
v_mfma_f32_16x16x32_bf16 v[220:223], a[204:207], v[100:103], v[220:223]
s_add_u32 m0, s41, 0x1b000
ds_read_b64_tr_b16 a[158:159], v18 offset:14336
v_mul_f32 v184, v46, v9
v_mfma_f32_16x16x32_bf16 v[216:219], a[204:207], a[44:47], v[216:219]
s_add_u32 s96, s16, 0xd8180
ds_read_b64_tr_b16 a[160:161], v18 offset:16384
v_mul_f32 v185, v46, v10
v_mfma_f32_16x16x32_bf16 v[216:219], a[200:203], a[40:43], v[216:219]
s_addc_u32 s97, s17, 0
ds_read_b64_tr_b16 a[162:163], v18 offset:18432
ds_read_b64_tr_b16 a[164:165], v18 offset:20480
v_mfma_f32_16x16x32_bf16 v[216:219], a[196:199], a[36:39], v[216:219]
global_load_lds_dwordx4 v14, s[96:97]
v_mfma_f32_16x16x32_bf16 v[216:219], a[192:195], a[32:35], v[216:219]
s_add_u32 m0, s41, 0x1c000
ds_read_b64_tr_b16 a[166:167], v18 offset:22528
v_mul_f32 v176, v184, v176
v_mfma_f32_16x16x32_bf16 v[216:219], a[188:191], a[28:31], v[216:219]
s_add_u32 s96, s16, 0x120180
ds_read_b64_tr_b16 a[168:169], v27 offset:24576
v_mul_f32 v177, v184, v177
v_mfma_f32_16x16x32_bf16 v[216:219], a[184:187], a[24:27], v[216:219]
s_waitcnt lgkmcnt(7)
ds_read_b64_tr_b16 a[170:171], v27 offset:26624
v_mul_f32 v178, v184, v178
v_mfma_f32_16x16x32_bf16 v[200:203], a[144:147], a[24:27], v[200:203]
s_addc_u32 s97, s17, 0
ds_read_b64_tr_b16 a[172:173], v27 offset:28672
ds_read_b64_tr_b16 a[174:175], v27 offset:30720
v_mfma_f32_16x16x32_bf16 v[200:203], a[148:151], a[28:31], v[200:203]
global_load_lds_dwordx4 v14, s[96:97]
v_mfma_f32_16x16x32_bf16 v[200:203], a[152:155], a[32:35], v[200:203]
s_waitcnt lgkmcnt(4)
ds_read_b64_tr_b16 a[176:177], v27 offset:32768
v_mul_f32 v179, v184, v179
v_mfma_f32_16x16x32_bf16 v[200:203], a[156:159], a[36:39], v[200:203]
s_add_u32 m0, s41, 0x1d000
ds_read_b64_tr_b16 a[178:179], v27 offset:34816
v_mul_f32 v180, v185, v180
v_mfma_f32_16x16x32_bf16 v[200:203], a[160:163], a[40:43], v[200:203]
s_add_u32 s96, s16, 0x168180
ds_read_b64_tr_b16 a[180:181], v27 offset:36864
v_mul_f32 v181, v185, v181
v_mfma_f32_16x16x32_bf16 v[200:203], a[164:167], a[44:47], v[200:203]
s_addc_u32 s97, s17, 0
ds_read_b64_tr_b16 a[182:183], v27 offset:38912
ds_read_b64_tr_b16 a[184:185], v27 offset:40960
v_mfma_f32_16x16x32_bf16 v[204:207], a[164:167], v[100:103], v[204:207]
global_load_lds_dwordx4 v14, s[96:97]
v_mfma_f32_16x16x32_bf16 v[204:207], a[160:163], v[96:99], v[204:207]
s_add_u32 m0, s41, 0x1e000
ds_read_b64_tr_b16 a[186:187], v27 offset:43008
v_mul_f32 v182, v185, v182
v_mfma_f32_16x16x32_bf16 v[204:207], a[156:159], v[92:95], v[204:207]
s_add_u32 s96, s20, 0x180
ds_read_b64_tr_b16 a[188:189], v27 offset:45056
v_mul_f32 v183, v185, v183
v_mfma_f32_16x16x32_bf16 v[204:207], a[152:155], v[88:91], v[204:207]
s_addc_u32 s97, s21, 0
ds_read_b64_tr_b16 a[190:191], v27 offset:47104
v_cvt_pk_bf16_f32 v176, v176, v177
v_mfma_f32_16x16x32_bf16 v[204:207], a[148:151], v[84:87], v[204:207]
ds_read_b64_tr_b16 a[192:193], v24 offset:24576
v_cvt_pk_bf16_f32 v178, v178, v179
v_mfma_f32_16x16x32_bf16 v[204:207], a[144:147], v[80:83], v[204:207]
s_waitcnt lgkmcnt(7)
ds_read_b64_tr_b16 a[194:195], v24 offset:26624
ds_read_b64_tr_b16 a[196:197], v24 offset:28672
v_mfma_f32_16x16x32_bf16 v[244:247], a[168:171], v[80:83], v[244:247]
global_load_lds_dwordx4 v14, s[96:97]
v_mfma_f32_16x16x32_bf16 v[244:247], a[172:175], v[84:87], v[244:247]
s_add_u32 m0, s41, 0x1f000
ds_read_b64_tr_b16 a[198:199], v24 offset:30720
v_cvt_pk_bf16_f32 v180, v180, v181
v_mfma_f32_16x16x32_bf16 v[244:247], a[176:179], v[88:91], v[244:247]
s_waitcnt lgkmcnt(4)
ds_read_b64_tr_b16 a[200:201], v24 offset:32768
v_cvt_pk_bf16_f32 v182, v182, v183
v_mfma_f32_16x16x32_bf16 v[244:247], a[180:183], v[92:95], v[244:247]
s_add_u32 s96, s20, 0x48180
ds_read_b64_tr_b16 a[202:203], v24 offset:34816
v_mov_b32 v177, s52
v_mfma_f32_16x16x32_bf16 v[244:247], a[184:187], v[96:99], v[244:247]
s_addc_u32 s97, s21, 0
ds_read_b64_tr_b16 a[204:205], v24 offset:36864
ds_read_b64_tr_b16 a[206:207], v24 offset:38912
v_mfma_f32_16x16x32_bf16 v[244:247], a[188:191], v[100:103], v[244:247]
global_load_lds_dwordx4 v14, s[96:97]
v_mfma_f32_16x16x32_bf16 v[240:243], a[188:191], a[44:47], v[240:243]
s_add_u32 m0, s41, 0x20000
ds_read_b64_tr_b16 a[144:145], v24 offset:40960
v_mov_b32 v179, s52
v_mfma_f32_16x16x32_bf16 v[240:243], a[184:187], a[40:43], v[240:243]
s_add_u32 s96, s20, 0x90180
ds_read_b64_tr_b16 a[146:147], v24 offset:43008
v_mov_b32 v181, s52
v_mfma_f32_16x16x32_bf16 v[240:243], a[180:183], a[36:39], v[240:243]
s_addc_u32 s97, s21, 0
ds_read_b64_tr_b16 a[148:149], v24 offset:45056
ds_read_b64_tr_b16 a[150:151], v24 offset:47104
v_mfma_f32_16x16x32_bf16 v[240:243], a[176:179], a[32:35], v[240:243]
global_load_lds_dwordx4 v14, s[96:97]
v_mfma_f32_16x16x32_bf16 v[240:243], a[172:175], a[28:31], v[240:243]
s_add_u32 m0, s41, 0x21000
ds_read_b64_tr_b16 a[152:153], v21 offset:24576
v_mov_b32 v183, s52
v_mfma_f32_16x16x32_bf16 v[240:243], a[168:171], a[24:27], v[240:243]
s_waitcnt lgkmcnt(7)
ds_read_b64_tr_b16 a[154:155], v21 offset:26624
v_permlane16_swap_b32 v176, v180
v_mfma_f32_16x16x32_bf16 v[224:227], a[192:195], a[24:27], v[224:227]
s_add_u32 s96, s20, 0xd8180
ds_read_b64_tr_b16 a[156:157], v21 offset:28672
v_permlane16_swap_b32 v178, v182
v_mfma_f32_16x16x32_bf16 v[224:227], a[196:199], a[28:31], v[224:227]
s_addc_u32 s97, s21, 0
ds_read_b64_tr_b16 a[158:159], v21 offset:30720
v_mfma_f32_16x16x32_bf16 v[224:227], a[200:203], a[32:35], v[224:227]
s_waitcnt lgkmcnt(4)
ds_read_b64_tr_b16 a[160:161], v21 offset:32768
ds_read_b64_tr_b16 a[162:163], v21 offset:34816
v_mfma_f32_16x16x32_bf16 v[224:227], a[204:207], a[36:39], v[224:227]
global_load_lds_dwordx4 v14, s[96:97]
v_mfma_f32_16x16x32_bf16 v[224:227], a[144:147], a[40:43], v[224:227]
ds_read_b64_tr_b16 a[164:165], v21 offset:36864
v_mfma_f32_16x16x32_bf16 v[224:227], a[148:151], a[44:47], v[224:227]
ds_read_b64_tr_b16 a[166:167], v21 offset:38912
v_mfma_f32_16x16x32_bf16 v[228:231], a[148:151], v[100:103], v[228:231]
ds_read_b64_tr_b16 a[168:169], v21 offset:40960
v_mfma_f32_16x16x32_bf16 v[228:231], a[144:147], v[96:99], v[228:231]
ds_read_b64_tr_b16 a[170:171], v21 offset:43008
v_mfma_f32_16x16x32_bf16 v[228:231], a[204:207], v[92:95], v[228:231]
ds_read_b64_tr_b16 a[172:173], v21 offset:45056
v_mfma_f32_16x16x32_bf16 v[228:231], a[200:203], v[88:91], v[228:231]
ds_read_b64_tr_b16 a[174:175], v21 offset:47104
v_mfma_f32_16x16x32_bf16 v[228:231], a[196:199], v[84:87], v[228:231]
ds_read_b64_tr_b16 a[176:177], v18 offset:24576
v_mfma_f32_16x16x32_bf16 v[228:231], a[192:195], v[80:83], v[228:231]
s_waitcnt lgkmcnt(7)
ds_read_b64_tr_b16 a[178:179], v18 offset:26624
v_mfma_f32_16x16x32_bf16 v[212:215], a[152:155], v[80:83], v[212:215]
ds_read_b64_tr_b16 a[180:181], v18 offset:28672
v_mfma_f32_16x16x32_bf16 v[212:215], a[156:159], v[84:87], v[212:215]
ds_read_b64_tr_b16 a[182:183], v18 offset:30720
v_mfma_f32_16x16x32_bf16 v[212:215], a[160:163], v[88:91], v[212:215]
s_waitcnt lgkmcnt(4)
ds_read_b64_tr_b16 a[184:185], v18 offset:32768
v_mfma_f32_16x16x32_bf16 v[212:215], a[164:167], v[92:95], v[212:215]
ds_read_b64_tr_b16 a[186:187], v18 offset:34816
v_mfma_f32_16x16x32_bf16 v[212:215], a[168:171], v[96:99], v[212:215]
ds_read_b64_tr_b16 a[188:189], v18 offset:36864
v_mfma_f32_16x16x32_bf16 v[212:215], a[172:175], v[100:103], v[212:215]
ds_read_b64_tr_b16 a[190:191], v18 offset:38912
v_mfma_f32_16x16x32_bf16 v[208:211], a[172:175], a[44:47], v[208:211]
ds_read_b64_tr_b16 a[192:193], v18 offset:40960
v_mfma_f32_16x16x32_bf16 v[208:211], a[168:171], a[40:43], v[208:211]
ds_read_b64_tr_b16 a[194:195], v18 offset:43008
v_mfma_f32_16x16x32_bf16 v[208:211], a[164:167], a[36:39], v[208:211]
s_waitcnt vmcnt(10)
ds_read_b64_tr_b16 a[196:197], v18 offset:45056
ds_read_b64_tr_b16 a[198:199], v18 offset:47104
v_mfma_f32_16x16x32_bf16 v[208:211], a[160:163], a[32:35], v[208:211]
s_barrier
v_mfma_f32_16x16x32_bf16 v[208:211], a[156:159], a[28:31], v[208:211]
s_add_u32 m0, s41, 0x22000
ds_read_b64_tr_b16 a[200:201], v18 offset:49152
s_add_u32 s96, s20, 0x120180
v_mfma_f32_16x16x32_bf16 v[208:211], a[152:155], a[24:27], v[208:211]
s_waitcnt lgkmcnt(7)
ds_read_b64_tr_b16 a[202:203], v18 offset:51200
ds_read_b64_tr_b16 a[204:205], v18 offset:53248
v_mfma_f32_16x16x32_bf16 v[192:195], a[176:179], a[24:27], v[192:195]
buffer_store_dwordx4 v[160:163], v43, s[36:39], s49 offen sc1
v_mfma_f32_16x16x32_bf16 v[192:195], a[180:183], a[28:31], v[192:195]
s_addc_u32 s97, s21, 0
ds_read_b64_tr_b16 a[206:207], v18 offset:55296
s_mov_b32 s49, 0x64000
v_mfma_f32_16x16x32_bf16 v[192:195], a[184:187], a[32:35], v[192:195]
s_waitcnt lgkmcnt(4)
ds_read_b64_tr_b16 a[144:145], v18 offset:57344
ds_read_b64_tr_b16 a[146:147], v18 offset:59392
v_mfma_f32_16x16x32_bf16 v[192:195], a[188:191], a[36:39], v[192:195]
global_load_lds_dwordx4 v14, s[96:97]
v_mfma_f32_16x16x32_bf16 v[192:195], a[192:195], a[40:43], v[192:195]
s_add_u32 m0, s41, 0x23000
ds_read_b64_tr_b16 a[148:149], v18 offset:61440
s_add_u32 s96, s20, 0x168180
v_mfma_f32_16x16x32_bf16 v[192:195], a[196:199], a[44:47], v[192:195]
s_addc_u32 s97, s21, 0
ds_read_b64_tr_b16 a[150:151], v18 offset:63488
ds_read_b64_tr_b16 a[152:153], v19
v_mfma_f32_16x16x32_bf16 v[196:199], a[196:199], v[100:103], v[196:199]
global_load_lds_dwordx4 v14, s[96:97]
v_mfma_f32_16x16x32_bf16 v[196:199], a[192:195], v[96:99], v[196:199]
s_add_u32 m0, s41, 0x24000
ds_read_b64_tr_b16 a[154:155], v19 offset:2048
s_add_u32 s96, s20, 0x1b0180
v_mfma_f32_16x16x32_bf16 v[196:199], a[188:191], v[92:95], v[196:199]
s_addc_u32 s97, s21, 0
ds_read_b64_tr_b16 a[156:157], v19 offset:4096
v_mfma_f32_16x16x32_bf16 v[196:199], a[184:187], v[88:91], v[196:199]
ds_read_b64_tr_b16 a[158:159], v19 offset:6144
ds_read_b64_tr_b16 a[160:161], v21 offset:49152
v_mfma_f32_16x16x32_bf16 v[196:199], a[180:183], v[84:87], v[196:199]
buffer_store_dwordx4 v[168:171], v43, s[36:39], s49 offen sc1
v_mfma_f32_16x16x32_bf16 v[196:199], a[176:179], v[80:83], v[196:199]
s_waitcnt lgkmcnt(7)
ds_read_b64_tr_b16 a[162:163], v21 offset:51200
s_mov_b32 s49, 0
v_mfma_f32_16x16x32_bf16 v[196:199], a[200:203], v[104:107], v[196:199]
ds_read_b64_tr_b16 a[164:165], v21 offset:53248
v_mfma_f32_16x16x32_bf16 v[196:199], a[204:207], v[108:111], v[196:199]
ds_read_b64_tr_b16 a[166:167], v21 offset:55296
v_mfma_f32_16x16x32_bf16 v[196:199], a[144:147], v[112:115], v[196:199]
s_waitcnt lgkmcnt(4)
ds_read_b64_tr_b16 a[168:169], v21 offset:57344
ds_read_b64_tr_b16 a[170:171], v21 offset:59392
v_mfma_f32_16x16x32_bf16 v[196:199], a[148:151], v[116:119], v[196:199]
global_load_lds_dwordx4 v14, s[96:97]
v_mfma_f32_16x16x32_bf16 v[196:199], a[152:155], v[120:123], v[196:199]
s_add_u32 m0, s41, 0x25000
ds_read_b64_tr_b16 a[172:173], v21 offset:61440
s_add_u32 s96, s20, 0x1f8180
v_mfma_f32_16x16x32_bf16 v[196:199], a[156:159], v[124:127], v[196:199]
s_addc_u32 s97, s21, 0
ds_read_b64_tr_b16 a[174:175], v21 offset:63488
v_mfma_f32_16x16x32_bf16 v[192:195], a[156:159], a[68:71], v[192:195]
ds_read_b64_tr_b16 a[176:177], v22
v_mfma_f32_16x16x32_bf16 v[192:195], a[152:155], a[64:67], v[192:195]
ds_read_b64_tr_b16 a[178:179], v22 offset:2048
ds_read_b64_tr_b16 a[180:181], v22 offset:4096
v_mfma_f32_16x16x32_bf16 v[192:195], a[148:151], a[60:63], v[192:195]
buffer_store_dwordx2 v[176:177], v44, s[36:39], s49 offen sc1
v_mfma_f32_16x16x32_bf16 v[192:195], a[144:147], a[56:59], v[192:195]
s_mov_b32 s49, 0x14000
ds_read_b64_tr_b16 a[182:183], v22 offset:6144
v_and_b32 v3, 31, v0
v_mfma_f32_16x16x32_bf16 v[192:195], a[204:207], a[52:55], v[192:195]
ds_read_b64_tr_b16 a[184:185], v24 offset:49152
v_lshrrev_b32 v4, 5, v0
v_mfma_f32_16x16x32_bf16 v[192:195], a[200:203], a[48:51], v[192:195]
s_waitcnt lgkmcnt(7)
ds_read_b64_tr_b16 a[186:187], v24 offset:51200
v_lshlrev_b32 v1, 2, v4
v_mfma_f32_16x16x32_bf16 v[208:211], a[160:163], a[48:51], v[208:211]
ds_read_b64_tr_b16 a[188:189], v24 offset:53248
ds_read_b64_tr_b16 a[190:191], v24 offset:55296
v_mfma_f32_16x16x32_bf16 v[208:211], a[164:167], a[52:55], v[208:211]
global_load_lds_dwordx4 v14, s[96:97]
v_mfma_f32_16x16x32_bf16 v[208:211], a[168:171], a[56:59], v[208:211]
s_waitcnt lgkmcnt(4)
ds_read_b64_tr_b16 a[192:193], v24 offset:57344
v_xor_b32 v1, v1, v0
v_mfma_f32_16x16x32_bf16 v[208:211], a[172:175], a[60:63], v[208:211]
s_add_u32 m0, s41, 0x26000
ds_read_b64_tr_b16 a[194:195], v24 offset:59392
v_lshlrev_b32 v30, 4, v1
v_mfma_f32_16x16x32_bf16 v[208:211], a[176:179], a[64:67], v[208:211]
s_add_u32 s96, s20, 0x240180
ds_read_b64_tr_b16 a[196:197], v24 offset:61440
v_and_b32 v2, 7, v3
v_mfma_f32_16x16x32_bf16 v[208:211], a[180:183], a[68:71], v[208:211]
s_addc_u32 s97, s21, 0
ds_read_b64_tr_b16 a[198:199], v24 offset:63488
ds_read_b64_tr_b16 a[200:201], v25
v_mfma_f32_16x16x32_bf16 v[212:215], a[180:183], v[124:127], v[212:215]
buffer_store_dwordx2 v[178:179], v44, s[36:39], s49 offen sc1
v_mfma_f32_16x16x32_bf16 v[212:215], a[176:179], v[120:123], v[212:215]
s_mov_b32 s49, 0x28000
ds_read_b64_tr_b16 a[202:203], v25 offset:2048
v_bfe_u32 v1, v3, 4, 1
v_mfma_f32_16x16x32_bf16 v[212:215], a[172:175], v[116:119], v[212:215]
ds_read_b64_tr_b16 a[204:205], v25 offset:4096
v_lshl_add_u32 v2, v1, 3, v2
v_mfma_f32_16x16x32_bf16 v[212:215], a[168:171], v[112:115], v[212:215]
ds_read_b64_tr_b16 a[206:207], v25 offset:6144
v_bfe_u32 v1, v3, 3, 1
v_mfma_f32_16x16x32_bf16 v[212:215], a[164:167], v[108:111], v[212:215]
ds_read_b64_tr_b16 a[144:145], v27 offset:49152
v_xor_b32 v1, 1, v1
v_mfma_f32_16x16x32_bf16 v[212:215], a[160:163], v[104:107], v[212:215]
s_waitcnt lgkmcnt(7)
ds_read_b64_tr_b16 a[146:147], v27 offset:51200
ds_read_b64_tr_b16 a[148:149], v27 offset:53248
v_mfma_f32_16x16x32_bf16 v[228:231], a[184:187], v[104:107], v[228:231]
global_load_lds_dwordx4 v14, s[96:97]
v_mfma_f32_16x16x32_bf16 v[228:231], a[188:191], v[108:111], v[228:231]
s_add_u32 m0, s41, 0x27000
ds_read_b64_tr_b16 a[150:151], v27 offset:55296
v_lshl_add_u32 v2, v1, 4, v2
v_mfma_f32_16x16x32_bf16 v[228:231], a[192:195], v[112:115], v[228:231]
s_waitcnt lgkmcnt(4)
ds_read_b64_tr_b16 a[152:153], v27 offset:57344
v_lshlrev_b32 v31, 3, v2
v_mfma_f32_16x16x32_bf16 v[228:231], a[196:199], v[116:119], v[228:231]
s_add_u32 s96, s20, 0x288180
ds_read_b64_tr_b16 a[154:155], v27 offset:59392
ds_read_b64_tr_b16 a[156:157], v27 offset:61440
v_mfma_f32_16x16x32_bf16 v[228:231], a[200:203], v[120:123], v[228:231]
buffer_store_dwordx2 v[180:181], v45, s[36:39], s49 offen sc1
v_mfma_f32_16x16x32_bf16 v[228:231], a[204:207], v[124:127], v[228:231]
s_addc_u32 s97, s21, 0
ds_read_b64_tr_b16 a[158:159], v27 offset:63488
v_add_u32 v31, 0x400, v31
v_mfma_f32_16x16x32_bf16 v[224:227], a[204:207], a[68:71], v[224:227]
s_mov_b32 s49, 0x3c000
ds_read_b64_tr_b16 a[160:161], v28
s_lshr_b32 s46, s40, 1
v_mfma_f32_16x16x32_bf16 v[224:227], a[200:203], a[64:67], v[224:227]
s_lshl_b32 s46, s46, 5
ds_read_b64_tr_b16 a[162:163], v28 offset:2048
s_add_u32 s46, s46, s44
v_mfma_f32_16x16x32_bf16 v[224:227], a[196:199], a[60:63], v[224:227]
s_add_u32 s46, s46, 32
ds_read_b64_tr_b16 a[164:165], v28 offset:4096
ds_read_b64_tr_b16 a[166:167], v28 offset:6144
v_mfma_f32_16x16x32_bf16 v[224:227], a[192:195], a[56:59], v[224:227]
global_load_lds_dwordx4 v14, s[96:97]
v_mfma_f32_16x16x32_bf16 v[224:227], a[188:191], a[52:55], v[224:227]
s_add_u32 m0, s41, 0
ds_read_b64_tr_b16 a[168:169], v19 offset:8192
s_add_u32 s96, s20, 0x2d0180
v_mfma_f32_16x16x32_bf16 v[224:227], a[184:187], a[48:51], v[224:227]
s_waitcnt lgkmcnt(7)
ds_read_b64_tr_b16 a[170:171], v19 offset:10240
s_addc_u32 s97, s21, 0
v_mfma_f32_16x16x32_bf16 v[240:243], a[144:147], a[48:51], v[240:243]
s_mul_i32 s46, s46, 0x14000
ds_read_b64_tr_b16 a[172:173], v19 offset:12288
s_and_b32 s47, s40, 1
v_mfma_f32_16x16x32_bf16 v[240:243], a[148:151], a[52:55], v[240:243]
s_mul_i32 s47, s47, 0x1400
ds_read_b64_tr_b16 a[174:175], v19 offset:14336
s_add_u32 s46, s46, s47
v_mfma_f32_16x16x32_bf16 v[240:243], a[152:155], a[56:59], v[240:243]
s_waitcnt lgkmcnt(4)
ds_read_b64_tr_b16 a[176:177], v19 offset:16384
ds_read_b64_tr_b16 a[178:179], v19 offset:18432
v_mfma_f32_16x16x32_bf16 v[240:243], a[156:159], a[60:63], v[240:243]
buffer_store_dwordx2 v[182:183], v45, s[36:39], s49 offen sc1
v_mfma_f32_16x16x32_bf16 v[240:243], a[160:163], a[64:67], v[240:243]
ds_read_b64_tr_b16 a[180:181], v19 offset:20480
v_lshl_add_u32 v36, v0, 4, s46
v_mfma_f32_16x16x32_bf16 v[240:243], a[164:167], a[68:71], v[240:243]
ds_read_b64_tr_b16 a[182:183], v19 offset:22528
v_lshrrev_b32 v4, 5, v0
v_mfma_f32_16x16x32_bf16 v[244:247], a[164:167], v[124:127], v[244:247]
ds_read_b64_tr_b16 a[184:185], v19 offset:24576
ds_read_b64_tr_b16 a[186:187], v19 offset:26624
v_mfma_f32_16x16x32_bf16 v[244:247], a[160:163], v[120:123], v[244:247]
buffer_load_dword a255, v53, s[24:27], 0 offen
v_mfma_f32_16x16x32_bf16 v[244:247], a[156:159], v[116:119], v[244:247]
ds_read_b64_tr_b16 a[188:189], v19 offset:28672
v_and_b32 v5, 3, v0
v_mfma_f32_16x16x32_bf16 v[244:247], a[152:155], v[112:115], v[244:247]
ds_read_b64_tr_b16 a[190:191], v19 offset:30720
v_bfe_u32 v6, v0, 2, 2
v_mfma_f32_16x16x32_bf16 v[244:247], a[148:151], v[108:111], v[244:247]
ds_read_b64_tr_b16 a[192:193], v22 offset:8192
v_lshl_add_u32 v6, v4, 3, v6
v_mfma_f32_16x16x32_bf16 v[244:247], a[144:147], v[104:107], v[244:247]
s_waitcnt lgkmcnt(7)
ds_read_b64_tr_b16 a[194:195], v22 offset:10240
v_add_u32 v7, 0, v6
v_mfma_f32_16x16x32_bf16 v[204:207], a[168:171], v[104:107], v[204:207]
ds_read_b64_tr_b16 a[196:197], v22 offset:12288
v_and_b32 v2, 7, v7
v_mfma_f32_16x16x32_bf16 v[204:207], a[172:175], v[108:111], v[204:207]
ds_read_b64_tr_b16 a[198:199], v22 offset:14336
v_bfe_u32 v1, v7, 4, 1
v_mfma_f32_16x16x32_bf16 v[204:207], a[176:179], v[112:115], v[204:207]
s_waitcnt lgkmcnt(4)
ds_read_b64_tr_b16 a[200:201], v22 offset:16384
v_lshl_add_u32 v2, v1, 3, v2
v_mfma_f32_16x16x32_bf16 v[204:207], a[180:183], v[116:119], v[204:207]
ds_read_b64_tr_b16 a[202:203], v22 offset:18432
v_bfe_u32 v1, v7, 3, 1
v_mfma_f32_16x16x32_bf16 v[204:207], a[184:187], v[120:123], v[204:207]
ds_read_b64_tr_b16 a[204:205], v22 offset:20480
v_xor_b32 v1, 1, v1
v_mfma_f32_16x16x32_bf16 v[204:207], a[188:191], v[124:127], v[204:207]
ds_read_b64_tr_b16 a[206:207], v22 offset:22528
v_lshl_add_u32 v2, v1, 4, v2
v_mfma_f32_16x16x32_bf16 v[200:203], a[188:191], a[68:71], v[200:203]
ds_read_b64_tr_b16 a[144:145], v22 offset:24576
v_lshlrev_b32 v2, 3, v2
v_mfma_f32_16x16x32_bf16 v[200:203], a[184:187], a[64:67], v[200:203]
ds_read_b64_tr_b16 a[146:147], v22 offset:26624
v_min_u32 v1, 1, v5
v_mfma_f32_16x16x32_bf16 v[200:203], a[180:183], a[60:63], v[200:203]
ds_read_b64_tr_b16 a[148:149], v22 offset:28672
v_mul_u32_u24 v1, 0x30040, v1
v_mfma_f32_16x16x32_bf16 v[200:203], a[176:179], a[56:59], v[200:203]
ds_read_b64_tr_b16 a[150:151], v22 offset:30720
v_xor_b32 v2, v2, v1
v_mfma_f32_16x16x32_bf16 v[200:203], a[172:175], a[52:55], v[200:203]
ds_read_b64_tr_b16 a[152:153], v25 offset:8192
v_add_u32 v2, 0x400, v2
v_mfma_f32_16x16x32_bf16 v[200:203], a[168:171], a[48:51], v[200:203]
s_waitcnt lgkmcnt(7)
ds_read_b64_tr_b16 a[154:155], v25 offset:10240
v_lshrrev_b32 v1, 1, v5
v_mfma_f32_16x16x32_bf16 v[216:219], a[192:195], a[48:51], v[216:219]
ds_read_b64_tr_b16 a[156:157], v25 offset:12288
v_mul_u32_u24 v1, 36, v1
v_mfma_f32_16x16x32_bf16 v[216:219], a[196:199], a[52:55], v[216:219]
ds_read_b64_tr_b16 a[158:159], v25 offset:14336
v_xor_b32 v7, v7, v1
v_mfma_f32_16x16x32_bf16 v[216:219], a[200:203], a[56:59], v[216:219]
s_waitcnt lgkmcnt(4)
ds_read_b64_tr_b16 a[160:161], v25 offset:16384
v_lshlrev_b32 v7, 4, v7
v_mfma_f32_16x16x32_bf16 v[216:219], a[204:207], a[60:63], v[216:219]
ds_read_b64_tr_b16 a[162:163], v25 offset:18432
v_max_f32 v192, 0, v192
v_mfma_f32_16x16x32_bf16 v[216:219], a[144:147], a[64:67], v[216:219]
ds_read_b64_tr_b16 a[164:165], v25 offset:20480
v_max_f32 v193, 0, v193
v_mfma_f32_16x16x32_bf16 v[216:219], a[148:151], a[68:71], v[216:219]
L_pg7:
s_cbranch_execz L_tr1
ds_read_b64_tr_b16 a[166:167], v25 offset:22528
v_max_f32 v194, 0, v194
v_mfma_f32_16x16x32_bf16 v[220:223], a[148:151], v[124:127], v[220:223]
ds_read_b64_tr_b16 a[168:169], v25 offset:24576
v_max_f32 v195, 0, v195
v_mfma_f32_16x16x32_bf16 v[220:223], a[144:147], v[120:123], v[220:223]
ds_read_b64_tr_b16 a[170:171], v25 offset:26624
v_max_f32 v196, 0, v196
v_mfma_f32_16x16x32_bf16 v[220:223], a[204:207], v[116:119], v[220:223]
ds_read_b64_tr_b16 a[172:173], v25 offset:28672
v_max_f32 v197, 0, v197
v_mfma_f32_16x16x32_bf16 v[220:223], a[200:203], v[112:115], v[220:223]
ds_read_b64_tr_b16 a[174:175], v25 offset:30720
v_max_f32 v198, 0, v198
v_mfma_f32_16x16x32_bf16 v[220:223], a[196:199], v[108:111], v[220:223]
ds_read_b64_tr_b16 a[176:177], v28 offset:8192
v_max_f32 v199, 0, v199
v_mfma_f32_16x16x32_bf16 v[220:223], a[192:195], v[104:107], v[220:223]
s_waitcnt lgkmcnt(7)
ds_read_b64_tr_b16 a[178:179], v28 offset:10240
ds_read_b64_tr_b16 a[180:181], v28 offset:12288
v_mfma_f32_16x16x32_bf16 v[236:239], a[152:155], v[104:107], v[236:239]
global_load_lds_dwordx4 v14, s[96:97]
v_mfma_f32_16x16x32_bf16 v[236:239], a[156:159], v[108:111], v[236:239]
s_add_u32 m0, s41, 0x1000
ds_read_b64_tr_b16 a[182:183], v28 offset:14336
v_mul_f32 v200, v192, v200
v_mfma_f32_16x16x32_bf16 v[236:239], a[160:163], v[112:115], v[236:239]
s_waitcnt lgkmcnt(4)
ds_read_b64_tr_b16 a[184:185], v28 offset:16384
v_mul_f32 v201, v193, v201
v_mfma_f32_16x16x32_bf16 v[236:239], a[164:167], v[116:119], v[236:239]
s_add_u32 s96, s20, 0x318180
ds_read_b64_tr_b16 a[186:187], v28 offset:18432
v_mul_f32 v202, v194, v202
v_mfma_f32_16x16x32_bf16 v[236:239], a[168:171], v[120:123], v[236:239]
s_addc_u32 s97, s21, 0
ds_read_b64_tr_b16 a[188:189], v28 offset:20480
ds_read_b64_tr_b16 a[190:191], v28 offset:22528
v_mfma_f32_16x16x32_bf16 v[236:239], a[172:175], v[124:127], v[236:239]
global_load_lds_dwordx4 v14, s[96:97]
v_mfma_f32_16x16x32_bf16 v[232:235], a[172:175], a[68:71], v[232:235]
s_add_u32 m0, s41, 0x2000
ds_read_b64_tr_b16 a[192:193], v28 offset:24576
v_mul_f32 v203, v195, v203
v_mfma_f32_16x16x32_bf16 v[232:235], a[168:171], a[64:67], v[232:235]
s_add_u32 s96, s16, 0x1b0180
ds_read_b64_tr_b16 a[194:195], v28 offset:26624
v_cvt_pk_bf16_f32 v192, v200, v201
v_mfma_f32_16x16x32_bf16 v[232:235], a[164:167], a[60:63], v[232:235]
s_waitcnt vmcnt(19)
ds_read_b64_tr_b16 a[196:197], v28 offset:28672
ds_read_b64_tr_b16 a[198:199], v28 offset:30720
v_mfma_f32_16x16x32_bf16 v[232:235], a[160:163], a[56:59], v[232:235]
s_barrier
v_mfma_f32_16x16x32_bf16 v[232:235], a[156:159], a[52:55], v[232:235]
s_addc_u32 s97, s17, 0
ds_read_b64_tr_b16 a[200:201], v19 offset:32768
v_cvt_pk_bf16_f32 v193, v202, v203
v_mfma_f32_16x16x32_bf16 v[232:235], a[152:155], a[48:51], v[232:235]
s_waitcnt lgkmcnt(7)
ds_read_b64_tr_b16 a[202:203], v19 offset:34816
ds_read_b64_tr_b16 a[204:205], v19 offset:36864
v_mfma_f32_16x16x32_bf16 v[248:251], a[176:179], a[48:51], v[248:251]
global_load_lds_dwordx4 v14, s[96:97]
v_mfma_f32_16x16x32_bf16 v[248:251], a[180:183], a[52:55], v[248:251]
s_add_u32 m0, s41, 0x3000
ds_read_b64_tr_b16 a[206:207], v19 offset:38912
v_accvgpr_write_b32 a104, v192
v_mfma_f32_16x16x32_bf16 v[248:251], a[184:187], a[56:59], v[248:251]
s_waitcnt lgkmcnt(4)
ds_read_b64_tr_b16 a[144:145], v19 offset:40960
v_accvgpr_write_b32 a105, v193
v_mfma_f32_16x16x32_bf16 v[248:251], a[188:191], a[60:63], v[248:251]
s_add_u32 s96, s16, 0x1f8180
ds_read_b64_tr_b16 a[146:147], v19 offset:43008
v_mul_f32 v204, v196, v204
v_mfma_f32_16x16x32_bf16 v[248:251], a[192:195], a[64:67], v[248:251]
s_addc_u32 s97, s17, 0
ds_read_b64_tr_b16 a[148:149], v19 offset:45056
ds_read_b64_tr_b16 a[150:151], v19 offset:47104
v_mfma_f32_16x16x32_bf16 v[248:251], a[196:199], a[68:71], v[248:251]
global_load_lds_dwordx4 v14, s[96:97]
v_mfma_f32_16x16x32_bf16 v[252:255], a[196:199], v[124:127], v[252:255]
s_add_u32 m0, s41, 0x4000
ds_read_b64_tr_b16 a[152:153], v19 offset:49152
v_mul_f32 v205, v197, v205
v_mfma_f32_16x16x32_bf16 v[252:255], a[192:195], v[120:123], v[252:255]
s_add_u32 s96, s16, 0x240180
ds_read_b64_tr_b16 a[154:155], v19 offset:51200
ds_read_b64_tr_b16 a[156:157], v19 offset:53248
v_mfma_f32_16x16x32_bf16 v[252:255], a[188:191], v[116:119], v[252:255]
buffer_load_dword a255, v53, s[24:27], 0 offen offset:128
v_mfma_f32_16x16x32_bf16 v[252:255], a[184:187], v[112:115], v[252:255]
s_addc_u32 s97, s17, 0
ds_read_b64_tr_b16 a[158:159], v19 offset:55296
v_mul_f32 v206, v198, v206
v_mfma_f32_16x16x32_bf16 v[252:255], a[180:183], v[108:111], v[252:255]
ds_read_b64_tr_b16 a[160:161], v22 offset:32768
v_mul_f32 v207, v199, v207
v_mfma_f32_16x16x32_bf16 v[252:255], a[176:179], v[104:107], v[252:255]
s_waitcnt lgkmcnt(7)
ds_read_b64_tr_b16 a[162:163], v22 offset:34816
v_cvt_pk_bf16_f32 v196, v204, v205
v_mfma_f32_16x16x32_bf16 v[132:135], a[200:203], v[56:59], 0
ds_read_b64_tr_b16 a[164:165], v22 offset:36864
v_cvt_pk_bf16_f32 v197, v206, v207
v_mfma_f32_16x16x32_bf16 v[132:135], a[204:207], v[60:63], v[132:135]
ds_read_b64_tr_b16 a[166:167], v22 offset:38912
v_accvgpr_write_b32 a108, v196
v_mfma_f32_16x16x32_bf16 v[132:135], a[144:147], v[64:67], v[132:135]
s_waitcnt lgkmcnt(4)
ds_read_b64_tr_b16 a[168:169], v22 offset:40960
v_accvgpr_write_b32 a109, v197
v_mfma_f32_16x16x32_bf16 v[132:135], a[148:151], v[68:71], v[132:135]
ds_read_b64_tr_b16 a[170:171], v22 offset:43008
v_max_f32 v208, 0, v208
v_mfma_f32_16x16x32_bf16 v[132:135], a[152:155], v[72:75], v[132:135]
ds_read_b64_tr_b16 a[172:173], v22 offset:45056
v_max_f32 v209, 0, v209
v_mfma_f32_16x16x32_bf16 v[132:135], a[156:159], v[76:79], v[132:135]
ds_read_b64_tr_b16 a[174:175], v22 offset:47104
v_max_f32 v210, 0, v210
v_mfma_f32_16x16x32_bf16 v[128:131], a[156:159], a[20:23], 0
ds_read_b64_tr_b16 a[176:177], v22 offset:49152
v_max_f32 v211, 0, v211
v_mfma_f32_16x16x32_bf16 v[128:131], a[152:155], a[16:19], v[128:131]
ds_read_b64_tr_b16 a[178:179], v22 offset:51200
v_max_f32 v212, 0, v212
v_mfma_f32_16x16x32_bf16 v[128:131], a[148:151], a[12:15], v[128:131]
ds_read_b64_tr_b16 a[180:181], v22 offset:53248
v_max_f32 v213, 0, v213
v_mfma_f32_16x16x32_bf16 v[128:131], a[144:147], a[8:11], v[128:131]
ds_read_b64_tr_b16 a[182:183], v22 offset:55296
v_max_f32 v214, 0, v214
v_mfma_f32_16x16x32_bf16 v[128:131], a[204:207], a[4:7], v[128:131]
ds_read_b64_tr_b16 a[184:185], v25 offset:32768
v_max_f32 v215, 0, v215
v_mfma_f32_16x16x32_bf16 v[128:131], a[200:203], a[0:3], v[128:131]
s_waitcnt lgkmcnt(7)
ds_read_b64_tr_b16 a[186:187], v25 offset:34816
v_mul_f32 v216, v208, v216
v_mfma_f32_16x16x32_bf16 v[144:147], a[160:163], a[0:3], 0
ds_read_b64_tr_b16 a[188:189], v25 offset:36864
v_mul_f32 v217, v209, v217
v_mfma_f32_16x16x32_bf16 v[144:147], a[164:167], a[4:7], v[144:147]
ds_read_b64_tr_b16 a[190:191], v25 offset:38912
v_mul_f32 v218, v210, v218
v_mfma_f32_16x16x32_bf16 v[144:147], a[168:171], a[8:11], v[144:147]
s_waitcnt lgkmcnt(4)
ds_read_b64_tr_b16 a[192:193], v25 offset:40960
v_mul_f32 v219, v211, v219
v_mfma_f32_16x16x32_bf16 v[144:147], a[172:175], a[12:15], v[144:147]
ds_read_b64_tr_b16 a[194:195], v25 offset:43008
v_cvt_pk_bf16_f32 v208, v216, v217
v_mfma_f32_16x16x32_bf16 v[144:147], a[176:179], a[16:19], v[144:147]
ds_read_b64_tr_b16 a[196:197], v25 offset:45056
v_cvt_pk_bf16_f32 v209, v218, v219
v_mfma_f32_16x16x32_bf16 v[144:147], a[180:183], a[20:23], v[144:147]
ds_read_b64_tr_b16 a[198:199], v25 offset:47104
v_accvgpr_write_b32 a106, v208
v_mfma_f32_16x16x32_bf16 v[148:151], a[180:183], v[76:79], 0
ds_read_b64_tr_b16 a[200:201], v25 offset:49152
v_accvgpr_write_b32 a107, v209
v_mfma_f32_16x16x32_bf16 v[148:151], a[176:179], v[72:75], v[148:151]
ds_read_b64_tr_b16 a[202:203], v25 offset:51200
v_mul_f32 v220, v212, v220
v_mfma_f32_16x16x32_bf16 v[148:151], a[172:175], v[68:71], v[148:151]
ds_read_b64_tr_b16 a[204:205], v25 offset:53248
v_mul_f32 v221, v213, v221
v_mfma_f32_16x16x32_bf16 v[148:151], a[168:171], v[64:67], v[148:151]
ds_read_b64_tr_b16 a[206:207], v25 offset:55296
ds_read_b64_tr_b16 a[144:145], v28 offset:32768
v_mfma_f32_16x16x32_bf16 v[148:151], a[164:167], v[60:63], v[148:151]
buffer_load_dword a255, v53, s[24:27], 0 offen offset:256
v_mfma_f32_16x16x32_bf16 v[148:151], a[160:163], v[56:59], v[148:151]
s_waitcnt lgkmcnt(7)
ds_read_b64_tr_b16 a[146:147], v28 offset:34816
v_mul_f32 v222, v214, v222
v_mfma_f32_16x16x32_bf16 v[164:167], a[184:187], v[56:59], 0
ds_read_b64_tr_b16 a[148:149], v28 offset:36864
v_mul_f32 v223, v215, v223
v_mfma_f32_16x16x32_bf16 v[164:167], a[188:191], v[60:63], v[164:167]
ds_read_b64_tr_b16 a[150:151], v28 offset:38912
v_cvt_pk_bf16_f32 v212, v220, v221
v_mfma_f32_16x16x32_bf16 v[164:167], a[192:195], v[64:67], v[164:167]
s_waitcnt lgkmcnt(4)
ds_read_b64_tr_b16 a[152:153], v28 offset:40960
v_cvt_pk_bf16_f32 v213, v222, v223
v_mfma_f32_16x16x32_bf16 v[164:167], a[196:199], v[68:71], v[164:167]
ds_read_b64_tr_b16 a[154:155], v28 offset:43008
v_accvgpr_write_b32 a110, v212
v_mfma_f32_16x16x32_bf16 v[164:167], a[200:203], v[72:75], v[164:167]
ds_read_b64_tr_b16 a[156:157], v28 offset:45056
v_accvgpr_write_b32 a111, v213
v_mfma_f32_16x16x32_bf16 v[164:167], a[204:207], v[76:79], v[164:167]
ds_read_b64_tr_b16 a[158:159], v28 offset:47104
v_max_f32 v224, 0, v224
v_mfma_f32_16x16x32_bf16 v[160:163], a[204:207], a[20:23], 0
ds_read_b64_tr_b16 a[160:161], v28 offset:49152
v_max_f32 v225, 0, v225
v_mfma_f32_16x16x32_bf16 v[160:163], a[200:203], a[16:19], v[160:163]
ds_read_b64_tr_b16 a[162:163], v28 offset:51200
v_max_f32 v226, 0, v226
v_mfma_f32_16x16x32_bf16 v[160:163], a[196:199], a[12:15], v[160:163]
s_waitcnt vmcnt(16)
ds_read_b64_tr_b16 a[164:165], v28 offset:53248
ds_read_b64_tr_b16 a[166:167], v28 offset:55296
v_mfma_f32_16x16x32_bf16 v[160:163], a[192:195], a[8:11], v[160:163]
s_barrier
v_mfma_f32_16x16x32_bf16 v[160:163], a[188:191], a[4:7], v[160:163]
ds_read_b64_tr_b16 a[168:169], v19 offset:57344
v_max_f32 v227, 0, v227
v_mfma_f32_16x16x32_bf16 v[160:163], a[184:187], a[0:3], v[160:163]
s_waitcnt lgkmcnt(7)
ds_read_b64_tr_b16 a[170:171], v19 offset:59392
v_max_f32 v228, 0, v228
v_mfma_f32_16x16x32_bf16 v[176:179], a[144:147], a[0:3], 0
ds_read_b64_tr_b16 a[172:173], v19 offset:61440
v_max_f32 v229, 0, v229
v_mfma_f32_16x16x32_bf16 v[176:179], a[148:151], a[4:7], v[176:179]
ds_read_b64_tr_b16 a[174:175], v19 offset:63488
v_max_f32 v230, 0, v230
v_mfma_f32_16x16x32_bf16 v[176:179], a[152:155], a[8:11], v[176:179]
s_waitcnt lgkmcnt(4)
ds_read_b64_tr_b16 a[176:177], v20
v_max_f32 v231, 0, v231
v_mfma_f32_16x16x32_bf16 v[176:179], a[156:159], a[12:15], v[176:179]
ds_read_b64_tr_b16 a[178:179], v20 offset:2048
v_mul_f32 v232, v224, v232
v_mfma_f32_16x16x32_bf16 v[176:179], a[160:163], a[16:19], v[176:179]
ds_read_b64_tr_b16 a[180:181], v20 offset:4096
v_mul_f32 v233, v225, v233
v_mfma_f32_16x16x32_bf16 v[176:179], a[164:167], a[20:23], v[176:179]
ds_read_b64_tr_b16 a[182:183], v20 offset:6144
v_mul_f32 v234, v226, v234
v_mfma_f32_16x16x32_bf16 v[180:183], a[164:167], v[76:79], 0
ds_read_b64_tr_b16 a[184:185], v20 offset:8192
v_mul_f32 v235, v227, v235
v_mfma_f32_16x16x32_bf16 v[180:183], a[160:163], v[72:75], v[180:183]
ds_read_b64_tr_b16 a[186:187], v20 offset:10240
v_cvt_pk_bf16_f32 v224, v232, v233
v_mfma_f32_16x16x32_bf16 v[180:183], a[156:159], v[68:71], v[180:183]
ds_read_b64_tr_b16 a[188:189], v20 offset:12288
v_cvt_pk_bf16_f32 v225, v234, v235
v_mfma_f32_16x16x32_bf16 v[180:183], a[152:155], v[64:67], v[180:183]
ds_read_b64_tr_b16 a[190:191], v20 offset:14336
v_accvgpr_write_b32 a112, v224
v_mfma_f32_16x16x32_bf16 v[180:183], a[148:151], v[60:63], v[180:183]
ds_read_b64_tr_b16 a[192:193], v22 offset:57344
v_accvgpr_write_b32 a113, v225
v_mfma_f32_16x16x32_bf16 v[180:183], a[144:147], v[56:59], v[180:183]
s_waitcnt lgkmcnt(7)
ds_read_b64_tr_b16 a[194:195], v22 offset:59392
v_mul_f32 v236, v228, v236
v_mfma_f32_16x16x32_bf16 v[140:143], a[168:171], v[56:59], 0
ds_read_b64_tr_b16 a[196:197], v22 offset:61440
v_mul_f32 v237, v229, v237
v_mfma_f32_16x16x32_bf16 v[140:143], a[172:175], v[60:63], v[140:143]
ds_read_b64_tr_b16 a[198:199], v22 offset:63488
v_mul_f32 v238, v230, v238
v_mfma_f32_16x16x32_bf16 v[140:143], a[176:179], v[64:67], v[140:143]
s_waitcnt lgkmcnt(4)
ds_read_b64_tr_b16 a[200:201], v23
ds_read_b64_tr_b16 a[202:203], v23 offset:2048
v_mfma_f32_16x16x32_bf16 v[140:143], a[180:183], v[68:71], v[140:143]
global_load_lds_dwordx4 v14, s[96:97]
v_mfma_f32_16x16x32_bf16 v[140:143], a[184:187], v[72:75], v[140:143]
s_add_u32 m0, s41, 0x5000
ds_read_b64_tr_b16 a[204:205], v23 offset:4096
v_mul_f32 v239, v231, v239
v_mfma_f32_16x16x32_bf16 v[140:143], a[188:191], v[76:79], v[140:143]
s_add_u32 s96, s16, 0x288180
ds_read_b64_tr_b16 a[206:207], v23 offset:6144
v_cvt_pk_bf16_f32 v228, v236, v237
v_mfma_f32_16x16x32_bf16 v[136:139], a[188:191], a[20:23], 0
s_addc_u32 s97, s17, 0
ds_read_b64_tr_b16 a[144:145], v23 offset:8192
ds_read_b64_tr_b16 a[146:147], v23 offset:10240
v_mfma_f32_16x16x32_bf16 v[136:139], a[184:187], a[16:19], v[136:139]
global_load_lds_dwordx4 v14, s[96:97]
v_mfma_f32_16x16x32_bf16 v[136:139], a[180:183], a[12:15], v[136:139]
s_add_u32 m0, s41, 0x6000
ds_read_b64_tr_b16 a[148:149], v23 offset:12288
v_cvt_pk_bf16_f32 v229, v238, v239
v_mfma_f32_16x16x32_bf16 v[136:139], a[176:179], a[8:11], v[136:139]
s_add_u32 s96, s16, 0x2d0180
ds_read_b64_tr_b16 a[150:151], v23 offset:14336
v_accvgpr_write_b32 a116, v228
v_mfma_f32_16x16x32_bf16 v[136:139], a[172:175], a[4:7], v[136:139]
s_addc_u32 s97, s17, 0
ds_read_b64_tr_b16 a[152:153], v25 offset:57344
v_accvgpr_write_b32 a117, v229
v_mfma_f32_16x16x32_bf16 v[136:139], a[168:171], a[0:3], v[136:139]
s_waitcnt lgkmcnt(7)
ds_read_b64_tr_b16 a[154:155], v25 offset:59392
ds_read_b64_tr_b16 a[156:157], v25 offset:61440
v_mfma_f32_16x16x32_bf16 v[152:155], a[192:195], a[0:3], 0
global_load_lds_dwordx4 v14, s[96:97]
v_mfma_f32_16x16x32_bf16 v[152:155], a[196:199], a[4:7], v[152:155]
s_add_u32 m0, s41, 0x7000
ds_read_b64_tr_b16 a[158:159], v25 offset:63488
v_max_f32 v240, 0, v240
v_mfma_f32_16x16x32_bf16 v[152:155], a[200:203], a[8:11], v[152:155]
s_waitcnt lgkmcnt(4)
ds_read_b64_tr_b16 a[160:161], v26
v_max_f32 v241, 0, v241
v_mfma_f32_16x16x32_bf16 v[152:155], a[204:207], a[12:15], v[152:155]
s_add_u32 s96, s16, 0x318180
ds_read_b64_tr_b16 a[162:163], v26 offset:2048
v_max_f32 v242, 0, v242
v_mfma_f32_16x16x32_bf16 v[152:155], a[144:147], a[16:19], v[152:155]
s_addc_u32 s97, s17, 0
ds_read_b64_tr_b16 a[164:165], v26 offset:4096
ds_read_b64_tr_b16 a[166:167], v26 offset:6144
v_mfma_f32_16x16x32_bf16 v[152:155], a[148:151], a[20:23], v[152:155]
global_load_lds_dwordx4 v14, s[96:97]
v_mfma_f32_16x16x32_bf16 v[156:159], a[148:151], v[76:79], 0
s_add_u32 m0, s41, 0x8000
ds_read_b64_tr_b16 a[168:169], v26 offset:8192
v_max_f32 v243, 0, v243
v_mfma_f32_16x16x32_bf16 v[156:159], a[144:147], v[72:75], v[156:159]
s_add_u32 s96, s16, 0x360180
ds_read_b64_tr_b16 a[170:171], v26 offset:10240
v_max_f32 v244, 0, v244
v_mfma_f32_16x16x32_bf16 v[156:159], a[204:207], v[68:71], v[156:159]
s_addc_u32 s97, s17, 0
ds_read_b64_tr_b16 a[172:173], v26 offset:12288
v_max_f32 v245, 0, v245
v_mfma_f32_16x16x32_bf16 v[156:159], a[200:203], v[64:67], v[156:159]
ds_read_b64_tr_b16 a[174:175], v26 offset:14336
ds_read_b64_tr_b16 a[176:177], v28 offset:57344
v_mfma_f32_16x16x32_bf16 v[156:159], a[196:199], v[60:63], v[156:159]
global_load_lds_dwordx4 v14, s[96:97]
v_mfma_f32_16x16x32_bf16 v[156:159], a[192:195], v[56:59], v[156:159]
s_waitcnt lgkmcnt(7)
ds_read_b64_tr_b16 a[178:179], v28 offset:59392
v_max_f32 v246, 0, v246
v_mfma_f32_16x16x32_bf16 v[172:175], a[152:155], v[56:59], 0
s_add_u32 m0, s41, 0x9000
ds_read_b64_tr_b16 a[180:181], v28 offset:61440
v_max_f32 v247, 0, v247
v_mfma_f32_16x16x32_bf16 v[172:175], a[156:159], v[60:63], v[172:175]
s_add_u32 s96, s16, 0x3a8180
ds_read_b64_tr_b16 a[182:183], v28 offset:63488
v_mul_f32 v248, v240, v248
v_mfma_f32_16x16x32_bf16 v[172:175], a[160:163], v[64:67], v[172:175]
s_waitcnt lgkmcnt(4)
ds_read_b64_tr_b16 a[184:185], v29
v_mul_f32 v249, v241, v249
v_mfma_f32_16x16x32_bf16 v[172:175], a[164:167], v[68:71], v[172:175]
s_addc_u32 s97, s17, 0
ds_read_b64_tr_b16 a[186:187], v29 offset:2048
ds_read_b64_tr_b16 a[188:189], v29 offset:4096
v_mfma_f32_16x16x32_bf16 v[172:175], a[168:171], v[72:75], v[172:175]
global_load_lds_dwordx4 v14, s[96:97]
v_mfma_f32_16x16x32_bf16 v[172:175], a[172:175], v[76:79], v[172:175]
s_add_u32 m0, s41, 0xa000
ds_read_b64_tr_b16 a[190:191], v29 offset:6144
v_mul_f32 v250, v242, v250
v_mfma_f32_16x16x32_bf16 v[168:171], a[172:175], a[20:23], 0
s_add_u32 s96, s16, 0x3f0180
ds_read_b64_tr_b16 a[192:193], v29 offset:8192
v_mul_f32 v251, v243, v251
v_mfma_f32_16x16x32_bf16 v[168:171], a[168:171], a[16:19], v[168:171]
s_addc_u32 s97, s17, 0
ds_read_b64_tr_b16 a[194:195], v29 offset:10240
v_cvt_pk_bf16_f32 v240, v248, v249
v_mfma_f32_16x16x32_bf16 v[168:171], a[164:167], a[12:15], v[168:171]
s_waitcnt vmcnt(10)
ds_read_b64_tr_b16 a[196:197], v29 offset:12288
ds_read_b64_tr_b16 a[198:199], v29 offset:14336
v_mfma_f32_16x16x32_bf16 v[168:171], a[160:163], a[8:11], v[168:171]
s_barrier
v_mfma_f32_16x16x32_bf16 v[168:171], a[156:159], a[4:7], v[168:171]
s_and_b32 s94, s2, 1
ds_read_b64_tr_b16 a[200:201], v29 offset:16384
v_cvt_pk_bf16_f32 v241, v250, v251
v_mfma_f32_16x16x32_bf16 v[168:171], a[152:155], a[0:3], v[168:171]
s_waitcnt lgkmcnt(7)
ds_read_b64_tr_b16 a[202:203], v29 offset:18432
ds_read_b64_tr_b16 a[204:205], v29 offset:20480
v_mfma_f32_16x16x32_bf16 v[184:187], a[176:179], a[0:3], 0
global_load_lds_dwordx4 v14, s[96:97]
v_mfma_f32_16x16x32_bf16 v[184:187], a[180:183], a[4:7], v[184:187]
s_lshl_b32 s94, s94, 7
ds_read_b64_tr_b16 a[206:207], v29 offset:22528
v_accvgpr_write_b32 a114, v240
v_mfma_f32_16x16x32_bf16 v[184:187], a[184:187], a[8:11], v[184:187]
s_waitcnt lgkmcnt(4)
ds_read_b64_tr_b16 a[144:145], v29 offset:24576
v_accvgpr_write_b32 a115, v241
v_mfma_f32_16x16x32_bf16 v[184:187], a[188:191], a[12:15], v[184:187]
s_mov_b32 s3, 1
ds_read_b64_tr_b16 a[146:147], v29 offset:26624
v_mul_f32 v252, v244, v252
v_mfma_f32_16x16x32_bf16 v[184:187], a[192:195], a[16:19], v[184:187]
s_cmp_lg_u32 s40, 0
s_cbranch_scc1 L_arr
s_atomic_add s3, s[32:33], s94
L_arr:
ds_read_b64_tr_b16 a[148:149], v29 offset:28672
v_mul_f32 v253, v245, v253
v_mfma_f32_16x16x32_bf16 v[184:187], a[196:199], a[20:23], v[184:187]
s_add_u32 m0, s41, 0xb000
ds_read_b64_tr_b16 a[150:151], v29 offset:30720
v_mul_f32 v254, v246, v254
v_mfma_f32_16x16x32_bf16 v[188:191], a[196:199], v[76:79], 0
s_add_u32 s96, s16, 0x438180
ds_read_b64_tr_b16 a[152:153], v27
v_mul_f32 v255, v247, v255
v_mfma_f32_16x16x32_bf16 v[188:191], a[192:195], v[72:75], v[188:191]
s_addc_u32 s97, s17, 0
ds_read_b64_tr_b16 a[154:155], v27 offset:2048
ds_read_b64_tr_b16 a[156:157], v27 offset:4096
v_mfma_f32_16x16x32_bf16 v[188:191], a[188:191], v[68:71], v[188:191]
global_load_lds_dwordx4 v14, s[96:97]
v_mfma_f32_16x16x32_bf16 v[188:191], a[184:187], v[64:67], v[188:191]
s_add_u32 m0, s41, 0xc000
ds_read_b64_tr_b16 a[158:159], v27 offset:6144
v_cvt_pk_bf16_f32 v244, v252, v253
v_mfma_f32_16x16x32_bf16 v[188:191], a[180:183], v[60:63], v[188:191]
s_add_u32 s96, s16, 0x480180
ds_read_b64_tr_b16 a[160:161], v26 offset:16384
v_cvt_pk_bf16_f32 v245, v254, v255
v_mfma_f32_16x16x32_bf16 v[188:191], a[176:179], v[56:59], v[188:191]
s_waitcnt lgkmcnt(7)
ds_read_b64_tr_b16 a[162:163], v26 offset:18432
v_accvgpr_write_b32 a118, v244
v_mfma_f32_16x16x32_bf16 v[188:191], a[200:203], v[80:83], v[188:191]
s_addc_u32 s97, s17, 0
ds_read_b64_tr_b16 a[164:165], v26 offset:20480
ds_read_b64_tr_b16 a[166:167], v26 offset:22528
v_mfma_f32_16x16x32_bf16 v[188:191], a[204:207], v[84:87], v[188:191]
global_load_lds_dwordx4 v14, s[96:97]
v_mfma_f32_16x16x32_bf16 v[188:191], a[144:147], v[88:91], v[188:191]
s_waitcnt lgkmcnt(4)
ds_read_b64_tr_b16 a[168:169], v26 offset:24576
v_accvgpr_write_b32 a119, v245
v_mfma_f32_16x16x32_bf16 v[188:191], a[148:151], v[92:95], v[188:191]
s_add_u32 m0, s41, 0xd000
ds_read_b64_tr_b16 a[170:171], v26 offset:26624
v_and_b32 v1, 1, v5
v_mfma_f32_16x16x32_bf16 v[188:191], a[152:155], v[96:99], v[188:191]
s_add_u32 s96, s16, 0x4c8180
ds_read_b64_tr_b16 a[172:173], v26 offset:28672
v_lshl_add_u32 v7, v1, 3, v7
v_mfma_f32_16x16x32_bf16 v[188:191], a[156:159], v[100:103], v[188:191]
s_addc_u32 s97, s17, 0
ds_read_b64_tr_b16 a[174:175], v26 offset:30720
ds_read_b64_tr_b16 a[176:177], v24
v_mfma_f32_16x16x32_bf16 v[184:187], a[156:159], a[44:47], v[184:187]
global_load_lds_dwordx4 v14, s[96:97]
v_mfma_f32_16x16x32_bf16 v[184:187], a[152:155], a[40:43], v[184:187]
s_add_u32 m0, s41, 0xe000
ds_read_b64_tr_b16 a[178:179], v24 offset:2048
v_and_b32 v1, 16, v0
v_mfma_f32_16x16x32_bf16 v[184:187], a[148:151], a[36:39], v[184:187]
s_add_u32 s96, s20, 0x360180
ds_read_b64_tr_b16 a[180:181], v24 offset:4096
v_cmp_eq_u32 vcc, 0, v1
v_mfma_f32_16x16x32_bf16 v[184:187], a[144:147], a[32:35], v[184:187]
ds_read_b64_tr_b16 a[182:183], v24 offset:6144
v_cndmask_b32 v7, v2, v7, vcc
v_mfma_f32_16x16x32_bf16 v[184:187], a[204:207], a[28:31], v[184:187]
s_addc_u32 s97, s21, 0
ds_read_b64_tr_b16 a[184:185], v23 offset:16384
v_add_u32 v32, 0, v7
v_mfma_f32_16x16x32_bf16 v[184:187], a[200:203], a[24:27], v[184:187]
s_waitcnt lgkmcnt(7)
ds_read_b64_tr_b16 a[186:187], v23 offset:18432
ds_read_b64_tr_b16 a[188:189], v23 offset:20480
v_mfma_f32_16x16x32_bf16 v[168:171], a[160:163], a[24:27], v[168:171]
global_load_lds_dwordx4 v14, s[96:97]
v_mfma_f32_16x16x32_bf16 v[168:171], a[164:167], a[28:31], v[168:171]
s_add_u32 m0, s41, 0xf000
ds_read_b64_tr_b16 a[190:191], v23 offset:22528
v_add_u32 v7, 4, v6
v_mfma_f32_16x16x32_bf16 v[168:171], a[168:171], a[32:35], v[168:171]
s_waitcnt lgkmcnt(4)
ds_read_b64_tr_b16 a[192:193], v23 offset:24576
v_and_b32 v2, 7, v7
v_mfma_f32_16x16x32_bf16 v[168:171], a[172:175], a[36:39], v[168:171]
s_add_u32 s96, s20, 0x3a8180
ds_read_b64_tr_b16 a[194:195], v23 offset:26624
v_bfe_u32 v1, v7, 4, 1
v_mfma_f32_16x16x32_bf16 v[168:171], a[176:179], a[40:43], v[168:171]
s_addc_u32 s97, s21, 0
ds_read_b64_tr_b16 a[196:197], v23 offset:28672
ds_read_b64_tr_b16 a[198:199], v23 offset:30720
v_mfma_f32_16x16x32_bf16 v[168:171], a[180:183], a[44:47], v[168:171]
global_load_lds_dwordx4 v14, s[96:97]
v_mfma_f32_16x16x32_bf16 v[172:175], a[180:183], v[100:103], v[172:175]
s_add_u32 m0, s41, 0x10000
ds_read_b64_tr_b16 a[200:201], v21
v_lshl_add_u32 v2, v1, 3, v2
v_mfma_f32_16x16x32_bf16 v[172:175], a[176:179], v[96:99], v[172:175]
s_add_u32 s96, s20, 0x3f0180
ds_read_b64_tr_b16 a[202:203], v21 offset:2048
v_bfe_u32 v1, v7, 3, 1
v_mfma_f32_16x16x32_bf16 v[172:175], a[172:175], v[92:95], v[172:175]
s_addc_u32 s97, s21, 0
ds_read_b64_tr_b16 a[204:205], v21 offset:4096
ds_read_b64_tr_b16 a[206:207], v21 offset:6144
v_mfma_f32_16x16x32_bf16 v[172:175], a[168:171], v[88:91], v[172:175]
global_load_lds_dwordx4 v14, s[96:97]
v_mfma_f32_16x16x32_bf16 v[172:175], a[164:167], v[84:87], v[172:175]
s_add_u32 m0, s41, 0x11000
ds_read_b64_tr_b16 a[144:145], v20 offset:16384
v_xor_b32 v1, 1, v1
v_mfma_f32_16x16x32_bf16 v[172:175], a[160:163], v[80:83], v[172:175]
s_waitcnt lgkmcnt(7)
ds_read_b64_tr_b16 a[146:147], v20 offset:18432
v_lshl_add_u32 v2, v1, 4, v2
v_mfma_f32_16x16x32_bf16 v[156:159], a[184:187], v[80:83], v[156:159]
s_add_u32 s96, s20, 0x438180
ds_read_b64_tr_b16 a[148:149], v20 offset:20480
v_lshlrev_b32 v2, 3, v2
v_mfma_f32_16x16x32_bf16 v[156:159], a[188:191], v[84:87], v[156:159]
s_addc_u32 s97, s21, 0
ds_read_b64_tr_b16 a[150:151], v20 offset:22528
v_min_u32 v1, 1, v5
v_mfma_f32_16x16x32_bf16 v[156:159], a[192:195], v[88:91], v[156:159]
s_waitcnt lgkmcnt(4)
ds_read_b64_tr_b16 a[152:153], v20 offset:24576
ds_read_b64_tr_b16 a[154:155], v20 offset:26624
v_mfma_f32_16x16x32_bf16 v[156:159], a[196:199], v[92:95], v[156:159]
global_load_lds_dwordx4 v14, s[96:97]
v_mfma_f32_16x16x32_bf16 v[156:159], a[200:203], v[96:99], v[156:159]
s_add_u32 m0, s41, 0x12000
ds_read_b64_tr_b16 a[156:157], v20 offset:28672
v_mul_u32_u24 v1, 0x30040, v1
v_mfma_f32_16x16x32_bf16 v[156:159], a[204:207], v[100:103], v[156:159]
s_add_u32 s96, s20, 0x480180
ds_read_b64_tr_b16 a[158:159], v20 offset:30720
v_xor_b32 v2, v2, v1
v_mfma_f32_16x16x32_bf16 v[152:155], a[204:207], a[44:47], v[152:155]
s_addc_u32 s97, s21, 0
ds_read_b64_tr_b16 a[160:161], v18
ds_read_b64_tr_b16 a[162:163], v18 offset:2048
v_mfma_f32_16x16x32_bf16 v[152:155], a[200:203], a[40:43], v[152:155]
global_load_lds_dwordx4 v14, s[96:97]
v_mfma_f32_16x16x32_bf16 v[152:155], a[196:199], a[36:39], v[152:155]
s_waitcnt vmcnt(11)
ds_read_b64_tr_b16 a[164:165], v18 offset:4096
ds_read_b64_tr_b16 a[166:167], v18 offset:6144
v_mfma_f32_16x16x32_bf16 v[152:155], a[192:195], a[32:35], v[152:155]
s_barrier
v_mfma_f32_16x16x32_bf16 v[152:155], a[188:191], a[28:31], v[152:155]
s_add_u32 m0, s41, 0x13000
ds_read_b64_tr_b16 a[168:169], v27 offset:8192
v_add_u32 v2, 0x400, v2
v_mfma_f32_16x16x32_bf16 v[152:155], a[184:187], a[24:27], v[152:155]
s_waitcnt lgkmcnt(7)
ds_read_b64_tr_b16 a[170:171], v27 offset:10240
v_lshrrev_b32 v1, 1, v5
v_mfma_f32_16x16x32_bf16 v[136:139], a[144:147], a[24:27], v[136:139]
s_add_u32 s96, s20, 0x4c8180
ds_read_b64_tr_b16 a[172:173], v27 offset:12288
v_mul_u32_u24 v1, 36, v1
v_mfma_f32_16x16x32_bf16 v[136:139], a[148:151], a[28:31], v[136:139]
s_addc_u32 s97, s21, 0
ds_read_b64_tr_b16 a[174:175], v27 offset:14336
v_xor_b32 v7, v7, v1
v_mfma_f32_16x16x32_bf16 v[136:139], a[152:155], a[32:35], v[136:139]
s_waitcnt lgkmcnt(4)
ds_read_b64_tr_b16 a[176:177], v27 offset:16384
ds_read_b64_tr_b16 a[178:179], v27 offset:18432
v_mfma_f32_16x16x32_bf16 v[136:139], a[156:159], a[36:39], v[136:139]
global_load_lds_dwordx4 v14, s[96:97]
v_mfma_f32_16x16x32_bf16 v[136:139], a[160:163], a[40:43], v[136:139]
s_add_u32 m0, s41, 0x14000
ds_read_b64_tr_b16 a[180:181], v27 offset:20480
v_lshlrev_b32 v7, 4, v7
v_mfma_f32_16x16x32_bf16 v[136:139], a[164:167], a[44:47], v[136:139]
s_add_u32 s96, s16, 0
ds_read_b64_tr_b16 a[182:183], v27 offset:22528
v_and_b32 v1, 1, v5
v_mfma_f32_16x16x32_bf16 v[140:143], a[164:167], v[100:103], v[140:143]
s_addc_u32 s97, s17, 0
ds_read_b64_tr_b16 a[184:185], v27 offset:24576
ds_read_b64_tr_b16 a[186:187], v27 offset:26624
v_mfma_f32_16x16x32_bf16 v[140:143], a[160:163], v[96:99], v[140:143]
global_load_lds_dwordx4 v15, s[96:97]
v_mfma_f32_16x16x32_bf16 v[140:143], a[156:159], v[92:95], v[140:143]
s_add_u32 m0, s41, 0x15000
ds_read_b64_tr_b16 a[188:189], v27 offset:28672
v_lshl_add_u32 v7, v1, 3, v7
L_pg8:
s_cbranch_execz L_tr2
v_mfma_f32_16x16x32_bf16 v[140:143], a[152:155], v[88:91], v[140:143]
s_add_u32 s96, s16, 0x90000
ds_read_b64_tr_b16 a[190:191], v27 offset:30720
v_and_b32 v1, 16, v0
v_mfma_f32_16x16x32_bf16 v[140:143], a[148:151], v[84:87], v[140:143]
s_addc_u32 s97, s17, 0
ds_read_b64_tr_b16 a[192:193], v24 offset:8192
v_cmp_eq_u32 vcc, 0, v1
v_mfma_f32_16x16x32_bf16 v[140:143], a[144:147], v[80:83], v[140:143]
s_waitcnt lgkmcnt(7)
ds_read_b64_tr_b16 a[194:195], v24 offset:10240
v_cndmask_b32 v7, v2, v7, vcc
v_mfma_f32_16x16x32_bf16 v[180:183], a[168:171], v[80:83], v[180:183]
ds_read_b64_tr_b16 a[196:197], v24 offset:12288
ds_read_b64_tr_b16 a[198:199], v24 offset:14336
v_mfma_f32_16x16x32_bf16 v[180:183], a[172:175], v[84:87], v[180:183]
global_load_lds_dwordx4 v15, s[96:97]
v_mfma_f32_16x16x32_bf16 v[180:183], a[176:179], v[88:91], v[180:183]
s_waitcnt lgkmcnt(4)
ds_read_b64_tr_b16 a[200:201], v24 offset:16384
v_add_u32 v33, 0, v7
v_mfma_f32_16x16x32_bf16 v[180:183], a[180:183], v[92:95], v[180:183]
s_add_u32 m0, s41, 0x16000
ds_read_b64_tr_b16 a[202:203], v24 offset:18432
v_add_u32 v7, 16, v6
v_mfma_f32_16x16x32_bf16 v[180:183], a[184:187], v[96:99], v[180:183]
s_add_u32 s96, s16, 0x120000
ds_read_b64_tr_b16 a[204:205], v24 offset:20480
v_and_b32 v2, 7, v7
v_mfma_f32_16x16x32_bf16 v[180:183], a[188:191], v[100:103], v[180:183]
s_addc_u32 s97, s17, 0
ds_read_b64_tr_b16 a[206:207], v24 offset:22528
v_bfe_u32 v1, v7, 4, 1
v_mfma_f32_16x16x32_bf16 v[176:179], a[188:191], a[44:47], v[176:179]
ds_read_b64_tr_b16 a[144:145], v24 offset:24576
v_lshl_add_u32 v2, v1, 3, v2
v_mfma_f32_16x16x32_bf16 v[176:179], a[184:187], a[40:43], v[176:179]
ds_read_b64_tr_b16 a[146:147], v24 offset:26624
v_bfe_u32 v1, v7, 3, 1
v_mfma_f32_16x16x32_bf16 v[176:179], a[180:183], a[36:39], v[176:179]
ds_read_b64_tr_b16 a[148:149], v24 offset:28672
v_xor_b32 v1, 1, v1
v_mfma_f32_16x16x32_bf16 v[176:179], a[176:179], a[32:35], v[176:179]
ds_read_b64_tr_b16 a[150:151], v24 offset:30720
ds_read_b64_tr_b16 a[152:153], v21 offset:8192
v_mfma_f32_16x16x32_bf16 v[176:179], a[172:175], a[28:31], v[176:179]
global_load_lds_dwordx4 v15, s[96:97]
v_mfma_f32_16x16x32_bf16 v[176:179], a[168:171], a[24:27], v[176:179]
s_waitcnt lgkmcnt(7)
ds_read_b64_tr_b16 a[154:155], v21 offset:10240
v_lshl_add_u32 v2, v1, 4, v2
v_mfma_f32_16x16x32_bf16 v[160:163], a[192:195], a[24:27], v[160:163]
s_add_u32 m0, s41, 0x17000
ds_read_b64_tr_b16 a[156:157], v21 offset:12288
v_lshlrev_b32 v2, 3, v2
v_mfma_f32_16x16x32_bf16 v[160:163], a[196:199], a[28:31], v[160:163]
s_add_u32 s96, s20, 0
ds_read_b64_tr_b16 a[158:159], v21 offset:14336
v_min_u32 v1, 1, v5
v_mfma_f32_16x16x32_bf16 v[160:163], a[200:203], a[32:35], v[160:163]
s_waitcnt lgkmcnt(4)
ds_read_b64_tr_b16 a[160:161], v21 offset:16384
v_mul_u32_u24 v1, 0x30040, v1
v_mfma_f32_16x16x32_bf16 v[160:163], a[204:207], a[36:39], v[160:163]
s_addc_u32 s97, s21, 0
ds_read_b64_tr_b16 a[162:163], v21 offset:18432
v_xor_b32 v2, v2, v1
v_mfma_f32_16x16x32_bf16 v[160:163], a[144:147], a[40:43], v[160:163]
ds_read_b64_tr_b16 a[164:165], v21 offset:20480
v_add_u32 v2, 0x400, v2
v_mfma_f32_16x16x32_bf16 v[160:163], a[148:151], a[44:47], v[160:163]
ds_read_b64_tr_b16 a[166:167], v21 offset:22528
v_lshrrev_b32 v1, 1, v5
v_mfma_f32_16x16x32_bf16 v[164:167], a[148:151], v[100:103], v[164:167]
ds_read_b64_tr_b16 a[168:169], v21 offset:24576
v_mul_u32_u24 v1, 36, v1
v_mfma_f32_16x16x32_bf16 v[164:167], a[144:147], v[96:99], v[164:167]
ds_read_b64_tr_b16 a[170:171], v21 offset:26624
ds_read_b64_tr_b16 a[172:173], v21 offset:28672
v_mfma_f32_16x16x32_bf16 v[164:167], a[204:207], v[92:95], v[164:167]
global_load_lds_dwordx4 v15, s[96:97]
v_mfma_f32_16x16x32_bf16 v[164:167], a[200:203], v[88:91], v[164:167]
s_add_u32 m0, s41, 0x18000
ds_read_b64_tr_b16 a[174:175], v21 offset:30720
v_xor_b32 v7, v7, v1
v_mfma_f32_16x16x32_bf16 v[164:167], a[196:199], v[84:87], v[164:167]
s_add_u32 s96, s20, 0x90000
ds_read_b64_tr_b16 a[176:177], v18 offset:8192
v_lshlrev_b32 v7, 4, v7
v_mfma_f32_16x16x32_bf16 v[164:167], a[192:195], v[80:83], v[164:167]
s_waitcnt lgkmcnt(7)
ds_read_b64_tr_b16 a[178:179], v18 offset:10240
v_and_b32 v1, 1, v5
v_mfma_f32_16x16x32_bf16 v[148:151], a[152:155], v[80:83], v[148:151]
s_addc_u32 s97, s21, 0
ds_read_b64_tr_b16 a[180:181], v18 offset:12288
v_lshl_add_u32 v7, v1, 3, v7
v_mfma_f32_16x16x32_bf16 v[148:151], a[156:159], v[84:87], v[148:151]
ds_read_b64_tr_b16 a[182:183], v18 offset:14336
v_and_b32 v1, 16, v0
v_mfma_f32_16x16x32_bf16 v[148:151], a[160:163], v[88:91], v[148:151]
s_waitcnt lgkmcnt(4)
ds_read_b64_tr_b16 a[184:185], v18 offset:16384
v_cmp_eq_u32 vcc, 0, v1
v_mfma_f32_16x16x32_bf16 v[148:151], a[164:167], v[92:95], v[148:151]
ds_read_b64_tr_b16 a[186:187], v18 offset:18432
v_cndmask_b32 v7, v2, v7, vcc
v_mfma_f32_16x16x32_bf16 v[148:151], a[168:171], v[96:99], v[148:151]
ds_read_b64_tr_b16 a[188:189], v18 offset:20480
ds_read_b64_tr_b16 a[190:191], v18 offset:22528
v_mfma_f32_16x16x32_bf16 v[148:151], a[172:175], v[100:103], v[148:151]
global_load_lds_dwordx4 v15, s[96:97]
v_mfma_f32_16x16x32_bf16 v[144:147], a[172:175], a[44:47], v[144:147]
s_add_u32 m0, s41, 0x19000
ds_read_b64_tr_b16 a[192:193], v18 offset:24576
v_add_u32 v34, 0, v7
v_mfma_f32_16x16x32_bf16 v[144:147], a[168:171], a[40:43], v[144:147]
s_add_u32 s96, s20, 0x120000
ds_read_b64_tr_b16 a[194:195], v18 offset:26624
v_add_u32 v7, 20, v6
v_mfma_f32_16x16x32_bf16 v[144:147], a[164:167], a[36:39], v[144:147]
s_waitcnt vmcnt(11)
ds_read_b64_tr_b16 a[196:197], v18 offset:28672
ds_read_b64_tr_b16 a[198:199], v18 offset:30720
v_mfma_f32_16x16x32_bf16 v[144:147], a[160:163], a[32:35], v[144:147]
s_barrier
v_mfma_f32_16x16x32_bf16 v[144:147], a[156:159], a[28:31], v[144:147]
s_addc_u32 s97, s21, 0
ds_read_b64_tr_b16 a[200:201], v18 offset:32768
v_and_b32 v2, 7, v7
v_mfma_f32_16x16x32_bf16 v[144:147], a[152:155], a[24:27], v[144:147]
s_waitcnt lgkmcnt(7)
ds_read_b64_tr_b16 a[202:203], v18 offset:34816
v_bfe_u32 v1, v7, 4, 1
v_mfma_f32_16x16x32_bf16 v[128:131], a[176:179], a[24:27], v[128:131]
ds_read_b64_tr_b16 a[204:205], v18 offset:36864
v_lshl_add_u32 v2, v1, 3, v2
v_mfma_f32_16x16x32_bf16 v[128:131], a[180:183], a[28:31], v[128:131]
ds_read_b64_tr_b16 a[206:207], v18 offset:38912
v_bfe_u32 v1, v7, 3, 1
v_mfma_f32_16x16x32_bf16 v[128:131], a[184:187], a[32:35], v[128:131]
s_waitcnt lgkmcnt(4)
ds_read_b64_tr_b16 a[144:145], v18 offset:40960
ds_read_b64_tr_b16 a[146:147], v18 offset:43008
v_mfma_f32_16x16x32_bf16 v[128:131], a[188:191], a[36:39], v[128:131]
global_load_lds_dwordx4 v15, s[96:97]
v_mfma_f32_16x16x32_bf16 v[128:131], a[192:195], a[40:43], v[128:131]
s_add_u32 m0, s41, 0x1a000
ds_read_b64_tr_b16 a[148:149], v18 offset:45056
v_xor_b32 v1, 1, v1
v_mfma_f32_16x16x32_bf16 v[128:131], a[196:199], a[44:47], v[128:131]
s_add_u32 s96, s16, 0x1b0000
ds_read_b64_tr_b16 a[150:151], v18 offset:47104
v_lshl_add_u32 v2, v1, 4, v2
v_mfma_f32_16x16x32_bf16 v[132:135], a[196:199], v[100:103], v[132:135]
s_addc_u32 s97, s17, 0
ds_read_b64_tr_b16 a[152:153], v18 offset:49152
v_lshlrev_b32 v2, 3, v2
v_mfma_f32_16x16x32_bf16 v[132:135], a[192:195], v[96:99], v[132:135]
ds_read_b64_tr_b16 a[154:155], v18 offset:51200
v_min_u32 v1, 1, v5
v_mfma_f32_16x16x32_bf16 v[132:135], a[188:191], v[92:95], v[132:135]
ds_read_b64_tr_b16 a[156:157], v18 offset:53248
v_mul_u32_u24 v1, 0x30040, v1
v_mfma_f32_16x16x32_bf16 v[132:135], a[184:187], v[88:91], v[132:135]
ds_read_b64_tr_b16 a[158:159], v18 offset:55296
v_xor_b32 v2, v2, v1
v_mfma_f32_16x16x32_bf16 v[132:135], a[180:183], v[84:87], v[132:135]
ds_read_b64_tr_b16 a[160:161], v21 offset:32768
v_add_u32 v2, 0x400, v2
v_mfma_f32_16x16x32_bf16 v[132:135], a[176:179], v[80:83], v[132:135]
s_waitcnt lgkmcnt(7)
ds_read_b64_tr_b16 a[162:163], v21 offset:34816
ds_read_b64_tr_b16 a[164:165], v21 offset:36864
v_mfma_f32_16x16x32_bf16 v[132:135], a[200:203], v[104:107], v[132:135]
global_load_lds_dwordx4 v15, s[96:97]
v_mfma_f32_16x16x32_bf16 v[132:135], a[204:207], v[108:111], v[132:135]
s_add_u32 m0, s41, 0x1b000
ds_read_b64_tr_b16 a[166:167], v21 offset:38912
v_lshrrev_b32 v1, 1, v5
v_mfma_f32_16x16x32_bf16 v[132:135], a[144:147], v[112:115], v[132:135]
s_waitcnt lgkmcnt(4)
ds_read_b64_tr_b16 a[168:169], v21 offset:40960
v_mul_u32_u24 v1, 36, v1
v_mfma_f32_16x16x32_bf16 v[132:135], a[148:151], v[116:119], v[132:135]
s_add_u32 s96, s16, 0x240000
ds_read_b64_tr_b16 a[170:171], v21 offset:43008
v_xor_b32 v7, v7, v1
v_mfma_f32_16x16x32_bf16 v[132:135], a[152:155], v[120:123], v[132:135]
s_addc_u32 s97, s17, 0
ds_read_b64_tr_b16 a[172:173], v21 offset:45056
v_lshlrev_b32 v7, 4, v7
v_mfma_f32_16x16x32_bf16 v[132:135], a[156:159], v[124:127], v[132:135]
ds_read_b64_tr_b16 a[174:175], v21 offset:47104
v_and_b32 v1, 1, v5
v_mfma_f32_16x16x32_bf16 v[128:131], a[156:159], a[68:71], v[128:131]
ds_read_b64_tr_b16 a[176:177], v21 offset:49152
v_lshl_add_u32 v7, v1, 3, v7
v_mfma_f32_16x16x32_bf16 v[128:131], a[152:155], a[64:67], v[128:131]
ds_read_b64_tr_b16 a[178:179], v21 offset:51200
v_and_b32 v1, 16, v0
v_mfma_f32_16x16x32_bf16 v[128:131], a[148:151], a[60:63], v[128:131]
ds_read_b64_tr_b16 a[180:181], v21 offset:53248
ds_read_b64_tr_b16 a[182:183], v21 offset:55296
v_mfma_f32_16x16x32_bf16 v[128:131], a[144:147], a[56:59], v[128:131]
global_load_lds_dwordx4 v15, s[96:97]
v_mfma_f32_16x16x32_bf16 v[128:131], a[204:207], a[52:55], v[128:131]
s_add_u32 m0, s41, 0x1c000
ds_read_b64_tr_b16 a[184:185], v24 offset:32768
v_cmp_eq_u32 vcc, 0, v1
v_mfma_f32_16x16x32_bf16 v[128:131], a[200:203], a[48:51], v[128:131]
s_waitcnt lgkmcnt(7)
ds_read_b64_tr_b16 a[186:187], v24 offset:34816
v_cndmask_b32 v7, v2, v7, vcc
v_mfma_f32_16x16x32_bf16 v[144:147], a[160:163], a[48:51], v[144:147]
s_add_u32 s96, s16, 0x2d0000
ds_read_b64_tr_b16 a[188:189], v24 offset:36864
v_add_u32 v35, 0, v7
v_mfma_f32_16x16x32_bf16 v[144:147], a[164:167], a[52:55], v[144:147]
s_addc_u32 s97, s17, 0
ds_read_b64_tr_b16 a[190:191], v24 offset:38912
s_lshl_b32 s46, s2, 2
v_mfma_f32_16x16x32_bf16 v[144:147], a[168:171], a[56:59], v[144:147]
s_waitcnt lgkmcnt(4)
ds_read_b64_tr_b16 a[192:193], v24 offset:40960
s_add_u32 s46, s46, s40
v_mfma_f32_16x16x32_bf16 v[144:147], a[172:175], a[60:63], v[144:147]
s_mul_i32 s46, s46, 0x300
ds_read_b64_tr_b16 a[194:195], v24 offset:43008
v_lshl_add_u32 v5, v0, 7, s46
v_mfma_f32_16x16x32_bf16 v[144:147], a[176:179], a[64:67], v[144:147]
ds_read_b64_tr_b16 a[196:197], v24 offset:45056
v_cmp_gt_u32 vcc, 6, v0
v_mfma_f32_16x16x32_bf16 v[144:147], a[180:183], a[68:71], v[144:147]
ds_read_b64_tr_b16 a[198:199], v24 offset:47104
ds_read_b64_tr_b16 a[200:201], v24 offset:49152
v_mfma_f32_16x16x32_bf16 v[148:151], a[180:183], v[124:127], v[148:151]
global_load_lds_dwordx4 v15, s[96:97]
v_mfma_f32_16x16x32_bf16 v[148:151], a[176:179], v[120:123], v[148:151]
s_add_u32 m0, s41, 0x1d000
ds_read_b64_tr_b16 a[202:203], v24 offset:51200
v_mov_b32 v6, 0x80000000
v_mfma_f32_16x16x32_bf16 v[148:151], a[172:175], v[116:119], v[148:151]
s_add_u32 s96, s20, 0x1b0000
ds_read_b64_tr_b16 a[204:205], v24 offset:53248
v_cndmask_b32 v5, v6, v5, vcc
v_mfma_f32_16x16x32_bf16 v[148:151], a[168:171], v[112:115], v[148:151]
s_addc_u32 s97, s21, 0
ds_read_b64_tr_b16 a[206:207], v24 offset:55296
v_mfma_f32_16x16x32_bf16 v[148:151], a[164:167], v[108:111], v[148:151]
ds_read_b64_tr_b16 a[144:145], v27 offset:32768
v_mfma_f32_16x16x32_bf16 v[148:151], a[160:163], v[104:107], v[148:151]
s_waitcnt lgkmcnt(7)
ds_read_b64_tr_b16 a[146:147], v27 offset:34816
v_mfma_f32_16x16x32_bf16 v[164:167], a[184:187], v[104:107], v[164:167]
ds_read_b64_tr_b16 a[148:149], v27 offset:36864
v_mfma_f32_16x16x32_bf16 v[164:167], a[188:191], v[108:111], v[164:167]
ds_read_b64_tr_b16 a[150:151], v27 offset:38912
v_mfma_f32_16x16x32_bf16 v[164:167], a[192:195], v[112:115], v[164:167]
s_waitcnt lgkmcnt(4)
ds_read_b64_tr_b16 a[152:153], v27 offset:40960
v_mfma_f32_16x16x32_bf16 v[164:167], a[196:199], v[116:119], v[164:167]
ds_read_b64_tr_b16 a[154:155], v27 offset:43008
ds_read_b64_tr_b16 a[156:157], v27 offset:45056
v_mfma_f32_16x16x32_bf16 v[164:167], a[200:203], v[120:123], v[164:167]
buffer_load_dword a255, v5, s[12:15], 0 offen
v_mfma_f32_16x16x32_bf16 v[164:167], a[204:207], v[124:127], v[164:167]
ds_read_b64_tr_b16 a[158:159], v27 offset:47104
v_and_b32 v10, 1, v0
v_mfma_f32_16x16x32_bf16 v[160:163], a[204:207], a[68:71], v[160:163]
ds_read_b64_tr_b16 a[160:161], v27 offset:49152
v_lshlrev_b32 v10, 7, v10
v_mfma_f32_16x16x32_bf16 v[160:163], a[200:203], a[64:67], v[160:163]
ds_read_b64_tr_b16 a[162:163], v27 offset:51200
v_lshrrev_b32 v6, 3, v0
v_mfma_f32_16x16x32_bf16 v[160:163], a[196:199], a[60:63], v[160:163]
s_waitcnt vmcnt(10)
ds_read_b64_tr_b16 a[164:165], v27 offset:53248
ds_read_b64_tr_b16 a[166:167], v27 offset:55296
v_mfma_f32_16x16x32_bf16 v[160:163], a[192:195], a[56:59], v[160:163]
s_barrier
v_mfma_f32_16x16x32_bf16 v[160:163], a[188:191], a[52:55], v[160:163]
ds_read_b64_tr_b16 a[168:169], v18 offset:57344
v_and_b32 v1, 6, v6
v_mfma_f32_16x16x32_bf16 v[160:163], a[184:187], a[48:51], v[160:163]
s_waitcnt lgkmcnt(7)
ds_read_b64_tr_b16 a[170:171], v18 offset:59392
ds_read_b64_tr_b16 a[172:173], v18 offset:61440
v_mfma_f32_16x16x32_bf16 v[176:179], a[144:147], a[48:51], v[176:179]
global_load_lds_dwordx4 v15, s[96:97]
v_mfma_f32_16x16x32_bf16 v[176:179], a[148:151], a[52:55], v[176:179]
s_add_u32 m0, s41, 0x1e000
ds_read_b64_tr_b16 a[174:175], v18 offset:63488
v_and_b32 v5, 7, v0
v_mfma_f32_16x16x32_bf16 v[176:179], a[152:155], a[56:59], v[176:179]
s_waitcnt lgkmcnt(4)
ds_read_b64_tr_b16 a[176:177], v19
v_xor_b32 v5, v5, v1
v_mfma_f32_16x16x32_bf16 v[176:179], a[156:159], a[60:63], v[176:179]
s_add_u32 s96, s20, 0x240000
ds_read_b64_tr_b16 a[178:179], v19 offset:2048
s_addc_u32 s97, s21, 0
v_mfma_f32_16x16x32_bf16 v[176:179], a[160:163], a[64:67], v[176:179]
s_and_b32 s46, s40, 1
ds_read_b64_tr_b16 a[180:181], v19 offset:4096
ds_read_b64_tr_b16 a[182:183], v19 offset:6144
v_mfma_f32_16x16x32_bf16 v[176:179], a[164:167], a[68:71], v[176:179]
global_load_lds_dwordx4 v15, s[96:97]
v_mfma_f32_16x16x32_bf16 v[180:183], a[164:167], v[124:127], v[180:183]
s_add_u32 m0, s41, 0x1f000
ds_read_b64_tr_b16 a[184:185], v19 offset:8192
s_add_u32 s96, s20, 0x2d0000
v_mfma_f32_16x16x32_bf16 v[180:183], a[160:163], v[120:123], v[180:183]
s_addc_u32 s97, s21, 0
ds_read_b64_tr_b16 a[186:187], v19 offset:10240
s_lshr_b32 s47, s40, 1
v_mfma_f32_16x16x32_bf16 v[180:183], a[156:159], v[116:119], v[180:183]
s_mul_i32 s62, s46, 20
ds_read_b64_tr_b16 a[188:189], v19 offset:12288
s_lshl_b32 s63, s47, 3
v_mfma_f32_16x16x32_bf16 v[180:183], a[152:155], v[112:115], v[180:183]
s_add_u32 s62, s62, s63
ds_read_b64_tr_b16 a[190:191], v19 offset:14336
v_add_u32 v7, s62, v6
v_mfma_f32_16x16x32_bf16 v[180:183], a[148:151], v[108:111], v[180:183]
s_mul_i32 s62, s46, 0x120
ds_read_b64_tr_b16 a[192:193], v21 offset:57344
s_mul_i32 s63, s47, 36
v_mfma_f32_16x16x32_bf16 v[180:183], a[144:147], v[104:107], v[180:183]
s_waitcnt lgkmcnt(7)
ds_read_b64_tr_b16 a[194:195], v21 offset:59392
s_add_u32 s62, s62, s63
v_mfma_f32_16x16x32_bf16 v[140:143], a[168:171], v[104:107], v[140:143]
s_add_u32 s62, s62, 16
ds_read_b64_tr_b16 a[196:197], v21 offset:61440
v_lshrrev_b32 v1, 2, v6
v_mfma_f32_16x16x32_bf16 v[140:143], a[172:175], v[108:111], v[140:143]
ds_read_b64_tr_b16 a[198:199], v21 offset:63488
v_mul_u32_u24 v1, 0x90, v1
v_mfma_f32_16x16x32_bf16 v[140:143], a[176:179], v[112:115], v[140:143]
s_waitcnt lgkmcnt(4)
ds_read_b64_tr_b16 a[200:201], v22
ds_read_b64_tr_b16 a[202:203], v22 offset:2048
v_mfma_f32_16x16x32_bf16 v[140:143], a[180:183], v[116:119], v[140:143]
global_load_lds_dwordx4 v15, s[96:97]
v_mfma_f32_16x16x32_bf16 v[140:143], a[184:187], v[120:123], v[140:143]
s_add_u32 m0, s41, 0x20000
ds_read_b64_tr_b16 a[204:205], v22 offset:4096
v_and_b32 v4, 3, v6
v_mfma_f32_16x16x32_bf16 v[140:143], a[188:191], v[124:127], v[140:143]
s_add_u32 s96, s16, 0x360000
ds_read_b64_tr_b16 a[206:207], v22 offset:6144
v_add3_u32 v4, v4, v1, s62
v_mfma_f32_16x16x32_bf16 v[136:139], a[188:191], a[68:71], v[136:139]
s_addc_u32 s97, s17, 0
ds_read_b64_tr_b16 a[144:145], v22 offset:8192
s_and_b32 s46, s45, 7
v_mfma_f32_16x16x32_bf16 v[136:139], a[184:187], a[64:67], v[136:139]
s_lshl_b32 s47, s46, 7
ds_read_b64_tr_b16 a[146:147], v22 offset:10240
v_lshl_add_u32 v2, v5, 4, s47
v_mfma_f32_16x16x32_bf16 v[136:139], a[180:183], a[60:63], v[136:139]
ds_read_b64_tr_b16 a[148:149], v22 offset:12288
v_mul_u32_u24 v1, 0x480, v7
v_mfma_f32_16x16x32_bf16 v[136:139], a[176:179], a[56:59], v[136:139]
ds_read_b64_tr_b16 a[150:151], v22 offset:14336
v_add_u32 v37, v1, v2
v_mfma_f32_16x16x32_bf16 v[136:139], a[172:175], a[52:55], v[136:139]
ds_read_b64_tr_b16 a[152:153], v24 offset:57344
v_mul_u32_u24 v1, 0x480, v4
v_mfma_f32_16x16x32_bf16 v[136:139], a[168:171], a[48:51], v[136:139]
s_waitcnt lgkmcnt(7)
ds_read_b64_tr_b16 a[154:155], v24 offset:59392
ds_read_b64_tr_b16 a[156:157], v24 offset:61440
v_mfma_f32_16x16x32_bf16 v[152:155], a[192:195], a[48:51], v[152:155]
global_load_lds_dwordx4 v15, s[96:97]
v_mfma_f32_16x16x32_bf16 v[152:155], a[196:199], a[52:55], v[152:155]
s_add_u32 m0, s41, 0x21000
ds_read_b64_tr_b16 a[158:159], v24 offset:63488
v_add_u32 v38, v1, v2
v_mfma_f32_16x16x32_bf16 v[152:155], a[200:203], a[56:59], v[152:155]
s_waitcnt lgkmcnt(4)
ds_read_b64_tr_b16 a[160:161], v25
s_add_u32 s96, s16, 0x3f0000
v_mfma_f32_16x16x32_bf16 v[152:155], a[204:207], a[60:63], v[152:155]
s_addc_u32 s97, s17, 0
ds_read_b64_tr_b16 a[162:163], v25 offset:2048
v_max_f32 v128, 0, v128
v_mfma_f32_16x16x32_bf16 v[152:155], a[144:147], a[64:67], v[152:155]
s_lshr_b32 s62, s46, 1
ds_read_b64_tr_b16 a[164:165], v25 offset:4096
v_max_f32 v129, 0, v129
v_mfma_f32_16x16x32_bf16 v[152:155], a[148:151], a[68:71], v[152:155]
s_lshl_b32 s62, s62, 5
ds_read_b64_tr_b16 a[166:167], v25 offset:6144
v_max_f32 v130, 0, v130
v_mfma_f32_16x16x32_bf16 v[156:159], a[148:151], v[124:127], v[156:159]
s_add_u32 s62, s62, 0x400
ds_read_b64_tr_b16 a[168:169], v25 offset:8192
v_max_f32 v131, 0, v131
v_mfma_f32_16x16x32_bf16 v[156:159], a[144:147], v[120:123], v[156:159]
ds_read_b64_tr_b16 a[170:171], v25 offset:10240
v_max_f32 v132, 0, v132
v_mfma_f32_16x16x32_bf16 v[156:159], a[204:207], v[116:119], v[156:159]
ds_read_b64_tr_b16 a[172:173], v25 offset:12288
ds_read_b64_tr_b16 a[174:175], v25 offset:14336
v_mfma_f32_16x16x32_bf16 v[156:159], a[200:203], v[112:115], v[156:159]
global_load_lds_dwordx4 v15, s[96:97]
v_mfma_f32_16x16x32_bf16 v[156:159], a[196:199], v[108:111], v[156:159]
s_add_u32 m0, s41, 0x22000
ds_read_b64_tr_b16 a[176:177], v27 offset:57344
v_max_f32 v133, 0, v133
v_mfma_f32_16x16x32_bf16 v[156:159], a[192:195], v[104:107], v[156:159]
s_waitcnt lgkmcnt(7)
ds_read_b64_tr_b16 a[178:179], v27 offset:59392
v_max_f32 v134, 0, v134
v_mfma_f32_16x16x32_bf16 v[172:175], a[152:155], v[104:107], v[172:175]
s_add_u32 s96, s16, 0x480000
ds_read_b64_tr_b16 a[180:181], v27 offset:61440
v_max_f32 v135, 0, v135
v_mfma_f32_16x16x32_bf16 v[172:175], a[156:159], v[108:111], v[172:175]
s_addc_u32 s97, s17, 0
ds_read_b64_tr_b16 a[182:183], v27 offset:63488
v_mul_f32 v136, v128, v136
v_mfma_f32_16x16x32_bf16 v[172:175], a[160:163], v[112:115], v[172:175]
s_waitcnt lgkmcnt(4)
ds_read_b64_tr_b16 a[184:185], v28
v_mul_f32 v137, v129, v137
v_mfma_f32_16x16x32_bf16 v[172:175], a[164:167], v[116:119], v[172:175]
ds_read_b64_tr_b16 a[186:187], v28 offset:2048
v_mul_f32 v138, v130, v138
v_mfma_f32_16x16x32_bf16 v[172:175], a[168:171], v[120:123], v[172:175]
ds_read_b64_tr_b16 a[188:189], v28 offset:4096
v_mul_f32 v139, v131, v139
v_mfma_f32_16x16x32_bf16 v[172:175], a[172:175], v[124:127], v[172:175]
ds_read_b64_tr_b16 a[190:191], v28 offset:6144
ds_read_b64_tr_b16 a[192:193], v28 offset:8192
v_mfma_f32_16x16x32_bf16 v[168:171], a[172:175], a[68:71], v[168:171]
global_load_lds_dwordx4 v15, s[96:97]
v_mfma_f32_16x16x32_bf16 v[168:171], a[168:171], a[64:67], v[168:171]
s_add_u32 m0, s41, 0x23000
ds_read_b64_tr_b16 a[194:195], v28 offset:10240
v_cvt_pk_bf16_f32 v128, v136, v137
v_mfma_f32_16x16x32_bf16 v[168:171], a[164:167], a[60:63], v[168:171]
s_waitcnt vmcnt(10)
ds_read_b64_tr_b16 a[196:197], v28 offset:12288
ds_read_b64_tr_b16 a[198:199], v28 offset:14336
v_mfma_f32_16x16x32_bf16 v[168:171], a[160:163], a[56:59], v[168:171]
s_barrier
v_mfma_f32_16x16x32_bf16 v[168:171], a[156:159], a[52:55], v[168:171]
s_add_u32 s96, s20, 0x360000
ds_read_b64_tr_b16 a[200:201], v19 offset:16384
v_cvt_pk_bf16_f32 v129, v138, v139
v_mfma_f32_16x16x32_bf16 v[168:171], a[152:155], a[48:51], v[168:171]
s_waitcnt lgkmcnt(7)
ds_read_b64_tr_b16 a[202:203], v19 offset:18432
v_accvgpr_write_b32 a120, v128
v_mfma_f32_16x16x32_bf16 v[184:187], a[176:179], a[48:51], v[184:187]
s_addc_u32 s97, s21, 0
ds_read_b64_tr_b16 a[204:205], v25 offset:16384
v_accvgpr_write_b32 a121, v129
v_mfma_f32_16x16x32_bf16 v[184:187], a[180:183], a[52:55], v[184:187]
ds_read_b64_tr_b16 a[206:207], v25 offset:18432
v_mul_f32 v140, v132, v140
v_mfma_f32_16x16x32_bf16 v[184:187], a[184:187], a[56:59], v[184:187]
s_waitcnt lgkmcnt(4)
ds_read_b64_tr_b16 a[144:145], v19 offset:20480
v_mul_f32 v141, v133, v141
v_mfma_f32_16x16x32_bf16 v[184:187], a[188:191], a[60:63], v[184:187]
ds_read_b64_tr_b16 a[146:147], v19 offset:22528
ds_read_b64_tr_b16 a[148:149], v25 offset:20480
v_mfma_f32_16x16x32_bf16 v[184:187], a[192:195], a[64:67], v[184:187]
global_load_lds_dwordx4 v15, s[96:97]
v_mfma_f32_16x16x32_bf16 v[184:187], a[196:199], a[68:71], v[184:187]
s_add_u32 m0, s41, 0x24000
ds_read_b64_tr_b16 a[150:151], v25 offset:22528
v_mul_f32 v142, v134, v142
v_mfma_f32_16x16x32_bf16 v[188:191], a[196:199], v[124:127], v[188:191]
s_add_u32 s96, s20, 0x3f0000
ds_read_b64_tr_b16 a[152:153], v19 offset:24576
v_mul_f32 v143, v135, v143
v_mfma_f32_16x16x32_bf16 v[188:191], a[192:195], v[120:123], v[188:191]
s_addc_u32 s97, s21, 0
ds_read_b64_tr_b16 a[154:155], v19 offset:26624
v_cvt_pk_bf16_f32 v132, v140, v141
v_mfma_f32_16x16x32_bf16 v[188:191], a[188:191], v[116:119], v[188:191]
ds_read_b64_tr_b16 a[156:157], v25 offset:24576
v_cvt_pk_bf16_f32 v133, v142, v143
v_mfma_f32_16x16x32_bf16 v[188:191], a[184:187], v[112:115], v[188:191]
ds_read_b64_tr_b16 a[158:159], v25 offset:26624
v_accvgpr_write_b32 a124, v132
v_mfma_f32_16x16x32_bf16 v[188:191], a[180:183], v[108:111], v[188:191]
ds_read_b64_tr_b16 a[160:161], v22 offset:16384
v_accvgpr_write_b32 a125, v133
v_mfma_f32_16x16x32_bf16 v[188:191], a[176:179], v[104:107], v[188:191]
s_waitcnt lgkmcnt(7)
ds_read_b64_tr_b16 a[162:163], v22 offset:18432
v_max_f32 v144, 0, v144
v_mfma_f32_16x16x32_bf16 v[228:231], a[200:203], v[56:59], 0
ds_read_b64_tr_b16 a[164:165], v28 offset:16384
ds_read_b64_tr_b16 a[166:167], v28 offset:18432
v_mfma_f32_16x16x32_bf16 v[228:231], a[204:207], v[60:63], v[228:231]
global_load_lds_dwordx4 v15, s[96:97]
v_mfma_f32_16x16x32_bf16 v[228:231], a[144:147], v[64:67], v[228:231]
s_waitcnt lgkmcnt(4)
ds_read_b64_tr_b16 a[168:169], v22 offset:20480
v_max_f32 v145, 0, v145
v_mfma_f32_16x16x32_bf16 v[228:231], a[148:151], v[68:71], v[228:231]
s_add_u32 m0, s41, 0x25000
ds_read_b64_tr_b16 a[170:171], v22 offset:22528
v_max_f32 v146, 0, v146
v_mfma_f32_16x16x32_bf16 v[228:231], a[152:155], v[72:75], v[228:231]
s_add_u32 s96, s20, 0x480000
ds_read_b64_tr_b16 a[172:173], v28 offset:20480
v_max_f32 v147, 0, v147
v_mfma_f32_16x16x32_bf16 v[228:231], a[156:159], v[76:79], v[228:231]
s_addc_u32 s97, s21, 0
ds_read_b64_tr_b16 a[174:175], v28 offset:22528
v_max_f32 v148, 0, v148
v_mfma_f32_16x16x32_bf16 v[224:227], a[156:159], a[20:23], 0
ds_read_b64_tr_b16 a[176:177], v22 offset:24576
v_max_f32 v149, 0, v149
v_mfma_f32_16x16x32_bf16 v[224:227], a[152:155], a[16:19], v[224:227]
ds_read_b64_tr_b16 a[178:179], v22 offset:26624
v_max_f32 v150, 0, v150
v_mfma_f32_16x16x32_bf16 v[224:227], a[148:151], a[12:15], v[224:227]
ds_read_b64_tr_b16 a[180:181], v28 offset:24576
v_max_f32 v151, 0, v151
v_mfma_f32_16x16x32_bf16 v[224:227], a[144:147], a[8:11], v[224:227]
ds_read_b64_tr_b16 a[182:183], v28 offset:26624
v_mul_f32 v152, v144, v152
v_mfma_f32_16x16x32_bf16 v[224:227], a[204:207], a[4:7], v[224:227]
ds_read_b64_tr_b16 a[184:185], v19 offset:28672
v_mul_f32 v153, v145, v153
v_mfma_f32_16x16x32_bf16 v[224:227], a[200:203], a[0:3], v[224:227]
s_waitcnt lgkmcnt(7)
ds_read_b64_tr_b16 a[186:187], v19 offset:30720
ds_read_b64_tr_b16 a[188:189], v25 offset:28672
v_mfma_f32_16x16x32_bf16 v[240:243], a[160:163], a[0:3], 0
global_load_lds_dwordx4 v15, s[96:97]
v_mfma_f32_16x16x32_bf16 v[240:243], a[164:167], a[4:7], v[240:243]
s_add_u32 m0, s41, 0x26000
ds_read_b64_tr_b16 a[190:191], v25 offset:30720
v_mul_f32 v154, v146, v154
v_mfma_f32_16x16x32_bf16 v[240:243], a[168:171], a[8:11], v[240:243]
s_waitcnt lgkmcnt(4)
ds_read_b64_tr_b16 a[192:193], v19 offset:32768
v_mul_f32 v155, v147, v155
v_mfma_f32_16x16x32_bf16 v[240:243], a[172:175], a[12:15], v[240:243]
s_add_u32 s96, s24, 0
ds_read_b64_tr_b16 a[194:195], v19 offset:34816
v_cvt_pk_bf16_f32 v144, v152, v153
v_mfma_f32_16x16x32_bf16 v[240:243], a[176:179], a[16:19], v[240:243]
s_addc_u32 s97, s25, 0
ds_read_b64_tr_b16 a[196:197], v25 offset:32768
v_cvt_pk_bf16_f32 v145, v154, v155
v_mfma_f32_16x16x32_bf16 v[240:243], a[180:183], a[20:23], v[240:243]
ds_read_b64_tr_b16 a[198:199], v25 offset:34816
v_accvgpr_write_b32 a122, v144
v_mfma_f32_16x16x32_bf16 v[244:247], a[180:183], v[76:79], 0
ds_read_b64_tr_b16 a[200:201], v19 offset:36864
v_accvgpr_write_b32 a123, v145
v_mfma_f32_16x16x32_bf16 v[244:247], a[176:179], v[72:75], v[244:247]
ds_read_b64_tr_b16 a[202:203], v19 offset:38912
ds_read_b64_tr_b16 a[204:205], v25 offset:36864
v_mfma_f32_16x16x32_bf16 v[244:247], a[172:175], v[68:71], v[244:247]
global_load_lds_dwordx4 v16, s[96:97]
v_mfma_f32_16x16x32_bf16 v[244:247], a[168:171], v[64:67], v[244:247]
s_add_u32 m0, s41, 0x27000
ds_read_b64_tr_b16 a[206:207], v25 offset:38912
v_mul_f32 v156, v148, v156
v_mfma_f32_16x16x32_bf16 v[244:247], a[164:167], v[60:63], v[244:247]
s_add_u32 s96, s24, 0x9000
ds_read_b64_tr_b16 a[144:145], v22 offset:28672
v_mul_f32 v157, v149, v157
v_mfma_f32_16x16x32_bf16 v[244:247], a[160:163], v[56:59], v[244:247]
s_waitcnt lgkmcnt(7)
ds_read_b64_tr_b16 a[146:147], v22 offset:30720
v_mul_f32 v158, v150, v158
v_mfma_f32_16x16x32_bf16 v[236:239], a[184:187], v[56:59], 0
s_addc_u32 s97, s25, 0
ds_read_b64_tr_b16 a[148:149], v28 offset:28672
ds_read_b64_tr_b16 a[150:151], v28 offset:30720
v_mfma_f32_16x16x32_bf16 v[236:239], a[188:191], v[60:63], v[236:239]
global_load_lds_dwordx4 v16, s[96:97]
L_pg9:
s_cbranch_execz L_tr2
v_mfma_f32_16x16x32_bf16 v[236:239], a[192:195], v[64:67], v[236:239]
s_waitcnt lgkmcnt(4)
ds_read_b64_tr_b16 a[152:153], v22 offset:32768
v_mul_f32 v159, v151, v159
v_mfma_f32_16x16x32_bf16 v[236:239], a[196:199], v[68:71], v[236:239]
s_add_u32 m0, s41, 0
ds_read_b64_tr_b16 a[154:155], v22 offset:34816
v_cvt_pk_bf16_f32 v148, v156, v157
v_mfma_f32_16x16x32_bf16 v[236:239], a[200:203], v[72:75], v[236:239]
s_add_u32 s96, s24, 0x12000
ds_read_b64_tr_b16 a[156:157], v28 offset:32768
v_cvt_pk_bf16_f32 v149, v158, v159
v_mfma_f32_16x16x32_bf16 v[236:239], a[204:207], v[76:79], v[236:239]
s_addc_u32 s97, s25, 0
ds_read_b64_tr_b16 a[158:159], v28 offset:34816
ds_read_b64_tr_b16 a[160:161], v22 offset:36864
v_mfma_f32_16x16x32_bf16 v[232:235], a[204:207], a[20:23], 0
global_load_lds_dwordx4 v16, s[96:97]
v_mfma_f32_16x16x32_bf16 v[232:235], a[200:203], a[16:19], v[232:235]
s_add_u32 m0, s41, 0x1000
ds_read_b64_tr_b16 a[162:163], v22 offset:38912
v_accvgpr_write_b32 a126, v148
v_mfma_f32_16x16x32_bf16 v[232:235], a[196:199], a[12:15], v[232:235]
s_waitcnt vmcnt(9)
ds_read_b64_tr_b16 a[164:165], v28 offset:36864
ds_read_b64_tr_b16 a[166:167], v28 offset:38912
v_mfma_f32_16x16x32_bf16 v[232:235], a[192:195], a[8:11], v[232:235]
s_barrier
v_mfma_f32_16x16x32_bf16 v[232:235], a[188:191], a[4:7], v[232:235]
s_add_u32 s96, s24, 0x1b000
ds_read_b64_tr_b16 a[168:169], v19 offset:40960
v_accvgpr_write_b32 a127, v149
v_mfma_f32_16x16x32_bf16 v[232:235], a[184:187], a[0:3], v[232:235]
s_waitcnt lgkmcnt(7)
ds_read_b64_tr_b16 a[170:171], v19 offset:43008
v_max_f32 v160, 0, v160
v_mfma_f32_16x16x32_bf16 v[248:251], a[144:147], a[0:3], 0
s_addc_u32 s97, s25, 0
ds_read_b64_tr_b16 a[172:173], v25 offset:40960
ds_read_b64_tr_b16 a[174:175], v25 offset:43008
v_mfma_f32_16x16x32_bf16 v[248:251], a[148:151], a[4:7], v[248:251]
global_load_lds_dwordx4 v16, s[96:97]
v_mfma_f32_16x16x32_bf16 v[248:251], a[152:155], a[8:11], v[248:251]
s_waitcnt lgkmcnt(4)
ds_read_b64_tr_b16 a[176:177], v19 offset:45056
v_max_f32 v161, 0, v161
v_mfma_f32_16x16x32_bf16 v[248:251], a[156:159], a[12:15], v[248:251]
s_add_u32 m0, s41, 0x2000
ds_read_b64_tr_b16 a[178:179], v19 offset:47104
v_max_f32 v162, 0, v162
v_mfma_f32_16x16x32_bf16 v[248:251], a[160:163], a[16:19], v[248:251]
s_add_u32 s96, s24, 0x24000
ds_read_b64_tr_b16 a[180:181], v25 offset:45056
v_max_f32 v163, 0, v163
v_mfma_f32_16x16x32_bf16 v[248:251], a[164:167], a[20:23], v[248:251]
s_addc_u32 s97, s25, 0
ds_read_b64_tr_b16 a[182:183], v25 offset:47104
ds_read_b64_tr_b16 a[184:185], v19 offset:49152
v_mfma_f32_16x16x32_bf16 v[252:255], a[164:167], v[76:79], 0
global_load_lds_dwordx4 v16, s[96:97]
v_mfma_f32_16x16x32_bf16 v[252:255], a[160:163], v[72:75], v[252:255]
s_add_u32 m0, s41, 0x3000
ds_read_b64_tr_b16 a[186:187], v19 offset:51200
v_max_f32 v164, 0, v164
v_mfma_f32_16x16x32_bf16 v[252:255], a[156:159], v[68:71], v[252:255]
s_add_u32 s96, s24, 0x2d000
ds_read_b64_tr_b16 a[188:189], v25 offset:49152
v_max_f32 v165, 0, v165
v_mfma_f32_16x16x32_bf16 v[252:255], a[152:155], v[64:67], v[252:255]
s_addc_u32 s97, s25, 0
ds_read_b64_tr_b16 a[190:191], v25 offset:51200
ds_read_b64_tr_b16 a[192:193], v22 offset:40960
v_mfma_f32_16x16x32_bf16 v[252:255], a[148:151], v[60:63], v[252:255]
global_load_lds_dwordx4 v16, s[96:97]
v_mfma_f32_16x16x32_bf16 v[252:255], a[144:147], v[56:59], v[252:255]
s_waitcnt lgkmcnt(7)
ds_read_b64_tr_b16 a[194:195], v22 offset:43008
v_max_f32 v166, 0, v166
v_mfma_f32_16x16x32_bf16 v[228:231], a[168:171], v[80:83], v[228:231]
s_add_u32 m0, s41, 0x4000
ds_read_b64_tr_b16 a[196:197], v28 offset:40960
v_max_f32 v167, 0, v167
v_mfma_f32_16x16x32_bf16 v[228:231], a[172:175], v[84:87], v[228:231]
s_add_u32 s96, s24, 0x80
ds_read_b64_tr_b16 a[198:199], v28 offset:43008
v_mul_f32 v168, v160, v168
v_mfma_f32_16x16x32_bf16 v[228:231], a[176:179], v[88:91], v[228:231]
s_waitcnt lgkmcnt(4)
ds_read_b64_tr_b16 a[200:201], v22 offset:45056
v_mul_f32 v169, v161, v169
v_mfma_f32_16x16x32_bf16 v[228:231], a[180:183], v[92:95], v[228:231]
s_addc_u32 s97, s25, 0
ds_read_b64_tr_b16 a[202:203], v22 offset:47104
ds_read_b64_tr_b16 a[204:205], v28 offset:45056
v_mfma_f32_16x16x32_bf16 v[228:231], a[184:187], v[96:99], v[228:231]
global_load_lds_dwordx4 v16, s[96:97]
v_mfma_f32_16x16x32_bf16 v[228:231], a[188:191], v[100:103], v[228:231]
s_add_u32 m0, s41, 0x5000
ds_read_b64_tr_b16 a[206:207], v28 offset:47104
v_mul_f32 v170, v162, v170
v_mfma_f32_16x16x32_bf16 v[224:227], a[188:191], a[44:47], v[224:227]
s_add_u32 s96, s24, 0x9080
ds_read_b64_tr_b16 a[144:145], v22 offset:49152
v_mul_f32 v171, v163, v171
v_mfma_f32_16x16x32_bf16 v[224:227], a[184:187], a[40:43], v[224:227]
s_addc_u32 s97, s25, 0
ds_read_b64_tr_b16 a[146:147], v22 offset:51200
ds_read_b64_tr_b16 a[148:149], v28 offset:49152
v_mfma_f32_16x16x32_bf16 v[224:227], a[180:183], a[36:39], v[224:227]
global_load_lds_dwordx4 v16, s[96:97]
v_mfma_f32_16x16x32_bf16 v[224:227], a[176:179], a[32:35], v[224:227]
s_add_u32 m0, s41, 0x6000
ds_read_b64_tr_b16 a[150:151], v28 offset:51200
v_cvt_pk_bf16_f32 v160, v168, v169
v_mfma_f32_16x16x32_bf16 v[224:227], a[172:175], a[28:31], v[224:227]
s_add_u32 s96, s24, 0x12080
ds_read_b64_tr_b16 a[152:153], v19 offset:53248
v_cvt_pk_bf16_f32 v161, v170, v171
v_mfma_f32_16x16x32_bf16 v[224:227], a[168:171], a[24:27], v[224:227]
s_waitcnt lgkmcnt(7)
ds_read_b64_tr_b16 a[154:155], v19 offset:55296
v_accvgpr_write_b32 a128, v160
v_mfma_f32_16x16x32_bf16 v[240:243], a[192:195], a[24:27], v[240:243]
s_addc_u32 s97, s25, 0
ds_read_b64_tr_b16 a[156:157], v25 offset:53248
ds_read_b64_tr_b16 a[158:159], v25 offset:55296
v_mfma_f32_16x16x32_bf16 v[240:243], a[196:199], a[28:31], v[240:243]
global_load_lds_dwordx4 v16, s[96:97]
v_mfma_f32_16x16x32_bf16 v[240:243], a[200:203], a[32:35], v[240:243]
s_waitcnt lgkmcnt(4)
ds_read_b64_tr_b16 a[160:161], v19 offset:57344
v_accvgpr_write_b32 a129, v161
v_mfma_f32_16x16x32_bf16 v[240:243], a[204:207], a[36:39], v[240:243]
s_add_u32 m0, s41, 0x7000
ds_read_b64_tr_b16 a[162:163], v19 offset:59392
v_mul_f32 v172, v164, v172
v_mfma_f32_16x16x32_bf16 v[240:243], a[144:147], a[40:43], v[240:243]
s_add_u32 s96, s24, 0x1b080
ds_read_b64_tr_b16 a[164:165], v25 offset:57344
v_mul_f32 v173, v165, v173
v_mfma_f32_16x16x32_bf16 v[240:243], a[148:151], a[44:47], v[240:243]
s_addc_u32 s97, s25, 0
ds_read_b64_tr_b16 a[166:167], v25 offset:59392
ds_read_b64_tr_b16 a[168:169], v19 offset:61440
v_mfma_f32_16x16x32_bf16 v[244:247], a[148:151], v[100:103], v[244:247]
global_load_lds_dwordx4 v16, s[96:97]
v_mfma_f32_16x16x32_bf16 v[244:247], a[144:147], v[96:99], v[244:247]
s_add_u32 m0, s41, 0x8000
ds_read_b64_tr_b16 a[170:171], v19 offset:63488
v_mul_f32 v174, v166, v174
v_mfma_f32_16x16x32_bf16 v[244:247], a[204:207], v[92:95], v[244:247]
s_add_u32 s96, s24, 0x24080
ds_read_b64_tr_b16 a[172:173], v25 offset:61440
v_mul_f32 v175, v167, v175
v_mfma_f32_16x16x32_bf16 v[244:247], a[200:203], v[88:91], v[244:247]
s_addc_u32 s97, s25, 0
ds_read_b64_tr_b16 a[174:175], v25 offset:63488
ds_read_b64_tr_b16 a[176:177], v22 offset:53248
v_mfma_f32_16x16x32_bf16 v[244:247], a[196:199], v[84:87], v[244:247]
global_load_lds_dwordx4 v16, s[96:97]
v_mfma_f32_16x16x32_bf16 v[244:247], a[192:195], v[80:83], v[244:247]
s_waitcnt lgkmcnt(7)
ds_read_b64_tr_b16 a[178:179], v22 offset:55296
v_cvt_pk_bf16_f32 v164, v172, v173
v_mfma_f32_16x16x32_bf16 v[236:239], a[152:155], v[80:83], v[236:239]
s_add_u32 m0, s41, 0x9000
ds_read_b64_tr_b16 a[180:181], v28 offset:53248
v_cvt_pk_bf16_f32 v165, v174, v175
v_mfma_f32_16x16x32_bf16 v[236:239], a[156:159], v[84:87], v[236:239]
s_add_u32 s96, s24, 0x2d080
ds_read_b64_tr_b16 a[182:183], v28 offset:55296
v_accvgpr_write_b32 a132, v164
v_mfma_f32_16x16x32_bf16 v[236:239], a[160:163], v[88:91], v[236:239]
s_waitcnt lgkmcnt(4)
ds_read_b64_tr_b16 a[184:185], v22 offset:57344
v_accvgpr_write_b32 a133, v165
v_mfma_f32_16x16x32_bf16 v[236:239], a[164:167], v[92:95], v[236:239]
s_addc_u32 s97, s25, 0
ds_read_b64_tr_b16 a[186:187], v22 offset:59392
ds_read_b64_tr_b16 a[188:189], v28 offset:57344
v_mfma_f32_16x16x32_bf16 v[236:239], a[168:171], v[96:99], v[236:239]
global_load_lds_dwordx4 v16, s[96:97]
v_mfma_f32_16x16x32_bf16 v[236:239], a[172:175], v[100:103], v[236:239]
s_add_u32 m0, s41, 0xa000
ds_read_b64_tr_b16 a[190:191], v28 offset:59392
v_max_f32 v176, 0, v176
v_mfma_f32_16x16x32_bf16 v[232:235], a[172:175], a[44:47], v[232:235]
s_add_u32 s96, s24, 0x36000
ds_read_b64_tr_b16 a[192:193], v22 offset:61440
v_max_f32 v177, 0, v177
v_mfma_f32_16x16x32_bf16 v[232:235], a[168:171], a[40:43], v[232:235]
s_addc_u32 s97, s25, 0
ds_read_b64_tr_b16 a[194:195], v22 offset:63488
v_max_f32 v178, 0, v178
v_mfma_f32_16x16x32_bf16 v[232:235], a[164:167], a[36:39], v[232:235]
s_waitcnt vmcnt(12)
ds_read_b64_tr_b16 a[196:197], v28 offset:61440
ds_read_b64_tr_b16 a[198:199], v28 offset:63488
v_mfma_f32_16x16x32_bf16 v[232:235], a[160:163], a[32:35], v[232:235]
s_barrier
v_mfma_f32_16x16x32_bf16 v[232:235], a[156:159], a[28:31], v[232:235]
ds_read_b64_tr_b16 a[200:201], v20
v_max_f32 v179, 0, v179
v_mfma_f32_16x16x32_bf16 v[232:235], a[152:155], a[24:27], v[232:235]
s_waitcnt lgkmcnt(7)
ds_read_b64_tr_b16 a[202:203], v20 offset:2048
ds_read_b64_tr_b16 a[204:205], v26
v_mfma_f32_16x16x32_bf16 v[248:251], a[176:179], a[24:27], v[248:251]
global_load_lds_dwordx4 v16, s[96:97]
v_mfma_f32_16x16x32_bf16 v[248:251], a[180:183], a[28:31], v[248:251]
s_add_u32 m0, s41, 0xb000
ds_read_b64_tr_b16 a[206:207], v26 offset:2048
v_max_f32 v180, 0, v180
v_mfma_f32_16x16x32_bf16 v[248:251], a[184:187], a[32:35], v[248:251]
s_waitcnt lgkmcnt(4)
ds_read_b64_tr_b16 a[144:145], v20 offset:4096
v_max_f32 v181, 0, v181
v_mfma_f32_16x16x32_bf16 v[248:251], a[188:191], a[36:39], v[248:251]
s_add_u32 s96, s24, 0x3f000
ds_read_b64_tr_b16 a[146:147], v20 offset:6144
v_max_f32 v182, 0, v182
v_mfma_f32_16x16x32_bf16 v[248:251], a[192:195], a[40:43], v[248:251]
s_addc_u32 s97, s25, 0
ds_read_b64_tr_b16 a[148:149], v26 offset:4096
ds_read_b64_tr_b16 a[150:151], v26 offset:6144
v_mfma_f32_16x16x32_bf16 v[248:251], a[196:199], a[44:47], v[248:251]
global_load_lds_dwordx4 v16, s[96:97]
v_mfma_f32_16x16x32_bf16 v[252:255], a[196:199], v[100:103], v[252:255]
s_add_u32 m0, s41, 0xc000
ds_read_b64_tr_b16 a[152:153], v20 offset:8192
v_max_f32 v183, 0, v183
v_mfma_f32_16x16x32_bf16 v[252:255], a[192:195], v[96:99], v[252:255]
s_add_u32 s96, s24, 0
ds_read_b64_tr_b16 a[154:155], v20 offset:10240
v_mul_f32 v184, v176, v184
v_mfma_f32_16x16x32_bf16 v[252:255], a[188:191], v[92:95], v[252:255]
s_addc_u32 s97, s25, 0
ds_read_b64_tr_b16 a[156:157], v26 offset:8192
ds_read_b64_tr_b16 a[158:159], v26 offset:10240
v_mfma_f32_16x16x32_bf16 v[252:255], a[184:187], v[88:91], v[252:255]
global_load_lds_dwordx4 v17, s[96:97]
v_mfma_f32_16x16x32_bf16 v[252:255], a[180:183], v[84:87], v[252:255]
s_add_u32 m0, s41, 0xd000
ds_read_b64_tr_b16 a[160:161], v20 offset:12288
v_mul_f32 v185, v177, v185
v_mfma_f32_16x16x32_bf16 v[252:255], a[176:179], v[80:83], v[252:255]
s_waitcnt lgkmcnt(7)
ds_read_b64_tr_b16 a[162:163], v20 offset:14336
v_mul_f32 v186, v178, v186
v_mfma_f32_16x16x32_bf16 v[228:231], a[200:203], v[104:107], v[228:231]
s_add_u32 s96, s24, 0x36080
ds_read_b64_tr_b16 a[164:165], v26 offset:12288
v_mul_f32 v187, v179, v187
v_mfma_f32_16x16x32_bf16 v[228:231], a[204:207], v[108:111], v[228:231]
s_addc_u32 s97, s25, 0
ds_read_b64_tr_b16 a[166:167], v26 offset:14336
v_cvt_pk_bf16_f32 v176, v184, v185
v_mfma_f32_16x16x32_bf16 v[228:231], a[144:147], v[112:115], v[228:231]
s_waitcnt lgkmcnt(4)
ds_read_b64_tr_b16 a[168:169], v20 offset:16384
ds_read_b64_tr_b16 a[170:171], v20 offset:18432
v_mfma_f32_16x16x32_bf16 v[228:231], a[148:151], v[116:119], v[228:231]
global_load_lds_dwordx4 v16, s[96:97]
v_mfma_f32_16x16x32_bf16 v[228:231], a[152:155], v[120:123], v[228:231]
s_add_u32 m0, s41, 0xe000
ds_read_b64_tr_b16 a[172:173], v26 offset:16384
v_cvt_pk_bf16_f32 v177, v186, v187
v_mfma_f32_16x16x32_bf16 v[228:231], a[156:159], v[124:127], v[228:231]
s_add_u32 s96, s24, 0x3f080
ds_read_b64_tr_b16 a[174:175], v26 offset:18432
v_accvgpr_write_b32 a130, v176
v_mfma_f32_16x16x32_bf16 v[224:227], a[156:159], a[68:71], v[224:227]
s_addc_u32 s97, s25, 0
ds_read_b64_tr_b16 a[176:177], v20 offset:20480
ds_read_b64_tr_b16 a[178:179], v20 offset:22528
v_mfma_f32_16x16x32_bf16 v[224:227], a[152:155], a[64:67], v[224:227]
global_load_lds_dwordx4 v16, s[96:97]
v_mfma_f32_16x16x32_bf16 v[224:227], a[148:151], a[60:63], v[224:227]
s_add_u32 m0, s41, 0xf000
ds_read_b64_tr_b16 a[180:181], v26 offset:20480
v_accvgpr_write_b32 a131, v177
v_mfma_f32_16x16x32_bf16 v[224:227], a[144:147], a[56:59], v[224:227]
s_add_u32 s96, s24, 0x80
ds_read_b64_tr_b16 a[182:183], v26 offset:22528
v_mul_f32 v188, v180, v188
v_mfma_f32_16x16x32_bf16 v[224:227], a[204:207], a[52:55], v[224:227]
s_addc_u32 s97, s25, 0
ds_read_b64_tr_b16 a[184:185], v23
v_mul_f32 v189, v181, v189
v_mfma_f32_16x16x32_bf16 v[224:227], a[200:203], a[48:51], v[224:227]
s_waitcnt lgkmcnt(7)
ds_read_b64_tr_b16 a[186:187], v23 offset:2048
ds_read_b64_tr_b16 a[188:189], v29
v_mfma_f32_16x16x32_bf16 v[232:235], a[160:163], a[48:51], v[232:235]
global_load_lds_dwordx4 v17, s[96:97]
v_mfma_f32_16x16x32_bf16 v[232:235], a[164:167], a[52:55], v[232:235]
s_add_u32 m0, s41, 0x10000
ds_read_b64_tr_b16 a[190:191], v29 offset:2048
v_mul_f32 v190, v182, v190
v_mfma_f32_16x16x32_bf16 v[232:235], a[168:171], a[56:59], v[232:235]
s_waitcnt lgkmcnt(4)
ds_read_b64_tr_b16 a[192:193], v23 offset:4096
v_mul_f32 v191, v183, v191
v_mfma_f32_16x16x32_bf16 v[232:235], a[172:175], a[60:63], v[232:235]
s_add_u32 s96, s24, 0x100
ds_read_b64_tr_b16 a[194:195], v23 offset:6144
v_cvt_pk_bf16_f32 v180, v188, v189
v_mfma_f32_16x16x32_bf16 v[232:235], a[176:179], a[64:67], v[232:235]
s_addc_u32 s97, s25, 0
ds_read_b64_tr_b16 a[196:197], v29 offset:4096
ds_read_b64_tr_b16 a[198:199], v29 offset:6144
v_mfma_f32_16x16x32_bf16 v[232:235], a[180:183], a[68:71], v[232:235]
global_load_lds_dwordx4 v16, s[96:97]
v_mfma_f32_16x16x32_bf16 v[236:239], a[180:183], v[124:127], v[236:239]
s_add_u32 m0, s41, 0x11000
ds_read_b64_tr_b16 a[200:201], v23 offset:8192
v_cvt_pk_bf16_f32 v181, v190, v191
v_mfma_f32_16x16x32_bf16 v[236:239], a[176:179], v[120:123], v[236:239]
s_add_u32 s96, s24, 0x9100
ds_read_b64_tr_b16 a[202:203], v23 offset:10240
v_accvgpr_write_b32 a134, v180
v_mfma_f32_16x16x32_bf16 v[236:239], a[172:175], v[116:119], v[236:239]
s_addc_u32 s97, s25, 0
ds_read_b64_tr_b16 a[204:205], v29 offset:8192
ds_read_b64_tr_b16 a[206:207], v29 offset:10240
v_mfma_f32_16x16x32_bf16 v[236:239], a[168:171], v[112:115], v[236:239]
global_load_lds_dwordx4 v16, s[96:97]
v_mfma_f32_16x16x32_bf16 v[236:239], a[164:167], v[108:111], v[236:239]
s_add_u32 m0, s41, 0x12000
ds_read_b64_tr_b16 a[144:145], v23 offset:12288
v_accvgpr_write_b32 a135, v181
v_mfma_f32_16x16x32_bf16 v[236:239], a[160:163], v[104:107], v[236:239]
s_waitcnt lgkmcnt(7)
ds_read_b64_tr_b16 a[146:147], v23 offset:14336
v_and_b32 v2, 1, v5
v_mfma_f32_16x16x32_bf16 v[244:247], a[184:187], v[104:107], v[244:247]
s_add_u32 s96, s24, 0x12100
ds_read_b64_tr_b16 a[148:149], v29 offset:12288
v_lshl_add_u32 v2, v2, 4, s62
v_mfma_f32_16x16x32_bf16 v[244:247], a[188:191], v[108:111], v[244:247]
s_addc_u32 s97, s25, 0
ds_read_b64_tr_b16 a[150:151], v29 offset:14336
v_lshrrev_b32 v5, 1, v5
v_mfma_f32_16x16x32_bf16 v[244:247], a[192:195], v[112:115], v[244:247]
s_waitcnt lgkmcnt(4)
ds_read_b64_tr_b16 a[152:153], v23 offset:16384
ds_read_b64_tr_b16 a[154:155], v23 offset:18432
v_mfma_f32_16x16x32_bf16 v[244:247], a[196:199], v[116:119], v[244:247]
global_load_lds_dwordx4 v16, s[96:97]
v_mfma_f32_16x16x32_bf16 v[244:247], a[200:203], v[120:123], v[244:247]
s_add_u32 m0, s41, 0x13000
ds_read_b64_tr_b16 a[156:157], v29 offset:16384
v_max_f32 v224, 0, v224
v_mfma_f32_16x16x32_bf16 v[244:247], a[204:207], v[124:127], v[244:247]
s_add_u32 s96, s24, 0x1b100
ds_read_b64_tr_b16 a[158:159], v29 offset:18432
v_max_f32 v225, 0, v225
v_mfma_f32_16x16x32_bf16 v[240:243], a[204:207], a[68:71], v[240:243]
s_addc_u32 s97, s25, 0
ds_read_b64_tr_b16 a[160:161], v23 offset:20480
ds_read_b64_tr_b16 a[162:163], v23 offset:22528
v_mfma_f32_16x16x32_bf16 v[240:243], a[200:203], a[64:67], v[240:243]
global_load_lds_dwordx4 v16, s[96:97]
v_mfma_f32_16x16x32_bf16 v[240:243], a[196:199], a[60:63], v[240:243]
s_waitcnt vmcnt(10)
ds_read_b64_tr_b16 a[164:165], v29 offset:20480
ds_read_b64_tr_b16 a[166:167], v29 offset:22528
v_mfma_f32_16x16x32_bf16 v[240:243], a[192:195], a[56:59], v[240:243]
s_barrier
v_mfma_f32_16x16x32_bf16 v[240:243], a[188:191], a[52:55], v[240:243]
s_add_u32 m0, s41, 0x14000
ds_read_b64_tr_b16 a[168:169], v20 offset:24576
v_max_f32 v226, 0, v226
v_mfma_f32_16x16x32_bf16 v[240:243], a[184:187], a[48:51], v[240:243]
s_waitcnt lgkmcnt(7)
ds_read_b64_tr_b16 a[170:171], v20 offset:26624
v_max_f32 v227, 0, v227
v_mfma_f32_16x16x32_bf16 v[248:251], a[144:147], a[48:51], v[248:251]
s_add_u32 s96, s24, 0x24100
ds_read_b64_tr_b16 a[172:173], v20 offset:28672
v_max_f32 v228, 0, v228
v_mfma_f32_16x16x32_bf16 v[248:251], a[148:151], a[52:55], v[248:251]
s_addc_u32 s97, s25, 0
ds_read_b64_tr_b16 a[174:175], v20 offset:30720
v_max_f32 v229, 0, v229
v_mfma_f32_16x16x32_bf16 v[248:251], a[152:155], a[56:59], v[248:251]
s_waitcnt lgkmcnt(4)
ds_read_b64_tr_b16 a[176:177], v18
ds_read_b64_tr_b16 a[178:179], v18 offset:2048
v_mfma_f32_16x16x32_bf16 v[248:251], a[156:159], a[60:63], v[248:251]
global_load_lds_dwordx4 v16, s[96:97]
v_mfma_f32_16x16x32_bf16 v[248:251], a[160:163], a[64:67], v[248:251]
s_add_u32 m0, s41, 0x15000
ds_read_b64_tr_b16 a[180:181], v18 offset:4096
v_max_f32 v230, 0, v230
v_mfma_f32_16x16x32_bf16 v[248:251], a[164:167], a[68:71], v[248:251]
s_add_u32 s96, s24, 0x2d100
ds_read_b64_tr_b16 a[182:183], v18 offset:6144
v_max_f32 v231, 0, v231
v_mfma_f32_16x16x32_bf16 v[252:255], a[164:167], v[124:127], v[252:255]
s_addc_u32 s97, s25, 0
ds_read_b64_tr_b16 a[184:185], v18 offset:8192
ds_read_b64_tr_b16 a[186:187], v18 offset:10240
v_mfma_f32_16x16x32_bf16 v[252:255], a[160:163], v[120:123], v[252:255]
global_load_lds_dwordx4 v16, s[96:97]
v_mfma_f32_16x16x32_bf16 v[252:255], a[156:159], v[116:119], v[252:255]
s_add_u32 m0, s41, 0x16000
ds_read_b64_tr_b16 a[188:189], v18 offset:12288
v_mul_f32 v232, v224, v232
v_mfma_f32_16x16x32_bf16 v[252:255], a[152:155], v[112:115], v[252:255]
s_add_u32 s96, s24, 0x36100
ds_read_b64_tr_b16 a[190:191], v18 offset:14336
v_mul_f32 v233, v225, v233
v_mfma_f32_16x16x32_bf16 v[252:255], a[148:151], v[108:111], v[252:255]
s_addc_u32 s97, s25, 0
ds_read_b64_tr_b16 a[192:193], v23 offset:24576
v_mul_f32 v234, v226, v234
v_mfma_f32_16x16x32_bf16 v[252:255], a[144:147], v[104:107], v[252:255]
s_waitcnt lgkmcnt(7)
ds_read_b64_tr_b16 a[194:195], v23 offset:26624
ds_read_b64_tr_b16 a[196:197], v23 offset:28672
v_mfma_f32_16x16x32_bf16 v[208:211], a[168:171], a[76:79], 0
global_load_lds_dwordx4 v16, s[96:97]
v_mfma_f32_16x16x32_bf16 v[208:211], a[172:175], a[84:87], v[208:211]
s_add_u32 m0, s41, 0x17000
ds_read_b64_tr_b16 a[198:199], v23 offset:30720
v_mul_f32 v235, v227, v235
v_mfma_f32_16x16x32_bf16 v[208:211], a[176:179], a[92:95], v[208:211]
s_waitcnt lgkmcnt(4)
ds_read_b64_tr_b16 a[200:201], v21
v_cvt_pk_bf16_f32 v224, v232, v233
v_mfma_f32_16x16x32_bf16 v[208:211], a[180:183], a[100:103], v[208:211]
s_add_u32 s96, s24, 0x3f100
ds_read_b64_tr_b16 a[202:203], v21 offset:2048
v_cvt_pk_bf16_f32 v225, v234, v235
v_mfma_f32_16x16x32_bf16 v[208:211], a[184:187], a[108:111], v[208:211]
s_addc_u32 s97, s25, 0
ds_read_b64_tr_b16 a[204:205], v21 offset:4096
ds_read_b64_tr_b16 a[206:207], v21 offset:6144
v_mfma_f32_16x16x32_bf16 v[208:211], a[188:191], a[116:119], v[208:211]
global_load_lds_dwordx4 v16, s[96:97]
v_mfma_f32_16x16x32_bf16 v[192:195], a[188:191], a[112:115], 0
s_add_u32 m0, s41, 0x18000
ds_read_b64_tr_b16 a[144:145], v21 offset:8192
v_accvgpr_write_b32 a136, v224
v_mfma_f32_16x16x32_bf16 v[192:195], a[184:187], a[104:107], v[192:195]
s_add_u32 s96, s24, 0x100
ds_read_b64_tr_b16 a[146:147], v21 offset:10240
v_accvgpr_write_b32 a137, v225
v_mfma_f32_16x16x32_bf16 v[192:195], a[180:183], a[96:99], v[192:195]
s_addc_u32 s97, s25, 0
ds_read_b64_tr_b16 a[148:149], v21 offset:12288
ds_read_b64_tr_b16 a[150:151], v21 offset:14336
v_mfma_f32_16x16x32_bf16 v[192:195], a[176:179], a[88:91], v[192:195]
global_load_lds_dwordx4 v17, s[96:97]
v_mfma_f32_16x16x32_bf16 v[192:195], a[172:175], a[80:83], v[192:195]
s_add_u32 m0, s41, 0x19000
ds_read_b64_tr_b16 a[152:153], v26 offset:24576
v_mul_f32 v236, v228, v236
v_mfma_f32_16x16x32_bf16 v[192:195], a[168:171], a[72:75], v[192:195]
s_waitcnt lgkmcnt(7)
ds_read_b64_tr_b16 a[154:155], v26 offset:26624
v_mul_f32 v237, v229, v237
v_mfma_f32_16x16x32_bf16 v[196:199], a[192:195], a[72:75], 0
s_add_u32 s96, s24, 0x180
ds_read_b64_tr_b16 a[156:157], v26 offset:28672
v_mul_f32 v238, v230, v238
v_mfma_f32_16x16x32_bf16 v[196:199], a[196:199], a[80:83], v[196:199]
s_addc_u32 s97, s25, 0
ds_read_b64_tr_b16 a[158:159], v26 offset:30720
v_mul_f32 v239, v231, v239
v_mfma_f32_16x16x32_bf16 v[196:199], a[200:203], a[88:91], v[196:199]
s_waitcnt lgkmcnt(4)
ds_read_b64_tr_b16 a[160:161], v24
ds_read_b64_tr_b16 a[162:163], v24 offset:2048
v_mfma_f32_16x16x32_bf16 v[196:199], a[204:207], a[96:99], v[196:199]
global_load_lds_dwordx4 v16, s[96:97]
v_mfma_f32_16x16x32_bf16 v[196:199], a[144:147], a[104:107], v[196:199]
s_add_u32 m0, s41, 0x1a000
ds_read_b64_tr_b16 a[164:165], v24 offset:4096
v_cvt_pk_bf16_f32 v228, v236, v237
v_mfma_f32_16x16x32_bf16 v[196:199], a[148:151], a[112:115], v[196:199]
s_add_u32 s96, s24, 0x9180
ds_read_b64_tr_b16 a[166:167], v24 offset:6144
v_cvt_pk_bf16_f32 v229, v238, v239
v_mfma_f32_16x16x32_bf16 v[212:215], a[148:151], a[116:119], 0
s_addc_u32 s97, s25, 0
ds_read_b64_tr_b16 a[168:169], v24 offset:8192
ds_read_b64_tr_b16 a[170:171], v24 offset:10240
v_mfma_f32_16x16x32_bf16 v[212:215], a[144:147], a[108:111], v[212:215]
global_load_lds_dwordx4 v16, s[96:97]
v_mfma_f32_16x16x32_bf16 v[212:215], a[204:207], a[100:103], v[212:215]
s_add_u32 m0, s41, 0x1b000
ds_read_b64_tr_b16 a[172:173], v24 offset:12288
v_accvgpr_write_b32 a140, v228
v_mfma_f32_16x16x32_bf16 v[212:215], a[200:203], a[92:95], v[212:215]
s_add_u32 s96, s24, 0x12180
ds_read_b64_tr_b16 a[174:175], v24 offset:14336
v_accvgpr_write_b32 a141, v229
v_mfma_f32_16x16x32_bf16 v[212:215], a[196:199], a[84:87], v[212:215]
s_addc_u32 s97, s25, 0
ds_read_b64_tr_b16 a[176:177], v29 offset:24576
v_max_f32 v240, 0, v240
v_mfma_f32_16x16x32_bf16 v[212:215], a[192:195], a[76:79], v[212:215]
s_waitcnt lgkmcnt(7)
ds_read_b64_tr_b16 a[178:179], v29 offset:26624
ds_read_b64_tr_b16 a[180:181], v29 offset:28672
v_mfma_f32_16x16x32_bf16 v[216:219], a[152:155], a[76:79], 0
global_load_lds_dwordx4 v16, s[96:97]
v_mfma_f32_16x16x32_bf16 v[216:219], a[156:159], a[84:87], v[216:219]
s_add_u32 m0, s41, 0x1c000
ds_read_b64_tr_b16 a[182:183], v29 offset:30720
v_max_f32 v241, 0, v241
v_mfma_f32_16x16x32_bf16 v[216:219], a[160:163], a[92:95], v[216:219]
s_waitcnt lgkmcnt(4)
ds_read_b64_tr_b16 a[184:185], v27
v_max_f32 v242, 0, v242
v_mfma_f32_16x16x32_bf16 v[216:219], a[164:167], a[100:103], v[216:219]
s_add_u32 s96, s24, 0x1b180
ds_read_b64_tr_b16 a[186:187], v27 offset:2048
v_max_f32 v243, 0, v243
v_mfma_f32_16x16x32_bf16 v[216:219], a[168:171], a[108:111], v[216:219]
s_addc_u32 s97, s25, 0
ds_read_b64_tr_b16 a[188:189], v27 offset:4096
ds_read_b64_tr_b16 a[190:191], v27 offset:6144
v_mfma_f32_16x16x32_bf16 v[216:219], a[172:175], a[116:119], v[216:219]
global_load_lds_dwordx4 v16, s[96:97]
v_mfma_f32_16x16x32_bf16 v[200:203], a[172:175], a[112:115], 0
s_add_u32 m0, s41, 0x1d000
ds_read_b64_tr_b16 a[192:193], v27 offset:8192
v_max_f32 v244, 0, v244
v_mfma_f32_16x16x32_bf16 v[200:203], a[168:171], a[104:107], v[200:203]
s_add_u32 s96, s24, 0x24180
ds_read_b64_tr_b16 a[194:195], v27 offset:10240
v_max_f32 v245, 0, v245
v_mfma_f32_16x16x32_bf16 v[200:203], a[164:167], a[96:99], v[200:203]
s_addc_u32 s97, s25, 0
ds_read_b64_tr_b16 a[196:197], v27 offset:12288
ds_read_b64_tr_b16 a[198:199], v27 offset:14336
v_mfma_f32_16x16x32_bf16 v[200:203], a[160:163], a[88:91], v[200:203]
global_load_lds_dwordx4 v16, s[96:97]
v_mfma_f32_16x16x32_bf16 v[200:203], a[156:159], a[80:83], v[200:203]
s_add_u32 m0, s41, 0x1e000
ds_read_b64_tr_b16 a[200:201], v18 offset:16384
v_max_f32 v246, 0, v246
v_mfma_f32_16x16x32_bf16 v[200:203], a[152:155], a[72:75], v[200:203]
s_waitcnt lgkmcnt(7)
ds_read_b64_tr_b16 a[202:203], v18 offset:18432
v_max_f32 v247, 0, v247
v_mfma_f32_16x16x32_bf16 v[204:207], a[176:179], a[72:75], 0
s_add_u32 s96, s24, 0x2d180
ds_read_b64_tr_b16 a[204:205], v18 offset:20480
v_mul_f32 v248, v240, v248
v_mfma_f32_16x16x32_bf16 v[204:207], a[180:183], a[80:83], v[204:207]
s_addc_u32 s97, s25, 0
ds_read_b64_tr_b16 a[206:207], v18 offset:22528
v_mul_f32 v249, v241, v249
v_mfma_f32_16x16x32_bf16 v[204:207], a[184:187], a[88:91], v[204:207]
s_waitcnt lgkmcnt(4)
ds_read_b64_tr_b16 a[144:145], v18 offset:24576
ds_read_b64_tr_b16 a[146:147], v18 offset:26624
v_mfma_f32_16x16x32_bf16 v[204:207], a[188:191], a[96:99], v[204:207]
global_load_lds_dwordx4 v16, s[96:97]
v_mfma_f32_16x16x32_bf16 v[204:207], a[192:195], a[104:107], v[204:207]
s_add_u32 m0, s41, 0x1f000
ds_read_b64_tr_b16 a[148:149], v18 offset:28672
v_mul_f32 v250, v242, v250
v_mfma_f32_16x16x32_bf16 v[204:207], a[196:199], a[112:115], v[204:207]
s_add_u32 s96, s24, 0x36180
ds_read_b64_tr_b16 a[150:151], v18 offset:30720
ds_read_b64_tr_b16 a[152:153], v18 offset:32768
v_mfma_f32_16x16x32_bf16 v[220:223], a[196:199], a[116:119], 0
buffer_load_dword v53, v10, s[32:35], 0 offen sc1
v_mfma_f32_16x16x32_bf16 v[220:223], a[192:195], a[108:111], v[220:223]
s_addc_u32 s97, s25, 0
ds_read_b64_tr_b16 a[154:155], v18 offset:34816
L_pg10:
s_cbranch_execz L_tr2
v_mul_f32 v251, v243, v251
v_mfma_f32_16x16x32_bf16 v[220:223], a[188:191], a[100:103], v[220:223]
ds_read_b64_tr_b16 a[156:157], v18 offset:36864
v_cvt_pk_bf16_f32 v240, v248, v249
v_mfma_f32_16x16x32_bf16 v[220:223], a[184:187], a[92:95], v[220:223]
ds_read_b64_tr_b16 a[158:159], v18 offset:38912
ds_read_b64_tr_b16 a[160:161], v21 offset:16384
v_mfma_f32_16x16x32_bf16 v[220:223], a[180:183], a[84:87], v[220:223]
global_load_lds_dwordx4 v16, s[96:97]
v_mfma_f32_16x16x32_bf16 v[220:223], a[176:179], a[76:79], v[220:223]
s_waitcnt lgkmcnt(7)
ds_read_b64_tr_b16 a[162:163], v21 offset:18432
v_cvt_pk_bf16_f32 v241, v250, v251
v_mfma_f32_16x16x32_bf16 v[144:147], a[200:203], a[76:79], 0
s_add_u32 m0, s41, 0x20000
ds_read_b64_tr_b16 a[164:165], v21 offset:20480
v_accvgpr_write_b32 a138, v240
v_mfma_f32_16x16x32_bf16 v[144:147], a[204:207], a[84:87], v[144:147]
s_add_u32 s96, s24, 0x3f180
ds_read_b64_tr_b16 a[166:167], v21 offset:22528
v_accvgpr_write_b32 a139, v241
v_mfma_f32_16x16x32_bf16 v[144:147], a[144:147], a[92:95], v[144:147]
s_waitcnt lgkmcnt(4)
ds_read_b64_tr_b16 a[168:169], v21 offset:24576
v_mul_f32 v252, v244, v252
v_mfma_f32_16x16x32_bf16 v[144:147], a[148:151], a[100:103], v[144:147]
s_addc_u32 s97, s25, 0
ds_read_b64_tr_b16 a[170:171], v21 offset:26624
ds_read_b64_tr_b16 a[172:173], v21 offset:28672
v_mfma_f32_16x16x32_bf16 v[144:147], a[152:155], a[108:111], v[144:147]
global_load_lds_dwordx4 v16, s[96:97]
v_mfma_f32_16x16x32_bf16 v[144:147], a[156:159], a[116:119], v[144:147]
s_add_u32 m0, s41, 0x21000
ds_read_b64_tr_b16 a[174:175], v21 offset:30720
v_mul_f32 v253, v245, v253
v_mfma_f32_16x16x32_bf16 v[128:131], a[156:159], a[112:115], 0
s_add_u32 s96, s24, 0x180
ds_read_b64_tr_b16 a[176:177], v21 offset:32768
v_mul_f32 v254, v246, v254
v_mfma_f32_16x16x32_bf16 v[128:131], a[152:155], a[104:107], v[128:131]
s_addc_u32 s97, s25, 0
ds_read_b64_tr_b16 a[178:179], v21 offset:34816
ds_read_b64_tr_b16 a[180:181], v21 offset:36864
v_mfma_f32_16x16x32_bf16 v[128:131], a[148:151], a[96:99], v[128:131]
global_load_lds_dwordx4 v17, s[96:97]
v_mfma_f32_16x16x32_bf16 v[128:131], a[144:147], a[88:91], v[128:131]
s_add_u32 m0, s41, 0x22000
ds_read_b64_tr_b16 a[182:183], v21 offset:38912
v_mul_f32 v255, v247, v255
v_mfma_f32_16x16x32_bf16 v[128:131], a[204:207], a[80:83], v[128:131]
s_add_u32 s96, s24, 0x200
ds_read_b64_tr_b16 a[184:185], v24 offset:16384
v_cvt_pk_bf16_f32 v244, v252, v253
v_mfma_f32_16x16x32_bf16 v[128:131], a[200:203], a[72:75], v[128:131]
s_waitcnt lgkmcnt(7)
ds_read_b64_tr_b16 a[186:187], v24 offset:18432
v_cvt_pk_bf16_f32 v245, v254, v255
v_mfma_f32_16x16x32_bf16 v[132:135], a[160:163], a[72:75], 0
s_addc_u32 s97, s25, 0
ds_read_b64_tr_b16 a[188:189], v24 offset:20480
ds_read_b64_tr_b16 a[190:191], v24 offset:22528
v_mfma_f32_16x16x32_bf16 v[132:135], a[164:167], a[80:83], v[132:135]
global_load_lds_dwordx4 v16, s[96:97]
v_mfma_f32_16x16x32_bf16 v[132:135], a[168:171], a[88:91], v[132:135]
s_waitcnt lgkmcnt(4)
ds_read_b64_tr_b16 a[192:193], v24 offset:24576
v_accvgpr_write_b32 a142, v244
v_mfma_f32_16x16x32_bf16 v[132:135], a[172:175], a[96:99], v[132:135]
ds_read_b64_tr_b16 a[194:195], v24 offset:26624
v_accvgpr_write_b32 a143, v245
v_mfma_f32_16x16x32_bf16 v[132:135], a[176:179], a[104:107], v[132:135]
ds_read_b64_tr_b16 a[196:197], v24 offset:28672
v_mul_u32_u24 v1, 36, v5
v_mfma_f32_16x16x32_bf16 v[132:135], a[180:183], a[112:115], v[132:135]
ds_read_b64_tr_b16 a[198:199], v24 offset:30720
v_add_u32 v1, v1, v7
v_mfma_f32_16x16x32_bf16 v[148:151], a[180:183], a[116:119], 0
ds_read_b64_tr_b16 a[200:201], v24 offset:32768
v_mul_u32_u24 v1, 0x480, v1
v_mfma_f32_16x16x32_bf16 v[148:151], a[176:179], a[108:111], v[148:151]
ds_read_b64_tr_b16 a[202:203], v24 offset:34816
v_add_u32 v39, v1, v2
v_mfma_f32_16x16x32_bf16 v[148:151], a[172:175], a[100:103], v[148:151]
ds_read_b64_tr_b16 a[204:205], v24 offset:36864
v_mul_u32_u24 v1, v5, v5
v_mfma_f32_16x16x32_bf16 v[148:151], a[168:171], a[92:95], v[148:151]
ds_read_b64_tr_b16 a[206:207], v24 offset:38912
v_mul_u32_u24 v1, v1, v5
v_mfma_f32_16x16x32_bf16 v[148:151], a[164:167], a[84:87], v[148:151]
ds_read_b64_tr_b16 a[144:145], v27 offset:16384
v_mul_u32_u24 v1, 0x48, v1
v_mfma_f32_16x16x32_bf16 v[148:151], a[160:163], a[76:79], v[148:151]
s_waitcnt lgkmcnt(7)
ds_read_b64_tr_b16 a[146:147], v27 offset:18432
v_add_u32 v1, v1, v4
v_mfma_f32_16x16x32_bf16 v[152:155], a[184:187], a[76:79], 0
ds_read_b64_tr_b16 a[148:149], v27 offset:20480
v_mul_u32_u24 v1, 0x480, v1
v_mfma_f32_16x16x32_bf16 v[152:155], a[188:191], a[84:87], v[152:155]
ds_read_b64_tr_b16 a[150:151], v27 offset:22528
v_add_u32 v40, v1, v2
v_mfma_f32_16x16x32_bf16 v[152:155], a[192:195], a[92:95], v[152:155]
s_waitcnt lgkmcnt(4)
ds_read_b64_tr_b16 a[152:153], v27 offset:24576
s_lshl_b32 s63, s60, 2
v_mfma_f32_16x16x32_bf16 v[152:155], a[196:199], a[100:103], v[152:155]
s_lshr_b32 s95, s45, 3
ds_read_b64_tr_b16 a[154:155], v27 offset:26624
s_add_u32 s63, s63, s95
v_mfma_f32_16x16x32_bf16 v[152:155], a[200:203], a[108:111], v[152:155]
s_lshl_b32 s63, s63, 2
ds_read_b64_tr_b16 a[156:157], v27 offset:28672
s_add_u32 s63, s63, s40
v_mfma_f32_16x16x32_bf16 v[152:155], a[204:207], a[116:119], v[152:155]
ds_read_b64_tr_b16 a[158:159], v27 offset:30720
v_and_b32 v5, 15, v0
v_mfma_f32_16x16x32_bf16 v[136:139], a[204:207], a[112:115], 0
ds_read_b64_tr_b16 a[160:161], v27 offset:32768
v_lshrrev_b32 v6, 4, v0
v_mfma_f32_16x16x32_bf16 v[136:139], a[200:203], a[104:107], v[136:139]
s_mul_i32 s57, s63, 0x48000
ds_read_b64_tr_b16 a[162:163], v27 offset:34816
s_mul_i32 s95, s46, 0x8000
v_mfma_f32_16x16x32_bf16 v[136:139], a[196:199], a[96:99], v[136:139]
s_waitcnt vmcnt(14)
ds_read_b64_tr_b16 a[164:165], v27 offset:36864
ds_read_b64_tr_b16 a[166:167], v27 offset:38912
v_mfma_f32_16x16x32_bf16 v[136:139], a[192:195], a[88:91], v[136:139]
s_barrier
v_mfma_f32_16x16x32_bf16 v[136:139], a[188:191], a[80:83], v[136:139]
s_add_u32 m0, s41, 0x23000
ds_read_b64_tr_b16 a[168:169], v18 offset:40960
s_add_u32 s96, s24, 0x9200
v_mfma_f32_16x16x32_bf16 v[136:139], a[184:187], a[72:75], v[136:139]
s_waitcnt lgkmcnt(7)
ds_read_b64_tr_b16 a[170:171], v18 offset:43008
s_addc_u32 s97, s25, 0
v_mfma_f32_16x16x32_bf16 v[140:143], a[144:147], a[72:75], 0
s_add_u32 s95, s95, s57
ds_read_b64_tr_b16 a[172:173], v18 offset:45056
ds_read_b64_tr_b16 a[174:175], v18 offset:47104
v_mfma_f32_16x16x32_bf16 v[140:143], a[148:151], a[80:83], v[140:143]
global_load_lds_dwordx4 v16, s[96:97]
v_mfma_f32_16x16x32_bf16 v[140:143], a[152:155], a[88:91], v[140:143]
s_waitcnt lgkmcnt(4)
ds_read_b64_tr_b16 a[176:177], v18 offset:49152
v_lshl_add_u32 v41, v0, 4, s95
v_mfma_f32_16x16x32_bf16 v[140:143], a[156:159], a[96:99], v[140:143]
s_add_u32 m0, s41, 0x24000
ds_read_b64_tr_b16 a[178:179], v18 offset:51200
s_add_u32 s96, s24, 0x12200
v_mfma_f32_16x16x32_bf16 v[140:143], a[160:163], a[104:107], v[140:143]
s_addc_u32 s97, s25, 0
ds_read_b64_tr_b16 a[180:181], v21 offset:40960
ds_read_b64_tr_b16 a[182:183], v21 offset:43008
v_mfma_f32_16x16x32_bf16 v[140:143], a[164:167], a[112:115], v[140:143]
global_load_lds_dwordx4 v16, s[96:97]
v_mfma_f32_16x16x32_bf16 v[156:159], a[164:167], a[116:119], 0
s_add_u32 m0, s41, 0x25000
ds_read_b64_tr_b16 a[184:185], v21 offset:45056
s_add_u32 s96, s24, 0x1b200
v_mfma_f32_16x16x32_bf16 v[156:159], a[160:163], a[108:111], v[156:159]
s_addc_u32 s97, s25, 0
ds_read_b64_tr_b16 a[186:187], v21 offset:47104
ds_read_b64_tr_b16 a[188:189], v21 offset:49152
v_mfma_f32_16x16x32_bf16 v[156:159], a[156:159], a[100:103], v[156:159]
global_load_lds_dwordx4 v16, s[96:97]
v_mfma_f32_16x16x32_bf16 v[156:159], a[152:155], a[92:95], v[156:159]
s_add_u32 m0, s41, 0x26000
ds_read_b64_tr_b16 a[190:191], v21 offset:51200
s_add_u32 s96, s24, 0x24200
v_mfma_f32_16x16x32_bf16 v[156:159], a[148:151], a[84:87], v[156:159]
s_addc_u32 s97, s25, 0
ds_read_b64_tr_b16 a[192:193], v24 offset:40960
s_xor_b32 s55, s40, s46
v_mfma_f32_16x16x32_bf16 v[156:159], a[144:147], a[76:79], v[156:159]
s_waitcnt lgkmcnt(7)
ds_read_b64_tr_b16 a[194:195], v24 offset:43008
ds_read_b64_tr_b16 a[196:197], v24 offset:45056
v_mfma_f32_16x16x32_bf16 v[208:211], a[168:171], a[124:127], v[208:211]
global_load_lds_dwordx4 v16, s[96:97]
v_mfma_f32_16x16x32_bf16 v[208:211], a[172:175], a[132:135], v[208:211]
s_add_u32 m0, s41, 0x27000
ds_read_b64_tr_b16 a[198:199], v24 offset:47104
s_add_u32 s96, s24, 0x2d200
v_mfma_f32_16x16x32_bf16 v[208:211], a[176:179], a[140:143], v[208:211]
s_addc_u32 s97, s25, 0
ds_read_b64_tr_b16 a[200:201], v24 offset:49152
s_lshl_b32 s55, s55, 31
v_mfma_f32_16x16x32_bf16 v[192:195], a[176:179], a[136:139], v[192:195]
s_lshr_b32 s95, s46, 1
ds_read_b64_tr_b16 a[202:203], v24 offset:51200
ds_read_b64_tr_b16 a[204:205], v27 offset:40960
v_mfma_f32_16x16x32_bf16 v[192:195], a[172:175], a[128:131], v[192:195]
global_load_lds_dwordx4 v16, s[96:97]
v_mfma_f32_16x16x32_bf16 v[192:195], a[168:171], a[120:123], v[192:195]
s_waitcnt lgkmcnt(7)
ds_read_b64_tr_b16 a[206:207], v27 offset:43008
s_add_u32 m0, s41, 0
v_mfma_f32_16x16x32_bf16 v[196:199], a[180:183], a[120:123], v[196:199]
s_add_u32 s96, s24, 0x36200
ds_read_b64_tr_b16 a[144:145], v27 offset:45056
s_addc_u32 s97, s25, 0
v_mfma_f32_16x16x32_bf16 v[196:199], a[184:187], a[128:131], v[196:199]
s_mul_i32 s95, s95, 0x2000
ds_read_b64_tr_b16 a[146:147], v27 offset:47104
s_add_u32 s95, s95, s57
v_mfma_f32_16x16x32_bf16 v[196:199], a[188:191], a[136:139], v[196:199]
s_ashr_i32 s56, s55, 31
ds_read_b64_tr_b16 a[148:149], v27 offset:49152
ds_read_b64_tr_b16 a[150:151], v27 offset:51200
v_mfma_f32_16x16x32_bf16 v[212:215], a[188:191], a[140:143], v[212:215]
global_load_lds_dwordx4 v16, s[96:97]
v_mfma_f32_16x16x32_bf16 v[212:215], a[184:187], a[132:135], v[212:215]
s_add_u32 m0, s41, 0x1000
ds_read_b64_tr_b16 a[152:153], v18 offset:53248
s_add_u32 s96, s24, 0x3f200
v_mfma_f32_16x16x32_bf16 v[212:215], a[180:183], a[124:127], v[212:215]
s_waitcnt lgkmcnt(7)
ds_read_b64_tr_b16 a[154:155], v18 offset:55296
s_addc_u32 s97, s25, 0
v_mfma_f32_16x16x32_bf16 v[216:219], a[192:195], a[124:127], v[216:219]
s_andn2_b32 s56, 0x1f8, s56
ds_read_b64_tr_b16 a[156:157], v18 offset:57344
v_lshlrev_b32 v1, 3, v0
v_mfma_f32_16x16x32_bf16 v[216:219], a[196:199], a[132:135], v[216:219]
ds_read_b64_tr_b16 a[158:159], v18 offset:59392
ds_read_b64_tr_b16 a[160:161], v18 offset:61440
v_mfma_f32_16x16x32_bf16 v[216:219], a[200:203], a[140:143], v[216:219]
global_load_lds_dwordx4 v16, s[96:97]
v_mfma_f32_16x16x32_bf16 v[200:203], a[200:203], a[136:139], v[200:203]
s_add_u32 s49, s92, 0x800000
ds_read_b64_tr_b16 a[162:163], v18 offset:63488
v_cvt_pk_bf16_f32 v56, v192, v193
v_mfma_f32_16x16x32_bf16 v[200:203], a[196:199], a[128:131], v[200:203]
s_add_u32 m0, s41, 0x2000
ds_read_b64_tr_b16 a[164:165], v21 offset:53248
v_cvt_pk_bf16_f32 v57, v194, v195
v_mfma_f32_16x16x32_bf16 v[200:203], a[192:195], a[120:123], v[200:203]
s_waitcnt lgkmcnt(7)
ds_read_b64_tr_b16 a[166:167], v21 offset:55296
v_cvt_pk_bf16_f32 v58, v196, v197
v_mfma_f32_16x16x32_bf16 v[204:207], a[204:207], a[120:123], v[204:207]
s_add_u32 s96, s24, 0x200
ds_read_b64_tr_b16 a[168:169], v21 offset:57344
v_cvt_pk_bf16_f32 v59, v198, v199
v_mfma_f32_16x16x32_bf16 v[204:207], a[144:147], a[128:131], v[204:207]
s_addc_u32 s97, s25, 0
ds_read_b64_tr_b16 a[170:171], v21 offset:59392
ds_read_b64_tr_b16 a[172:173], v21 offset:61440
v_mfma_f32_16x16x32_bf16 v[204:207], a[148:151], a[136:139], v[204:207]
buffer_store_dwordx4 v[56:59], v47, s[36:39], s49 offen sc1
v_mfma_f32_16x16x32_bf16 v[220:223], a[148:151], a[140:143], v[220:223]
s_add_u32 s49, s93, 0x800000
ds_read_b64_tr_b16 a[174:175], v21 offset:63488
v_cvt_pk_bf16_f32 v60, v208, v209
v_mfma_f32_16x16x32_bf16 v[220:223], a[144:147], a[132:135], v[220:223]
ds_read_b64_tr_b16 a[176:177], v24 offset:53248
v_cvt_pk_bf16_f32 v61, v210, v211
v_mfma_f32_16x16x32_bf16 v[220:223], a[204:207], a[124:127], v[220:223]
s_waitcnt lgkmcnt(7)
ds_read_b64_tr_b16 a[178:179], v24 offset:55296
ds_read_b64_tr_b16 a[180:181], v24 offset:57344
v_mfma_f32_16x16x32_bf16 v[144:147], a[152:155], a[124:127], v[144:147]
global_load_lds_dwordx4 v17, s[96:97]
v_mfma_f32_16x16x32_bf16 v[144:147], a[156:159], a[132:135], v[144:147]
s_add_u32 m0, s41, 0x3000
ds_read_b64_tr_b16 a[182:183], v24 offset:59392
v_cvt_pk_bf16_f32 v62, v212, v213
v_mfma_f32_16x16x32_bf16 v[144:147], a[160:163], a[140:143], v[144:147]
s_add_u32 s96, s24, 0x280
ds_read_b64_tr_b16 a[184:185], v24 offset:61440
v_cvt_pk_bf16_f32 v63, v214, v215
v_mfma_f32_16x16x32_bf16 v[128:131], a[160:163], a[136:139], v[128:131]
s_addc_u32 s97, s25, 0
ds_read_b64_tr_b16 a[186:187], v24 offset:63488
v_cvt_pk_bf16_f32 v64, v200, v201
v_mfma_f32_16x16x32_bf16 v[128:131], a[156:159], a[128:131], v[128:131]
ds_read_b64_tr_b16 a[188:189], v27 offset:53248
v_cvt_pk_bf16_f32 v65, v202, v203
v_mfma_f32_16x16x32_bf16 v[128:131], a[152:155], a[120:123], v[128:131]
s_waitcnt lgkmcnt(7)
ds_read_b64_tr_b16 a[190:191], v27 offset:55296
ds_read_b64_tr_b16 a[192:193], v27 offset:57344
v_mfma_f32_16x16x32_bf16 v[132:135], a[164:167], a[120:123], v[132:135]
global_load_lds_dwordx4 v16, s[96:97]
v_mfma_f32_16x16x32_bf16 v[132:135], a[168:171], a[128:131], v[132:135]
ds_read_b64_tr_b16 a[194:195], v27 offset:59392
v_cvt_pk_bf16_f32 v66, v204, v205
v_mfma_f32_16x16x32_bf16 v[132:135], a[172:175], a[136:139], v[132:135]
ds_read_b64_tr_b16 a[196:197], v27 offset:61440
v_cvt_pk_bf16_f32 v67, v206, v207
v_mfma_f32_16x16x32_bf16 v[148:151], a[172:175], a[140:143], v[148:151]
ds_read_b64_tr_b16 a[198:199], v27 offset:63488
v_cvt_pk_bf16_f32 v68, v216, v217
v_mfma_f32_16x16x32_bf16 v[148:151], a[168:171], a[132:135], v[148:151]
ds_read_b64_tr_b16 a[200:201], v28
v_cvt_pk_bf16_f32 v69, v218, v219
v_mfma_f32_16x16x32_bf16 v[148:151], a[164:167], a[124:127], v[148:151]
s_waitcnt lgkmcnt(7)
ds_read_b64_tr_b16 a[202:203], v28 offset:2048
v_cvt_pk_bf16_f32 v70, v220, v221
v_mfma_f32_16x16x32_bf16 v[152:155], a[176:179], a[124:127], v[152:155]
ds_read_b64_tr_b16 a[204:205], v28 offset:4096
v_cvt_pk_bf16_f32 v71, v222, v223
v_mfma_f32_16x16x32_bf16 v[152:155], a[180:183], a[132:135], v[152:155]
ds_read_b64_tr_b16 a[206:207], v28 offset:6144
v_and_b32 v1, s56, v1
v_mfma_f32_16x16x32_bf16 v[152:155], a[184:187], a[140:143], v[152:155]
ds_read_b64_tr_b16 a[144:145], v28 offset:8192
v_add_u32 v42, s95, v1
v_mfma_f32_16x16x32_bf16 v[136:139], a[184:187], a[136:139], v[136:139]
s_lshl_b32 s95, s63, 4
ds_read_b64_tr_b16 a[146:147], v28 offset:10240
v_cvt_pk_bf16_f32 v72, v128, v129
v_mfma_f32_16x16x32_bf16 v[136:139], a[180:183], a[128:131], v[136:139]
ds_read_b64_tr_b16 a[148:149], v28 offset:12288
v_cvt_pk_bf16_f32 v73, v130, v131
v_mfma_f32_16x16x32_bf16 v[136:139], a[176:179], a[120:123], v[136:139]
s_waitcnt lgkmcnt(7)
ds_read_b64_tr_b16 a[150:151], v28 offset:14336
v_cvt_pk_bf16_f32 v74, v132, v133
v_mfma_f32_16x16x32_bf16 v[140:143], a[188:191], a[120:123], v[140:143]
ds_read_b64_tr_b16 a[152:153], v28 offset:16384
v_cvt_pk_bf16_f32 v75, v134, v135
v_mfma_f32_16x16x32_bf16 v[140:143], a[192:195], a[128:131], v[140:143]
ds_read_b64_tr_b16 a[154:155], v28 offset:18432
v_cvt_pk_bf16_f32 v76, v144, v145
v_mfma_f32_16x16x32_bf16 v[140:143], a[196:199], a[136:139], v[140:143]
ds_read_b64_tr_b16 a[156:157], v28 offset:20480
v_cvt_pk_bf16_f32 v77, v146, v147
v_mfma_f32_16x16x32_bf16 v[156:159], a[196:199], a[140:143], v[156:159]
ds_read_b64_tr_b16 a[158:159], v28 offset:22528
v_cvt_pk_bf16_f32 v78, v148, v149
v_mfma_f32_16x16x32_bf16 v[156:159], a[192:195], a[132:135], v[156:159]
s_waitcnt vmcnt(14)
ds_read_b64_tr_b16 a[160:161], v25
v_cvt_pk_bf16_f32 v79, v150, v151
v_mfma_f32_16x16x32_bf16 v[156:159], a[188:191], a[124:127], v[156:159]
s_waitcnt lgkmcnt(7)
ds_read_b64_tr_b16 a[162:163], v25 offset:2048
v_add_u32 v7, s95, v5
v_mfma_f32_16x16x32_bf16 v[188:191], a[200:203], a[76:79], 0
ds_read_b64_tr_b16 a[164:165], v25 offset:4096
ds_read_b64_tr_b16 a[166:167], v25 offset:6144
v_mfma_f32_16x16x32_bf16 v[188:191], a[204:207], a[84:87], v[188:191]
buffer_store_dwordx4 v[60:63], v47, s[36:39], s49 offen sc1
v_mfma_f32_16x16x32_bf16 v[188:191], a[144:147], a[92:95], v[188:191]
s_waitcnt lgkmcnt(4)
ds_read_b64_tr_b16 a[168:169], v25 offset:8192
v_lshlrev_b32 v9, 2, v7
v_mfma_f32_16x16x32_bf16 v[188:191], a[148:151], a[100:103], v[188:191]
s_add_u32 s49, s92, 0x804000
ds_read_b64_tr_b16 a[170:171], v25 offset:10240
v_cvt_pk_bf16_f32 v80, v136, v137
v_mfma_f32_16x16x32_bf16 v[188:191], a[152:155], a[108:111], v[188:191]
ds_read_b64_tr_b16 a[172:173], v25 offset:12288
v_cvt_pk_bf16_f32 v81, v138, v139
v_mfma_f32_16x16x32_bf16 v[188:191], a[156:159], a[116:119], v[188:191]
ds_read_b64_tr_b16 a[174:175], v25 offset:14336
v_cvt_pk_bf16_f32 v82, v140, v141
v_mfma_f32_16x16x32_bf16 v[172:175], a[156:159], a[112:115], 0
ds_read_b64_tr_b16 a[176:177], v25 offset:16384
v_cvt_pk_bf16_f32 v83, v142, v143
v_mfma_f32_16x16x32_bf16 v[172:175], a[152:155], a[104:107], v[172:175]
ds_read_b64_tr_b16 a[178:179], v25 offset:18432
v_cvt_pk_bf16_f32 v84, v152, v153
v_mfma_f32_16x16x32_bf16 v[172:175], a[148:151], a[96:99], v[172:175]
ds_read_b64_tr_b16 a[180:181], v25 offset:20480
v_cvt_pk_bf16_f32 v85, v154, v155
v_mfma_f32_16x16x32_bf16 v[172:175], a[144:147], a[88:91], v[172:175]
ds_read_b64_tr_b16 a[182:183], v25 offset:22528
v_cvt_pk_bf16_f32 v86, v156, v157
v_mfma_f32_16x16x32_bf16 v[172:175], a[204:207], a[80:83], v[172:175]
ds_read_b64_tr_b16 a[184:185], v22
v_cvt_pk_bf16_f32 v87, v158, v159
v_mfma_f32_16x16x32_bf16 v[172:175], a[200:203], a[72:75], v[172:175]
s_waitcnt lgkmcnt(7)
ds_read_b64_tr_b16 a[186:187], v22 offset:2048
v_mul_u32_u24 v7, 0x480, v7
v_mfma_f32_16x16x32_bf16 v[168:171], a[160:163], a[72:75], 0
ds_read_b64_tr_b16 a[188:189], v22 offset:4096
v_lshl_add_u32 v7, v6, 3, v7
v_mfma_f32_16x16x32_bf16 v[168:171], a[164:167], a[80:83], v[168:171]
ds_read_b64_tr_b16 a[190:191], v22 offset:6144
v_add_u32 v11, s47, v7
v_mfma_f32_16x16x32_bf16 v[168:171], a[168:171], a[88:91], v[168:171]
s_waitcnt lgkmcnt(4)
ds_read_b64_tr_b16 a[192:193], v22 offset:8192
s_or_b32 s62, s62, s55
v_mfma_f32_16x16x32_bf16 v[168:171], a[172:175], a[96:99], v[168:171]
ds_read_b64_tr_b16 a[194:195], v22 offset:10240
v_add_u32 v12, s62, v7
v_mfma_f32_16x16x32_bf16 v[168:171], a[176:179], a[104:107], v[168:171]
s_and_b32 s95, s63, 1
ds_read_b64_tr_b16 a[196:197], v22 offset:12288
s_lshl_b32 s95, s95, 4
v_mfma_f32_16x16x32_bf16 v[168:171], a[180:183], a[112:115], v[168:171]
ds_read_b64_tr_b16 a[198:199], v22 offset:14336
v_add_u32 v7, s95, v5
v_mfma_f32_16x16x32_bf16 v[184:187], a[180:183], a[116:119], 0
s_lshr_b32 s56, s63, 1
ds_read_b64_tr_b16 a[200:201], v22 offset:16384
s_mul_i32 s95, s56, 0x8400
v_mfma_f32_16x16x32_bf16 v[184:187], a[176:179], a[108:111], v[184:187]
ds_read_b64_tr_b16 a[202:203], v22 offset:18432
v_lshl_add_u32 v1, v7, 4, s95
v_mfma_f32_16x16x32_bf16 v[184:187], a[172:175], a[100:103], v[184:187]
ds_read_b64_tr_b16 a[204:205], v22 offset:20480
v_lshl_add_u32 v43, v6, 9, v1
v_mfma_f32_16x16x32_bf16 v[184:187], a[168:171], a[92:95], v[184:187]
s_mul_i32 s95, s56, 0x1080
ds_read_b64_tr_b16 a[206:207], v22 offset:22528
v_lshl_add_u32 v1, v7, 2, s95
v_mfma_f32_16x16x32_bf16 v[184:187], a[164:167], a[84:87], v[184:187]
ds_read_b64_tr_b16 a[144:145], v19
v_cmp_gt_u32 vcc, 0x80, v53
s_nop 0
s_cbranch_vccnz L_spin_f1
L_back_f1:
v_mfma_f32_16x16x32_bf16 v[184:187], a[160:163], a[76:79], v[184:187]
s_waitcnt lgkmcnt(7)
ds_read_b64_tr_b16 a[146:147], v19 offset:2048
v_lshl_add_u32 v44, v6, 10, v1
v_mfma_f32_16x16x32_bf16 v[180:183], a[184:187], a[76:79], 0
ds_read_b64_tr_b16 a[148:149], v19 offset:4096
v_and_b32 v1, 31, v0
v_mfma_f32_16x16x32_bf16 v[180:183], a[188:191], a[84:87], v[180:183]
s_add_u32 s80, s36, 0x2c81000
ds_read_b64_tr_b16 a[150:151], v19 offset:6144
s_addc_u32 s81, s37, 0
v_mfma_f32_16x16x32_bf16 v[180:183], a[192:195], a[92:95], v[180:183]
s_waitcnt lgkmcnt(4)
ds_read_b64_tr_b16 a[152:153], v19 offset:8192
s_add_u32 s82, s36, 0x2c83000
v_mfma_f32_16x16x32_bf16 v[180:183], a[196:199], a[100:103], v[180:183]
s_addc_u32 s83, s37, 0
ds_read_b64_tr_b16 a[154:155], v19 offset:10240
s_add_u32 s84, s36, 0x2c85000
v_mfma_f32_16x16x32_bf16 v[180:183], a[200:203], a[108:111], v[180:183]
s_addc_u32 s85, s37, 0
ds_read_b64_tr_b16 a[156:157], v19 offset:12288
s_add_u32 s86, s36, 0x2c87000
v_mfma_f32_16x16x32_bf16 v[180:183], a[204:207], a[116:119], v[180:183]
s_addc_u32 s87, s37, 0
ds_read_b64_tr_b16 a[158:159], v19 offset:14336
ds_read_b64_tr_b16 a[160:161], v19 offset:16384
v_mfma_f32_16x16x32_bf16 v[164:167], a[204:207], a[112:115], 0
buffer_store_dwordx4 v[64:67], v47, s[36:39], s49 offen sc1
v_mfma_f32_16x16x32_bf16 v[164:167], a[200:203], a[104:107], v[164:167]
s_add_u32 s49, s93, 0x804000
ds_read_b64_tr_b16 a[162:163], v19 offset:18432
s_add_u32 s88, s36, 0x2c80000
v_mfma_f32_16x16x32_bf16 v[164:167], a[196:199], a[96:99], v[164:167]
s_waitcnt vmcnt(13)
ds_read_b64_tr_b16 a[164:165], v19 offset:20480
ds_read_b64_tr_b16 a[166:167], v19 offset:22528
v_mfma_f32_16x16x32_bf16 v[164:167], a[192:195], a[88:91], v[164:167]
s_barrier
v_mfma_f32_16x16x32_bf16 v[164:167], a[188:191], a[80:83], v[164:167]
s_addc_u32 s89, s37, 0
ds_read_b64_tr_b16 a[168:169], v19 offset:24576
s_add_u32 m0, s41, 0x4000
v_mfma_f32_16x16x32_bf16 v[164:167], a[184:187], a[72:75], v[164:167]
s_waitcnt lgkmcnt(7)
ds_read_b64_tr_b16 a[170:171], v19 offset:26624
s_add_u32 s96, s24, 0x9280
v_mfma_f32_16x16x32_bf16 v[160:163], a[144:147], a[72:75], 0
s_addc_u32 s97, s25, 0
ds_read_b64_tr_b16 a[172:173], v19 offset:28672
ds_read_b64_tr_b16 a[174:175], v19 offset:30720
v_mfma_f32_16x16x32_bf16 v[160:163], a[148:151], a[80:83], v[160:163]
global_load_lds_dwordx4 v16, s[96:97]
v_mfma_f32_16x16x32_bf16 v[160:163], a[152:155], a[88:91], v[160:163]
s_waitcnt lgkmcnt(4)
ds_read_b64_tr_b16 a[176:177], v19 offset:32768
s_add_u32 m0, s41, 0x5000
v_mfma_f32_16x16x32_bf16 v[160:163], a[156:159], a[96:99], v[160:163]
s_add_u32 s96, s24, 0x12280
ds_read_b64_tr_b16 a[178:179], v19 offset:34816
s_addc_u32 s97, s25, 0
v_mfma_f32_16x16x32_bf16 v[160:163], a[160:163], a[104:107], v[160:163]
s_add_u32 s90, s36, 0x2c88400
ds_read_b64_tr_b16 a[180:181], v22 offset:24576
ds_read_b64_tr_b16 a[182:183], v22 offset:26624
v_mfma_f32_16x16x32_bf16 v[160:163], a[164:167], a[112:115], v[160:163]
global_load_lds_dwordx4 v16, s[96:97]
v_mfma_f32_16x16x32_bf16 v[176:179], a[164:167], a[116:119], 0
s_addc_u32 s91, s37, 0
ds_read_b64_tr_b16 a[184:185], v22 offset:28672
s_add_u32 m0, s41, 0x6000
v_mfma_f32_16x16x32_bf16 v[176:179], a[160:163], a[108:111], v[176:179]
s_add_u32 s96, s24, 0x1b280
ds_read_b64_tr_b16 a[186:187], v22 offset:30720
s_addc_u32 s97, s25, 0
v_mfma_f32_16x16x32_bf16 v[176:179], a[156:159], a[100:103], v[176:179]
s_lshr_b32 s95, s63, 1
ds_read_b64_tr_b16 a[188:189], v22 offset:32768
ds_read_b64_tr_b16 a[190:191], v22 offset:34816
v_mfma_f32_16x16x32_bf16 v[176:179], a[152:155], a[92:95], v[176:179]
global_load_lds_dwordx4 v16, s[96:97]
v_mfma_f32_16x16x32_bf16 v[176:179], a[148:151], a[84:87], v[176:179]
s_add_u32 m0, s41, 0x7000
ds_read_b64_tr_b16 a[192:193], v25 offset:24576
s_add_u32 s96, s24, 0x24280
v_mfma_f32_16x16x32_bf16 v[176:179], a[144:147], a[76:79], v[176:179]
s_waitcnt lgkmcnt(7)
ds_read_b64_tr_b16 a[194:195], v25 offset:26624
s_addc_u32 s97, s25, 0
v_mfma_f32_16x16x32_bf16 v[176:179], a[168:171], a[124:127], v[176:179]
s_lshl_b32 s95, s95, 11
ds_read_b64_tr_b16 a[196:197], v25 offset:28672
ds_read_b64_tr_b16 a[198:199], v25 offset:30720
v_mfma_f32_16x16x32_bf16 v[176:179], a[172:175], a[132:135], v[176:179]
global_load_lds_dwordx4 v16, s[96:97]
v_mfma_f32_16x16x32_bf16 v[176:179], a[176:179], a[140:143], v[176:179]
s_add_u32 m0, s41, 0x8000
ds_read_b64_tr_b16 a[200:201], v25 offset:32768
s_add_u32 s96, s24, 0x2d280
v_mfma_f32_16x16x32_bf16 v[160:163], a[176:179], a[136:139], v[160:163]
s_addc_u32 s97, s25, 0
ds_read_b64_tr_b16 a[202:203], v25 offset:34816
ds_read_b64_tr_b16 a[204:205], v28 offset:24576
v_mfma_f32_16x16x32_bf16 v[160:163], a[172:175], a[128:131], v[160:163]
global_load_lds_dwordx4 v16, s[96:97]
v_mfma_f32_16x16x32_bf16 v[160:163], a[168:171], a[120:123], v[160:163]
s_waitcnt lgkmcnt(7)
ds_read_b64_tr_b16 a[206:207], v28 offset:26624
s_add_u32 m0, s41, 0x9000
v_mfma_f32_16x16x32_bf16 v[164:167], a[180:183], a[120:123], v[164:167]
s_add_u32 s96, s24, 0x36280
ds_read_b64_tr_b16 a[144:145], v28 offset:28672
s_addc_u32 s97, s25, 0
v_mfma_f32_16x16x32_bf16 v[164:167], a[184:187], a[128:131], v[164:167]
s_add_u32 s95, s95, 0x2ed0000
ds_read_b64_tr_b16 a[146:147], v28 offset:30720
s_and_b32 s56, s45, 3
v_mfma_f32_16x16x32_bf16 v[164:167], a[188:191], a[136:139], v[164:167]
s_lshl_b32 s56, s56, 9
ds_read_b64_tr_b16 a[148:149], v28 offset:32768
ds_read_b64_tr_b16 a[150:151], v28 offset:34816
v_mfma_f32_16x16x32_bf16 v[180:183], a[188:191], a[140:143], v[180:183]
global_load_lds_dwordx4 v16, s[96:97]
v_mfma_f32_16x16x32_bf16 v[180:183], a[184:187], a[132:135], v[180:183]
s_add_u32 m0, s41, 0xa000
ds_read_b64_tr_b16 a[152:153], v28 offset:36864
s_add_u32 s96, s24, 0x3f280
v_mfma_f32_16x16x32_bf16 v[180:183], a[180:183], a[124:127], v[180:183]
s_waitcnt lgkmcnt(7)
ds_read_b64_tr_b16 a[154:155], v28 offset:38912
s_addc_u32 s97, s25, 0
v_mfma_f32_16x16x32_bf16 v[184:187], a[192:195], a[124:127], v[184:187]
s_add_u32 s95, s95, s56
ds_read_b64_tr_b16 a[156:157], v28 offset:40960
v_min_u32 v51, 1, v0
v_mfma_f32_16x16x32_bf16 v[184:187], a[196:199], a[132:135], v[184:187]
ds_read_b64_tr_b16 a[158:159], v28 offset:43008
ds_read_b64_tr_b16 a[160:161], v28 offset:45056
v_mfma_f32_16x16x32_bf16 v[184:187], a[200:203], a[140:143], v[184:187]
buffer_store_dwordx4 v[68:71], v47, s[36:39], s49 offen sc1
v_mfma_f32_16x16x32_bf16 v[168:171], a[200:203], a[136:139], v[168:171]
s_add_u32 s49, s92, 0x808000
ds_read_b64_tr_b16 a[162:163], v28 offset:47104
v_cvt_pk_bf16_f32 v88, v160, v161
v_mfma_f32_16x16x32_bf16 v[168:171], a[196:199], a[128:131], v[168:171]
L_pg11:
s_cbranch_execz L_tr2
ds_read_b64_tr_b16 a[164:165], v25 offset:36864
v_cvt_pk_bf16_f32 v89, v162, v163
v_mfma_f32_16x16x32_bf16 v[168:171], a[192:195], a[120:123], v[168:171]
s_waitcnt lgkmcnt(7)
ds_read_b64_tr_b16 a[166:167], v25 offset:38912
v_cvt_pk_bf16_f32 v90, v164, v165
v_mfma_f32_16x16x32_bf16 v[172:175], a[204:207], a[120:123], v[172:175]
ds_read_b64_tr_b16 a[168:169], v25 offset:40960
ds_read_b64_tr_b16 a[170:171], v25 offset:43008
v_mfma_f32_16x16x32_bf16 v[172:175], a[144:147], a[128:131], v[172:175]
global_load_lds_dwordx4 v16, s[96:97]
v_mfma_f32_16x16x32_bf16 v[172:175], a[148:151], a[136:139], v[172:175]
s_add_u32 m0, s41, 0xb000
ds_read_b64_tr_b16 a[172:173], v25 offset:45056
v_cvt_pk_bf16_f32 v91, v166, v167
v_mfma_f32_16x16x32_bf16 v[188:191], a[148:151], a[140:143], v[188:191]
s_add_u32 s96, s24, 0x280
ds_read_b64_tr_b16 a[174:175], v25 offset:47104
v_cvt_pk_bf16_f32 v92, v176, v177
v_mfma_f32_16x16x32_bf16 v[188:191], a[144:147], a[132:135], v[188:191]
s_addc_u32 s97, s25, 0
ds_read_b64_tr_b16 a[176:177], v22 offset:36864
v_cvt_pk_bf16_f32 v93, v178, v179
v_mfma_f32_16x16x32_bf16 v[188:191], a[204:207], a[124:127], v[188:191]
s_waitcnt lgkmcnt(7)
ds_read_b64_tr_b16 a[178:179], v22 offset:38912
ds_read_b64_tr_b16 a[180:181], v22 offset:40960
v_mfma_f32_16x16x32_bf16 v[156:159], a[152:155], a[76:79], 0
global_load_lds_dwordx4 v17, s[96:97]
v_mfma_f32_16x16x32_bf16 v[156:159], a[156:159], a[84:87], v[156:159]
s_add_u32 m0, s41, 0xc000
ds_read_b64_tr_b16 a[182:183], v22 offset:43008
v_cvt_pk_bf16_f32 v94, v180, v181
v_mfma_f32_16x16x32_bf16 v[156:159], a[160:163], a[92:95], v[156:159]
s_add_u32 s96, s24, 0x300
ds_read_b64_tr_b16 a[184:185], v22 offset:45056
v_cvt_pk_bf16_f32 v95, v182, v183
v_mfma_f32_16x16x32_bf16 v[140:143], a[160:163], a[88:91], 0
s_addc_u32 s97, s25, 0
ds_read_b64_tr_b16 a[186:187], v22 offset:47104
v_cvt_pk_bf16_f32 v96, v168, v169
v_mfma_f32_16x16x32_bf16 v[140:143], a[156:159], a[80:83], v[140:143]
ds_read_b64_tr_b16 a[188:189], v19 offset:36864
v_cvt_pk_bf16_f32 v97, v170, v171
v_mfma_f32_16x16x32_bf16 v[140:143], a[152:155], a[72:75], v[140:143]
s_waitcnt lgkmcnt(7)
ds_read_b64_tr_b16 a[190:191], v19 offset:38912
ds_read_b64_tr_b16 a[192:193], v19 offset:40960
v_mfma_f32_16x16x32_bf16 v[136:139], a[164:167], a[72:75], 0
global_load_lds_dwordx4 v16, s[96:97]
v_mfma_f32_16x16x32_bf16 v[136:139], a[168:171], a[80:83], v[136:139]
s_add_u32 m0, s41, 0xd000
ds_read_b64_tr_b16 a[194:195], v19 offset:43008
v_cvt_pk_bf16_f32 v98, v172, v173
v_mfma_f32_16x16x32_bf16 v[136:139], a[172:175], a[88:91], v[136:139]
s_add_u32 s96, s24, 0x9300
ds_read_b64_tr_b16 a[196:197], v19 offset:45056
v_cvt_pk_bf16_f32 v99, v174, v175
v_mfma_f32_16x16x32_bf16 v[152:155], a[172:175], a[92:95], 0
s_addc_u32 s97, s25, 0
ds_read_b64_tr_b16 a[198:199], v19 offset:47104
ds_read_b64_tr_b16 a[200:201], v19 offset:49152
v_mfma_f32_16x16x32_bf16 v[152:155], a[168:171], a[84:87], v[152:155]
global_load_lds_dwordx4 v16, s[96:97]
v_mfma_f32_16x16x32_bf16 v[152:155], a[164:167], a[76:79], v[152:155]
s_waitcnt lgkmcnt(7)
ds_read_b64_tr_b16 a[202:203], v19 offset:51200
v_cvt_pk_bf16_f32 v100, v184, v185
v_mfma_f32_16x16x32_bf16 v[148:151], a[176:179], a[76:79], 0
s_add_u32 m0, s41, 0xe000
ds_read_b64_tr_b16 a[204:205], v19 offset:53248
v_cvt_pk_bf16_f32 v101, v186, v187
v_mfma_f32_16x16x32_bf16 v[148:151], a[180:183], a[84:87], v[148:151]
s_add_u32 s96, s24, 0x12300
ds_read_b64_tr_b16 a[206:207], v19 offset:55296
v_cvt_pk_bf16_f32 v102, v188, v189
v_mfma_f32_16x16x32_bf16 v[148:151], a[184:187], a[92:95], v[148:151]
s_addc_u32 s97, s25, 0
ds_read_b64_tr_b16 a[144:145], v19 offset:57344
ds_read_b64_tr_b16 a[146:147], v19 offset:59392
v_mfma_f32_16x16x32_bf16 v[132:135], a[184:187], a[88:91], 0
global_load_lds_dwordx4 v16, s[96:97]
v_mfma_f32_16x16x32_bf16 v[132:135], a[180:183], a[80:83], v[132:135]
s_add_u32 m0, s41, 0xf000
ds_read_b64_tr_b16 a[148:149], v19 offset:61440
v_cvt_pk_bf16_f32 v103, v190, v191
v_mfma_f32_16x16x32_bf16 v[132:135], a[176:179], a[72:75], v[132:135]
s_waitcnt lgkmcnt(7)
ds_read_b64_tr_b16 a[150:151], v19 offset:63488
v_lshl_add_u32 v51, v51, 31, s95
v_mfma_f32_16x16x32_bf16 v[128:131], a[188:191], a[72:75], 0
s_mov_b32 s95, 0x2ec0000
ds_read_b64_tr_b16 a[152:153], v20
s_add_u32 s96, s24, 0x1b300
v_mfma_f32_16x16x32_bf16 v[128:131], a[192:195], a[80:83], v[128:131]
s_addc_u32 s97, s25, 0
ds_read_b64_tr_b16 a[154:155], v20 offset:2048
ds_read_b64_tr_b16 a[156:157], v20 offset:4096
v_mfma_f32_16x16x32_bf16 v[128:131], a[196:199], a[88:91], v[128:131]
buffer_store_dwordx4 v[72:75], v47, s[36:39], s49 offen sc1
v_mfma_f32_16x16x32_bf16 v[144:147], a[196:199], a[92:95], 0
s_add_u32 s49, s93, 0x808000
ds_read_b64_tr_b16 a[158:159], v20 offset:6144
s_lshl_b32 s46, s61, 2
v_mfma_f32_16x16x32_bf16 v[144:147], a[192:195], a[84:87], v[144:147]
s_add_u32 s46, s46, s40
ds_read_b64_tr_b16 a[160:161], v22 offset:49152
s_mul_i32 s47, s46, 0x10800
v_mfma_f32_16x16x32_bf16 v[144:147], a[188:191], a[76:79], v[144:147]
s_waitcnt lgkmcnt(7)
ds_read_b64_tr_b16 a[162:163], v22 offset:51200
s_lshl_b32 s62, s44, 10
v_mfma_f32_16x16x32_bf16 v[144:147], a[200:203], a[100:103], v[144:147]
s_add_u32 s47, s47, s62
ds_read_b64_tr_b16 a[164:165], v22 offset:53248
ds_read_b64_tr_b16 a[166:167], v22 offset:55296
v_mfma_f32_16x16x32_bf16 v[144:147], a[204:207], a[108:111], v[144:147]
buffer_load_dword v9, v9, s[36:39], s95 offen sc1
v_mfma_f32_16x16x32_bf16 v[144:147], a[144:147], a[116:119], v[144:147]
s_waitcnt lgkmcnt(4)
ds_read_b64_tr_b16 a[168:169], v22 offset:57344
v_lshrrev_b32 v4, 5, v0
v_mfma_f32_16x16x32_bf16 v[144:147], a[148:151], a[124:127], v[144:147]
ds_read_b64_tr_b16 a[170:171], v22 offset:59392
ds_read_b64_tr_b16 a[172:173], v22 offset:61440
v_mfma_f32_16x16x32_bf16 v[144:147], a[152:155], a[132:135], v[144:147]
global_load_lds_dwordx4 v16, s[96:97]
v_mfma_f32_16x16x32_bf16 v[144:147], a[156:159], a[140:143], v[144:147]
ds_read_b64_tr_b16 a[174:175], v22 offset:63488
v_lshl_add_u32 v45, v0, 4, s47
v_mfma_f32_16x16x32_bf16 v[128:131], a[156:159], a[136:139], v[128:131]
s_mul_i32 s47, s46, 0x2100
ds_read_b64_tr_b16 a[176:177], v23
s_lshl_b32 s62, s44, 7
v_mfma_f32_16x16x32_bf16 v[128:131], a[152:155], a[128:131], v[128:131]
s_add_u32 s47, s47, s62
ds_read_b64_tr_b16 a[178:179], v23 offset:2048
s_add_u32 s47, s47, 0x2c00000
v_mfma_f32_16x16x32_bf16 v[128:131], a[148:151], a[120:123], v[128:131]
ds_read_b64_tr_b16 a[180:181], v23 offset:4096
v_lshl_add_u32 v1, v1, 2, s47
v_mfma_f32_16x16x32_bf16 v[128:131], a[144:147], a[112:115], v[128:131]
ds_read_b64_tr_b16 a[182:183], v23 offset:6144
v_lshrrev_b32 v2, 5, v0
v_mfma_f32_16x16x32_bf16 v[128:131], a[204:207], a[104:107], v[128:131]
ds_read_b64_tr_b16 a[184:185], v25 offset:49152
v_mul_u32_u24 v2, 0x1080, v2
v_mfma_f32_16x16x32_bf16 v[128:131], a[200:203], a[96:99], v[128:131]
s_waitcnt lgkmcnt(7)
ds_read_b64_tr_b16 a[186:187], v25 offset:51200
v_add_u32 v46, v2, v1
v_mfma_f32_16x16x32_bf16 v[132:135], a[160:163], a[96:99], v[132:135]
ds_read_b64_tr_b16 a[188:189], v25 offset:53248
v_mul_u32_u24 v2, 0x500, v4
v_mfma_f32_16x16x32_bf16 v[132:135], a[164:167], a[104:107], v[132:135]
ds_read_b64_tr_b16 a[190:191], v25 offset:55296
v_add_u32 v2, v2, v31
v_mfma_f32_16x16x32_bf16 v[132:135], a[168:171], a[112:115], v[132:135]
s_waitcnt lgkmcnt(4)
ds_read_b64_tr_b16 a[192:193], v25 offset:57344
s_lshl_b32 s46, s61, 2
v_mfma_f32_16x16x32_bf16 v[132:135], a[172:175], a[120:123], v[132:135]
s_add_u32 s46, s46, s40
ds_read_b64_tr_b16 a[194:195], v25 offset:59392
s_mul_i32 s46, s46, 0xa00
v_mfma_f32_16x16x32_bf16 v[132:135], a[176:179], a[128:131], v[132:135]
s_mul_i32 s47, s44, 0x14000
ds_read_b64_tr_b16 a[196:197], v25 offset:61440
s_add_u32 s95, s46, s47
v_mfma_f32_16x16x32_bf16 v[132:135], a[180:183], a[136:139], v[132:135]
ds_read_b64_tr_b16 a[198:199], v25 offset:63488
ds_read_b64_tr_b16 a[200:201], v26
v_mfma_f32_16x16x32_bf16 v[148:151], a[180:183], a[140:143], v[148:151]
buffer_load_dwordx4 a[0:3], v30, s[36:39], s95 offen sc1
v_mfma_f32_16x16x32_bf16 v[148:151], a[176:179], a[132:135], v[148:151]
ds_read_b64_tr_b16 a[202:203], v26 offset:2048
v_mfma_f32_16x16x32_bf16 v[148:151], a[172:175], a[124:127], v[148:151]
ds_read_b64_tr_b16 a[204:205], v26 offset:4096
ds_read_b64_tr_b16 a[206:207], v26 offset:6144
v_mfma_f32_16x16x32_bf16 v[148:151], a[168:171], a[116:119], v[148:151]
buffer_load_dwordx4 a[4:7], v30, s[36:39], s95 offen offset:1280 sc1
v_mfma_f32_16x16x32_bf16 v[148:151], a[164:167], a[108:111], v[148:151]
ds_read_b64_tr_b16 a[144:145], v28 offset:49152
v_mfma_f32_16x16x32_bf16 v[148:151], a[160:163], a[100:103], v[148:151]
s_waitcnt lgkmcnt(7)
ds_read_b64_tr_b16 a[146:147], v28 offset:51200
ds_read_b64_tr_b16 a[148:149], v28 offset:53248
v_mfma_f32_16x16x32_bf16 v[152:155], a[184:187], a[100:103], v[152:155]
buffer_load_dword v14, v2, s[36:39], s95 offen sc1
v_mfma_f32_16x16x32_bf16 v[152:155], a[188:191], a[108:111], v[152:155]
s_add_u32 s95, s47, 0x280000
ds_read_b64_tr_b16 a[150:151], v28 offset:55296
v_mfma_f32_16x16x32_bf16 v[152:155], a[192:195], a[116:119], v[152:155]
s_waitcnt lgkmcnt(4)
ds_read_b64_tr_b16 a[152:153], v28 offset:57344
ds_read_b64_tr_b16 a[154:155], v28 offset:59392
v_mfma_f32_16x16x32_bf16 v[152:155], a[196:199], a[124:127], v[152:155]
buffer_store_dwordx4 v[76:79], v47, s[36:39], s49 offen sc1
v_mfma_f32_16x16x32_bf16 v[152:155], a[200:203], a[132:135], v[152:155]
s_add_u32 s49, s92, 0x80c000
ds_read_b64_tr_b16 a[156:157], v28 offset:61440
v_cvt_pk_bf16_f32 v104, v128, v129
v_mfma_f32_16x16x32_bf16 v[152:155], a[204:207], a[140:143], v[152:155]
ds_read_b64_tr_b16 a[158:159], v28 offset:63488
v_cvt_pk_bf16_f32 v105, v130, v131
v_mfma_f32_16x16x32_bf16 v[136:139], a[204:207], a[136:139], v[136:139]
ds_read_b64_tr_b16 a[160:161], v29
ds_read_b64_tr_b16 a[162:163], v29 offset:2048
v_mfma_f32_16x16x32_bf16 v[136:139], a[200:203], a[128:131], v[136:139]
buffer_load_dwordx4 a[40:43], v30, s[36:39], s95 offen sc1
v_mfma_f32_16x16x32_bf16 v[136:139], a[196:199], a[120:123], v[136:139]
s_waitcnt vmcnt(18)
ds_read_b64_tr_b16 a[164:165], v29 offset:4096
ds_read_b64_tr_b16 a[166:167], v29 offset:6144
v_mfma_f32_16x16x32_bf16 v[136:139], a[192:195], a[112:115], v[136:139]
s_barrier
v_mfma_f32_16x16x32_bf16 v[136:139], a[188:191], a[104:107], v[136:139]
s_add_u32 m0, s41, 0x10000
ds_read_b64_tr_b16 a[168:169], v29 offset:8192
v_cvt_pk_bf16_f32 v106, v132, v133
v_mfma_f32_16x16x32_bf16 v[136:139], a[184:187], a[96:99], v[136:139]
s_waitcnt lgkmcnt(7)
ds_read_b64_tr_b16 a[170:171], v29 offset:10240
ds_read_b64_tr_b16 a[172:173], v29 offset:12288
v_mfma_f32_16x16x32_bf16 v[140:143], a[144:147], a[96:99], v[140:143]
buffer_load_dwordx2 a[52:53], v31, s[36:39], s95 offen sc1
v_mfma_f32_16x16x32_bf16 v[140:143], a[148:151], a[104:107], v[140:143]
s_add_u32 s96, s24, 0x24300
ds_read_b64_tr_b16 a[174:175], v29 offset:14336
v_cvt_pk_bf16_f32 v107, v134, v135
v_mfma_f32_16x16x32_bf16 v[140:143], a[152:155], a[112:115], v[140:143]
s_waitcnt lgkmcnt(4)
ds_read_b64_tr_b16 a[176:177], v29 offset:16384
ds_read_b64_tr_b16 a[178:179], v29 offset:18432
v_mfma_f32_16x16x32_bf16 v[140:143], a[156:159], a[120:123], v[140:143]
buffer_load_dwordx4 a[44:47], v30, s[36:39], s95 offen offset:1280 sc1
v_mfma_f32_16x16x32_bf16 v[140:143], a[160:163], a[128:131], v[140:143]
s_addc_u32 s97, s25, 0
ds_read_b64_tr_b16 a[180:181], v29 offset:20480
v_cvt_pk_bf16_f32 v108, v144, v145
v_mfma_f32_16x16x32_bf16 v[140:143], a[164:167], a[136:139], v[140:143]
ds_read_b64_tr_b16 a[182:183], v29 offset:22528
v_cvt_pk_bf16_f32 v109, v146, v147
v_mfma_f32_16x16x32_bf16 v[156:159], a[164:167], a[140:143], v[156:159]
ds_read_b64_tr_b16 a[184:185], v29 offset:24576
ds_read_b64_tr_b16 a[186:187], v29 offset:26624
v_mfma_f32_16x16x32_bf16 v[156:159], a[160:163], a[132:135], v[156:159]
buffer_load_dwordx2 a[56:57], v31, s[36:39], s95 offen offset:1280 sc1
v_mfma_f32_16x16x32_bf16 v[156:159], a[156:159], a[124:127], v[156:159]
ds_read_b64_tr_b16 a[188:189], v29 offset:28672
v_cvt_pk_bf16_f32 v110, v148, v149
v_mfma_f32_16x16x32_bf16 v[156:159], a[152:155], a[116:119], v[156:159]
ds_read_b64_tr_b16 a[190:191], v29 offset:30720
ds_read_b64_tr_b16 a[192:193], v26 offset:8192
v_mfma_f32_16x16x32_bf16 v[156:159], a[148:151], a[108:111], v[156:159]
global_load_lds_dwordx4 v16, s[96:97]
v_mfma_f32_16x16x32_bf16 v[156:159], a[144:147], a[100:103], v[156:159]
s_waitcnt lgkmcnt(7)
ds_read_b64_tr_b16 a[194:195], v26 offset:10240
v_cvt_pk_bf16_f32 v111, v150, v151
v_mfma_f32_16x16x32_bf16 v[188:191], a[168:171], a[76:79], 0
s_add_u32 m0, s41, 0x11000
ds_read_b64_tr_b16 a[196:197], v26 offset:12288
v_add_u32 v30, 0, v30
v_mfma_f32_16x16x32_bf16 v[188:191], a[172:175], a[84:87], v[188:191]
s_add_u32 s96, s24, 0x2d300
ds_read_b64_tr_b16 a[198:199], v26 offset:14336
v_add_u32 v31, 0, v31
v_mfma_f32_16x16x32_bf16 v[188:191], a[176:179], a[92:95], v[188:191]
s_waitcnt lgkmcnt(4)
ds_read_b64_tr_b16 a[200:201], v26 offset:16384
v_mov_b32 v15, 0
v_mfma_f32_16x16x32_bf16 v[188:191], a[180:183], a[100:103], v[188:191]
s_addc_u32 s97, s25, 0
ds_read_b64_tr_b16 a[202:203], v26 offset:18432
ds_read_b64_tr_b16 a[204:205], v26 offset:20480
v_mfma_f32_16x16x32_bf16 v[188:191], a[184:187], a[108:111], v[188:191]
global_load_lds_dwordx4 v16, s[96:97]
v_mfma_f32_16x16x32_bf16 v[188:191], a[188:191], a[116:119], v[188:191]
s_add_u32 m0, s41, 0x12000
ds_read_b64_tr_b16 a[206:207], v26 offset:22528
v_cvt_pk_bf16_f32 v112, v136, v137
v_mfma_f32_16x16x32_bf16 v[172:175], a[188:191], a[112:115], 0
s_add_u32 s96, s24, 0x36300
ds_read_b64_tr_b16 a[144:145], v26 offset:24576
v_cvt_pk_bf16_f32 v113, v138, v139
v_mfma_f32_16x16x32_bf16 v[172:175], a[184:187], a[104:107], v[172:175]
s_addc_u32 s97, s25, 0
ds_read_b64_tr_b16 a[146:147], v26 offset:26624
ds_read_b64_tr_b16 a[148:149], v26 offset:28672
v_mfma_f32_16x16x32_bf16 v[172:175], a[180:183], a[96:99], v[172:175]
buffer_store_dwordx4 v[80:83], v47, s[36:39], s49 offen sc1
v_mfma_f32_16x16x32_bf16 v[172:175], a[176:179], a[88:91], v[172:175]
s_add_u32 s49, s93, 0x80c000
ds_read_b64_tr_b16 a[150:151], v26 offset:30720
v_cvt_pk_bf16_f32 v114, v140, v141
v_mfma_f32_16x16x32_bf16 v[172:175], a[172:175], a[80:83], v[172:175]
ds_read_b64_tr_b16 a[152:153], v23 offset:8192
v_cvt_pk_bf16_f32 v115, v142, v143
v_mfma_f32_16x16x32_bf16 v[172:175], a[168:171], a[72:75], v[172:175]
s_waitcnt lgkmcnt(7)
ds_read_b64_tr_b16 a[154:155], v23 offset:10240
v_cvt_pk_bf16_f32 v116, v152, v153
v_mfma_f32_16x16x32_bf16 v[168:171], a[192:195], a[72:75], 0
ds_read_b64_tr_b16 a[156:157], v23 offset:12288
ds_read_b64_tr_b16 a[158:159], v23 offset:14336
v_mfma_f32_16x16x32_bf16 v[168:171], a[196:199], a[80:83], v[168:171]
global_load_lds_dwordx4 v16, s[96:97]
v_mfma_f32_16x16x32_bf16 v[168:171], a[200:203], a[88:91], v[168:171]
s_waitcnt lgkmcnt(4)
ds_read_b64_tr_b16 a[160:161], v23 offset:16384
v_cvt_pk_bf16_f32 v117, v154, v155
v_mfma_f32_16x16x32_bf16 v[168:171], a[204:207], a[96:99], v[168:171]
s_add_u32 m0, s41, 0x13000
ds_read_b64_tr_b16 a[162:163], v23 offset:18432
v_cvt_pk_bf16_f32 v118, v156, v157
v_mfma_f32_16x16x32_bf16 v[168:171], a[144:147], a[104:107], v[168:171]
s_add_u32 s96, s24, 0x3f300
ds_read_b64_tr_b16 a[164:165], v23 offset:20480
v_cvt_pk_bf16_f32 v119, v158, v159
v_mfma_f32_16x16x32_bf16 v[168:171], a[148:151], a[112:115], v[168:171]
s_addc_u32 s97, s25, 0
ds_read_b64_tr_b16 a[166:167], v23 offset:22528
ds_read_b64_tr_b16 a[168:169], v23 offset:24576
v_mfma_f32_16x16x32_bf16 v[184:187], a[148:151], a[116:119], 0
global_load_lds_dwordx4 v16, s[96:97]
v_mfma_f32_16x16x32_bf16 v[184:187], a[144:147], a[108:111], v[184:187]
s_add_u32 m0, s41, 0x14000
ds_read_b64_tr_b16 a[170:171], v23 offset:26624
v_mov_b32 v54, 0xdddd
v_mfma_f32_16x16x32_bf16 v[184:187], a[204:207], a[100:103], v[184:187]
s_add_u32 s96, s24, 0x300
ds_read_b64_tr_b16 a[172:173], v23 offset:28672
s_addc_u32 s97, s25, 0
v_mfma_f32_16x16x32_bf16 v[184:187], a[200:203], a[92:95], v[184:187]
ds_read_b64_tr_b16 a[174:175], v23 offset:30720
v_mfma_f32_16x16x32_bf16 v[184:187], a[196:199], a[84:87], v[184:187]
ds_read_b64_tr_b16 a[176:177], v20 offset:8192
v_mfma_f32_16x16x32_bf16 v[184:187], a[192:195], a[76:79], v[184:187]
s_waitcnt lgkmcnt(7)
ds_read_b64_tr_b16 a[178:179], v20 offset:10240
ds_read_b64_tr_b16 a[180:181], v20 offset:12288
v_mfma_f32_16x16x32_bf16 v[180:183], a[152:155], a[76:79], 0
global_load_lds_dwordx4 v17, s[96:97]
v_mfma_f32_16x16x32_bf16 v[180:183], a[156:159], a[84:87], v[180:183]
s_add_u32 m0, s41, 0x15000
ds_read_b64_tr_b16 a[182:183], v20 offset:14336
s_add_u32 s96, s24, 0x380
v_mfma_f32_16x16x32_bf16 v[180:183], a[160:163], a[92:95], v[180:183]
s_waitcnt lgkmcnt(4)
ds_read_b64_tr_b16 a[184:185], v20 offset:16384
s_addc_u32 s97, s25, 0
v_mfma_f32_16x16x32_bf16 v[180:183], a[164:167], a[100:103], v[180:183]
ds_read_b64_tr_b16 a[186:187], v20 offset:18432
ds_read_b64_tr_b16 a[188:189], v20 offset:20480
v_mfma_f32_16x16x32_bf16 v[180:183], a[168:171], a[108:111], v[180:183]
global_load_lds_dwordx4 v16, s[96:97]
v_mfma_f32_16x16x32_bf16 v[180:183], a[172:175], a[116:119], v[180:183]
s_add_u32 m0, s41, 0x16000
ds_read_b64_tr_b16 a[190:191], v20 offset:22528
s_add_u32 s96, s24, 0x9380
v_mfma_f32_16x16x32_bf16 v[164:167], a[172:175], a[112:115], 0
s_addc_u32 s97, s25, 0
ds_read_b64_tr_b16 a[192:193], v20 offset:24576
v_mfma_f32_16x16x32_bf16 v[164:167], a[168:171], a[104:107], v[164:167]
ds_read_b64_tr_b16 a[194:195], v20 offset:26624
v_mfma_f32_16x16x32_bf16 v[164:167], a[164:167], a[96:99], v[164:167]
ds_read_b64_tr_b16 a[196:197], v20 offset:28672
ds_read_b64_tr_b16 a[198:199], v20 offset:30720
v_mfma_f32_16x16x32_bf16 v[164:167], a[160:163], a[88:91], v[164:167]
global_load_lds_dwordx4 v16, s[96:97]
v_mfma_f32_16x16x32_bf16 v[164:167], a[156:159], a[80:83], v[164:167]
s_add_u32 m0, s41, 0x17000
ds_read_b64_tr_b16 a[200:201], v18
s_add_u32 s96, s24, 0x12380
v_mfma_f32_16x16x32_bf16 v[164:167], a[152:155], a[72:75], v[164:167]
s_waitcnt lgkmcnt(7)
ds_read_b64_tr_b16 a[202:203], v18 offset:2048
s_addc_u32 s97, s25, 0
v_mfma_f32_16x16x32_bf16 v[160:163], a[176:179], a[72:75], 0
ds_read_b64_tr_b16 a[204:205], v18 offset:4096
v_mfma_f32_16x16x32_bf16 v[160:163], a[180:183], a[80:83], v[160:163]
ds_read_b64_tr_b16 a[206:207], v18 offset:6144
v_mfma_f32_16x16x32_bf16 v[160:163], a[184:187], a[88:91], v[160:163]
s_waitcnt lgkmcnt(4)
ds_read_b64_tr_b16 a[144:145], v18 offset:8192
ds_read_b64_tr_b16 a[146:147], v18 offset:10240
v_mfma_f32_16x16x32_bf16 v[160:163], a[188:191], a[96:99], v[160:163]
buffer_store_dwordx4 v[84:87], v47, s[36:39], s49 offen sc1
v_mfma_f32_16x16x32_bf16 v[160:163], a[192:195], a[104:107], v[160:163]
s_add_u32 s49, s92, 0x810000
ds_read_b64_tr_b16 a[148:149], v21
v_mfma_f32_16x16x32_bf16 v[160:163], a[196:199], a[112:115], v[160:163]
ds_read_b64_tr_b16 a[150:151], v21 offset:2048
v_mfma_f32_16x16x32_bf16 v[176:179], a[196:199], a[116:119], 0
ds_read_b64_tr_b16 a[152:153], v21 offset:4096
ds_read_b64_tr_b16 a[154:155], v21 offset:6144
v_mfma_f32_16x16x32_bf16 v[176:179], a[192:195], a[108:111], v[176:179]
global_load_lds_dwordx4 v16, s[96:97]
v_mfma_f32_16x16x32_bf16 v[176:179], a[188:191], a[100:103], v[176:179]
s_add_u32 m0, s41, 0x18000
ds_read_b64_tr_b16 a[156:157], v21 offset:8192
s_add_u32 s96, s24, 0x1b380
v_mfma_f32_16x16x32_bf16 v[176:179], a[184:187], a[92:95], v[176:179]
s_addc_u32 s97, s25, 0
ds_read_b64_tr_b16 a[158:159], v21 offset:10240
v_mfma_f32_16x16x32_bf16 v[176:179], a[180:183], a[84:87], v[176:179]
ds_read_b64_tr_b16 a[160:161], v24
v_mfma_f32_16x16x32_bf16 v[176:179], a[176:179], a[76:79], v[176:179]
s_waitcnt lgkmcnt(7)
ds_read_b64_tr_b16 a[162:163], v24 offset:2048
ds_read_b64_tr_b16 a[164:165], v24 offset:4096
v_mfma_f32_16x16x32_bf16 v[176:179], a[200:203], a[124:127], v[176:179]
global_load_lds_dwordx4 v16, s[96:97]
v_mfma_f32_16x16x32_bf16 v[176:179], a[204:207], a[132:135], v[176:179]
s_add_u32 m0, s41, 0x19000
ds_read_b64_tr_b16 a[166:167], v24 offset:6144
s_add_u32 s96, s24, 0x24380
v_mfma_f32_16x16x32_bf16 v[176:179], a[144:147], a[140:143], v[176:179]
s_addc_u32 s97, s25, 0
ds_read_b64_tr_b16 a[168:169], v24 offset:8192
v_mfma_f32_16x16x32_bf16 v[160:163], a[144:147], a[136:139], v[160:163]
ds_read_b64_tr_b16 a[170:171], v24 offset:10240
v_mfma_f32_16x16x32_bf16 v[160:163], a[204:207], a[128:131], v[160:163]
ds_read_b64_tr_b16 a[172:173], v27
v_mfma_f32_16x16x32_bf16 v[160:163], a[200:203], a[120:123], v[160:163]
s_waitcnt lgkmcnt(7)
ds_read_b64_tr_b16 a[174:175], v27 offset:2048
ds_read_b64_tr_b16 a[176:177], v27 offset:4096
v_mfma_f32_16x16x32_bf16 v[164:167], a[148:151], a[120:123], v[164:167]
global_load_lds_dwordx4 v16, s[96:97]
v_mfma_f32_16x16x32_bf16 v[164:167], a[152:155], a[128:131], v[164:167]
s_add_u32 m0, s41, 0x1a000
ds_read_b64_tr_b16 a[178:179], v27 offset:6144
s_add_u32 s96, s24, 0x2d380
v_mfma_f32_16x16x32_bf16 v[164:167], a[156:159], a[136:139], v[164:167]
s_addc_u32 s97, s25, 0
ds_read_b64_tr_b16 a[180:181], v27 offset:8192
v_mfma_f32_16x16x32_bf16 v[180:183], a[156:159], a[140:143], v[180:183]
ds_read_b64_tr_b16 a[182:183], v27 offset:10240
ds_read_b64_tr_b16 a[184:185], v27 offset:12288
v_mfma_f32_16x16x32_bf16 v[180:183], a[152:155], a[132:135], v[180:183]
global_load_lds_dwordx4 v16, s[96:97]
v_mfma_f32_16x16x32_bf16 v[180:183], a[148:151], a[124:127], v[180:183]
s_waitcnt lgkmcnt(7)
ds_read_b64_tr_b16 a[186:187], v27 offset:14336
s_add_u32 m0, s41, 0x1b000
v_mfma_f32_16x16x32_bf16 v[184:187], a[160:163], a[124:127], v[184:187]
s_add_u32 s96, s24, 0x36380
ds_read_b64_tr_b16 a[188:189], v27 offset:16384
s_addc_u32 s97, s25, 0
v_mfma_f32_16x16x32_bf16 v[184:187], a[164:167], a[132:135], v[184:187]
ds_read_b64_tr_b16 a[190:191], v27 offset:18432
v_mfma_f32_16x16x32_bf16 v[184:187], a[168:171], a[140:143], v[184:187]
ds_read_b64_tr_b16 a[192:193], v27 offset:20480
ds_read_b64_tr_b16 a[194:195], v27 offset:22528
v_mfma_f32_16x16x32_bf16 v[168:171], a[168:171], a[136:139], v[168:171]
global_load_lds_dwordx4 v16, s[96:97]
v_mfma_f32_16x16x32_bf16 v[168:171], a[164:167], a[128:131], v[168:171]
ds_read_b64_tr_b16 a[196:197], v24 offset:12288
v_cvt_pk_bf16_f32 v120, v160, v161
v_mfma_f32_16x16x32_bf16 v[168:171], a[160:163], a[120:123], v[168:171]
s_waitcnt lgkmcnt(7)
ds_read_b64_tr_b16 a[198:199], v24 offset:14336
v_cvt_pk_bf16_f32 v121, v162, v163
v_mfma_f32_16x16x32_bf16 v[172:175], a[172:175], a[120:123], v[172:175]
ds_read_b64_tr_b16 a[200:201], v24 offset:16384
v_cvt_pk_bf16_f32 v122, v164, v165
v_mfma_f32_16x16x32_bf16 v[172:175], a[176:179], a[128:131], v[172:175]
ds_read_b64_tr_b16 a[202:203], v24 offset:18432
v_cvt_pk_bf16_f32 v123, v166, v167
v_mfma_f32_16x16x32_bf16 v[172:175], a[180:183], a[136:139], v[172:175]
ds_read_b64_tr_b16 a[204:205], v24 offset:20480
v_cvt_pk_bf16_f32 v124, v176, v177
v_mfma_f32_16x16x32_bf16 v[188:191], a[180:183], a[140:143], v[188:191]
ds_read_b64_tr_b16 a[206:207], v24 offset:22528
v_cvt_pk_bf16_f32 v125, v178, v179
v_mfma_f32_16x16x32_bf16 v[188:191], a[176:179], a[132:135], v[188:191]
ds_read_b64_tr_b16 a[144:145], v21 offset:12288
v_cvt_pk_bf16_f32 v126, v180, v181
s_waitcnt vmcnt(14)
v_mfma_f32_32x32x4_2b_bf16 v[192:223], a[52:53], v[14:15], 0
buffer_store_dwordx4 v[88:91], v47, s[36:39], s49 offen sc1
v_mfma_f32_16x16x32_bf16 v[188:191], a[172:175], a[124:127], v[188:191]
s_waitcnt lgkmcnt(7)
ds_read_b64_tr_b16 a[146:147], v21 offset:14336
v_cvt_pk_bf16_f32 v127, v182, v183
v_mfma_f32_16x16x32_bf16 v[156:159], a[184:187], a[76:79], 0
s_add_u32 s49, s93, 0x810000
ds_read_b64_tr_b16 a[148:149], v21 offset:16384
v_mfma_f32_16x16x32_bf16 v[156:159], a[188:191], a[84:87], v[156:159]
ds_read_b64_tr_b16 a[150:151], v21 offset:18432
v_mfma_f32_16x16x32_bf16 v[156:159], a[192:195], a[92:95], v[156:159]
ds_read_b64_tr_b16 a[152:153], v21 offset:20480
v_mfma_f32_16x16x32_bf16 v[140:143], a[192:195], a[88:91], 0
ds_read_b64_tr_b16 a[154:155], v21 offset:22528
v_cvt_pk_bf16_f32 v56, v168, v169
v_mfma_f32_16x16x32_bf16 v[140:143], a[188:191], a[80:83], v[140:143]
ds_read_b64_tr_b16 a[156:157], v18 offset:12288
v_cvt_pk_bf16_f32 v57, v170, v171
v_mfma_f32_16x16x32_bf16 v[140:143], a[184:187], a[72:75], v[140:143]
s_waitcnt lgkmcnt(7)
ds_read_b64_tr_b16 a[158:159], v18 offset:14336
v_cvt_pk_bf16_f32 v58, v172, v173
v_mfma_f32_16x16x32_bf16 v[136:139], a[196:199], a[72:75], 0
ds_read_b64_tr_b16 a[160:161], v18 offset:16384
v_cvt_pk_bf16_f32 v59, v174, v175
v_mfma_f32_16x16x32_bf16 v[136:139], a[200:203], a[80:83], v[136:139]
ds_read_b64_tr_b16 a[162:163], v18 offset:18432
v_cvt_pk_bf16_f32 v60, v184, v185
v_mfma_f32_16x16x32_bf16 v[136:139], a[204:207], a[88:91], v[136:139]
s_waitcnt vmcnt(13)
ds_read_b64_tr_b16 a[164:165], v18 offset:20480
ds_read_b64_tr_b16 a[166:167], v18 offset:22528
v_mfma_f32_16x16x32_bf16 v[152:155], a[204:207], a[92:95], 0
s_barrier
v_mfma_f32_16x16x32_bf16 v[152:155], a[200:203], a[84:87], v[152:155]
s_add_u32 m0, s41, 0x1c000
ds_read_b64_tr_b16 a[168:169], v18 offset:24576
v_cvt_pk_bf16_f32 v61, v186, v187
v_mfma_f32_16x16x32_bf16 v[152:155], a[196:199], a[76:79], v[152:155]
s_waitcnt lgkmcnt(7)
ds_read_b64_tr_b16 a[170:171], v18 offset:26624
v_cvt_pk_bf16_f32 v62, v188, v189
v_mfma_f32_16x16x32_bf16 v[148:151], a[144:147], a[76:79], 0
s_add_u32 s96, s24, 0x3f380
ds_read_b64_tr_b16 a[172:173], v18 offset:28672
v_cvt_pk_bf16_f32 v63, v190, v191
v_mfma_f32_16x16x32_bf16 v[148:151], a[148:151], a[84:87], v[148:151]
s_addc_u32 s97, s25, 0
ds_read_b64_tr_b16 a[174:175], v18 offset:30720
ds_read_b64_tr_b16 a[176:177], v18 offset:32768
v_mfma_f32_16x16x32_bf16 v[148:151], a[152:155], a[92:95], v[148:151]
global_load_lds_dwordx4 v16, s[96:97]
v_mfma_f32_16x16x32_bf16 v[132:135], a[152:155], a[88:91], 0
s_add_u32 m0, s41, 0x1d000
ds_read_b64_tr_b16 a[178:179], v18 offset:34816
s_add_u32 s96, s24, 0x380
v_mfma_f32_16x16x32_bf16 v[132:135], a[148:151], a[80:83], v[132:135]
s_addc_u32 s97, s25, 0
ds_read_b64_tr_b16 a[180:181], v18 offset:36864
v_mfma_f32_16x16x32_bf16 v[132:135], a[144:147], a[72:75], v[132:135]
s_waitcnt lgkmcnt(7)
ds_read_b64_tr_b16 a[182:183], v18 offset:38912
ds_read_b64_tr_b16 a[184:185], v18 offset:40960
v_mfma_f32_16x16x32_bf16 v[128:131], a[156:159], a[72:75], 0
L_pg12:
s_cbranch_execz L_tr3
global_load_lds_dwordx4 v17, s[96:97]
v_mfma_f32_16x16x32_bf16 v[128:131], a[160:163], a[80:83], v[128:131]
s_add_u32 m0, s41, 0x1e000
ds_read_b64_tr_b16 a[186:187], v18 offset:43008
s_add_u32 s96, s24, 0x400
v_mfma_f32_16x16x32_bf16 v[128:131], a[164:167], a[88:91], v[128:131]
s_addc_u32 s97, s25, 0
ds_read_b64_tr_b16 a[188:189], v18 offset:45056
ds_read_b64_tr_b16 a[190:191], v18 offset:47104
v_mfma_f32_16x16x32_bf16 v[144:147], a[164:167], a[92:95], 0
global_load_lds_dwordx4 v16, s[96:97]
v_mfma_f32_16x16x32_bf16 v[144:147], a[160:163], a[84:87], v[144:147]
s_add_u32 m0, s41, 0x1f000
ds_read_b64_tr_b16 a[192:193], v21 offset:24576
s_add_u32 s96, s24, 0x9400
v_mfma_f32_16x16x32_bf16 v[144:147], a[156:159], a[76:79], v[144:147]
s_waitcnt lgkmcnt(7)
ds_read_b64_tr_b16 a[194:195], v21 offset:26624
s_addc_u32 s97, s25, 0
v_mfma_f32_16x16x32_bf16 v[144:147], a[168:171], a[100:103], v[144:147]
ds_read_b64_tr_b16 a[196:197], v21 offset:28672
ds_read_b64_tr_b16 a[198:199], v21 offset:30720
v_mfma_f32_16x16x32_bf16 v[144:147], a[172:175], a[108:111], v[144:147]
global_load_lds_dwordx4 v16, s[96:97]
v_mfma_f32_16x16x32_bf16 v[144:147], a[176:179], a[116:119], v[144:147]
s_waitcnt lgkmcnt(4)
ds_read_b64_tr_b16 a[200:201], v21 offset:32768
s_add_u32 m0, s41, 0x20000
v_mfma_f32_16x16x32_bf16 v[144:147], a[180:183], a[124:127], v[144:147]
s_add_u32 s96, s24, 0x12400
ds_read_b64_tr_b16 a[202:203], v21 offset:34816
s_addc_u32 s97, s25, 0
v_mfma_f32_32x32x4_2b_bf16 v[224:255], a[56:57], v[14:15], 0
buffer_store_dwordx4 v[92:95], v47, s[36:39], s49 offen sc1
v_mfma_f32_16x16x32_bf16 v[144:147], a[184:187], a[132:135], v[144:147]
s_add_u32 s49, s92, 0x814000
ds_read_b64_tr_b16 a[204:205], v21 offset:36864
v_mfma_f32_16x16x32_bf16 v[144:147], a[188:191], a[140:143], v[144:147]
ds_read_b64_tr_b16 a[206:207], v21 offset:38912
v_mfma_f32_16x16x32_bf16 v[128:131], a[188:191], a[136:139], v[128:131]
ds_read_b64_tr_b16 a[144:145], v21 offset:40960
v_mfma_f32_16x16x32_bf16 v[128:131], a[184:187], a[128:131], v[128:131]
ds_read_b64_tr_b16 a[146:147], v21 offset:43008
v_mfma_f32_16x16x32_bf16 v[128:131], a[180:183], a[120:123], v[128:131]
ds_read_b64_tr_b16 a[148:149], v21 offset:45056
v_mfma_f32_16x16x32_bf16 v[128:131], a[176:179], a[112:115], v[128:131]
ds_read_b64_tr_b16 a[150:151], v21 offset:47104
ds_read_b64_tr_b16 a[152:153], v24 offset:24576
v_mfma_f32_16x16x32_bf16 v[128:131], a[172:175], a[104:107], v[128:131]
global_load_lds_dwordx4 v16, s[96:97]
v_mfma_f32_16x16x32_bf16 v[128:131], a[168:171], a[96:99], v[128:131]
s_waitcnt lgkmcnt(7)
ds_read_b64_tr_b16 a[154:155], v24 offset:26624
s_add_u32 m0, s41, 0x21000
v_mfma_f32_16x16x32_bf16 v[132:135], a[192:195], a[96:99], v[132:135]
s_add_u32 s96, s24, 0x1b400
ds_read_b64_tr_b16 a[156:157], v24 offset:28672
s_addc_u32 s97, s25, 0
v_mfma_f32_16x16x32_bf16 v[132:135], a[196:199], a[104:107], v[132:135]
ds_read_b64_tr_b16 a[158:159], v24 offset:30720
v_mfma_f32_16x16x32_bf16 v[132:135], a[200:203], a[112:115], v[132:135]
s_waitcnt lgkmcnt(4)
ds_read_b64_tr_b16 a[160:161], v24 offset:32768
ds_read_b64_tr_b16 a[162:163], v24 offset:34816
v_mfma_f32_16x16x32_bf16 v[132:135], a[204:207], a[120:123], v[132:135]
global_load_lds_dwordx4 v16, s[96:97]
v_mfma_f32_16x16x32_bf16 v[132:135], a[144:147], a[128:131], v[132:135]
s_add_u32 m0, s41, 0x22000
ds_read_b64_tr_b16 a[164:165], v24 offset:36864
s_add_u32 s96, s24, 0x24400
v_mfma_f32_16x16x32_bf16 v[132:135], a[148:151], a[136:139], v[132:135]
s_addc_u32 s97, s25, 0
ds_read_b64_tr_b16 a[166:167], v24 offset:38912
s_lshl_b32 s46, s60, 2
v_mfma_f32_16x16x32_bf16 v[148:151], a[148:151], a[140:143], v[148:151]
ds_read_b64_tr_b16 a[168:169], v24 offset:40960
v_mfma_f32_16x16x32_bf16 v[148:151], a[144:147], a[132:135], v[148:151]
ds_read_b64_tr_b16 a[170:171], v24 offset:43008
ds_read_b64_tr_b16 a[172:173], v24 offset:45056
v_mfma_f32_16x16x32_bf16 v[148:151], a[204:207], a[124:127], v[148:151]
global_load_lds_dwordx4 v16, s[96:97]
v_mfma_f32_16x16x32_bf16 v[148:151], a[200:203], a[116:119], v[148:151]
s_add_u32 m0, s41, 0x23000
ds_read_b64_tr_b16 a[174:175], v24 offset:47104
s_add_u32 s96, s24, 0x2d400
v_mfma_f32_16x16x32_bf16 v[148:151], a[196:199], a[108:111], v[148:151]
s_addc_u32 s97, s25, 0
ds_read_b64_tr_b16 a[176:177], v27 offset:24576
v_mfma_f32_16x16x32_bf16 v[148:151], a[192:195], a[100:103], v[148:151]
s_waitcnt lgkmcnt(7)
ds_read_b64_tr_b16 a[178:179], v27 offset:26624
v_mfma_f32_16x16x32_bf16 v[152:155], a[152:155], a[100:103], v[152:155]
ds_read_b64_tr_b16 a[180:181], v27 offset:28672
ds_read_b64_tr_b16 a[182:183], v27 offset:30720
v_mfma_f32_16x16x32_bf16 v[152:155], a[156:159], a[108:111], v[152:155]
global_load_lds_dwordx4 v16, s[96:97]
v_mfma_f32_16x16x32_bf16 v[152:155], a[160:163], a[116:119], v[152:155]
s_waitcnt lgkmcnt(4)
ds_read_b64_tr_b16 a[184:185], v27 offset:32768
s_add_u32 m0, s41, 0x24000
v_mfma_f32_16x16x32_bf16 v[152:155], a[164:167], a[124:127], v[152:155]
s_add_u32 s96, s24, 0x36400
ds_read_b64_tr_b16 a[186:187], v27 offset:34816
v_cvt_pk_bf16_f32 v64, v128, v129
v_mfma_f32_16x16x32_bf16 v[152:155], a[168:171], a[132:135], v[152:155]
s_addc_u32 s97, s25, 0
ds_read_b64_tr_b16 a[188:189], v27 offset:36864
v_cvt_pk_bf16_f32 v65, v130, v131
v_mfma_f32_16x16x32_bf16 v[152:155], a[172:175], a[140:143], v[152:155]
ds_read_b64_tr_b16 a[190:191], v27 offset:38912
ds_read_b64_tr_b16 a[192:193], v27 offset:40960
v_mfma_f32_16x16x32_bf16 v[136:139], a[172:175], a[136:139], v[136:139]
global_load_lds_dwordx4 v16, s[96:97]
v_mfma_f32_16x16x32_bf16 v[136:139], a[168:171], a[128:131], v[136:139]
s_add_u32 m0, s41, 0x25000
ds_read_b64_tr_b16 a[194:195], v27 offset:43008
v_cvt_pk_bf16_f32 v66, v132, v133
v_mfma_f32_16x16x32_bf16 v[136:139], a[164:167], a[120:123], v[136:139]
s_add_u32 s96, s24, 0x3f400
ds_read_b64_tr_b16 a[196:197], v27 offset:45056
v_cvt_pk_bf16_f32 v67, v134, v135
v_mfma_f32_32x32x16_bf16 v[192:207], a[40:43], a[0:3], v[192:207]
buffer_store_dwordx4 v[96:99], v47, s[36:39], s49 offen sc1
v_mfma_f32_16x16x32_bf16 v[136:139], a[160:163], a[112:115], v[136:139]
s_addc_u32 s97, s25, 0
ds_read_b64_tr_b16 a[198:199], v27 offset:47104
v_cvt_pk_bf16_f32 v68, v144, v145
v_mfma_f32_16x16x32_bf16 v[136:139], a[156:159], a[104:107], v[136:139]
s_add_u32 s49, s93, 0x814000
ds_read_b64_tr_b16 a[200:201], v27 offset:49152
v_cvt_pk_bf16_f32 v69, v146, v147
v_mfma_f32_16x16x32_bf16 v[136:139], a[152:155], a[96:99], v[136:139]
s_waitcnt lgkmcnt(7)
ds_read_b64_tr_b16 a[202:203], v27 offset:51200
v_cvt_pk_bf16_f32 v70, v148, v149
v_mfma_f32_16x16x32_bf16 v[140:143], a[176:179], a[96:99], v[140:143]
ds_read_b64_tr_b16 a[204:205], v27 offset:53248
v_cvt_pk_bf16_f32 v71, v150, v151
v_mfma_f32_16x16x32_bf16 v[140:143], a[180:183], a[104:107], v[140:143]
ds_read_b64_tr_b16 a[206:207], v27 offset:55296
v_mfma_f32_16x16x32_bf16 v[140:143], a[184:187], a[112:115], v[140:143]
s_waitcnt lgkmcnt(4)
ds_read_b64_tr_b16 a[144:145], v27 offset:57344
v_mfma_f32_16x16x32_bf16 v[140:143], a[188:191], a[120:123], v[140:143]
ds_read_b64_tr_b16 a[146:147], v27 offset:59392
ds_read_b64_tr_b16 a[148:149], v27 offset:61440
v_mfma_f32_16x16x32_bf16 v[140:143], a[192:195], a[128:131], v[140:143]
global_load_lds_dwordx4 v16, s[96:97]
v_mfma_f32_16x16x32_bf16 v[140:143], a[196:199], a[136:139], v[140:143]
s_add_u32 m0, s41, 0x26000
ds_read_b64_tr_b16 a[150:151], v27 offset:63488
s_add_u32 s96, s24, 0x400
v_mfma_f32_16x16x32_bf16 v[156:159], a[196:199], a[140:143], v[156:159]
s_addc_u32 s97, s25, 0
ds_read_b64_tr_b16 a[152:153], v28
v_mfma_f32_16x16x32_bf16 v[156:159], a[192:195], a[132:135], v[156:159]
ds_read_b64_tr_b16 a[154:155], v28 offset:2048
v_mfma_f32_16x16x32_bf16 v[156:159], a[188:191], a[124:127], v[156:159]
ds_read_b64_tr_b16 a[156:157], v28 offset:4096
ds_read_b64_tr_b16 a[158:159], v28 offset:6144
v_mfma_f32_16x16x32_bf16 v[156:159], a[184:187], a[116:119], v[156:159]
global_load_lds_dwordx4 v17, s[96:97]
v_mfma_f32_16x16x32_bf16 v[156:159], a[180:183], a[108:111], v[156:159]
ds_read_b64_tr_b16 a[160:161], v24 offset:49152
v_lshlrev_b32 v17, s46, v50
v_mfma_f32_16x16x32_bf16 v[156:159], a[176:179], a[100:103], v[156:159]
s_waitcnt lgkmcnt(7)
ds_read_b64_tr_b16 a[162:163], v24 offset:51200
s_mov_b32 s78, 0
v_mfma_f32_16x16x32_bf16 v[188:191], a[200:203], a[76:79], 0
ds_read_b64_tr_b16 a[164:165], v24 offset:53248
v_add_u32 v16, 0x500, v31
v_mfma_f32_16x16x32_bf16 v[188:191], a[204:207], a[84:87], v[188:191]
s_add_u32 s46, s54, 0xa000
ds_read_b64_tr_b16 a[166:167], v24 offset:55296
v_and_b32 v5, 15, v0
v_mfma_f32_16x16x32_bf16 v[188:191], a[144:147], a[92:95], v[188:191]
s_waitcnt lgkmcnt(4)
ds_read_b64_tr_b16 a[168:169], v24 offset:57344
v_mul_u32_u24 v5, 0x90, v5
v_mfma_f32_16x16x32_bf16 v[188:191], a[148:151], a[100:103], v[188:191]
ds_read_b64_tr_b16 a[170:171], v24 offset:59392
v_cvt_pk_bf16_f32 v72, v136, v137
v_mfma_f32_16x16x32_bf16 v[188:191], a[152:155], a[108:111], v[188:191]
ds_read_b64_tr_b16 a[172:173], v24 offset:61440
v_cvt_pk_bf16_f32 v73, v138, v139
v_mfma_f32_16x16x32_bf16 v[188:191], a[156:159], a[116:119], v[188:191]
ds_read_b64_tr_b16 a[174:175], v24 offset:63488
v_cvt_pk_bf16_f32 v74, v140, v141
v_mfma_f32_16x16x32_bf16 v[172:175], a[156:159], a[112:115], 0
ds_read_b64_tr_b16 a[176:177], v25
v_cvt_pk_bf16_f32 v75, v142, v143
v_mfma_f32_16x16x32_bf16 v[172:175], a[152:155], a[104:107], v[172:175]
ds_read_b64_tr_b16 a[178:179], v25 offset:2048
v_cvt_pk_bf16_f32 v76, v152, v153
v_mfma_f32_16x16x32_bf16 v[172:175], a[148:151], a[96:99], v[172:175]
ds_read_b64_tr_b16 a[180:181], v25 offset:4096
v_cvt_pk_bf16_f32 v77, v154, v155
v_mfma_f32_16x16x32_bf16 v[172:175], a[144:147], a[88:91], v[172:175]
ds_read_b64_tr_b16 a[182:183], v25 offset:6144
v_cvt_pk_bf16_f32 v78, v156, v157
v_mfma_f32_16x16x32_bf16 v[172:175], a[204:207], a[80:83], v[172:175]
ds_read_b64_tr_b16 a[184:185], v21 offset:49152
v_cvt_pk_bf16_f32 v79, v158, v159
v_mfma_f32_16x16x32_bf16 v[172:175], a[200:203], a[72:75], v[172:175]
s_waitcnt lgkmcnt(7)
ds_read_b64_tr_b16 a[186:187], v21 offset:51200
v_lshrrev_b32 v6, 4, v0
v_mfma_f32_16x16x32_bf16 v[168:171], a[160:163], a[72:75], 0
ds_read_b64_tr_b16 a[188:189], v21 offset:53248
v_lshl_add_u32 v5, v6, 3, v5
v_mfma_f32_16x16x32_bf16 v[168:171], a[164:167], a[80:83], v[168:171]
ds_read_b64_tr_b16 a[190:191], v21 offset:55296
v_add_u32 v55, s46, v5
v_mfma_f32_32x32x16_bf16 v[224:239], a[44:47], a[0:3], v[224:239]
buffer_store_dwordx4 v[100:103], v47, s[36:39], s49 offen sc1
v_mfma_f32_16x16x32_bf16 v[168:171], a[168:171], a[88:91], v[168:171]
s_waitcnt lgkmcnt(4)
ds_read_b64_tr_b16 a[192:193], v21 offset:57344
v_lshrrev_b32 v6, 3, v0
v_mfma_f32_16x16x32_bf16 v[168:171], a[172:175], a[96:99], v[168:171]
s_add_u32 s49, s92, 0x818000
ds_read_b64_tr_b16 a[194:195], v21 offset:59392
v_and_b32 v5, 7, v0
v_mfma_f32_16x16x32_bf16 v[168:171], a[176:179], a[104:107], v[168:171]
ds_read_b64_tr_b16 a[196:197], v21 offset:61440
v_lshlrev_b32 v5, 4, v5
v_mfma_f32_16x16x32_bf16 v[168:171], a[180:183], a[112:115], v[168:171]
ds_read_b64_tr_b16 a[198:199], v21 offset:63488
v_mul_u32_u24 v10, 0x90, v6
v_mfma_f32_16x16x32_bf16 v[184:187], a[180:183], a[116:119], 0
ds_read_b64_tr_b16 a[200:201], v22
v_add3_u32 v10, v10, v5, s46
v_mfma_f32_16x16x32_bf16 v[184:187], a[176:179], a[108:111], v[184:187]
ds_read_b64_tr_b16 a[202:203], v22 offset:2048
v_readfirstlane_b32 s47, v11
v_mfma_f32_16x16x32_bf16 v[184:187], a[172:175], a[100:103], v[184:187]
ds_read_b64_tr_b16 a[204:205], v22 offset:4096
v_max3_f32 v1, v192, v193, v194
v_mfma_f32_16x16x32_bf16 v[184:187], a[168:171], a[92:95], v[184:187]
ds_read_b64_tr_b16 a[206:207], v22 offset:6144
v_max3_f32 v1, v1, v195, v196
v_mfma_f32_16x16x32_bf16 v[184:187], a[164:167], a[84:87], v[184:187]
ds_read_b64_tr_b16 a[144:145], v18 offset:49152
v_max3_f32 v1, v1, v197, v198
v_mfma_f32_16x16x32_bf16 v[184:187], a[160:163], a[76:79], v[184:187]
s_waitcnt lgkmcnt(7)
ds_read_b64_tr_b16 a[146:147], v18 offset:51200
v_max3_f32 v1, v1, v199, v200
v_mfma_f32_16x16x32_bf16 v[180:183], a[184:187], a[76:79], 0
ds_read_b64_tr_b16 a[148:149], v18 offset:53248
v_max3_f32 v1, v1, v201, v202
v_mfma_f32_16x16x32_bf16 v[180:183], a[188:191], a[84:87], v[180:183]
ds_read_b64_tr_b16 a[150:151], v18 offset:55296
v_max3_f32 v1, v1, v203, v204
v_mfma_f32_16x16x32_bf16 v[180:183], a[192:195], a[92:95], v[180:183]
s_waitcnt lgkmcnt(4)
ds_read_b64_tr_b16 a[152:153], v18 offset:57344
v_max3_f32 v1, v1, v205, v206
v_mfma_f32_16x16x32_bf16 v[180:183], a[196:199], a[100:103], v[180:183]
ds_read_b64_tr_b16 a[154:155], v18 offset:59392
v_max3_f32 v1, v1, v207, v224
v_mfma_f32_16x16x32_bf16 v[180:183], a[200:203], a[108:111], v[180:183]
ds_read_b64_tr_b16 a[156:157], v18 offset:61440
v_max3_f32 v1, v1, v225, v226
v_mfma_f32_16x16x32_bf16 v[180:183], a[204:207], a[116:119], v[180:183]
ds_read_b64_tr_b16 a[158:159], v18 offset:63488
v_max3_f32 v1, v1, v227, v228
v_mfma_f32_16x16x32_bf16 v[164:167], a[204:207], a[112:115], 0
ds_read_b64_tr_b16 a[160:161], v19
v_max3_f32 v1, v1, v229, v230
v_mfma_f32_16x16x32_bf16 v[164:167], a[200:203], a[104:107], v[164:167]
ds_read_b64_tr_b16 a[162:163], v19 offset:2048
v_max3_f32 v1, v1, v231, v232
v_mfma_f32_16x16x32_bf16 v[164:167], a[196:199], a[96:99], v[164:167]
s_waitcnt vmcnt(19)
ds_read_b64_tr_b16 a[164:165], v19 offset:4096
ds_read_b64_tr_b16 a[166:167], v19 offset:6144
v_mfma_f32_16x16x32_bf16 v[164:167], a[192:195], a[88:91], v[164:167]
s_barrier
v_mfma_f32_16x16x32_bf16 v[164:167], a[188:191], a[80:83], v[164:167]
s_add_u32 m0, s54, 0x800
ds_read_b64_tr_b16 a[168:169], v19 offset:8192
v_max3_f32 v1, v1, v233, v234
v_mfma_f32_16x16x32_bf16 v[164:167], a[184:187], a[72:75], v[164:167]
s_waitcnt lgkmcnt(7)
ds_read_b64_tr_b16 a[170:171], v19 offset:10240
v_max3_f32 v1, v1, v235, v236
v_mfma_f32_16x16x32_bf16 v[160:163], a[144:147], a[72:75], 0
s_add_u32 s96, s36, 0x800
ds_read_b64_tr_b16 a[172:173], v19 offset:12288
v_max3_f32 v1, v1, v237, v238
v_mfma_f32_16x16x32_bf16 v[160:163], a[148:151], a[80:83], v[160:163]
s_addc_u32 s97, s37, 0
ds_read_b64_tr_b16 a[174:175], v19 offset:14336
v_max_f32 v1, v1, v239
v_mfma_f32_16x16x32_bf16 v[160:163], a[152:155], a[88:91], v[160:163]
s_waitcnt lgkmcnt(4)
ds_read_b64_tr_b16 a[176:177], v19 offset:16384
ds_read_b64_tr_b16 a[178:179], v19 offset:18432
v_mfma_f32_16x16x32_bf16 v[160:163], a[156:159], a[96:99], v[160:163]
global_load_lds_dwordx4 v36, s[96:97] offset:-2048 sc1
v_mfma_f32_16x16x32_bf16 v[160:163], a[160:163], a[104:107], v[160:163]
ds_read_b64_tr_b16 a[180:181], v22 offset:8192
v_mul_u32_u24 v6, 0x480, v6
v_mfma_f32_16x16x32_bf16 v[160:163], a[164:167], a[112:115], v[160:163]
ds_read_b64_tr_b16 a[182:183], v22 offset:10240
ds_read_b64_tr_b16 a[184:185], v22 offset:12288
v_mfma_f32_16x16x32_bf16 v[176:179], a[164:167], a[116:119], 0
global_load_lds_dwordx4 v36, s[96:97] offset:-1024 sc1
v_mfma_f32_32x32x16_bf16 v[208:223], a[40:43], a[4:7], v[208:223]
buffer_store_dwordx4 v[104:107], v47, s[36:39], s49 offen sc1
v_mfma_f32_16x16x32_bf16 v[176:179], a[160:163], a[108:111], v[176:179]
s_add_u32 s49, s93, 0x818000
ds_read_b64_tr_b16 a[186:187], v22 offset:14336
v_add3_u32 v3, v6, v5, s47
v_mfma_f32_16x16x32_bf16 v[176:179], a[156:159], a[100:103], v[176:179]
ds_read_b64_tr_b16 a[188:189], v22 offset:16384
v_mfma_f32_16x16x32_bf16 v[176:179], a[152:155], a[92:95], v[176:179]
ds_read_b64_tr_b16 a[190:191], v22 offset:18432
v_mfma_f32_16x16x32_bf16 v[176:179], a[148:151], a[84:87], v[176:179]
ds_read_b64_tr_b16 a[192:193], v25 offset:8192
v_mfma_f32_16x16x32_bf16 v[176:179], a[144:147], a[76:79], v[176:179]
s_waitcnt lgkmcnt(7)
ds_read_b64_tr_b16 a[194:195], v25 offset:10240
v_mfma_f32_16x16x32_bf16 v[176:179], a[168:171], a[124:127], v[176:179]
ds_read_b64_tr_b16 a[196:197], v25 offset:12288
ds_read_b64_tr_b16 a[198:199], v25 offset:14336
v_mfma_f32_16x16x32_bf16 v[176:179], a[172:175], a[132:135], v[176:179]
global_load_lds_dwordx4 v36, s[96:97] sc1
v_mfma_f32_16x16x32_bf16 v[176:179], a[176:179], a[140:143], v[176:179]
ds_read_b64_tr_b16 a[200:201], v25 offset:16384
v_mfma_f32_16x16x32_bf16 v[160:163], a[176:179], a[136:139], v[160:163]
ds_read_b64_tr_b16 a[202:203], v25 offset:18432
v_mfma_f32_16x16x32_bf16 v[160:163], a[172:175], a[128:131], v[160:163]
ds_read_b64_tr_b16 a[204:205], v28 offset:8192
v_mfma_f32_16x16x32_bf16 v[160:163], a[168:171], a[120:123], v[160:163]
s_waitcnt lgkmcnt(7)
ds_read_b64_tr_b16 a[206:207], v28 offset:10240
ds_read_b64_tr_b16 a[144:145], v28 offset:12288
v_mfma_f32_16x16x32_bf16 v[164:167], a[180:183], a[120:123], v[164:167]
global_load_lds_dwordx4 v36, s[96:97] offset:1024 sc1
v_mfma_f32_16x16x32_bf16 v[164:167], a[184:187], a[128:131], v[164:167]
ds_read_b64_tr_b16 a[146:147], v28 offset:14336
v_mfma_f32_16x16x32_bf16 v[164:167], a[188:191], a[136:139], v[164:167]
ds_read_b64_tr_b16 a[148:149], v28 offset:16384
v_mfma_f32_16x16x32_bf16 v[180:183], a[188:191], a[140:143], v[180:183]
ds_read_b64_tr_b16 a[150:151], v28 offset:18432
v_mfma_f32_16x16x32_bf16 v[180:183], a[184:187], a[132:135], v[180:183]
ds_read_b64_tr_b16 a[152:153], v28 offset:20480
v_mfma_f32_16x16x32_bf16 v[180:183], a[180:183], a[124:127], v[180:183]
s_waitcnt lgkmcnt(7)
ds_read_b64_tr_b16 a[154:155], v28 offset:22528
ds_read_b64_tr_b16 a[156:157], v28 offset:24576
v_mfma_f32_16x16x32_bf16 v[184:187], a[192:195], a[124:127], v[184:187]
global_load_lds_dwordx4 v36, s[96:97] offset:2048 sc1
v_mfma_f32_16x16x32_bf16 v[184:187], a[196:199], a[132:135], v[184:187]
s_add_u32 m0, s54, 0x5800
ds_read_b64_tr_b16 a[158:159], v28 offset:26624
s_add_u32 s96, s36, 0x3000
v_mfma_f32_16x16x32_bf16 v[184:187], a[200:203], a[140:143], v[184:187]
s_addc_u32 s97, s37, 0
ds_read_b64_tr_b16 a[160:161], v28 offset:28672
v_mfma_f32_16x16x32_bf16 v[168:171], a[200:203], a[136:139], v[168:171]
ds_read_b64_tr_b16 a[162:163], v28 offset:30720
ds_read_b64_tr_b16 a[164:165], v25 offset:20480
v_mfma_f32_16x16x32_bf16 v[168:171], a[196:199], a[128:131], v[168:171]
global_load_lds_dwordx4 v36, s[96:97] offset:-2048 sc1
v_mfma_f32_16x16x32_bf16 v[168:171], a[192:195], a[120:123], v[168:171]
s_waitcnt lgkmcnt(7)
ds_read_b64_tr_b16 a[166:167], v25 offset:22528
v_cvt_pk_bf16_f32 v80, v160, v161
v_mfma_f32_16x16x32_bf16 v[172:175], a[204:207], a[120:123], v[172:175]
ds_read_b64_tr_b16 a[168:169], v25 offset:24576
v_cvt_pk_bf16_f32 v81, v162, v163
v_mfma_f32_16x16x32_bf16 v[172:175], a[144:147], a[128:131], v[172:175]
ds_read_b64_tr_b16 a[170:171], v25 offset:26624
v_cvt_pk_bf16_f32 v82, v164, v165
v_mfma_f32_16x16x32_bf16 v[172:175], a[148:151], a[136:139], v[172:175]
ds_read_b64_tr_b16 a[172:173], v25 offset:28672
ds_read_b64_tr_b16 a[174:175], v25 offset:30720
v_mfma_f32_16x16x32_bf16 v[188:191], a[148:151], a[140:143], v[188:191]
global_load_lds_dwordx4 v36, s[96:97] offset:-1024 sc1
v_mfma_f32_16x16x32_bf16 v[188:191], a[144:147], a[132:135], v[188:191]
ds_read_b64_tr_b16 a[176:177], v22 offset:20480
v_cvt_pk_bf16_f32 v83, v166, v167
v_mfma_f32_16x16x32_bf16 v[188:191], a[204:207], a[124:127], v[188:191]
s_waitcnt lgkmcnt(7)
ds_read_b64_tr_b16 a[178:179], v22 offset:22528
v_cvt_pk_bf16_f32 v84, v176, v177
v_mfma_f32_32x32x16_bf16 v[240:255], a[44:47], a[4:7], v[240:255]
buffer_store_dwordx4 v[108:111], v47, s[36:39], s49 offen sc1
v_mfma_f32_16x16x32_bf16 v[156:159], a[152:155], a[76:79], 0
s_add_u32 s49, s92, 0x81c000
ds_read_b64_tr_b16 a[180:181], v22 offset:24576
v_cvt_pk_bf16_f32 v85, v178, v179
v_mfma_f32_16x16x32_bf16 v[156:159], a[156:159], a[84:87], v[156:159]
ds_read_b64_tr_b16 a[182:183], v22 offset:26624
v_cvt_pk_bf16_f32 v86, v180, v181
v_mfma_f32_16x16x32_bf16 v[156:159], a[160:163], a[92:95], v[156:159]
ds_read_b64_tr_b16 a[184:185], v22 offset:28672
v_cvt_pk_bf16_f32 v87, v182, v183
v_mfma_f32_16x16x32_bf16 v[140:143], a[160:163], a[88:91], 0
ds_read_b64_tr_b16 a[186:187], v22 offset:30720
v_cvt_pk_bf16_f32 v88, v168, v169
v_mfma_f32_16x16x32_bf16 v[140:143], a[156:159], a[80:83], v[140:143]
ds_read_b64_tr_b16 a[188:189], v19 offset:20480
v_cvt_pk_bf16_f32 v89, v170, v171
v_mfma_f32_16x16x32_bf16 v[140:143], a[152:155], a[72:75], v[140:143]
s_waitcnt lgkmcnt(7)
ds_read_b64_tr_b16 a[190:191], v19 offset:22528
v_cvt_pk_bf16_f32 v90, v172, v173
v_mfma_f32_16x16x32_bf16 v[136:139], a[164:167], a[72:75], 0
ds_read_b64_tr_b16 a[192:193], v19 offset:24576
ds_read_b64_tr_b16 a[194:195], v19 offset:26624
v_mfma_f32_16x16x32_bf16 v[136:139], a[168:171], a[80:83], v[136:139]
global_load_lds_dwordx4 v36, s[96:97] sc1
v_mfma_f32_16x16x32_bf16 v[136:139], a[172:175], a[88:91], v[136:139]
s_waitcnt vmcnt(22)
ds_read_b64_tr_b16 a[196:197], v19 offset:28672
ds_read_b64_tr_b16 a[198:199], v19 offset:30720
v_mfma_f32_16x16x32_bf16 v[152:155], a[172:175], a[92:95], 0
s_barrier
v_mfma_f32_16x16x32_bf16 v[152:155], a[168:171], a[84:87], v[152:155]
ds_read_b64_tr_b16 a[200:201], v19 offset:32768
v_max3_f32 v2, v208, v209, v210
v_mfma_f32_16x16x32_bf16 v[152:155], a[164:167], a[76:79], v[152:155]
s_waitcnt lgkmcnt(7)
ds_read_b64_tr_b16 a[202:203], v19 offset:34816
ds_read_b64_tr_b16 a[204:205], v19 offset:36864
v_mfma_f32_16x16x32_bf16 v[148:151], a[176:179], a[76:79], 0
global_load_lds_dwordx4 v36, s[96:97] offset:1024 sc1
v_mfma_f32_16x16x32_bf16 v[148:151], a[180:183], a[84:87], v[148:151]
ds_read_b64_tr_b16 a[206:207], v19 offset:38912
v_max3_f32 v2, v2, v211, v212
v_mfma_f32_16x16x32_bf16 v[148:151], a[184:187], a[92:95], v[148:151]
ds_read_b64_tr_b16 a[144:145], v19 offset:40960
v_max3_f32 v2, v2, v213, v214
v_mfma_f32_16x16x32_bf16 v[132:135], a[184:187], a[88:91], 0
ds_read_b64_tr_b16 a[146:147], v19 offset:43008
v_max3_f32 v2, v2, v215, v216
v_mfma_f32_16x16x32_bf16 v[132:135], a[180:183], a[80:83], v[132:135]
ds_read_b64_tr_b16 a[148:149], v19 offset:45056
v_max3_f32 v2, v2, v217, v218
v_mfma_f32_16x16x32_bf16 v[132:135], a[176:179], a[72:75], v[132:135]
s_waitcnt lgkmcnt(7)
ds_read_b64_tr_b16 a[150:151], v19 offset:47104
ds_read_b64_tr_b16 a[152:153], v19 offset:49152
v_mfma_f32_16x16x32_bf16 v[128:131], a[188:191], a[72:75], 0
global_load_lds_dwordx4 v36, s[96:97] offset:2048 sc1
v_mfma_f32_16x16x32_bf16 v[128:131], a[192:195], a[80:83], v[128:131]
s_add_u32 m0, s54, 0xa800
ds_read_b64_tr_b16 a[154:155], v19 offset:51200
v_max3_f32 v2, v2, v219, v220
v_mfma_f32_16x16x32_bf16 v[128:131], a[196:199], a[88:91], v[128:131]
s_add_u32 s96, s36, 0x5800
ds_read_b64_tr_b16 a[156:157], v19 offset:53248
v_max3_f32 v2, v2, v221, v222
v_mfma_f32_16x16x32_bf16 v[144:147], a[196:199], a[92:95], 0
s_addc_u32 s97, s37, 0
ds_read_b64_tr_b16 a[158:159], v19 offset:55296
ds_read_b64_tr_b16 a[160:161], v22 offset:32768
v_mfma_f32_16x16x32_bf16 v[144:147], a[192:195], a[84:87], v[144:147]
global_load_lds_dwordx4 v36, s[96:97] offset:-2048 sc1
v_mfma_f32_16x16x32_bf16 v[144:147], a[188:191], a[76:79], v[144:147]
s_waitcnt lgkmcnt(7)
ds_read_b64_tr_b16 a[162:163], v22 offset:34816
v_max3_f32 v2, v2, v223, v240
v_mfma_f32_16x16x32_bf16 v[144:147], a[200:203], a[100:103], v[144:147]
ds_read_b64_tr_b16 a[164:165], v22 offset:36864
v_max3_f32 v2, v2, v241, v242
v_mfma_f32_16x16x32_bf16 v[144:147], a[204:207], a[108:111], v[144:147]
ds_read_b64_tr_b16 a[166:167], v22 offset:38912
v_max3_f32 v2, v2, v243, v244
v_mfma_f32_16x16x32_bf16 v[144:147], a[144:147], a[116:119], v[144:147]
s_waitcnt lgkmcnt(4)
ds_read_b64_tr_b16 a[168:169], v22 offset:40960
ds_read_b64_tr_b16 a[170:171], v22 offset:43008
v_mfma_f32_16x16x32_bf16 v[144:147], a[148:151], a[124:127], v[144:147]
global_load_lds_dwordx4 v36, s[96:97] offset:-1024 sc1
v_mfma_f32_16x16x32_bf16 v[144:147], a[152:155], a[132:135], v[144:147]
ds_read_b64_tr_b16 a[172:173], v22 offset:45056
v_max3_f32 v2, v2, v245, v246
v_mfma_f32_16x16x32_bf16 v[144:147], a[156:159], a[140:143], v[144:147]
ds_read_b64_tr_b16 a[174:175], v22 offset:47104
v_max3_f32 v2, v2, v247, v248
v_mfma_f32_16x16x32_bf16 v[128:131], a[156:159], a[136:139], v[128:131]
ds_read_b64_tr_b16 a[176:177], v22 offset:49152
v_max3_f32 v2, v2, v249, v250
v_mfma_f32_16x16x32_bf16 v[128:131], a[152:155], a[128:131], v[128:131]
ds_read_b64_tr_b16 a[178:179], v22 offset:51200
ds_read_b64_tr_b16 a[180:181], v22 offset:53248
v_mfma_f32_16x16x32_bf16 v[128:131], a[148:151], a[120:123], v[128:131]
buffer_store_dwordx4 v[112:115], v47, s[36:39], s49 offen sc1
v_mfma_f32_16x16x32_bf16 v[128:131], a[144:147], a[112:115], v[128:131]
s_add_u32 s49, s93, 0x81c000
ds_read_b64_tr_b16 a[182:183], v22 offset:55296
v_max3_f32 v2, v2, v251, v252
v_mfma_f32_16x16x32_bf16 v[128:131], a[204:207], a[104:107], v[128:131]
ds_read_b64_tr_b16 a[184:185], v25 offset:32768
v_max3_f32 v2, v2, v253, v254
v_mfma_f32_16x16x32_bf16 v[128:131], a[200:203], a[96:99], v[128:131]
s_waitcnt lgkmcnt(7)
ds_read_b64_tr_b16 a[186:187], v25 offset:34816
v_max_f32 v2, v2, v255
v_mfma_f32_16x16x32_bf16 v[132:135], a[160:163], a[96:99], v[132:135]
ds_read_b64_tr_b16 a[188:189], v25 offset:36864
ds_read_b64_tr_b16 a[190:191], v25 offset:38912
v_mfma_f32_16x16x32_bf16 v[132:135], a[164:167], a[104:107], v[132:135]
global_load_lds_dwordx4 v36, s[96:97] sc1
v_mfma_f32_16x16x32_bf16 v[132:135], a[168:171], a[112:115], v[132:135]
s_waitcnt lgkmcnt(4)
ds_read_b64_tr_b16 a[192:193], v25 offset:40960
v_permlane32_swap_b32 v1, v2
v_mfma_f32_16x16x32_bf16 v[132:135], a[172:175], a[120:123], v[132:135]
ds_read_b64_tr_b16 a[194:195], v25 offset:43008
v_max_f32 v1, v1, v2
v_mfma_f32_16x16x32_bf16 v[132:135], a[176:179], a[128:131], v[132:135]
ds_read_b64_tr_b16 a[196:197], v25 offset:45056
v_sub_f32 v1, 0xc2b40000, v1
v_mfma_f32_16x16x32_bf16 v[132:135], a[180:183], a[136:139], v[132:135]
ds_read_b64_tr_b16 a[198:199], v25 offset:47104
ds_read_b64_tr_b16 a[200:201], v25 offset:49152
v_mfma_f32_16x16x32_bf16 v[148:151], a[180:183], a[140:143], v[148:151]
global_load_lds_dwordx4 v36, s[96:97] offset:1024 sc1
v_mfma_f32_16x16x32_bf16 v[148:151], a[176:179], a[132:135], v[148:151]
ds_read_b64_tr_b16 a[202:203], v25 offset:51200
v_cvt_pk_bf16_f32 v2, v1, v1
v_mfma_f32_16x16x32_bf16 v[148:151], a[172:175], a[124:127], v[148:151]
ds_read_b64_tr_b16 a[204:205], v25 offset:53248
v_lshlrev_b32 v2, 16, v2
v_mfma_f32_16x16x32_bf16 v[148:151], a[168:171], a[116:119], v[148:151]
ds_read_b64_tr_b16 a[206:207], v25 offset:55296
v_sub_f32 v2, v1, v2
v_mfma_f32_16x16x32_bf16 v[148:151], a[164:167], a[108:111], v[148:151]
ds_read_b64_tr_b16 a[144:145], v28 offset:32768
v_cvt_pk_bf16_f32 v15, v1, v2
v_mfma_f32_16x16x32_bf16 v[148:151], a[160:163], a[100:103], v[148:151]
s_waitcnt lgkmcnt(7)
ds_read_b64_tr_b16 a[146:147], v28 offset:34816
ds_read_b64_tr_b16 a[148:149], v28 offset:36864
v_mfma_f32_16x16x32_bf16 v[152:155], a[184:187], a[100:103], v[152:155]
L_pg13:
s_cbranch_execz L_tr3
global_load_lds_dwordx4 v36, s[96:97] offset:2048 sc1
v_mfma_f32_16x16x32_bf16 v[152:155], a[188:191], a[108:111], v[152:155]
s_add_u32 m0, s41, 0x27000
ds_read_b64_tr_b16 a[150:151], v28 offset:38912
v_cvt_pk_bf16_f32 v91, v174, v175
v_mfma_f32_16x16x32_bf16 v[152:155], a[192:195], a[116:119], v[152:155]
s_waitcnt lgkmcnt(4)
ds_read_b64_tr_b16 a[152:153], v28 offset:40960
v_cvt_pk_bf16_f32 v92, v184, v185
v_mfma_f32_16x16x32_bf16 v[152:155], a[196:199], a[124:127], v[152:155]
s_add_u32 s96, s12, 0
ds_read_b64_tr_b16 a[154:155], v28 offset:43008
v_cvt_pk_bf16_f32 v93, v186, v187
v_mfma_f32_16x16x32_bf16 v[152:155], a[200:203], a[132:135], v[152:155]
s_addc_u32 s97, s13, 0
ds_read_b64_tr_b16 a[156:157], v28 offset:45056
ds_read_b64_tr_b16 a[158:159], v28 offset:47104
v_mfma_f32_16x16x32_bf16 v[152:155], a[204:207], a[140:143], v[152:155]
global_load_lds_dwordx4 v37, s[96:97]
v_mfma_f32_16x16x32_bf16 v[136:139], a[204:207], a[136:139], v[136:139]
s_add_u32 m0, s41, 0xf000
ds_read_b64_tr_b16 a[160:161], v28 offset:49152
v_cvt_pk_bf16_f32 v94, v188, v189
v_mfma_f32_16x16x32_bf16 v[136:139], a[200:203], a[128:131], v[136:139]
s_add_u32 s96, s12, 0xa200
ds_read_b64_tr_b16 a[162:163], v28 offset:51200
v_cvt_pk_bf16_f32 v95, v190, v191
v_mfma_f32_16x16x32_bf16 v[136:139], a[196:199], a[120:123], v[136:139]
s_waitcnt vmcnt(24)
ds_read_b64_tr_b16 a[164:165], v28 offset:53248
ds_read_b64_tr_b16 a[166:167], v28 offset:55296
v_mfma_f32_16x16x32_bf16 v[136:139], a[192:195], a[112:115], v[136:139]
s_barrier
v_mfma_f32_32x32x4_2b_bf16 v[192:223], a[52:53], v[14:15], 0
buffer_store_dwordx4 v[116:119], v47, s[36:39], s49 offen sc1
v_mfma_f32_16x16x32_bf16 v[136:139], a[188:191], a[104:107], v[136:139]
s_addc_u32 s97, s13, 0
ds_read_b64_tr_b16 a[168:169], v28 offset:57344
v_cvt_pk_bf16_f32 v96, v128, v129
v_mfma_f32_16x16x32_bf16 v[136:139], a[184:187], a[96:99], v[136:139]
s_waitcnt lgkmcnt(7)
ds_read_b64_tr_b16 a[170:171], v28 offset:59392
v_cvt_pk_bf16_f32 v97, v130, v131
v_mfma_f32_16x16x32_bf16 v[140:143], a[144:147], a[96:99], v[140:143]
s_add_u32 s49, s92, 0x820000
ds_read_b64_tr_b16 a[172:173], v28 offset:61440
v_cvt_pk_bf16_f32 v98, v132, v133
v_mfma_f32_16x16x32_bf16 v[140:143], a[148:151], a[104:107], v[140:143]
ds_read_b64_tr_b16 a[174:175], v28 offset:63488
v_cvt_pk_bf16_f32 v99, v134, v135
v_mfma_f32_16x16x32_bf16 v[140:143], a[152:155], a[112:115], v[140:143]
s_waitcnt lgkmcnt(4)
ds_read_b64_tr_b16 a[176:177], v29
ds_read_b64_tr_b16 a[178:179], v29 offset:2048
v_mfma_f32_16x16x32_bf16 v[140:143], a[156:159], a[120:123], v[140:143]
global_load_lds_dwordx4 v37, s[96:97]
v_mfma_f32_16x16x32_bf16 v[140:143], a[160:163], a[128:131], v[140:143]
s_add_u32 m0, s41, 0x10000
ds_read_b64_tr_b16 a[180:181], v29 offset:4096
v_cvt_pk_bf16_f32 v100, v144, v145
v_mfma_f32_16x16x32_bf16 v[140:143], a[164:167], a[136:139], v[140:143]
s_add_u32 s96, s12, 0x14400
ds_read_b64_tr_b16 a[182:183], v29 offset:6144
v_cvt_pk_bf16_f32 v101, v146, v147
v_mfma_f32_16x16x32_bf16 v[156:159], a[164:167], a[140:143], v[156:159]
s_addc_u32 s97, s13, 0
ds_read_b64_tr_b16 a[184:185], v29 offset:8192
ds_read_b64_tr_b16 a[186:187], v29 offset:10240
v_mfma_f32_16x16x32_bf16 v[156:159], a[160:163], a[132:135], v[156:159]
global_load_lds_dwordx4 v37, s[96:97]
v_mfma_f32_16x16x32_bf16 v[156:159], a[156:159], a[124:127], v[156:159]
s_add_u32 m0, s41, 0x11000
ds_read_b64_tr_b16 a[188:189], v29 offset:12288
v_cvt_pk_bf16_f32 v102, v148, v149
v_mfma_f32_16x16x32_bf16 v[156:159], a[152:155], a[116:119], v[156:159]
s_add_u32 s96, s12, 0x1e600
ds_read_b64_tr_b16 a[190:191], v29 offset:14336
v_cvt_pk_bf16_f32 v103, v150, v151
v_mfma_f32_16x16x32_bf16 v[156:159], a[148:151], a[108:111], v[156:159]
s_addc_u32 s97, s13, 0
ds_read_b64_tr_b16 a[192:193], v25 offset:57344
v_mfma_f32_16x16x32_bf16 v[156:159], a[144:147], a[100:103], v[156:159]
s_waitcnt lgkmcnt(7)
ds_read_b64_tr_b16 a[194:195], v25 offset:59392
ds_read_b64_tr_b16 a[196:197], v25 offset:61440
v_mfma_f32_16x16x32_bf16 v[188:191], a[168:171], a[76:79], 0
global_load_lds_dwordx4 v37, s[96:97]
v_mfma_f32_16x16x32_bf16 v[188:191], a[172:175], a[84:87], v[188:191]
s_add_u32 m0, s41, 0x12000
ds_read_b64_tr_b16 a[198:199], v25 offset:63488
s_add_u32 s96, s12, 0x28800
v_mfma_f32_16x16x32_bf16 v[188:191], a[176:179], a[92:95], v[188:191]
s_waitcnt lgkmcnt(4)
ds_read_b64_tr_b16 a[200:201], v26
s_addc_u32 s97, s13, 0
v_mfma_f32_16x16x32_bf16 v[188:191], a[180:183], a[100:103], v[188:191]
ds_read_b64_tr_b16 a[202:203], v26 offset:2048
v_cvt_pk_bf16_f32 v104, v136, v137
v_mfma_f32_16x16x32_bf16 v[188:191], a[184:187], a[108:111], v[188:191]
ds_read_b64_tr_b16 a[204:205], v26 offset:4096
ds_read_b64_tr_b16 a[206:207], v26 offset:6144
v_mfma_f32_16x16x32_bf16 v[188:191], a[188:191], a[116:119], v[188:191]
global_load_lds_dwordx4 v37, s[96:97]
v_mfma_f32_16x16x32_bf16 v[172:175], a[188:191], a[112:115], 0
s_add_u32 m0, s41, 0x13000
ds_read_b64_tr_b16 a[144:145], v26 offset:8192
v_mov_b32 v128, 0
v_mfma_f32_16x16x32_bf16 v[172:175], a[184:187], a[104:107], v[172:175]
s_add_u32 s96, s12, 0x32a00
ds_read_b64_tr_b16 a[146:147], v26 offset:10240
v_mov_b32 v129, 0
v_mfma_f32_16x16x32_bf16 v[172:175], a[180:183], a[96:99], v[172:175]
s_addc_u32 s97, s13, 0
ds_read_b64_tr_b16 a[148:149], v26 offset:12288
v_mov_b32 v130, 0
v_mfma_f32_16x16x32_bf16 v[172:175], a[176:179], a[88:91], v[172:175]
ds_read_b64_tr_b16 a[150:151], v26 offset:14336
ds_read_b64_tr_b16 a[152:153], v22 offset:57344
v_mfma_f32_16x16x32_bf16 v[172:175], a[172:175], a[80:83], v[172:175]
global_load_lds_dwordx4 v37, s[96:97]
v_mfma_f32_16x16x32_bf16 v[172:175], a[168:171], a[72:75], v[172:175]
s_waitcnt lgkmcnt(7)
ds_read_b64_tr_b16 a[154:155], v22 offset:59392
v_mov_b32 v131, 0
v_mfma_f32_16x16x32_bf16 v[168:171], a[192:195], a[72:75], 0
s_add_u32 m0, s41, 0x14000
ds_read_b64_tr_b16 a[156:157], v22 offset:61440
v_mov_b32 v132, 0
v_mfma_f32_16x16x32_bf16 v[168:171], a[196:199], a[80:83], v[168:171]
s_add_u32 s96, s12, 0x3cc00
ds_read_b64_tr_b16 a[158:159], v22 offset:63488
v_mov_b32 v133, 0
v_mfma_f32_16x16x32_bf16 v[168:171], a[200:203], a[88:91], v[168:171]
s_waitcnt lgkmcnt(4)
ds_read_b64_tr_b16 a[160:161], v23
v_mov_b32 v134, 0
v_mfma_f32_32x32x16_bf16 v[192:207], a[40:43], a[0:3], v[192:207]
buffer_store_dwordx4 v[120:123], v47, s[36:39], s49 offen sc1
v_mfma_f32_16x16x32_bf16 v[168:171], a[204:207], a[96:99], v[168:171]
s_addc_u32 s97, s13, 0
ds_read_b64_tr_b16 a[162:163], v23 offset:2048
v_mov_b32 v135, 0
v_mfma_f32_16x16x32_bf16 v[168:171], a[144:147], a[104:107], v[168:171]
s_add_u32 s49, s93, 0x820000
ds_read_b64_tr_b16 a[164:165], v23 offset:4096
v_mov_b32 v136, 0
v_mfma_f32_16x16x32_bf16 v[168:171], a[148:151], a[112:115], v[168:171]
ds_read_b64_tr_b16 a[166:167], v23 offset:6144
v_mov_b32 v137, 0
v_mfma_f32_16x16x32_bf16 v[184:187], a[148:151], a[116:119], 0
ds_read_b64_tr_b16 a[168:169], v23 offset:8192
v_cvt_pk_bf16_f32 v105, v138, v139
v_mfma_f32_16x16x32_bf16 v[184:187], a[144:147], a[108:111], v[184:187]
ds_read_b64_tr_b16 a[170:171], v23 offset:10240
ds_read_b64_tr_b16 a[172:173], v23 offset:12288
v_mfma_f32_16x16x32_bf16 v[184:187], a[204:207], a[100:103], v[184:187]
global_load_lds_dwordx4 v37, s[96:97]
v_mfma_f32_16x16x32_bf16 v[184:187], a[200:203], a[92:95], v[184:187]
s_add_u32 m0, s41, 0x15000
ds_read_b64_tr_b16 a[174:175], v23 offset:14336
v_mov_b32 v138, 0
v_mfma_f32_16x16x32_bf16 v[184:187], a[196:199], a[84:87], v[184:187]
s_add_u32 s96, s12, 0x46e00
ds_read_b64_tr_b16 a[176:177], v19 offset:57344
v_mov_b32 v139, 0
v_mfma_f32_16x16x32_bf16 v[184:187], a[192:195], a[76:79], v[184:187]
s_waitcnt lgkmcnt(7)
ds_read_b64_tr_b16 a[178:179], v19 offset:59392
v_cvt_pk_bf16_f32 v106, v140, v141
v_mfma_f32_16x16x32_bf16 v[180:183], a[152:155], a[76:79], 0
s_addc_u32 s97, s13, 0
ds_read_b64_tr_b16 a[180:181], v19 offset:61440
ds_read_b64_tr_b16 a[182:183], v19 offset:63488
v_mfma_f32_16x16x32_bf16 v[180:183], a[156:159], a[84:87], v[180:183]
global_load_lds_dwordx4 v37, s[96:97]
v_mfma_f32_16x16x32_bf16 v[180:183], a[160:163], a[92:95], v[180:183]
s_waitcnt lgkmcnt(4)
ds_read_b64_tr_b16 a[184:185], v20
v_mov_b32 v140, 0
v_mfma_f32_16x16x32_bf16 v[180:183], a[164:167], a[100:103], v[180:183]
s_add_u32 m0, s41, 0x16000
ds_read_b64_tr_b16 a[186:187], v20 offset:2048
v_mov_b32 v141, 0
v_mfma_f32_16x16x32_bf16 v[180:183], a[168:171], a[108:111], v[180:183]
s_add_u32 s96, s12, 0x51000
ds_read_b64_tr_b16 a[188:189], v20 offset:4096
v_cvt_pk_bf16_f32 v107, v142, v143
v_mfma_f32_16x16x32_bf16 v[180:183], a[172:175], a[116:119], v[180:183]
s_addc_u32 s97, s13, 0
ds_read_b64_tr_b16 a[190:191], v20 offset:6144
ds_read_b64_tr_b16 a[192:193], v20 offset:8192
v_mfma_f32_16x16x32_bf16 v[164:167], a[172:175], a[112:115], 0
global_load_lds_dwordx4 v37, s[96:97]
v_mfma_f32_16x16x32_bf16 v[164:167], a[168:171], a[104:107], v[164:167]
s_add_u32 m0, s41, 0x17000
ds_read_b64_tr_b16 a[194:195], v20 offset:10240
v_mov_b32 v142, 0
v_mfma_f32_16x16x32_bf16 v[164:167], a[164:167], a[96:99], v[164:167]
s_waitcnt vmcnt(17)
ds_read_b64_tr_b16 a[196:197], v20 offset:12288
ds_read_b64_tr_b16 a[198:199], v20 offset:14336
v_mfma_f32_16x16x32_bf16 v[164:167], a[160:163], a[88:91], v[164:167]
s_barrier
v_mfma_f32_16x16x32_bf16 v[164:167], a[156:159], a[80:83], v[164:167]
s_add_u32 s96, s12, 0x5b200
ds_read_b64_tr_b16 a[200:201], v20 offset:16384
v_mov_b32 v143, 0
v_mfma_f32_16x16x32_bf16 v[164:167], a[152:155], a[72:75], v[164:167]
s_waitcnt lgkmcnt(7)
ds_read_b64_tr_b16 a[202:203], v20 offset:18432
v_mov_b32 v144, 0
v_mfma_f32_16x16x32_bf16 v[160:163], a[176:179], a[72:75], 0
s_addc_u32 s97, s13, 0
ds_read_b64_tr_b16 a[204:205], v20 offset:20480
ds_read_b64_tr_b16 a[206:207], v20 offset:22528
v_mfma_f32_16x16x32_bf16 v[160:163], a[180:183], a[80:83], v[160:163]
global_load_lds_dwordx4 v37, s[96:97]
v_mfma_f32_16x16x32_bf16 v[160:163], a[184:187], a[88:91], v[160:163]
s_waitcnt lgkmcnt(4)
ds_read_b64_tr_b16 a[144:145], v20 offset:24576
v_mov_b32 v145, 0
v_mfma_f32_16x16x32_bf16 v[160:163], a[188:191], a[96:99], v[160:163]
s_add_u32 m0, s41, 0x18000
ds_read_b64_tr_b16 a[146:147], v20 offset:26624
v_mov_b32 v146, 0
v_mfma_f32_16x16x32_bf16 v[160:163], a[192:195], a[104:107], v[160:163]
s_add_u32 s96, s12, 0x65400
ds_read_b64_tr_b16 a[148:149], v23 offset:16384
v_mov_b32 v147, 0
v_mfma_f32_16x16x32_bf16 v[160:163], a[196:199], a[112:115], v[160:163]
s_addc_u32 s97, s13, 0
ds_read_b64_tr_b16 a[150:151], v23 offset:18432
ds_read_b64_tr_b16 a[152:153], v23 offset:20480
v_mfma_f32_16x16x32_bf16 v[176:179], a[196:199], a[116:119], 0
global_load_lds_dwordx4 v37, s[96:97]
v_mfma_f32_16x16x32_bf16 v[176:179], a[192:195], a[108:111], v[176:179]
s_add_u32 m0, s41, 0x19000
ds_read_b64_tr_b16 a[154:155], v23 offset:22528
v_mov_b32 v148, 0
v_mfma_f32_32x32x16_bf16 v[208:223], a[40:43], a[4:7], v[208:223]
buffer_store_dwordx4 v[124:127], v47, s[36:39], s49 offen sc1
v_mfma_f32_16x16x32_bf16 v[176:179], a[188:191], a[100:103], v[176:179]
s_add_u32 s49, s92, 0x824000
ds_read_b64_tr_b16 a[156:157], v23 offset:24576
v_mov_b32 v149, 0
v_mfma_f32_16x16x32_bf16 v[176:179], a[184:187], a[92:95], v[176:179]
s_add_u32 s96, s12, 0x6f600
ds_read_b64_tr_b16 a[158:159], v23 offset:26624
v_mov_b32 v150, 0
v_mfma_f32_16x16x32_bf16 v[176:179], a[180:183], a[84:87], v[176:179]
s_addc_u32 s97, s13, 0
ds_read_b64_tr_b16 a[160:161], v26 offset:16384
v_mov_b32 v151, 0
v_mfma_f32_16x16x32_bf16 v[176:179], a[176:179], a[76:79], v[176:179]
s_waitcnt lgkmcnt(7)
ds_read_b64_tr_b16 a[162:163], v26 offset:18432
v_cvt_pk_bf16_f32 v108, v152, v153
v_mfma_f32_16x16x32_bf16 v[176:179], a[200:203], a[124:127], v[176:179]
ds_read_b64_tr_b16 a[164:165], v26 offset:20480
v_mov_b32 v152, 0
v_mfma_f32_16x16x32_bf16 v[176:179], a[204:207], a[132:135], v[176:179]
ds_read_b64_tr_b16 a[166:167], v26 offset:22528
ds_read_b64_tr_b16 a[168:169], v26 offset:24576
v_mfma_f32_16x16x32_bf16 v[176:179], a[144:147], a[140:143], v[176:179]
global_load_lds_dwordx4 v37, s[96:97]
v_mfma_f32_16x16x32_bf16 v[160:163], a[144:147], a[136:139], v[160:163]
s_add_u32 m0, s41, 0x1a000
ds_read_b64_tr_b16 a[170:171], v26 offset:26624
v_mov_b32 v153, 0
v_mfma_f32_16x16x32_bf16 v[160:163], a[204:207], a[128:131], v[160:163]
s_add_u32 s96, s12, 0x79800
ds_read_b64_tr_b16 a[172:173], v29 offset:16384
v_cvt_pk_bf16_f32 v109, v154, v155
v_mfma_f32_16x16x32_bf16 v[160:163], a[200:203], a[120:123], v[160:163]
s_waitcnt lgkmcnt(7)
ds_read_b64_tr_b16 a[174:175], v29 offset:18432
v_mov_b32 v154, 0
v_mfma_f32_16x16x32_bf16 v[164:167], a[148:151], a[120:123], v[164:167]
s_addc_u32 s97, s13, 0
ds_read_b64_tr_b16 a[176:177], v29 offset:20480
ds_read_b64_tr_b16 a[178:179], v29 offset:22528
v_mfma_f32_16x16x32_bf16 v[164:167], a[152:155], a[128:131], v[164:167]
global_load_lds_dwordx4 v37, s[96:97]
v_mfma_f32_16x16x32_bf16 v[164:167], a[156:159], a[136:139], v[164:167]
s_add_u32 m0, s41, 0x1b000
ds_read_b64_tr_b16 a[180:181], v29 offset:24576
v_mov_b32 v155, 0
v_mfma_f32_16x16x32_bf16 v[180:183], a[156:159], a[140:143], v[180:183]
s_add_u32 s96, s12, 0x83a00
ds_read_b64_tr_b16 a[182:183], v29 offset:26624
v_cvt_pk_bf16_f32 v110, v156, v157
v_mfma_f32_16x16x32_bf16 v[180:183], a[152:155], a[132:135], v[180:183]
s_addc_u32 s97, s13, 0
ds_read_b64_tr_b16 a[8:9], v32 offset:10240
v_mov_b32 v156, 0
v_mfma_f32_16x16x32_bf16 v[180:183], a[148:151], a[124:127], v[180:183]
s_waitcnt lgkmcnt(7)
ds_read_b64_tr_b16 a[10:11], v33 offset:10240
v_mfma_f32_16x16x32_bf16 v[184:187], a[160:163], a[124:127], v[184:187]
global_load_lds_dwordx4 v37, s[96:97]
v_mfma_f32_16x16x32_bf16 v[184:187], a[164:167], a[132:135], v[184:187]
s_add_u32 m0, s41, 0x1c000
ds_read_b64_tr_b16 a[12:13], v34 offset:10240
v_mov_b32 v157, 0
v_mfma_f32_16x16x32_bf16 v[184:187], a[168:171], a[140:143], v[184:187]
s_add_u32 s96, s12, 0x8dc00
ds_read_b64_tr_b16 a[14:15], v35 offset:10240
v_cvt_pk_bf16_f32 v111, v158, v159
v_mfma_f32_16x16x32_bf16 v[168:171], a[168:171], a[136:139], v[168:171]
s_addc_u32 s97, s13, 0
v_mov_b32 v158, 0
v_mfma_f32_16x16x32_bf16 v[168:171], a[164:167], a[128:131], v[168:171]
v_mov_b32 v159, 0
v_mfma_f32_16x16x32_bf16 v[168:171], a[160:163], a[120:123], v[168:171]
s_waitcnt lgkmcnt(4)
v_mfma_f32_16x16x32_bf16 v[172:175], a[172:175], a[120:123], v[172:175]
global_load_lds_dwordx4 v37, s[96:97]
v_mfma_f32_16x16x32_bf16 v[172:175], a[176:179], a[128:131], v[172:175]
s_add_u32 m0, s41, 0x1d000
v_cvt_pk_bf16_f32 v112, v160, v161
v_mfma_f32_16x16x32_bf16 v[172:175], a[180:183], a[136:139], v[172:175]
s_add_u32 s96, s12, 0x97e00
v_cvt_pk_bf16_f32 v113, v162, v163
v_mfma_f32_16x16x32_bf16 v[188:191], a[180:183], a[140:143], v[188:191]
s_addc_u32 s97, s13, 0
v_mfma_f32_16x16x32_bf16 v[188:191], a[176:179], a[132:135], v[188:191]
global_load_lds_dwordx4 v37, s[96:97]
v_mfma_f32_16x16x32_bf16 v[188:191], a[172:175], a[124:127], v[188:191]
v_cvt_pk_bf16_f32 v114, v164, v165
v_mfma_f32_32x32x4_2b_bf16 v[224:255], a[56:57], v[14:15], 0
v_exp_f32 v192, v192
v_exp_f32 v193, v193
v_exp_f32 v194, v194
v_exp_f32 v195, v195
v_exp_f32 v196, v196
v_exp_f32 v197, v197
v_exp_f32 v198, v198
v_exp_f32 v199, v199
v_cvt_pk_bf16_f32 v115, v166, v167
v_cvt_pk_bf16_f32 v116, v176, v177
v_cvt_pk_bf16_f32 v117, v178, v179
v_cvt_pk_bf16_f32 v118, v180, v181
v_cvt_pk_bf16_f32 v119, v182, v183
v_cvt_pk_bf16_f32 v120, v168, v169
v_cvt_pk_bf16_f32 v121, v170, v171
v_cvt_pk_bf16_f32 v122, v172, v173
v_cvt_pk_bf16_f32 v123, v174, v175
v_cvt_pk_bf16_f32 v124, v184, v185
v_cvt_pk_bf16_f32 v125, v186, v187
v_cvt_pk_bf16_f32 v126, v188, v189
v_cvt_pk_bf16_f32 v127, v190, v191
s_waitcnt lgkmcnt(0)
ds_read_b64 a[54:55], v31 offset:2560
v_exp_f32 v200, v200
v_exp_f32 v201, v201
v_exp_f32 v202, v202
v_exp_f32 v203, v203
v_smfmac_f32_32x32x32_bf16 v[128:143], a[8:11], v[192:199], v54
ds_read_b64_tr_b16 a[16:17], v32 offset:11520
v_exp_f32 v204, v204
v_exp_f32 v205, v205
v_exp_f32 v206, v206
v_exp_f32 v207, v207
v_mfma_f32_32x32x16_bf16 v[224:239], a[44:47], a[0:3], v[224:239]
buffer_store_dwordx4 v[56:59], v47, s[36:39], s49 offen sc1
ds_read_b64_tr_b16 a[18:19], v33 offset:11520
v_exp_f32 v208, v208
v_exp_f32 v209, v209
v_exp_f32 v210, v210
v_exp_f32 v211, v211
v_smfmac_f32_32x32x32_bf16 v[128:143], a[12:15], v[200:207], v54
s_add_u32 s49, s93, 0x824000
ds_read_b128 a[48:51], v30 offset:2560
v_exp_f32 v212, v212
v_exp_f32 v213, v213
v_exp_f32 v214, v214
v_exp_f32 v215, v215
v_mfma_f32_32x32x16_bf16 v[240:255], a[44:47], a[4:7], v[240:255]
ds_read_b64_tr_b16 a[20:21], v34 offset:11520
v_exp_f32 v216, v216
v_exp_f32 v217, v217
v_exp_f32 v218, v218
v_exp_f32 v219, v219
v_smfmac_f32_32x32x32_bf16 v[144:159], a[8:11], v[208:215], v54
s_waitcnt lgkmcnt(2)
ds_read_b64_tr_b16 a[22:23], v35 offset:11520
v_exp_f32 v220, v220
v_exp_f32 v221, v221
v_exp_f32 v222, v222
v_exp_f32 v223, v223
v_mfma_f32_32x32x4_2b_bf16 v[160:191], a[54:55], v[14:15], 0
v_exp_f32 v224, v224
v_exp_f32 v225, v225
v_exp_f32 v226, v226
v_exp_f32 v227, v227
v_exp_f32 v228, v228
v_exp_f32 v229, v229
v_exp_f32 v230, v230
v_exp_f32 v231, v231
v_smfmac_f32_32x32x32_bf16 v[144:159], a[12:15], v[216:223], v54
buffer_store_dwordx4 v[60:63], v47, s[36:39], s49 offen sc1
ds_read_b64 a[58:59], v31 offset:3840
v_exp_f32 v232, v232
v_exp_f32 v233, v233
v_exp_f32 v234, v234
v_exp_f32 v235, v235
v_smfmac_f32_32x32x32_bf16 v[128:143], a[16:19], v[224:231], v54
s_waitcnt lgkmcnt(1)
s_add_u32 s49, s92, 0x828000
ds_read_b64_tr_b16 a[8:9], v32 offset:12800
v_exp_f32 v236, v236
v_exp_f32 v237, v237
v_exp_f32 v238, v238
v_exp_f32 v239, v239
v_mfma_f32_32x32x16_bf16 v[160:175], a[48:51], a[0:3], v[160:175]
ds_read_b64_tr_b16 a[10:11], v33 offset:12800
v_exp_f32 v240, v240
v_exp_f32 v241, v241
v_exp_f32 v242, v242
v_exp_f32 v243, v243
v_smfmac_f32_32x32x32_bf16 v[128:143], a[20:23], v[232:239], v54
ds_read_b128 a[40:43], v30 offset:3840
v_exp_f32 v244, v244
v_exp_f32 v245, v245
v_exp_f32 v246, v246
v_exp_f32 v247, v247
v_mfma_f32_32x32x16_bf16 v[176:191], a[48:51], a[4:7], v[176:191]
ds_read_b64_tr_b16 a[12:13], v34 offset:12800
v_exp_f32 v248, v248
v_exp_f32 v249, v249
v_exp_f32 v250, v250
v_exp_f32 v251, v251
v_smfmac_f32_32x32x32_bf16 v[144:159], a[16:19], v[240:247], v54
s_waitcnt lgkmcnt(2)
ds_read_b64_tr_b16 a[14:15], v35 offset:12800
v_exp_f32 v252, v252
v_exp_f32 v253, v253
v_exp_f32 v254, v254
v_exp_f32 v255, v255
v_mfma_f32_32x32x4_2b_bf16 v[192:223], a[58:59], v[14:15], 0
v_exp_f32 v160, v160
v_exp_f32 v161, v161
v_exp_f32 v162, v162
v_exp_f32 v163, v163
v_exp_f32 v164, v164
v_exp_f32 v165, v165
v_exp_f32 v166, v166
v_exp_f32 v167, v167
v_smfmac_f32_32x32x32_bf16 v[144:159], a[20:23], v[248:255], v54
buffer_store_dwordx4 v[64:67], v47, s[36:39], s49 offen sc1
ds_read2st64_b64 a[52:55], v31 offset0:10 offset1:15
v_exp_f32 v168, v168
v_exp_f32 v169, v169
v_exp_f32 v170, v170
v_exp_f32 v171, v171
v_smfmac_f32_32x32x32_bf16 v[128:143], a[8:11], v[160:167], v54
s_waitcnt lgkmcnt(1)
s_add_u32 s49, s93, 0x828000
ds_read_b64_tr_b16 a[16:17], v32 offset:14080
v_exp_f32 v172, v172
v_exp_f32 v173, v173
v_exp_f32 v174, v174
v_exp_f32 v175, v175
v_mfma_f32_32x32x16_bf16 v[192:207], a[40:43], a[0:3], v[192:207]
global_load_dwordx2 a[240:241], v11, s[4:5]
ds_read_b64_tr_b16 a[18:19], v33 offset:14080
v_exp_f32 v176, v176
v_exp_f32 v177, v177
v_exp_f32 v178, v178
v_exp_f32 v179, v179
v_smfmac_f32_32x32x32_bf16 v[128:143], a[12:15], v[168:175], v54
ds_read_b128 a[44:47], v30 offset:5120
v_exp_f32 v180, v180
v_exp_f32 v181, v181
v_exp_f32 v182, v182
v_exp_f32 v183, v183
v_mfma_f32_32x32x16_bf16 v[208:223], a[40:43], a[4:7], v[208:223]
ds_read_b64_tr_b16 a[20:21], v34 offset:14080
v_exp_f32 v184, v184
v_exp_f32 v185, v185
v_exp_f32 v186, v186
v_exp_f32 v187, v187
v_smfmac_f32_32x32x32_bf16 v[144:159], a[8:11], v[176:183], v54
s_waitcnt lgkmcnt(2)
ds_read_b64_tr_b16 a[22:23], v35 offset:14080
v_exp_f32 v188, v188
v_exp_f32 v189, v189
v_exp_f32 v190, v190
v_exp_f32 v191, v191
v_mfma_f32_32x32x4_2b_bf16 v[224:255], a[52:53], v[14:15], 0
v_exp_f32 v192, v192
v_exp_f32 v193, v193
v_exp_f32 v194, v194
v_exp_f32 v195, v195
v_exp_f32 v196, v196
v_exp_f32 v197, v197
v_exp_f32 v198, v198
v_exp_f32 v199, v199
v_smfmac_f32_32x32x32_bf16 v[144:159], a[12:15], v[184:191], v54
buffer_store_dwordx4 v[68:71], v47, s[36:39], s49 offen sc1
ds_read2st64_b64 a[56:59], v16 offset0:10 offset1:15
v_exp_f32 v200, v200
v_exp_f32 v201, v201
v_exp_f32 v202, v202
v_exp_f32 v203, v203
v_smfmac_f32_32x32x32_bf16 v[128:143], a[16:19], v[192:199], v54
s_waitcnt lgkmcnt(1)
s_add_u32 s49, s92, 0x82c000
ds_read_b64_tr_b16 a[8:9], v32 offset:15360
v_exp_f32 v204, v204
v_exp_f32 v205, v205
v_exp_f32 v206, v206
v_exp_f32 v207, v207
v_mfma_f32_32x32x16_bf16 v[224:239], a[44:47], a[0:3], v[224:239]
global_load_dwordx2 a[242:243], v11, s[4:5] offset:32
ds_read_b64_tr_b16 a[10:11], v33 offset:15360
v_exp_f32 v208, v208
v_exp_f32 v209, v209
v_exp_f32 v210, v210
v_exp_f32 v211, v211
v_smfmac_f32_32x32x32_bf16 v[128:143], a[20:23], v[200:207], v54
ds_read_b128 a[48:51], v30 offset:6400
v_exp_f32 v212, v212
v_exp_f32 v213, v213
v_exp_f32 v214, v214
v_exp_f32 v215, v215
v_mfma_f32_32x32x16_bf16 v[240:255], a[44:47], a[4:7], v[240:255]
ds_read_b64_tr_b16 a[12:13], v34 offset:15360
v_exp_f32 v216, v216
v_exp_f32 v217, v217
v_exp_f32 v218, v218
v_exp_f32 v219, v219
v_smfmac_f32_32x32x32_bf16 v[144:159], a[16:19], v[208:215], v54
s_waitcnt lgkmcnt(2)
ds_read_b64_tr_b16 a[14:15], v35 offset:15360
v_exp_f32 v220, v220
v_exp_f32 v221, v221
v_exp_f32 v222, v222
v_exp_f32 v223, v223
v_mfma_f32_32x32x4_2b_bf16 v[160:191], a[56:57], v[14:15], 0
v_exp_f32 v224, v224
v_exp_f32 v225, v225
v_exp_f32 v226, v226
v_exp_f32 v227, v227
v_exp_f32 v228, v228
v_exp_f32 v229, v229
v_exp_f32 v230, v230
v_exp_f32 v231, v231
v_smfmac_f32_32x32x32_bf16 v[144:159], a[20:23], v[216:223], v54
buffer_store_dwordx4 v[72:75], v47, s[36:39], s49 offen sc1
v_exp_f32 v232, v232
v_exp_f32 v233, v233
v_exp_f32 v234, v234
v_exp_f32 v235, v235
v_smfmac_f32_32x32x32_bf16 v[128:143], a[8:11], v[224:231], v54
s_waitcnt lgkmcnt(0)
s_add_u32 s49, s93, 0x82c000
ds_read_b64_tr_b16 a[16:17], v32 offset:16640
v_exp_f32 v236, v236
v_exp_f32 v237, v237
v_exp_f32 v238, v238
v_exp_f32 v239, v239
v_mfma_f32_32x32x16_bf16 v[160:175], a[48:51], a[0:3], v[160:175]
global_load_dwordx2 a[244:245], v11, s[4:5] offset:64
ds_read_b64_tr_b16 a[18:19], v33 offset:16640
v_exp_f32 v240, v240
v_exp_f32 v241, v241
v_exp_f32 v242, v242
v_exp_f32 v243, v243
v_smfmac_f32_32x32x32_bf16 v[128:143], a[12:15], v[232:239], v54
ds_read_b128 a[40:43], v30 offset:7680
v_exp_f32 v244, v244
v_exp_f32 v245, v245
v_exp_f32 v246, v246
v_exp_f32 v247, v247
v_mfma_f32_32x32x16_bf16 v[176:191], a[48:51], a[4:7], v[176:191]
ds_read_b64_tr_b16 a[20:21], v34 offset:16640
v_exp_f32 v248, v248
v_exp_f32 v249, v249
v_exp_f32 v250, v250
v_exp_f32 v251, v251
v_smfmac_f32_32x32x32_bf16 v[144:159], a[8:11], v[240:247], v54
s_waitcnt lgkmcnt(2)
ds_read_b64_tr_b16 a[22:23], v35 offset:16640
v_exp_f32 v252, v252
v_exp_f32 v253, v253
v_exp_f32 v254, v254
v_exp_f32 v255, v255
v_mfma_f32_32x32x4_2b_bf16 v[192:223], a[54:55], v[14:15], 0
v_exp_f32 v160, v160
v_exp_f32 v161, v161
v_exp_f32 v162, v162
v_exp_f32 v163, v163
v_exp_f32 v164, v164
v_exp_f32 v165, v165
v_exp_f32 v166, v166
v_exp_f32 v167, v167
v_smfmac_f32_32x32x32_bf16 v[144:159], a[12:15], v[248:255], v54
buffer_store_dwordx4 v[76:79], v47, s[36:39], s49 offen sc1
v_exp_f32 v168, v168
v_exp_f32 v169, v169
v_exp_f32 v170, v170
v_exp_f32 v171, v171
v_smfmac_f32_32x32x32_bf16 v[128:143], a[16:19], v[160:167], v54
s_waitcnt lgkmcnt(0)
s_add_u32 s49, s92, 0x830000
ds_read_b64_tr_b16 a[8:9], v32 offset:17920
v_exp_f32 v172, v172
v_exp_f32 v173, v173
v_exp_f32 v174, v174
v_exp_f32 v175, v175
v_mfma_f32_32x32x16_bf16 v[192:207], a[40:43], a[0:3], v[192:207]
global_load_dwordx2 a[246:247], v11, s[4:5] offset:96
ds_read_b64_tr_b16 a[10:11], v33 offset:17920
v_exp_f32 v176, v176
v_exp_f32 v177, v177
v_exp_f32 v178, v178
v_exp_f32 v179, v179
v_smfmac_f32_32x32x32_bf16 v[128:143], a[20:23], v[168:175], v54
ds_read_b128 a[44:47], v30 offset:8960
v_exp_f32 v180, v180
v_exp_f32 v181, v181
v_exp_f32 v182, v182
v_exp_f32 v183, v183
v_mfma_f32_32x32x16_bf16 v[208:223], a[40:43], a[4:7], v[208:223]
ds_read_b64_tr_b16 a[12:13], v34 offset:17920
v_exp_f32 v184, v184
v_exp_f32 v185, v185
v_exp_f32 v186, v186
v_exp_f32 v187, v187
v_smfmac_f32_32x32x32_bf16 v[144:159], a[16:19], v[176:183], v54
s_waitcnt lgkmcnt(2)
ds_read_b64_tr_b16 a[14:15], v35 offset:17920
v_exp_f32 v188, v188
v_exp_f32 v189, v189
v_exp_f32 v190, v190
v_exp_f32 v191, v191
v_mfma_f32_32x32x4_2b_bf16 v[224:255], a[58:59], v[14:15], 0
v_exp_f32 v192, v192
v_exp_f32 v193, v193
v_exp_f32 v194, v194
v_exp_f32 v195, v195
v_exp_f32 v196, v196
v_exp_f32 v197, v197
v_exp_f32 v198, v198
v_exp_f32 v199, v199
v_smfmac_f32_32x32x32_bf16 v[144:159], a[20:23], v[184:191], v54
buffer_store_dwordx4 v[80:83], v47, s[36:39], s49 offen sc1
ds_read2st64_b64 a[52:55], v31 offset0:40 offset1:45
v_exp_f32 v200, v200
v_exp_f32 v201, v201
v_exp_f32 v202, v202
v_exp_f32 v203, v203
v_smfmac_f32_32x32x32_bf16 v[128:143], a[8:11], v[192:199], v54
L_pg14:
s_cbranch_execz L_tr3
s_waitcnt lgkmcnt(1)
s_add_u32 s49, s93, 0x830000
ds_read_b64_tr_b16 a[16:17], v32 offset:19200
v_exp_f32 v204, v204
v_exp_f32 v205, v205
v_exp_f32 v206, v206
v_exp_f32 v207, v207
v_mfma_f32_32x32x16_bf16 v[224:239], a[44:47], a[0:3], v[224:239]
buffer_load_dwordx2 a[248:249], v12, s[4:7], 0 offen
ds_read_b64_tr_b16 a[18:19], v33 offset:19200
v_exp_f32 v208, v208
v_exp_f32 v209, v209
v_exp_f32 v210, v210
v_exp_f32 v211, v211
v_smfmac_f32_32x32x32_bf16 v[128:143], a[12:15], v[200:207], v54
ds_read_b128 a[48:51], v30 offset:20480
v_exp_f32 v212, v212
v_exp_f32 v213, v213
v_exp_f32 v214, v214
v_exp_f32 v215, v215
v_mfma_f32_32x32x16_bf16 v[240:255], a[44:47], a[4:7], v[240:255]
ds_read_b64_tr_b16 a[20:21], v34 offset:19200
v_exp_f32 v216, v216
v_exp_f32 v217, v217
v_exp_f32 v218, v218
v_exp_f32 v219, v219
v_smfmac_f32_32x32x32_bf16 v[144:159], a[8:11], v[208:215], v54
s_waitcnt lgkmcnt(2)
ds_read_b64_tr_b16 a[22:23], v35 offset:19200
v_exp_f32 v220, v220
v_exp_f32 v221, v221
v_exp_f32 v222, v222
v_exp_f32 v223, v223
v_mfma_f32_32x32x4_2b_bf16 v[160:191], a[52:53], v[14:15], 0
v_exp_f32 v224, v224
v_exp_f32 v225, v225
v_exp_f32 v226, v226
v_exp_f32 v227, v227
v_exp_f32 v228, v228
v_exp_f32 v229, v229
v_exp_f32 v230, v230
v_exp_f32 v231, v231
v_smfmac_f32_32x32x32_bf16 v[144:159], a[12:15], v[216:223], v54
buffer_store_dwordx4 v[84:87], v47, s[36:39], s49 offen sc1
ds_read2st64_b64 a[56:59], v16 offset0:40 offset1:45
v_exp_f32 v232, v232
v_exp_f32 v233, v233
v_exp_f32 v234, v234
v_exp_f32 v235, v235
v_smfmac_f32_32x32x32_bf16 v[128:143], a[16:19], v[224:231], v54
s_waitcnt lgkmcnt(1)
s_add_u32 s49, s92, 0x834000
ds_read_b64_tr_b16 a[8:9], v32 offset:30720
v_exp_f32 v236, v236
v_exp_f32 v237, v237
v_exp_f32 v238, v238
v_exp_f32 v239, v239
v_mfma_f32_32x32x16_bf16 v[160:175], a[48:51], a[0:3], v[160:175]
ds_read_b64_tr_b16 a[10:11], v33 offset:30720
v_exp_f32 v240, v240
v_exp_f32 v241, v241
v_exp_f32 v242, v242
v_exp_f32 v243, v243
v_smfmac_f32_32x32x32_bf16 v[128:143], a[20:23], v[232:239], v54
ds_read_b128 a[40:43], v30 offset:21760
v_exp_f32 v244, v244
v_exp_f32 v245, v245
v_exp_f32 v246, v246
v_exp_f32 v247, v247
v_mfma_f32_32x32x16_bf16 v[176:191], a[48:51], a[4:7], v[176:191]
ds_read_b64_tr_b16 a[12:13], v34 offset:30720
v_exp_f32 v248, v248
v_exp_f32 v249, v249
v_exp_f32 v250, v250
v_exp_f32 v251, v251
v_smfmac_f32_32x32x32_bf16 v[144:159], a[16:19], v[240:247], v54
s_waitcnt lgkmcnt(2)
ds_read_b64_tr_b16 a[14:15], v35 offset:30720
v_exp_f32 v252, v252
v_exp_f32 v253, v253
v_exp_f32 v254, v254
v_exp_f32 v255, v255
v_mfma_f32_32x32x4_2b_bf16 v[192:223], a[56:57], v[14:15], 0
v_exp_f32 v160, v160
v_exp_f32 v161, v161
v_exp_f32 v162, v162
v_exp_f32 v163, v163
v_exp_f32 v164, v164
v_exp_f32 v165, v165
v_exp_f32 v166, v166
v_exp_f32 v167, v167
v_smfmac_f32_32x32x32_bf16 v[144:159], a[20:23], v[248:255], v54
buffer_store_dwordx4 v[88:91], v47, s[36:39], s49 offen sc1
v_exp_f32 v168, v168
v_exp_f32 v169, v169
v_exp_f32 v170, v170
v_exp_f32 v171, v171
v_smfmac_f32_32x32x32_bf16 v[128:143], a[8:11], v[160:167], v54
s_waitcnt lgkmcnt(0)
s_add_u32 s49, s93, 0x834000
ds_read_b64_tr_b16 a[16:17], v32 offset:32000
v_exp_f32 v172, v172
v_exp_f32 v173, v173
v_exp_f32 v174, v174
v_exp_f32 v175, v175
v_mfma_f32_32x32x16_bf16 v[192:207], a[40:43], a[0:3], v[192:207]
ds_read_b64_tr_b16 a[18:19], v33 offset:32000
v_exp_f32 v176, v176
v_exp_f32 v177, v177
v_exp_f32 v178, v178
v_exp_f32 v179, v179
v_smfmac_f32_32x32x32_bf16 v[128:143], a[12:15], v[168:175], v54
ds_read_b128 a[44:47], v30 offset:23040
v_exp_f32 v180, v180
v_exp_f32 v181, v181
v_exp_f32 v182, v182
v_exp_f32 v183, v183
v_mfma_f32_32x32x16_bf16 v[208:223], a[40:43], a[4:7], v[208:223]
ds_read_b64_tr_b16 a[20:21], v34 offset:32000
v_exp_f32 v184, v184
v_exp_f32 v185, v185
v_exp_f32 v186, v186
v_exp_f32 v187, v187
v_smfmac_f32_32x32x32_bf16 v[144:159], a[8:11], v[176:183], v54
s_waitcnt lgkmcnt(2)
ds_read_b64_tr_b16 a[22:23], v35 offset:32000
v_exp_f32 v188, v188
v_exp_f32 v189, v189
v_exp_f32 v190, v190
v_exp_f32 v191, v191
v_mfma_f32_32x32x4_2b_bf16 v[224:255], a[54:55], v[14:15], 0
v_exp_f32 v192, v192
v_exp_f32 v193, v193
v_exp_f32 v194, v194
v_exp_f32 v195, v195
v_exp_f32 v196, v196
v_exp_f32 v197, v197
v_exp_f32 v198, v198
v_exp_f32 v199, v199
v_smfmac_f32_32x32x32_bf16 v[144:159], a[12:15], v[184:191], v54
buffer_store_dwordx4 v[92:95], v47, s[36:39], s49 offen sc1
v_exp_f32 v200, v200
v_exp_f32 v201, v201
v_exp_f32 v202, v202
v_exp_f32 v203, v203
v_smfmac_f32_32x32x32_bf16 v[128:143], a[16:19], v[192:199], v54
s_waitcnt lgkmcnt(0)
s_add_u32 s49, s92, 0x838000
ds_read_b64_tr_b16 a[8:9], v32 offset:33280
v_exp_f32 v204, v204
v_exp_f32 v205, v205
v_exp_f32 v206, v206
v_exp_f32 v207, v207
v_mfma_f32_32x32x16_bf16 v[224:239], a[44:47], a[0:3], v[224:239]
ds_read_b64_tr_b16 a[10:11], v33 offset:33280
v_exp_f32 v208, v208
v_exp_f32 v209, v209
v_exp_f32 v210, v210
v_exp_f32 v211, v211
v_smfmac_f32_32x32x32_bf16 v[128:143], a[20:23], v[200:207], v54
ds_read_b128 a[48:51], v30 offset:24320
v_exp_f32 v212, v212
v_exp_f32 v213, v213
v_exp_f32 v214, v214
v_exp_f32 v215, v215
v_mfma_f32_32x32x16_bf16 v[240:255], a[44:47], a[4:7], v[240:255]
ds_read_b64_tr_b16 a[12:13], v34 offset:33280
v_exp_f32 v216, v216
v_exp_f32 v217, v217
v_exp_f32 v218, v218
v_exp_f32 v219, v219
v_smfmac_f32_32x32x32_bf16 v[144:159], a[16:19], v[208:215], v54
s_waitcnt lgkmcnt(2)
ds_read_b64_tr_b16 a[14:15], v35 offset:33280
v_exp_f32 v220, v220
v_exp_f32 v221, v221
v_exp_f32 v222, v222
v_exp_f32 v223, v223
v_mfma_f32_32x32x4_2b_bf16 v[160:191], a[58:59], v[14:15], 0
v_exp_f32 v224, v224
v_exp_f32 v225, v225
v_exp_f32 v226, v226
v_exp_f32 v227, v227
v_exp_f32 v228, v228
v_exp_f32 v229, v229
v_exp_f32 v230, v230
v_exp_f32 v231, v231
v_smfmac_f32_32x32x32_bf16 v[144:159], a[20:23], v[216:223], v54
buffer_store_dwordx4 v[96:99], v47, s[36:39], s49 offen sc1
ds_read2st64_b64 a[52:55], v31 offset0:50 offset1:55
v_exp_f32 v232, v232
v_exp_f32 v233, v233
v_exp_f32 v234, v234
v_exp_f32 v235, v235
v_smfmac_f32_32x32x32_bf16 v[128:143], a[8:11], v[224:231], v54
s_waitcnt lgkmcnt(1)
s_add_u32 s49, s93, 0x838000
ds_read_b64_tr_b16 a[16:17], v32 offset:34560
v_exp_f32 v236, v236
v_exp_f32 v237, v237
v_exp_f32 v238, v238
v_exp_f32 v239, v239
v_mfma_f32_32x32x16_bf16 v[160:175], a[48:51], a[0:3], v[160:175]
ds_read_b64_tr_b16 a[18:19], v33 offset:34560
v_exp_f32 v240, v240
v_exp_f32 v241, v241
v_exp_f32 v242, v242
v_exp_f32 v243, v243
v_smfmac_f32_32x32x32_bf16 v[128:143], a[12:15], v[232:239], v54
ds_read_b128 a[40:43], v30 offset:25600
v_exp_f32 v244, v244
v_exp_f32 v245, v245
v_exp_f32 v246, v246
v_exp_f32 v247, v247
v_mfma_f32_32x32x16_bf16 v[176:191], a[48:51], a[4:7], v[176:191]
ds_read_b64_tr_b16 a[20:21], v34 offset:34560
v_exp_f32 v248, v248
v_exp_f32 v249, v249
v_exp_f32 v250, v250
v_exp_f32 v251, v251
v_smfmac_f32_32x32x32_bf16 v[144:159], a[8:11], v[240:247], v54
s_waitcnt lgkmcnt(2)
ds_read_b64_tr_b16 a[22:23], v35 offset:34560
v_exp_f32 v252, v252
v_exp_f32 v253, v253
v_exp_f32 v254, v254
v_exp_f32 v255, v255
v_mfma_f32_32x32x4_2b_bf16 v[192:223], a[52:53], v[14:15], 0
v_exp_f32 v160, v160
v_exp_f32 v161, v161
v_exp_f32 v162, v162
v_exp_f32 v163, v163
v_exp_f32 v164, v164
v_exp_f32 v165, v165
v_exp_f32 v166, v166
v_exp_f32 v167, v167
v_smfmac_f32_32x32x32_bf16 v[144:159], a[12:15], v[248:255], v54
buffer_store_dwordx4 v[100:103], v47, s[36:39], s49 offen sc1
ds_read2st64_b64 a[56:59], v16 offset0:50 offset1:55
v_exp_f32 v168, v168
v_exp_f32 v169, v169
v_exp_f32 v170, v170
v_exp_f32 v171, v171
v_smfmac_f32_32x32x32_bf16 v[128:143], a[16:19], v[160:167], v54
s_waitcnt lgkmcnt(1)
s_add_u32 s49, s92, 0x83c000
ds_read_b64_tr_b16 a[8:9], v32 offset:35840
v_exp_f32 v172, v172
v_exp_f32 v173, v173
v_exp_f32 v174, v174
v_exp_f32 v175, v175
v_mfma_f32_32x32x16_bf16 v[192:207], a[40:43], a[0:3], v[192:207]
ds_read_b64_tr_b16 a[10:11], v33 offset:35840
v_exp_f32 v176, v176
v_exp_f32 v177, v177
v_exp_f32 v178, v178
v_exp_f32 v179, v179
v_smfmac_f32_32x32x32_bf16 v[128:143], a[20:23], v[168:175], v54
ds_read_b128 a[44:47], v30 offset:26880
v_exp_f32 v180, v180
v_exp_f32 v181, v181
v_exp_f32 v182, v182
v_exp_f32 v183, v183
v_mfma_f32_32x32x16_bf16 v[208:223], a[40:43], a[4:7], v[208:223]
ds_read_b64_tr_b16 a[12:13], v34 offset:35840
v_exp_f32 v184, v184
v_exp_f32 v185, v185
v_exp_f32 v186, v186
v_exp_f32 v187, v187
v_smfmac_f32_32x32x32_bf16 v[144:159], a[16:19], v[176:183], v54
s_waitcnt lgkmcnt(2)
ds_read_b64_tr_b16 a[14:15], v35 offset:35840
v_exp_f32 v188, v188
v_exp_f32 v189, v189
v_exp_f32 v190, v190
v_exp_f32 v191, v191
v_mfma_f32_32x32x4_2b_bf16 v[224:255], a[56:57], v[14:15], 0
v_exp_f32 v192, v192
v_exp_f32 v193, v193
v_exp_f32 v194, v194
v_exp_f32 v195, v195
v_exp_f32 v196, v196
v_exp_f32 v197, v197
v_exp_f32 v198, v198
v_exp_f32 v199, v199
v_smfmac_f32_32x32x32_bf16 v[144:159], a[20:23], v[184:191], v54
buffer_store_dwordx4 v[104:107], v47, s[36:39], s49 offen sc1
v_exp_f32 v200, v200
v_exp_f32 v201, v201
v_exp_f32 v202, v202
v_exp_f32 v203, v203
v_smfmac_f32_32x32x32_bf16 v[128:143], a[8:11], v[192:199], v54
s_waitcnt lgkmcnt(0)
s_add_u32 s49, s93, 0x83c000
ds_read_b64_tr_b16 a[16:17], v32 offset:37120
v_exp_f32 v204, v204
v_exp_f32 v205, v205
v_exp_f32 v206, v206
v_exp_f32 v207, v207
v_mfma_f32_32x32x16_bf16 v[224:239], a[44:47], a[0:3], v[224:239]
ds_read_b64_tr_b16 a[18:19], v33 offset:37120
v_exp_f32 v208, v208
v_exp_f32 v209, v209
v_exp_f32 v210, v210
v_exp_f32 v211, v211
v_smfmac_f32_32x32x32_bf16 v[128:143], a[12:15], v[200:207], v54
ds_read_b128 a[48:51], v30 offset:28160
v_exp_f32 v212, v212
v_exp_f32 v213, v213
v_exp_f32 v214, v214
v_exp_f32 v215, v215
v_mfma_f32_32x32x16_bf16 v[240:255], a[44:47], a[4:7], v[240:255]
ds_read_b64_tr_b16 a[20:21], v34 offset:37120
v_exp_f32 v216, v216
v_exp_f32 v217, v217
v_exp_f32 v218, v218
v_exp_f32 v219, v219
v_smfmac_f32_32x32x32_bf16 v[144:159], a[8:11], v[208:215], v54
s_waitcnt lgkmcnt(2)
ds_read_b64_tr_b16 a[22:23], v35 offset:37120
v_exp_f32 v220, v220
v_exp_f32 v221, v221
v_exp_f32 v222, v222
v_exp_f32 v223, v223
v_mfma_f32_32x32x4_2b_bf16 v[160:191], a[54:55], v[14:15], 0
v_exp_f32 v224, v224
v_exp_f32 v225, v225
v_exp_f32 v226, v226
v_exp_f32 v227, v227
v_exp_f32 v228, v228
v_exp_f32 v229, v229
v_exp_f32 v230, v230
v_exp_f32 v231, v231
v_smfmac_f32_32x32x32_bf16 v[144:159], a[12:15], v[216:223], v54
buffer_store_dwordx4 v[108:111], v47, s[36:39], s49 offen sc1
v_exp_f32 v232, v232
v_exp_f32 v233, v233
v_exp_f32 v234, v234
v_exp_f32 v235, v235
v_smfmac_f32_32x32x32_bf16 v[128:143], a[16:19], v[224:231], v54
s_waitcnt lgkmcnt(0)
s_add_u32 s49, s92, 0x840000
ds_read_b64_tr_b16 a[8:9], v32 offset:38400
v_exp_f32 v236, v236
v_exp_f32 v237, v237
v_exp_f32 v238, v238
v_exp_f32 v239, v239
v_mfma_f32_32x32x16_bf16 v[160:175], a[48:51], a[0:3], v[160:175]
ds_read_b64_tr_b16 a[10:11], v33 offset:38400
v_exp_f32 v240, v240
v_exp_f32 v241, v241
v_exp_f32 v242, v242
v_exp_f32 v243, v243
v_smfmac_f32_32x32x32_bf16 v[128:143], a[20:23], v[232:239], v54
s_waitcnt vmcnt(38)
s_barrier
ds_read_b128 a[40:43], v30 offset:29440
v_exp_f32 v244, v244
v_exp_f32 v245, v245
v_exp_f32 v246, v246
v_exp_f32 v247, v247
v_mfma_f32_32x32x16_bf16 v[176:191], a[48:51], a[4:7], v[176:191]
s_add_u32 m0, s54, 0x800
ds_read_b64_tr_b16 a[12:13], v34 offset:38400
v_exp_f32 v248, v248
v_exp_f32 v249, v249
v_exp_f32 v250, v250
v_exp_f32 v251, v251
v_smfmac_f32_32x32x32_bf16 v[144:159], a[16:19], v[240:247], v54
s_waitcnt lgkmcnt(2)
s_add_u32 s96, s36, 0x8000
ds_read_b64_tr_b16 a[14:15], v35 offset:38400
v_exp_f32 v252, v252
v_exp_f32 v253, v253
v_exp_f32 v254, v254
v_exp_f32 v255, v255
v_mfma_f32_32x32x4_2b_bf16 v[192:223], a[58:59], v[14:15], 0
v_exp_f32 v160, v160
v_exp_f32 v161, v161
v_exp_f32 v162, v162
v_exp_f32 v163, v163
v_exp_f32 v164, v164
v_exp_f32 v165, v165
v_exp_f32 v166, v166
v_exp_f32 v167, v167
v_smfmac_f32_32x32x32_bf16 v[144:159], a[20:23], v[248:255], v54
buffer_store_dwordx2 v[112:113], v48, s[36:39], s49 offen sc1
ds_read2st64_b64 a[52:55], v31 offset0:80 offset1:85
v_exp_f32 v168, v168
v_exp_f32 v169, v169
v_exp_f32 v170, v170
v_exp_f32 v171, v171
v_smfmac_f32_32x32x32_bf16 v[128:143], a[8:11], v[160:167], v54
s_waitcnt lgkmcnt(1)
s_addc_u32 s97, s37, 0
ds_read_b64_tr_b16 a[16:17], v32 offset:39680
v_exp_f32 v172, v172
v_exp_f32 v173, v173
v_exp_f32 v174, v174
v_exp_f32 v175, v175
v_mfma_f32_32x32x16_bf16 v[192:207], a[40:43], a[0:3], v[192:207]
global_load_lds_dwordx4 v36, s[96:97] offset:-2048 sc1
ds_read_b64_tr_b16 a[18:19], v33 offset:39680
v_exp_f32 v176, v176
v_exp_f32 v177, v177
v_exp_f32 v178, v178
v_exp_f32 v179, v179
v_smfmac_f32_32x32x32_bf16 v[128:143], a[12:15], v[168:175], v54
global_load_lds_dwordx4 v36, s[96:97] offset:-1024 sc1
ds_read_b128 a[44:47], v30 offset:40960
v_exp_f32 v180, v180
v_exp_f32 v181, v181
v_exp_f32 v182, v182
v_exp_f32 v183, v183
v_mfma_f32_32x32x16_bf16 v[208:223], a[40:43], a[4:7], v[208:223]
global_load_lds_dwordx4 v36, s[96:97] sc1
ds_read_b64_tr_b16 a[20:21], v34 offset:39680
v_exp_f32 v184, v184
v_exp_f32 v185, v185
v_exp_f32 v186, v186
v_exp_f32 v187, v187
v_smfmac_f32_32x32x32_bf16 v[144:159], a[8:11], v[176:183], v54
s_waitcnt lgkmcnt(2)
s_add_u32 s49, s92, 0x842000
ds_read_b64_tr_b16 a[22:23], v35 offset:39680
v_exp_f32 v188, v188
v_exp_f32 v189, v189
v_exp_f32 v190, v190
v_exp_f32 v191, v191
v_mfma_f32_32x32x4_2b_bf16 v[224:255], a[52:53], v[14:15], 0
v_exp_f32 v192, v192
v_exp_f32 v193, v193
v_exp_f32 v194, v194
v_exp_f32 v195, v195
v_exp_f32 v196, v196
v_exp_f32 v197, v197
v_exp_f32 v198, v198
v_exp_f32 v199, v199
v_smfmac_f32_32x32x32_bf16 v[144:159], a[12:15], v[184:191], v54
buffer_store_dwordx2 v[114:115], v48, s[36:39], s49 offen sc1
ds_read2st64_b64 a[56:59], v16 offset0:80 offset1:85
v_exp_f32 v200, v200
v_exp_f32 v201, v201
v_exp_f32 v202, v202
v_exp_f32 v203, v203
v_smfmac_f32_32x32x32_bf16 v[128:143], a[16:19], v[192:199], v54
s_waitcnt lgkmcnt(1)
s_add_u32 s49, s93, 0x840000
ds_read_b64_tr_b16 a[8:9], v32 offset:51200
v_exp_f32 v204, v204
v_exp_f32 v205, v205
v_exp_f32 v206, v206
v_exp_f32 v207, v207
v_mfma_f32_32x32x16_bf16 v[224:239], a[44:47], a[0:3], v[224:239]
global_load_lds_dwordx4 v36, s[96:97] offset:1024 sc1
ds_read_b64_tr_b16 a[10:11], v33 offset:51200
v_exp_f32 v208, v208
v_exp_f32 v209, v209
v_exp_f32 v210, v210
v_exp_f32 v211, v211
v_smfmac_f32_32x32x32_bf16 v[128:143], a[20:23], v[200:207], v54
global_load_lds_dwordx4 v36, s[96:97] offset:2048 sc1
ds_read_b128 a[48:51], v30 offset:42240
v_exp_f32 v212, v212
v_exp_f32 v213, v213
v_exp_f32 v214, v214
v_exp_f32 v215, v215
v_mfma_f32_32x32x16_bf16 v[240:255], a[44:47], a[4:7], v[240:255]
s_add_u32 m0, s41, 0x1e000
ds_read_b64_tr_b16 a[12:13], v34 offset:51200
v_exp_f32 v216, v216
v_exp_f32 v217, v217
v_exp_f32 v218, v218
v_exp_f32 v219, v219
v_smfmac_f32_32x32x32_bf16 v[144:159], a[16:19], v[208:215], v54
s_waitcnt lgkmcnt(2)
s_add_u32 s96, s12, 0
ds_read_b64_tr_b16 a[14:15], v35 offset:51200
v_exp_f32 v220, v220
v_exp_f32 v221, v221
v_exp_f32 v222, v222
v_exp_f32 v223, v223
v_mfma_f32_32x32x4_2b_bf16 v[160:191], a[56:57], v[14:15], 0
v_exp_f32 v224, v224
v_exp_f32 v225, v225
v_exp_f32 v226, v226
v_exp_f32 v227, v227
v_exp_f32 v228, v228
v_exp_f32 v229, v229
v_exp_f32 v230, v230
v_exp_f32 v231, v231
v_smfmac_f32_32x32x32_bf16 v[144:159], a[20:23], v[216:223], v54
buffer_store_dwordx2 v[116:117], v48, s[36:39], s49 offen sc1
v_exp_f32 v232, v232
v_exp_f32 v233, v233
v_exp_f32 v234, v234
v_exp_f32 v235, v235
v_smfmac_f32_32x32x32_bf16 v[128:143], a[8:11], v[224:231], v54
s_waitcnt lgkmcnt(0)
s_addc_u32 s97, s13, 0
ds_read_b64_tr_b16 a[16:17], v32 offset:52480
v_exp_f32 v236, v236
v_exp_f32 v237, v237
v_exp_f32 v238, v238
v_exp_f32 v239, v239
v_mfma_f32_32x32x16_bf16 v[160:175], a[48:51], a[0:3], v[160:175]
global_load_lds_dwordx4 v38, s[96:97]
ds_read_b64_tr_b16 a[18:19], v33 offset:52480
v_exp_f32 v240, v240
v_exp_f32 v241, v241
v_exp_f32 v242, v242
v_exp_f32 v243, v243
v_smfmac_f32_32x32x32_bf16 v[128:143], a[12:15], v[232:239], v54
s_add_u32 s49, s93, 0x842000
s_add_u32 m0, s41, 0x1f000
ds_read_b128 a[40:43], v30 offset:43520
v_exp_f32 v244, v244
v_exp_f32 v245, v245
v_exp_f32 v246, v246
v_exp_f32 v247, v247
v_mfma_f32_32x32x16_bf16 v[176:191], a[48:51], a[4:7], v[176:191]
s_add_u32 s96, s12, 0x14400
ds_read_b64_tr_b16 a[20:21], v34 offset:52480
v_exp_f32 v248, v248
v_exp_f32 v249, v249
v_exp_f32 v250, v250
v_exp_f32 v251, v251
v_smfmac_f32_32x32x32_bf16 v[144:159], a[8:11], v[240:247], v54
s_waitcnt lgkmcnt(2)
s_addc_u32 s97, s13, 0
ds_read_b64_tr_b16 a[22:23], v35 offset:52480
v_exp_f32 v252, v252
v_exp_f32 v253, v253
v_exp_f32 v254, v254
v_exp_f32 v255, v255
v_mfma_f32_32x32x4_2b_bf16 v[192:223], a[54:55], v[14:15], 0
v_exp_f32 v160, v160
v_exp_f32 v161, v161
v_exp_f32 v162, v162
v_exp_f32 v163, v163
v_exp_f32 v164, v164
v_exp_f32 v165, v165
v_exp_f32 v166, v166
v_exp_f32 v167, v167
v_smfmac_f32_32x32x32_bf16 v[144:159], a[12:15], v[248:255], v54
buffer_store_dwordx2 v[118:119], v48, s[36:39], s49 offen sc1
v_exp_f32 v168, v168
v_exp_f32 v169, v169
v_exp_f32 v170, v170
v_exp_f32 v171, v171
v_smfmac_f32_32x32x32_bf16 v[128:143], a[16:19], v[160:167], v54
s_waitcnt lgkmcnt(0)
s_add_u32 s49, s92, 0x844000
ds_read_b64_tr_b16 a[8:9], v32 offset:53760
v_exp_f32 v172, v172
v_exp_f32 v173, v173
v_exp_f32 v174, v174
v_exp_f32 v175, v175
v_mfma_f32_32x32x16_bf16 v[192:207], a[40:43], a[0:3], v[192:207]
global_load_lds_dwordx4 v38, s[96:97]
ds_read_b64_tr_b16 a[10:11], v33 offset:53760
v_exp_f32 v176, v176
v_exp_f32 v177, v177
v_exp_f32 v178, v178
v_exp_f32 v179, v179
v_smfmac_f32_32x32x32_bf16 v[128:143], a[20:23], v[168:175], v54
s_add_u32 m0, s41, 0x20000
s_add_u32 s96, s12, 0
ds_read_b128 a[44:47], v30 offset:44800
v_exp_f32 v180, v180
v_exp_f32 v181, v181
v_exp_f32 v182, v182
v_exp_f32 v183, v183
v_mfma_f32_32x32x16_bf16 v[208:223], a[40:43], a[4:7], v[208:223]
s_addc_u32 s97, s13, 0
ds_read_b64_tr_b16 a[12:13], v34 offset:53760
v_exp_f32 v184, v184
v_exp_f32 v185, v185
v_exp_f32 v186, v186
v_exp_f32 v187, v187
v_smfmac_f32_32x32x32_bf16 v[144:159], a[16:19], v[176:183], v54
s_waitcnt lgkmcnt(2)
ds_read_b64_tr_b16 a[14:15], v35 offset:53760
v_exp_f32 v188, v188
v_exp_f32 v189, v189
v_exp_f32 v190, v190
v_exp_f32 v191, v191
v_mfma_f32_32x32x4_2b_bf16 v[224:255], a[58:59], v[14:15], 0
v_exp_f32 v192, v192
v_exp_f32 v193, v193
v_exp_f32 v194, v194
v_exp_f32 v195, v195
v_exp_f32 v196, v196
v_exp_f32 v197, v197
v_exp_f32 v198, v198
v_exp_f32 v199, v199
v_smfmac_f32_32x32x32_bf16 v[144:159], a[20:23], v[184:191], v54
buffer_store_dwordx2 v[120:121], v48, s[36:39], s49 offen sc1
ds_read2st64_b64 a[52:55], v31 offset0:90 offset1:95
v_exp_f32 v200, v200
v_exp_f32 v201, v201
v_exp_f32 v202, v202
v_exp_f32 v203, v203
v_smfmac_f32_32x32x32_bf16 v[128:143], a[8:11], v[192:199], v54
s_waitcnt lgkmcnt(1)
s_add_u32 s49, s92, 0x846000
ds_read_b64_tr_b16 a[16:17], v32 offset:55040
v_exp_f32 v204, v204
v_exp_f32 v205, v205
v_exp_f32 v206, v206
v_exp_f32 v207, v207
v_mfma_f32_32x32x16_bf16 v[224:239], a[44:47], a[0:3], v[224:239]
global_load_lds_dwordx4 v39, s[96:97]
ds_read_b64_tr_b16 a[18:19], v33 offset:55040
v_exp_f32 v208, v208
v_exp_f32 v209, v209
v_exp_f32 v210, v210
v_exp_f32 v211, v211
v_smfmac_f32_32x32x32_bf16 v[128:143], a[12:15], v[200:207], v54
ds_read_b128 a[48:51], v30 offset:46080
v_exp_f32 v212, v212
v_exp_f32 v213, v213
v_exp_f32 v214, v214
v_exp_f32 v215, v215
v_mfma_f32_32x32x16_bf16 v[240:255], a[44:47], a[4:7], v[240:255]
ds_read_b64_tr_b16 a[20:21], v34 offset:55040
v_exp_f32 v216, v216
v_exp_f32 v217, v217
v_exp_f32 v218, v218
v_exp_f32 v219, v219
v_smfmac_f32_32x32x32_bf16 v[144:159], a[8:11], v[208:215], v54
s_waitcnt lgkmcnt(2)
ds_read_b64_tr_b16 a[22:23], v35 offset:55040
v_exp_f32 v220, v220
v_exp_f32 v221, v221
v_exp_f32 v222, v222
v_exp_f32 v223, v223
v_mfma_f32_32x32x4_2b_bf16 v[160:191], a[52:53], v[14:15], 0
v_exp_f32 v224, v224
v_exp_f32 v225, v225
v_exp_f32 v226, v226
v_exp_f32 v227, v227
v_exp_f32 v228, v228
v_exp_f32 v229, v229
v_exp_f32 v230, v230
v_exp_f32 v231, v231
v_smfmac_f32_32x32x32_bf16 v[144:159], a[12:15], v[216:223], v54
buffer_store_dwordx2 v[122:123], v48, s[36:39], s49 offen sc1
ds_read2st64_b64 a[56:59], v16 offset0:90 offset1:95
v_exp_f32 v232, v232
v_exp_f32 v233, v233
v_exp_f32 v234, v234
v_exp_f32 v235, v235
v_smfmac_f32_32x32x32_bf16 v[128:143], a[16:19], v[224:231], v54
s_waitcnt lgkmcnt(1)
s_add_u32 s49, s93, 0x844000
ds_read_b64_tr_b16 a[8:9], v32 offset:56320
v_exp_f32 v236, v236
v_exp_f32 v237, v237
v_exp_f32 v238, v238
v_exp_f32 v239, v239
v_mfma_f32_32x32x16_bf16 v[160:175], a[48:51], a[0:3], v[160:175]
ds_read_b64_tr_b16 a[10:11], v33 offset:56320
v_exp_f32 v240, v240
v_exp_f32 v241, v241
v_exp_f32 v242, v242
v_exp_f32 v243, v243
v_smfmac_f32_32x32x32_bf16 v[128:143], a[20:23], v[232:239], v54
ds_read_b128 a[40:43], v30 offset:47360
v_exp_f32 v244, v244
v_exp_f32 v245, v245
v_exp_f32 v246, v246
v_exp_f32 v247, v247
v_mfma_f32_32x32x16_bf16 v[176:191], a[48:51], a[4:7], v[176:191]
ds_read_b64_tr_b16 a[12:13], v34 offset:56320
v_exp_f32 v248, v248
v_exp_f32 v249, v249
v_exp_f32 v250, v250
v_exp_f32 v251, v251
v_smfmac_f32_32x32x32_bf16 v[144:159], a[16:19], v[240:247], v54
s_waitcnt lgkmcnt(2)
ds_read_b64_tr_b16 a[14:15], v35 offset:56320
v_exp_f32 v252, v252
v_exp_f32 v253, v253
v_exp_f32 v254, v254
v_exp_f32 v255, v255
v_mfma_f32_32x32x4_2b_bf16 v[192:223], a[56:57], v[14:15], 0
v_exp_f32 v160, v160
v_exp_f32 v161, v161
v_exp_f32 v162, v162
v_exp_f32 v163, v163
v_exp_f32 v164, v164
v_exp_f32 v165, v165
v_exp_f32 v166, v166
v_exp_f32 v167, v167
v_smfmac_f32_32x32x32_bf16 v[144:159], a[20:23], v[248:255], v54
buffer_store_dwordx2 v[124:125], v48, s[36:39], s49 offen sc1
v_exp_f32 v168, v168
v_exp_f32 v169, v169
v_exp_f32 v170, v170
v_exp_f32 v171, v171
v_smfmac_f32_32x32x32_bf16 v[128:143], a[8:11], v[160:167], v54
s_waitcnt lgkmcnt(0)
s_add_u32 s49, s93, 0x846000
ds_read_b64_tr_b16 a[16:17], v32 offset:57600
v_exp_f32 v172, v172
v_exp_f32 v173, v173
v_exp_f32 v174, v174
v_exp_f32 v175, v175
v_mfma_f32_32x32x16_bf16 v[192:207], a[40:43], a[0:3], v[192:207]
ds_read_b64_tr_b16 a[18:19], v33 offset:57600
v_exp_f32 v176, v176
v_exp_f32 v177, v177
v_exp_f32 v178, v178
v_exp_f32 v179, v179
v_smfmac_f32_32x32x32_bf16 v[128:143], a[12:15], v[168:175], v54
ds_read_b128 a[44:47], v30 offset:48640
v_exp_f32 v180, v180
v_exp_f32 v181, v181
v_exp_f32 v182, v182
v_exp_f32 v183, v183
v_mfma_f32_32x32x16_bf16 v[208:223], a[40:43], a[4:7], v[208:223]
ds_read_b64_tr_b16 a[20:21], v34 offset:57600
v_exp_f32 v184, v184
v_exp_f32 v185, v185
v_exp_f32 v186, v186
v_exp_f32 v187, v187
v_smfmac_f32_32x32x32_bf16 v[144:159], a[8:11], v[176:183], v54
s_waitcnt lgkmcnt(2)
ds_read_b64_tr_b16 a[22:23], v35 offset:57600
v_exp_f32 v188, v188
v_exp_f32 v189, v189
v_exp_f32 v190, v190
v_exp_f32 v191, v191
v_mfma_f32_32x32x4_2b_bf16 v[224:255], a[54:55], v[14:15], 0
v_exp_f32 v192, v192
v_exp_f32 v193, v193
v_exp_f32 v194, v194
v_exp_f32 v195, v195
v_exp_f32 v196, v196
v_exp_f32 v197, v197
v_exp_f32 v198, v198
v_exp_f32 v199, v199
v_smfmac_f32_32x32x32_bf16 v[144:159], a[12:15], v[184:191], v54
buffer_store_dwordx2 v[126:127], v48, s[36:39], s49 offen sc1
v_exp_f32 v200, v200
v_exp_f32 v201, v201
v_exp_f32 v202, v202
v_exp_f32 v203, v203
v_smfmac_f32_32x32x32_bf16 v[128:143], a[16:19], v[192:199], v54
s_waitcnt lgkmcnt(0)
ds_read_b64_tr_b16 a[8:9], v32 offset:58880
v_exp_f32 v204, v204
v_exp_f32 v205, v205
v_exp_f32 v206, v206
v_exp_f32 v207, v207
v_mfma_f32_32x32x16_bf16 v[224:239], a[44:47], a[0:3], v[224:239]
ds_read_b64_tr_b16 a[10:11], v33 offset:58880
v_exp_f32 v208, v208
v_exp_f32 v209, v209
v_exp_f32 v210, v210
v_exp_f32 v211, v211
v_smfmac_f32_32x32x32_bf16 v[128:143], a[20:23], v[200:207], v54
s_waitcnt vmcnt(9)
s_barrier
ds_read_b128 a[48:51], v30 offset:49920
v_exp_f32 v212, v212
v_exp_f32 v213, v213
v_exp_f32 v214, v214
v_exp_f32 v215, v215
v_mfma_f32_32x32x16_bf16 v[240:255], a[44:47], a[4:7], v[240:255]
s_add_u32 m0, s54, 0x5800
ds_read_b64_tr_b16 a[12:13], v34 offset:58880
v_exp_f32 v216, v216
v_exp_f32 v217, v217
v_exp_f32 v218, v218
v_exp_f32 v219, v219
v_smfmac_f32_32x32x32_bf16 v[144:159], a[16:19], v[208:215], v54
s_waitcnt lgkmcnt(2)
s_add_u32 s96, s36, 0xa800
L_pg15:
s_cbranch_execz L_tr3
ds_read_b64_tr_b16 a[14:15], v35 offset:58880
v_exp_f32 v220, v220
v_exp_f32 v221, v221
v_exp_f32 v222, v222
v_exp_f32 v223, v223
v_mfma_f32_32x32x4_2b_bf16 v[160:191], a[58:59], v[14:15], 0
v_exp_f32 v224, v224
v_exp_f32 v225, v225
v_exp_f32 v226, v226
v_exp_f32 v227, v227
v_exp_f32 v228, v228
v_exp_f32 v229, v229
v_exp_f32 v230, v230
v_exp_f32 v231, v231
v_smfmac_f32_32x32x32_bf16 v[144:159], a[20:23], v[216:223], v54
s_addc_u32 s97, s37, 0
ds_read2st64_b64 a[52:55], v31 offset0:0 offset1:5
v_exp_f32 v232, v232
v_exp_f32 v233, v233
v_exp_f32 v234, v234
v_exp_f32 v235, v235
v_smfmac_f32_32x32x32_bf16 v[128:143], a[8:11], v[224:231], v54
s_waitcnt lgkmcnt(1)
ds_read_b64_tr_b16 a[16:17], v32 offset:60160
v_exp_f32 v236, v236
v_exp_f32 v237, v237
v_exp_f32 v238, v238
v_exp_f32 v239, v239
v_mfma_f32_32x32x16_bf16 v[160:175], a[48:51], a[0:3], v[160:175]
global_load_lds_dwordx4 v36, s[96:97] offset:-2048 sc1
ds_read_b64_tr_b16 a[18:19], v33 offset:60160
v_exp_f32 v240, v240
v_exp_f32 v241, v241
v_exp_f32 v242, v242
v_exp_f32 v243, v243
v_smfmac_f32_32x32x32_bf16 v[128:143], a[12:15], v[232:239], v54
global_load_lds_dwordx4 v36, s[96:97] offset:-1024 sc1
ds_read_b128 a[40:43], v30
v_exp_f32 v244, v244
v_exp_f32 v245, v245
v_exp_f32 v246, v246
v_exp_f32 v247, v247
v_mfma_f32_32x32x16_bf16 v[176:191], a[48:51], a[4:7], v[176:191]
global_load_lds_dwordx4 v36, s[96:97] sc1
ds_read_b64_tr_b16 a[20:21], v34 offset:60160
v_exp_f32 v248, v248
v_exp_f32 v249, v249
v_exp_f32 v250, v250
v_exp_f32 v251, v251
v_smfmac_f32_32x32x32_bf16 v[144:159], a[8:11], v[240:247], v54
s_waitcnt lgkmcnt(2)
ds_read_b64_tr_b16 a[22:23], v35 offset:60160
v_exp_f32 v252, v252
v_exp_f32 v253, v253
v_exp_f32 v254, v254
v_exp_f32 v255, v255
v_mfma_f32_32x32x4_2b_bf16 v[192:223], a[52:53], v[14:15], 0
v_exp_f32 v160, v160
v_exp_f32 v161, v161
v_exp_f32 v162, v162
v_exp_f32 v163, v163
v_exp_f32 v164, v164
v_exp_f32 v165, v165
v_exp_f32 v166, v166
v_exp_f32 v167, v167
v_smfmac_f32_32x32x32_bf16 v[144:159], a[12:15], v[248:255], v54
global_load_lds_dwordx4 v36, s[96:97] offset:1024 sc1
ds_read2st64_b64 a[56:59], v16 offset0:0 offset1:5
v_exp_f32 v168, v168
v_exp_f32 v169, v169
v_exp_f32 v170, v170
v_exp_f32 v171, v171
v_smfmac_f32_32x32x32_bf16 v[128:143], a[16:19], v[160:167], v54
s_waitcnt lgkmcnt(1)
ds_read_b64_tr_b16 a[8:9], v32 offset:10240
v_exp_f32 v172, v172
v_exp_f32 v173, v173
v_exp_f32 v174, v174
v_exp_f32 v175, v175
v_mfma_f32_32x32x16_bf16 v[192:207], a[40:43], a[0:3], v[192:207]
global_load_lds_dwordx4 v36, s[96:97] offset:2048 sc1
ds_read_b64_tr_b16 a[10:11], v33 offset:10240
v_exp_f32 v176, v176
v_exp_f32 v177, v177
v_exp_f32 v178, v178
v_exp_f32 v179, v179
v_smfmac_f32_32x32x32_bf16 v[128:143], a[20:23], v[168:175], v54
s_add_u32 m0, s41, 0x21000
s_add_u32 s96, s12, 0x28800
ds_read_b128 a[44:47], v30 offset:1280
v_exp_f32 v180, v180
v_exp_f32 v181, v181
v_exp_f32 v182, v182
v_exp_f32 v183, v183
v_mfma_f32_32x32x16_bf16 v[208:223], a[40:43], a[4:7], v[208:223]
s_addc_u32 s97, s13, 0
ds_read_b64_tr_b16 a[12:13], v34 offset:10240
v_exp_f32 v184, v184
v_exp_f32 v185, v185
v_exp_f32 v186, v186
v_exp_f32 v187, v187
v_smfmac_f32_32x32x32_bf16 v[144:159], a[16:19], v[176:183], v54
s_waitcnt lgkmcnt(2)
ds_read_b64_tr_b16 a[14:15], v35 offset:10240
v_exp_f32 v188, v188
v_exp_f32 v189, v189
v_exp_f32 v190, v190
v_exp_f32 v191, v191
v_mfma_f32_32x32x4_2b_bf16 v[224:255], a[56:57], v[14:15], 0
v_exp_f32 v192, v192
v_exp_f32 v193, v193
v_exp_f32 v194, v194
v_exp_f32 v195, v195
v_exp_f32 v196, v196
v_exp_f32 v197, v197
v_exp_f32 v198, v198
v_exp_f32 v199, v199
v_smfmac_f32_32x32x32_bf16 v[144:159], a[20:23], v[184:191], v54
global_load_lds_dwordx4 v39, s[96:97]
v_exp_f32 v200, v200
v_exp_f32 v201, v201
v_exp_f32 v202, v202
v_exp_f32 v203, v203
v_smfmac_f32_32x32x32_bf16 v[128:143], a[8:11], v[192:199], v54
s_waitcnt lgkmcnt(0)
s_add_u32 m0, s41, 0x22000
ds_read_b64_tr_b16 a[16:17], v32 offset:11520
v_exp_f32 v204, v204
v_exp_f32 v205, v205
v_exp_f32 v206, v206
v_exp_f32 v207, v207
v_mfma_f32_32x32x16_bf16 v[224:239], a[44:47], a[0:3], v[224:239]
s_add_u32 s96, s12, 0x51000
ds_read_b64_tr_b16 a[18:19], v33 offset:11520
v_exp_f32 v208, v208
v_exp_f32 v209, v209
v_exp_f32 v210, v210
v_exp_f32 v211, v211
v_smfmac_f32_32x32x32_bf16 v[128:143], a[12:15], v[200:207], v54
s_addc_u32 s97, s13, 0
ds_read_b128 a[48:51], v30 offset:2560
v_exp_f32 v212, v212
v_exp_f32 v213, v213
v_exp_f32 v214, v214
v_exp_f32 v215, v215
v_mfma_f32_32x32x16_bf16 v[240:255], a[44:47], a[4:7], v[240:255]
ds_read_b64_tr_b16 a[20:21], v34 offset:11520
v_exp_f32 v216, v216
v_exp_f32 v217, v217
v_exp_f32 v218, v218
v_exp_f32 v219, v219
v_smfmac_f32_32x32x32_bf16 v[144:159], a[8:11], v[208:215], v54
s_waitcnt lgkmcnt(2)
ds_read_b64_tr_b16 a[22:23], v35 offset:11520
v_exp_f32 v220, v220
v_exp_f32 v221, v221
v_exp_f32 v222, v222
v_exp_f32 v223, v223
v_mfma_f32_32x32x4_2b_bf16 v[160:191], a[54:55], v[14:15], 0
v_exp_f32 v224, v224
v_exp_f32 v225, v225
v_exp_f32 v226, v226
v_exp_f32 v227, v227
v_exp_f32 v228, v228
v_exp_f32 v229, v229
v_exp_f32 v230, v230
v_exp_f32 v231, v231
v_smfmac_f32_32x32x32_bf16 v[144:159], a[12:15], v[216:223], v54
global_load_lds_dwordx4 v39, s[96:97]
v_exp_f32 v232, v232
v_exp_f32 v233, v233
v_exp_f32 v234, v234
v_exp_f32 v235, v235
v_smfmac_f32_32x32x32_bf16 v[128:143], a[16:19], v[224:231], v54
s_waitcnt lgkmcnt(0)
s_add_u32 m0, s41, 0x23000
ds_read_b64_tr_b16 a[8:9], v32 offset:12800
v_exp_f32 v236, v236
v_exp_f32 v237, v237
v_exp_f32 v238, v238
v_exp_f32 v239, v239
v_mfma_f32_32x32x16_bf16 v[160:175], a[48:51], a[0:3], v[160:175]
s_add_u32 s96, s12, 0x79800
ds_read_b64_tr_b16 a[10:11], v33 offset:12800
v_exp_f32 v240, v240
v_exp_f32 v241, v241
v_exp_f32 v242, v242
v_exp_f32 v243, v243
v_smfmac_f32_32x32x32_bf16 v[128:143], a[20:23], v[232:239], v54
s_addc_u32 s97, s13, 0
ds_read_b128 a[40:43], v30 offset:3840
v_exp_f32 v244, v244
v_exp_f32 v245, v245
v_exp_f32 v246, v246
v_exp_f32 v247, v247
v_mfma_f32_32x32x16_bf16 v[176:191], a[48:51], a[4:7], v[176:191]
ds_read_b64_tr_b16 a[12:13], v34 offset:12800
v_exp_f32 v248, v248
v_exp_f32 v249, v249
v_exp_f32 v250, v250
v_exp_f32 v251, v251
v_smfmac_f32_32x32x32_bf16 v[144:159], a[16:19], v[240:247], v54
s_waitcnt lgkmcnt(2)
ds_read_b64_tr_b16 a[14:15], v35 offset:12800
v_exp_f32 v252, v252
v_exp_f32 v253, v253
v_exp_f32 v254, v254
v_exp_f32 v255, v255
v_mfma_f32_32x32x4_2b_bf16 v[192:223], a[58:59], v[14:15], 0
v_exp_f32 v160, v160
v_exp_f32 v161, v161
v_exp_f32 v162, v162
v_exp_f32 v163, v163
v_exp_f32 v164, v164
v_exp_f32 v165, v165
v_exp_f32 v166, v166
v_exp_f32 v167, v167
v_smfmac_f32_32x32x32_bf16 v[144:159], a[20:23], v[248:255], v54
global_load_lds_dwordx4 v39, s[96:97]
ds_read2st64_b64 a[52:55], v31 offset0:10 offset1:15
v_exp_f32 v168, v168
v_exp_f32 v169, v169
v_exp_f32 v170, v170
v_exp_f32 v171, v171
v_smfmac_f32_32x32x32_bf16 v[128:143], a[8:11], v[160:167], v54
s_waitcnt lgkmcnt(1)
s_mov_b64 exec, 0
s_cmp_eq_u32 s40, 0
s_cbranch_scc1 L_pg16
s_cmp_eq_u32 s40, 1
s_cbranch_scc1 L_pg17
s_cmp_eq_u32 s40, 2
s_cbranch_scc1 L_pg18
s_branch L_pg19
L_tr4:
s_mov_b64 exec, -1
ds_read_b64_tr_b16 a[16:17], v32 offset:14080
v_exp_f32 v172, v172
v_exp_f32 v173, v173
v_exp_f32 v174, v174
v_exp_f32 v175, v175
v_mfma_f32_32x32x16_bf16 v[192:207], a[40:43], a[0:3], v[192:207]
s_add_u32 m0, s41, 0x24000
ds_read_b64_tr_b16 a[18:19], v33 offset:14080
v_exp_f32 v176, v176
v_exp_f32 v177, v177
v_exp_f32 v178, v178
v_exp_f32 v179, v179
v_smfmac_f32_32x32x32_bf16 v[128:143], a[12:15], v[168:175], v54
s_mov_b32 s48, 0
ds_read_b128 a[44:47], v30 offset:5120
v_exp_f32 v180, v180
v_exp_f32 v181, v181
v_exp_f32 v182, v182
v_exp_f32 v183, v183
v_mfma_f32_32x32x16_bf16 v[208:223], a[40:43], a[4:7], v[208:223]
ds_read_b64_tr_b16 a[20:21], v34 offset:14080
v_exp_f32 v184, v184
v_exp_f32 v185, v185
v_exp_f32 v186, v186
v_exp_f32 v187, v187
v_smfmac_f32_32x32x32_bf16 v[144:159], a[8:11], v[176:183], v54
s_waitcnt lgkmcnt(2)
s_waitcnt vmcnt(8)
ds_read_b64_tr_b16 a[22:23], v35 offset:14080
v_exp_f32 v188, v188
v_exp_f32 v189, v189
v_exp_f32 v190, v190
v_exp_f32 v191, v191
v_mfma_f32_32x32x4_2b_bf16 v[224:255], a[52:53], v[14:15], 0
v_exp_f32 v192, v192
v_exp_f32 v193, v193
v_exp_f32 v194, v194
v_exp_f32 v195, v195
v_exp_f32 v196, v196
v_exp_f32 v197, v197
v_exp_f32 v198, v198
v_exp_f32 v199, v199
v_smfmac_f32_32x32x32_bf16 v[144:159], a[12:15], v[184:191], v54
buffer_atomic_sub v50, v49, s[36:39], 0 offen
ds_read2st64_b64 a[56:59], v16 offset0:10 offset1:15
v_exp_f32 v200, v200
v_exp_f32 v201, v201
v_exp_f32 v202, v202
v_exp_f32 v203, v203
v_smfmac_f32_32x32x32_bf16 v[128:143], a[16:19], v[192:199], v54
s_waitcnt lgkmcnt(1)
ds_read_b64_tr_b16 a[8:9], v32 offset:15360
v_exp_f32 v204, v204
v_exp_f32 v205, v205
v_exp_f32 v206, v206
v_exp_f32 v207, v207
v_mfma_f32_32x32x16_bf16 v[224:239], a[44:47], a[0:3], v[224:239]
buffer_load_dwordx4 v40, s[12:15], s48 offen lds
ds_read_b64_tr_b16 a[10:11], v33 offset:15360
v_exp_f32 v208, v208
v_exp_f32 v209, v209
v_exp_f32 v210, v210
v_exp_f32 v211, v211
v_smfmac_f32_32x32x32_bf16 v[128:143], a[20:23], v[200:207], v54
ds_read_b128 a[48:51], v30 offset:6400
v_exp_f32 v212, v212
v_exp_f32 v213, v213
v_exp_f32 v214, v214
v_exp_f32 v215, v215
v_mfma_f32_32x32x16_bf16 v[240:255], a[44:47], a[4:7], v[240:255]
ds_read_b64_tr_b16 a[12:13], v34 offset:15360
v_exp_f32 v216, v216
v_exp_f32 v217, v217
v_exp_f32 v218, v218
v_exp_f32 v219, v219
v_smfmac_f32_32x32x32_bf16 v[144:159], a[16:19], v[208:215], v54
s_waitcnt lgkmcnt(2)
ds_read_b64_tr_b16 a[14:15], v35 offset:15360
v_exp_f32 v220, v220
v_exp_f32 v221, v221
v_exp_f32 v222, v222
v_exp_f32 v223, v223
v_mfma_f32_32x32x4_2b_bf16 v[160:191], a[56:57], v[14:15], 0
v_exp_f32 v224, v224
v_exp_f32 v225, v225
v_exp_f32 v226, v226
v_exp_f32 v227, v227
v_exp_f32 v228, v228
v_exp_f32 v229, v229
v_exp_f32 v230, v230
v_exp_f32 v231, v231
v_smfmac_f32_32x32x32_bf16 v[144:159], a[20:23], v[216:223], v54
v_exp_f32 v232, v232
v_exp_f32 v233, v233
v_exp_f32 v234, v234
v_exp_f32 v235, v235
v_smfmac_f32_32x32x32_bf16 v[128:143], a[8:11], v[224:231], v54
s_waitcnt lgkmcnt(0)
ds_read_b64_tr_b16 a[16:17], v32 offset:16640
v_exp_f32 v236, v236
v_exp_f32 v237, v237
v_exp_f32 v238, v238
v_exp_f32 v239, v239
v_mfma_f32_32x32x16_bf16 v[160:175], a[48:51], a[0:3], v[160:175]
ds_read_b64_tr_b16 a[18:19], v33 offset:16640
v_exp_f32 v240, v240
v_exp_f32 v241, v241
v_exp_f32 v242, v242
v_exp_f32 v243, v243
v_smfmac_f32_32x32x32_bf16 v[128:143], a[12:15], v[232:239], v54
ds_read_b128 a[40:43], v30 offset:7680
v_exp_f32 v244, v244
v_exp_f32 v245, v245
v_exp_f32 v246, v246
v_exp_f32 v247, v247
v_mfma_f32_32x32x16_bf16 v[176:191], a[48:51], a[4:7], v[176:191]
ds_read_b64_tr_b16 a[20:21], v34 offset:16640
v_exp_f32 v248, v248
v_exp_f32 v249, v249
v_exp_f32 v250, v250
v_exp_f32 v251, v251
v_smfmac_f32_32x32x32_bf16 v[144:159], a[8:11], v[240:247], v54
s_waitcnt lgkmcnt(2)
ds_read_b64_tr_b16 a[22:23], v35 offset:16640
v_exp_f32 v252, v252
v_exp_f32 v253, v253
v_exp_f32 v254, v254
v_exp_f32 v255, v255
v_mfma_f32_32x32x4_2b_bf16 v[192:223], a[54:55], v[14:15], 0
v_exp_f32 v160, v160
v_exp_f32 v161, v161
v_exp_f32 v162, v162
v_exp_f32 v163, v163
v_exp_f32 v164, v164
v_exp_f32 v165, v165
v_exp_f32 v166, v166
v_exp_f32 v167, v167
v_smfmac_f32_32x32x32_bf16 v[144:159], a[12:15], v[248:255], v54
v_exp_f32 v168, v168
v_exp_f32 v169, v169
v_exp_f32 v170, v170
v_exp_f32 v171, v171
v_smfmac_f32_32x32x32_bf16 v[128:143], a[16:19], v[160:167], v54
s_waitcnt lgkmcnt(0)
ds_read_b64_tr_b16 a[8:9], v32 offset:17920
v_exp_f32 v172, v172
v_exp_f32 v173, v173
v_exp_f32 v174, v174
v_exp_f32 v175, v175
v_mfma_f32_32x32x16_bf16 v[192:207], a[40:43], a[0:3], v[192:207]
ds_read_b64_tr_b16 a[10:11], v33 offset:17920
v_exp_f32 v176, v176
v_exp_f32 v177, v177
v_exp_f32 v178, v178
v_exp_f32 v179, v179
v_smfmac_f32_32x32x32_bf16 v[128:143], a[20:23], v[168:175], v54
s_waitcnt vmcnt(5)
s_barrier
ds_read_b128 a[44:47], v30 offset:8960
v_exp_f32 v180, v180
v_exp_f32 v181, v181
v_exp_f32 v182, v182
v_exp_f32 v183, v183
v_mfma_f32_32x32x16_bf16 v[208:223], a[40:43], a[4:7], v[208:223]
s_add_u32 m0, s54, 0xa800
ds_read_b64_tr_b16 a[12:13], v34 offset:17920
v_exp_f32 v184, v184
v_exp_f32 v185, v185
v_exp_f32 v186, v186
v_exp_f32 v187, v187
v_smfmac_f32_32x32x32_bf16 v[144:159], a[16:19], v[176:183], v54
s_waitcnt lgkmcnt(2)
s_add_u32 s96, s36, 0xd000
ds_read_b64_tr_b16 a[14:15], v35 offset:17920
v_exp_f32 v188, v188
v_exp_f32 v189, v189
v_exp_f32 v190, v190
v_exp_f32 v191, v191
v_mov_b32 v53, 0
v_mfma_f32_32x32x4_2b_bf16 v[224:255], a[58:59], v[14:15], 0
v_exp_f32 v192, v192
v_exp_f32 v193, v193
v_exp_f32 v194, v194
v_exp_f32 v195, v195
v_exp_f32 v196, v196
v_exp_f32 v197, v197
v_exp_f32 v198, v198
v_exp_f32 v199, v199
v_smfmac_f32_32x32x32_bf16 v[144:159], a[20:23], v[184:191], v54
buffer_atomic_add v53, v51, s[36:39], 0 offen sc0
ds_read2st64_b64 a[52:55], v31 offset0:40 offset1:45
v_exp_f32 v200, v200
v_exp_f32 v201, v201
v_exp_f32 v202, v202
v_exp_f32 v203, v203
v_smfmac_f32_32x32x32_bf16 v[128:143], a[8:11], v[192:199], v54
s_waitcnt lgkmcnt(1)
s_addc_u32 s97, s37, 0
ds_read_b64_tr_b16 a[16:17], v32 offset:19200
v_exp_f32 v204, v204
v_exp_f32 v205, v205
v_exp_f32 v206, v206
v_exp_f32 v207, v207
v_mfma_f32_32x32x16_bf16 v[224:239], a[44:47], a[0:3], v[224:239]
global_load_lds_dwordx4 v36, s[96:97] offset:-2048 sc1
ds_read_b64_tr_b16 a[18:19], v33 offset:19200
v_exp_f32 v208, v208
v_exp_f32 v209, v209
v_exp_f32 v210, v210
v_exp_f32 v211, v211
v_smfmac_f32_32x32x32_bf16 v[128:143], a[12:15], v[200:207], v54
global_load_lds_dwordx4 v36, s[96:97] offset:-1024 sc1
ds_read_b128 a[48:51], v30 offset:20480
v_exp_f32 v212, v212
v_exp_f32 v213, v213
v_exp_f32 v214, v214
v_exp_f32 v215, v215
v_mfma_f32_32x32x16_bf16 v[240:255], a[44:47], a[4:7], v[240:255]
global_load_lds_dwordx4 v36, s[96:97] sc1
ds_read_b64_tr_b16 a[20:21], v34 offset:19200
v_exp_f32 v216, v216
v_exp_f32 v217, v217
v_exp_f32 v218, v218
v_exp_f32 v219, v219
v_smfmac_f32_32x32x32_bf16 v[144:159], a[8:11], v[208:215], v54
s_waitcnt lgkmcnt(2)
ds_read_b64_tr_b16 a[22:23], v35 offset:19200
v_exp_f32 v220, v220
v_exp_f32 v221, v221
v_exp_f32 v222, v222
v_exp_f32 v223, v223
v_mfma_f32_32x32x4_2b_bf16 v[160:191], a[52:53], v[14:15], 0
v_exp_f32 v224, v224
v_exp_f32 v225, v225
v_exp_f32 v226, v226
v_exp_f32 v227, v227
v_exp_f32 v228, v228
v_exp_f32 v229, v229
v_exp_f32 v230, v230
v_exp_f32 v231, v231
v_smfmac_f32_32x32x32_bf16 v[144:159], a[12:15], v[216:223], v54
global_load_lds_dwordx4 v36, s[96:97] offset:1024 sc1
ds_read2st64_b64 a[56:59], v16 offset0:40 offset1:45
v_exp_f32 v232, v232
v_exp_f32 v233, v233
v_exp_f32 v234, v234
v_exp_f32 v235, v235
v_smfmac_f32_32x32x32_bf16 v[128:143], a[16:19], v[224:231], v54
s_waitcnt lgkmcnt(1)
ds_read_b64_tr_b16 a[8:9], v32 offset:30720
v_exp_f32 v236, v236
v_exp_f32 v237, v237
v_exp_f32 v238, v238
v_exp_f32 v239, v239
v_mfma_f32_32x32x16_bf16 v[160:175], a[48:51], a[0:3], v[160:175]
global_load_lds_dwordx4 v36, s[96:97] offset:2048 sc1
ds_read_b64_tr_b16 a[10:11], v33 offset:30720
v_exp_f32 v240, v240
v_exp_f32 v241, v241
v_exp_f32 v242, v242
v_exp_f32 v243, v243
v_smfmac_f32_32x32x32_bf16 v[128:143], a[20:23], v[232:239], v54
ds_read_b128 a[40:43], v30 offset:21760
v_exp_f32 v244, v244
v_exp_f32 v245, v245
v_exp_f32 v246, v246
v_exp_f32 v247, v247
v_mfma_f32_32x32x16_bf16 v[176:191], a[48:51], a[4:7], v[176:191]
ds_read_b64_tr_b16 a[12:13], v34 offset:30720
v_exp_f32 v248, v248
v_exp_f32 v249, v249
v_exp_f32 v250, v250
v_exp_f32 v251, v251
v_smfmac_f32_32x32x32_bf16 v[144:159], a[16:19], v[240:247], v54
s_waitcnt lgkmcnt(2)
ds_read_b64_tr_b16 a[14:15], v35 offset:30720
v_exp_f32 v252, v252
v_exp_f32 v253, v253
v_exp_f32 v254, v254
v_exp_f32 v255, v255
v_mfma_f32_32x32x4_2b_bf16 v[192:223], a[56:57], v[14:15], 0
v_exp_f32 v160, v160
v_exp_f32 v161, v161
v_exp_f32 v162, v162
v_exp_f32 v163, v163
v_exp_f32 v164, v164
v_exp_f32 v165, v165
v_exp_f32 v166, v166
v_exp_f32 v167, v167
v_smfmac_f32_32x32x32_bf16 v[144:159], a[20:23], v[248:255], v54
v_exp_f32 v168, v168
v_exp_f32 v169, v169
v_exp_f32 v170, v170
v_exp_f32 v171, v171
v_smfmac_f32_32x32x32_bf16 v[128:143], a[8:11], v[160:167], v54
s_waitcnt lgkmcnt(0)
ds_read_b64_tr_b16 a[16:17], v32 offset:32000
v_exp_f32 v172, v172
v_exp_f32 v173, v173
v_exp_f32 v174, v174
v_exp_f32 v175, v175
v_mfma_f32_32x32x16_bf16 v[192:207], a[40:43], a[0:3], v[192:207]
ds_read_b64_tr_b16 a[18:19], v33 offset:32000
v_exp_f32 v176, v176
v_exp_f32 v177, v177
v_exp_f32 v178, v178
v_exp_f32 v179, v179
v_smfmac_f32_32x32x32_bf16 v[128:143], a[12:15], v[168:175], v54
ds_read_b128 a[44:47], v30 offset:23040
v_exp_f32 v180, v180
v_exp_f32 v181, v181
v_exp_f32 v182, v182
v_exp_f32 v183, v183
v_mfma_f32_32x32x16_bf16 v[208:223], a[40:43], a[4:7], v[208:223]
ds_read_b64_tr_b16 a[20:21], v34 offset:32000
v_exp_f32 v184, v184
v_exp_f32 v185, v185
v_exp_f32 v186, v186
v_exp_f32 v187, v187
v_smfmac_f32_32x32x32_bf16 v[144:159], a[8:11], v[176:183], v54
s_waitcnt lgkmcnt(2)
ds_read_b64_tr_b16 a[22:23], v35 offset:32000
v_exp_f32 v188, v188
v_exp_f32 v189, v189
v_exp_f32 v190, v190
v_exp_f32 v191, v191
v_mfma_f32_32x32x4_2b_bf16 v[224:255], a[54:55], v[14:15], 0
v_exp_f32 v192, v192
v_exp_f32 v193, v193
v_exp_f32 v194, v194
v_exp_f32 v195, v195
v_exp_f32 v196, v196
v_exp_f32 v197, v197
v_exp_f32 v198, v198
v_exp_f32 v199, v199
v_smfmac_f32_32x32x32_bf16 v[144:159], a[12:15], v[184:191], v54
s_waitcnt vmcnt(5)
v_cmp_ne_u32 vcc, 0, v53
s_nop 0
s_cbranch_vccnz L_spin_f2
L_back_f2:
v_exp_f32 v200, v200
v_exp_f32 v201, v201
v_exp_f32 v202, v202
v_exp_f32 v203, v203
v_smfmac_f32_32x32x32_bf16 v[128:143], a[16:19], v[192:199], v54
s_waitcnt lgkmcnt(0)
s_add_u32 s100, s36, 0x841000
ds_read_b64_tr_b16 a[8:9], v32 offset:33280
v_exp_f32 v204, v204
v_exp_f32 v205, v205
v_exp_f32 v206, v206
v_exp_f32 v207, v207
v_mfma_f32_32x32x16_bf16 v[224:239], a[44:47], a[0:3], v[224:239]
s_addc_u32 s101, s37, 0
ds_read_b64_tr_b16 a[10:11], v33 offset:33280
v_exp_f32 v208, v208
v_exp_f32 v209, v209
v_exp_f32 v210, v210
v_exp_f32 v211, v211
v_smfmac_f32_32x32x32_bf16 v[128:143], a[20:23], v[200:207], v54
s_add_u32 s98, s36, 0x801000
s_addc_u32 s99, s37, 0
ds_read_b128 a[48:51], v30 offset:24320
v_exp_f32 v212, v212
v_exp_f32 v213, v213
v_exp_f32 v214, v214
v_exp_f32 v215, v215
v_mfma_f32_32x32x16_bf16 v[240:255], a[44:47], a[4:7], v[240:255]
global_load_dwordx4 a[60:63], v41, s[98:99] offset:-4096 sc1
ds_read_b64_tr_b16 a[12:13], v34 offset:33280
v_exp_f32 v216, v216
v_exp_f32 v217, v217
v_exp_f32 v218, v218
v_exp_f32 v219, v219
v_smfmac_f32_32x32x32_bf16 v[144:159], a[16:19], v[208:215], v54
s_waitcnt lgkmcnt(2)
ds_read_b64_tr_b16 a[14:15], v35 offset:33280
v_exp_f32 v220, v220
v_exp_f32 v221, v221
v_exp_f32 v222, v222
v_exp_f32 v223, v223
v_mfma_f32_32x32x4_2b_bf16 v[160:191], a[58:59], v[14:15], 0
v_exp_f32 v224, v224
v_exp_f32 v225, v225
v_exp_f32 v226, v226
v_exp_f32 v227, v227
v_exp_f32 v228, v228
v_exp_f32 v229, v229
v_exp_f32 v230, v230
v_exp_f32 v231, v231
v_smfmac_f32_32x32x32_bf16 v[144:159], a[20:23], v[216:223], v54
global_load_dwordx4 a[64:67], v41, s[98:99] offset:-3072 sc1
ds_read2st64_b64 a[52:55], v31 offset0:50 offset1:55
v_exp_f32 v232, v232
v_exp_f32 v233, v233
v_exp_f32 v234, v234
v_exp_f32 v235, v235
v_smfmac_f32_32x32x32_bf16 v[128:143], a[8:11], v[224:231], v54
s_waitcnt lgkmcnt(1)
ds_read_b64_tr_b16 a[16:17], v32 offset:34560
v_exp_f32 v236, v236
v_exp_f32 v237, v237
v_exp_f32 v238, v238
v_exp_f32 v239, v239
v_mfma_f32_32x32x16_bf16 v[160:175], a[48:51], a[0:3], v[160:175]
ds_read_b64_tr_b16 a[18:19], v33 offset:34560
v_exp_f32 v240, v240
v_exp_f32 v241, v241
v_exp_f32 v242, v242
v_exp_f32 v243, v243
v_smfmac_f32_32x32x32_bf16 v[128:143], a[12:15], v[232:239], v54
ds_read_b128 a[40:43], v30 offset:25600
v_exp_f32 v244, v244
v_exp_f32 v245, v245
v_exp_f32 v246, v246
v_exp_f32 v247, v247
v_mfma_f32_32x32x16_bf16 v[176:191], a[48:51], a[4:7], v[176:191]
global_load_dwordx2 a[188:189], v42, s[100:101] offset:-4096 sc1
ds_read_b64_tr_b16 a[20:21], v34 offset:34560
v_exp_f32 v248, v248
v_exp_f32 v249, v249
v_exp_f32 v250, v250
v_exp_f32 v251, v251
v_smfmac_f32_32x32x32_bf16 v[144:159], a[8:11], v[240:247], v54
s_waitcnt lgkmcnt(2)
ds_read_b64_tr_b16 a[22:23], v35 offset:34560
v_exp_f32 v252, v252
v_exp_f32 v253, v253
v_exp_f32 v254, v254
v_exp_f32 v255, v255
v_mfma_f32_32x32x4_2b_bf16 v[192:223], a[52:53], v[14:15], 0
v_exp_f32 v160, v160
v_exp_f32 v161, v161
v_exp_f32 v162, v162
v_exp_f32 v163, v163
v_exp_f32 v164, v164
v_exp_f32 v165, v165
v_exp_f32 v166, v166
v_exp_f32 v167, v167
v_smfmac_f32_32x32x32_bf16 v[144:159], a[12:15], v[248:255], v54
global_load_dwordx4 a[68:71], v41, s[98:99] offset:-2048 sc1
ds_read2st64_b64 a[56:59], v16 offset0:50 offset1:55
v_exp_f32 v168, v168
v_exp_f32 v169, v169
v_exp_f32 v170, v170
v_exp_f32 v171, v171
v_smfmac_f32_32x32x32_bf16 v[128:143], a[16:19], v[160:167], v54
s_waitcnt lgkmcnt(1)
ds_read_b64_tr_b16 a[8:9], v32 offset:35840
v_exp_f32 v172, v172
v_exp_f32 v173, v173
v_exp_f32 v174, v174
v_exp_f32 v175, v175
v_mfma_f32_32x32x16_bf16 v[192:207], a[40:43], a[0:3], v[192:207]
ds_read_b64_tr_b16 a[10:11], v33 offset:35840
v_exp_f32 v176, v176
v_exp_f32 v177, v177
v_exp_f32 v178, v178
v_exp_f32 v179, v179
v_smfmac_f32_32x32x32_bf16 v[128:143], a[20:23], v[168:175], v54
ds_read_b128 a[44:47], v30 offset:26880
v_exp_f32 v180, v180
v_exp_f32 v181, v181
v_exp_f32 v182, v182
v_exp_f32 v183, v183
v_mfma_f32_32x32x16_bf16 v[208:223], a[40:43], a[4:7], v[208:223]
global_load_dwordx4 a[72:75], v41, s[98:99] offset:-1024 sc1
ds_read_b64_tr_b16 a[12:13], v34 offset:35840
v_exp_f32 v184, v184
v_exp_f32 v185, v185
v_exp_f32 v186, v186
v_exp_f32 v187, v187
v_smfmac_f32_32x32x32_bf16 v[144:159], a[16:19], v[176:183], v54
s_waitcnt lgkmcnt(2)
ds_read_b64_tr_b16 a[14:15], v35 offset:35840
v_exp_f32 v188, v188
v_exp_f32 v189, v189
v_exp_f32 v190, v190
v_exp_f32 v191, v191
v_mfma_f32_32x32x4_2b_bf16 v[224:255], a[56:57], v[14:15], 0
v_exp_f32 v192, v192
v_exp_f32 v193, v193
v_exp_f32 v194, v194
v_exp_f32 v195, v195
v_exp_f32 v196, v196
v_exp_f32 v197, v197
v_exp_f32 v198, v198
v_exp_f32 v199, v199
v_smfmac_f32_32x32x32_bf16 v[144:159], a[20:23], v[184:191], v54
global_load_dwordx2 a[190:191], v42, s[100:101] offset:-3584 sc1
v_exp_f32 v200, v200
v_exp_f32 v201, v201
v_exp_f32 v202, v202
v_exp_f32 v203, v203
v_smfmac_f32_32x32x32_bf16 v[128:143], a[8:11], v[192:199], v54
s_waitcnt lgkmcnt(0)
ds_read_b64_tr_b16 a[16:17], v32 offset:37120
v_exp_f32 v204, v204
v_exp_f32 v205, v205
v_exp_f32 v206, v206
v_exp_f32 v207, v207
v_mfma_f32_32x32x16_bf16 v[224:239], a[44:47], a[0:3], v[224:239]
ds_read_b64_tr_b16 a[18:19], v33 offset:37120
v_exp_f32 v208, v208
v_exp_f32 v209, v209
v_exp_f32 v210, v210
v_exp_f32 v211, v211
v_smfmac_f32_32x32x32_bf16 v[128:143], a[12:15], v[200:207], v54
ds_read_b128 a[48:51], v30 offset:28160
v_exp_f32 v212, v212
v_exp_f32 v213, v213
v_exp_f32 v214, v214
v_exp_f32 v215, v215
v_mfma_f32_32x32x16_bf16 v[240:255], a[44:47], a[4:7], v[240:255]
global_load_dwordx4 a[76:79], v41, s[98:99] sc1
ds_read_b64_tr_b16 a[20:21], v34 offset:37120
v_exp_f32 v216, v216
v_exp_f32 v217, v217
v_exp_f32 v218, v218
v_exp_f32 v219, v219
v_smfmac_f32_32x32x32_bf16 v[144:159], a[8:11], v[208:215], v54
s_waitcnt lgkmcnt(2)
ds_read_b64_tr_b16 a[22:23], v35 offset:37120
v_exp_f32 v220, v220
v_exp_f32 v221, v221
v_exp_f32 v222, v222
v_exp_f32 v223, v223
v_mfma_f32_32x32x4_2b_bf16 v[160:191], a[54:55], v[14:15], 0
v_exp_f32 v224, v224
v_exp_f32 v225, v225
v_exp_f32 v226, v226
v_exp_f32 v227, v227
v_exp_f32 v228, v228
v_exp_f32 v229, v229
v_exp_f32 v230, v230
v_exp_f32 v231, v231
v_smfmac_f32_32x32x32_bf16 v[144:159], a[12:15], v[216:223], v54
global_load_dwordx4 a[80:83], v41, s[98:99] offset:1024 sc1
v_exp_f32 v232, v232
v_exp_f32 v233, v233
v_exp_f32 v234, v234
v_exp_f32 v235, v235
v_smfmac_f32_32x32x32_bf16 v[128:143], a[16:19], v[224:231], v54
s_waitcnt lgkmcnt(0)
ds_read_b64_tr_b16 a[8:9], v32 offset:38400
v_exp_f32 v236, v236
v_exp_f32 v237, v237
v_exp_f32 v238, v238
v_exp_f32 v239, v239
v_mfma_f32_32x32x16_bf16 v[160:175], a[48:51], a[0:3], v[160:175]
L_pg16:
s_cbranch_execz L_tr4
ds_read_b64_tr_b16 a[10:11], v33 offset:38400
v_exp_f32 v240, v240
v_exp_f32 v241, v241
v_exp_f32 v242, v242
v_exp_f32 v243, v243
v_smfmac_f32_32x32x32_bf16 v[128:143], a[20:23], v[232:239], v54
s_waitcnt vmcnt(8)
s_barrier
ds_read_b128 a[40:43], v30 offset:29440
v_exp_f32 v244, v244
v_exp_f32 v245, v245
v_exp_f32 v246, v246
v_exp_f32 v247, v247
v_mfma_f32_32x32x16_bf16 v[176:191], a[48:51], a[4:7], v[176:191]
global_load_dwordx2 a[192:193], v42, s[100:101] offset:-3072 sc1
ds_read_b64_tr_b16 a[12:13], v34 offset:38400
v_exp_f32 v248, v248
v_exp_f32 v249, v249
v_exp_f32 v250, v250
v_exp_f32 v251, v251
v_smfmac_f32_32x32x32_bf16 v[144:159], a[16:19], v[240:247], v54
s_waitcnt lgkmcnt(2)
s_add_u32 m0, s54, 0x800
ds_read_b64_tr_b16 a[14:15], v35 offset:38400
v_exp_f32 v252, v252
v_exp_f32 v253, v253
v_exp_f32 v254, v254
v_exp_f32 v255, v255
v_mfma_f32_32x32x4_2b_bf16 v[192:223], a[58:59], v[14:15], 0
v_exp_f32 v160, v160
v_exp_f32 v161, v161
v_exp_f32 v162, v162
v_exp_f32 v163, v163
v_exp_f32 v164, v164
v_exp_f32 v165, v165
v_exp_f32 v166, v166
v_exp_f32 v167, v167
v_smfmac_f32_32x32x32_bf16 v[144:159], a[20:23], v[248:255], v54
global_load_dwordx4 a[84:87], v41, s[98:99] offset:2048 sc1
ds_read2st64_b64 a[52:55], v31 offset0:80 offset1:85
v_exp_f32 v168, v168
v_exp_f32 v169, v169
v_exp_f32 v170, v170
v_exp_f32 v171, v171
v_smfmac_f32_32x32x32_bf16 v[128:143], a[8:11], v[160:167], v54
s_waitcnt lgkmcnt(1)
s_add_u32 s96, s36, 0xf800
ds_read_b64_tr_b16 a[16:17], v32 offset:39680
v_exp_f32 v172, v172
v_exp_f32 v173, v173
v_exp_f32 v174, v174
v_exp_f32 v175, v175
v_mfma_f32_32x32x16_bf16 v[192:207], a[40:43], a[0:3], v[192:207]
s_addc_u32 s97, s37, 0
ds_read_b64_tr_b16 a[18:19], v33 offset:39680
v_exp_f32 v176, v176
v_exp_f32 v177, v177
v_exp_f32 v178, v178
v_exp_f32 v179, v179
v_smfmac_f32_32x32x32_bf16 v[128:143], a[12:15], v[168:175], v54
global_load_lds_dwordx4 v36, s[96:97] offset:-2048 sc1
ds_read_b128 a[44:47], v30 offset:40960
v_exp_f32 v180, v180
v_exp_f32 v181, v181
v_exp_f32 v182, v182
v_exp_f32 v183, v183
v_mfma_f32_32x32x16_bf16 v[208:223], a[40:43], a[4:7], v[208:223]
global_load_lds_dwordx4 v36, s[96:97] offset:-1024 sc1
ds_read_b64_tr_b16 a[20:21], v34 offset:39680
v_exp_f32 v184, v184
v_exp_f32 v185, v185
v_exp_f32 v186, v186
v_exp_f32 v187, v187
v_smfmac_f32_32x32x32_bf16 v[144:159], a[8:11], v[176:183], v54
s_waitcnt lgkmcnt(2)
ds_read_b64_tr_b16 a[22:23], v35 offset:39680
v_exp_f32 v188, v188
v_exp_f32 v189, v189
v_exp_f32 v190, v190
v_exp_f32 v191, v191
v_mfma_f32_32x32x4_2b_bf16 v[224:255], a[52:53], v[14:15], 0
v_exp_f32 v192, v192
v_exp_f32 v193, v193
v_exp_f32 v194, v194
v_exp_f32 v195, v195
v_exp_f32 v196, v196
v_exp_f32 v197, v197
v_exp_f32 v198, v198
v_exp_f32 v199, v199
v_smfmac_f32_32x32x32_bf16 v[144:159], a[12:15], v[184:191], v54
global_load_lds_dwordx4 v36, s[96:97] sc1
ds_read2st64_b64 a[56:59], v16 offset0:80 offset1:85
v_exp_f32 v200, v200
v_exp_f32 v201, v201
v_exp_f32 v202, v202
v_exp_f32 v203, v203
v_smfmac_f32_32x32x32_bf16 v[128:143], a[16:19], v[192:199], v54
s_waitcnt lgkmcnt(1)
ds_read_b64_tr_b16 a[8:9], v32 offset:51200
v_exp_f32 v204, v204
v_exp_f32 v205, v205
v_exp_f32 v206, v206
v_exp_f32 v207, v207
v_mfma_f32_32x32x16_bf16 v[224:239], a[44:47], a[0:3], v[224:239]
global_load_lds_dwordx4 v36, s[96:97] offset:1024 sc1
ds_read_b64_tr_b16 a[10:11], v33 offset:51200
v_exp_f32 v208, v208
v_exp_f32 v209, v209
v_exp_f32 v210, v210
v_exp_f32 v211, v211
v_smfmac_f32_32x32x32_bf16 v[128:143], a[20:23], v[200:207], v54
global_load_lds_dwordx4 v36, s[96:97] offset:2048 sc1
ds_read_b128 a[48:51], v30 offset:42240
v_exp_f32 v212, v212
v_exp_f32 v213, v213
v_exp_f32 v214, v214
v_exp_f32 v215, v215
v_mfma_f32_32x32x16_bf16 v[240:255], a[44:47], a[4:7], v[240:255]
global_load_dwordx4 a[88:91], v41, s[98:99] offset:3072 sc1
ds_read_b64_tr_b16 a[12:13], v34 offset:51200
v_exp_f32 v216, v216
v_exp_f32 v217, v217
v_exp_f32 v218, v218
v_exp_f32 v219, v219
v_smfmac_f32_32x32x32_bf16 v[144:159], a[16:19], v[208:215], v54
s_waitcnt lgkmcnt(2)
ds_read_b64_tr_b16 a[14:15], v35 offset:51200
v_exp_f32 v220, v220
v_exp_f32 v221, v221
v_exp_f32 v222, v222
v_exp_f32 v223, v223
v_mfma_f32_32x32x4_2b_bf16 v[160:191], a[56:57], v[14:15], 0
v_exp_f32 v224, v224
v_exp_f32 v225, v225
v_exp_f32 v226, v226
v_exp_f32 v227, v227
v_exp_f32 v228, v228
v_exp_f32 v229, v229
v_exp_f32 v230, v230
v_exp_f32 v231, v231
v_smfmac_f32_32x32x32_bf16 v[144:159], a[20:23], v[216:223], v54
global_load_dwordx2 a[194:195], v42, s[100:101] offset:-2560 sc1
v_exp_f32 v232, v232
v_exp_f32 v233, v233
v_exp_f32 v234, v234
v_exp_f32 v235, v235
v_smfmac_f32_32x32x32_bf16 v[128:143], a[8:11], v[224:231], v54
s_waitcnt lgkmcnt(0)
s_add_u32 s98, s36, 0x803000
ds_read_b64_tr_b16 a[16:17], v32 offset:52480
v_exp_f32 v236, v236
v_exp_f32 v237, v237
v_exp_f32 v238, v238
v_exp_f32 v239, v239
v_mfma_f32_32x32x16_bf16 v[160:175], a[48:51], a[0:3], v[160:175]
s_addc_u32 s99, s37, 0
ds_read_b64_tr_b16 a[18:19], v33 offset:52480
v_exp_f32 v240, v240
v_exp_f32 v241, v241
v_exp_f32 v242, v242
v_exp_f32 v243, v243
v_smfmac_f32_32x32x32_bf16 v[128:143], a[12:15], v[232:239], v54
ds_read_b128 a[40:43], v30 offset:43520
v_exp_f32 v244, v244
v_exp_f32 v245, v245
v_exp_f32 v246, v246
v_exp_f32 v247, v247
v_mfma_f32_32x32x16_bf16 v[176:191], a[48:51], a[4:7], v[176:191]
global_load_dwordx4 a[92:95], v41, s[98:99] offset:-4096 sc1
ds_read_b64_tr_b16 a[20:21], v34 offset:52480
v_exp_f32 v248, v248
v_exp_f32 v249, v249
v_exp_f32 v250, v250
v_exp_f32 v251, v251
v_smfmac_f32_32x32x32_bf16 v[144:159], a[8:11], v[240:247], v54
s_waitcnt lgkmcnt(2)
ds_read_b64_tr_b16 a[22:23], v35 offset:52480
v_exp_f32 v252, v252
v_exp_f32 v253, v253
v_exp_f32 v254, v254
v_exp_f32 v255, v255
v_mfma_f32_32x32x4_2b_bf16 v[192:223], a[54:55], v[14:15], 0
v_exp_f32 v160, v160
v_exp_f32 v161, v161
v_exp_f32 v162, v162
v_exp_f32 v163, v163
v_exp_f32 v164, v164
v_exp_f32 v165, v165
v_exp_f32 v166, v166
v_exp_f32 v167, v167
v_smfmac_f32_32x32x32_bf16 v[144:159], a[12:15], v[248:255], v54
global_load_dwordx4 a[96:99], v41, s[98:99] offset:-3072 sc1
v_exp_f32 v168, v168
v_exp_f32 v169, v169
v_exp_f32 v170, v170
v_exp_f32 v171, v171
v_smfmac_f32_32x32x32_bf16 v[128:143], a[16:19], v[160:167], v54
s_waitcnt lgkmcnt(0)
ds_read_b64_tr_b16 a[8:9], v32 offset:53760
v_exp_f32 v172, v172
v_exp_f32 v173, v173
v_exp_f32 v174, v174
v_exp_f32 v175, v175
v_mfma_f32_32x32x16_bf16 v[192:207], a[40:43], a[0:3], v[192:207]
ds_read_b64_tr_b16 a[10:11], v33 offset:53760
v_exp_f32 v176, v176
v_exp_f32 v177, v177
v_exp_f32 v178, v178
v_exp_f32 v179, v179
v_smfmac_f32_32x32x32_bf16 v[128:143], a[20:23], v[168:175], v54
ds_read_b128 a[44:47], v30 offset:44800
v_exp_f32 v180, v180
v_exp_f32 v181, v181
v_exp_f32 v182, v182
v_exp_f32 v183, v183
v_mfma_f32_32x32x16_bf16 v[208:223], a[40:43], a[4:7], v[208:223]
global_load_dwordx2 a[196:197], v42, s[100:101] offset:-2048 sc1
ds_read_b64_tr_b16 a[12:13], v34 offset:53760
v_exp_f32 v184, v184
v_exp_f32 v185, v185
v_exp_f32 v186, v186
v_exp_f32 v187, v187
v_smfmac_f32_32x32x32_bf16 v[144:159], a[16:19], v[176:183], v54
s_waitcnt lgkmcnt(2)
ds_read_b64_tr_b16 a[14:15], v35 offset:53760
v_exp_f32 v188, v188
v_exp_f32 v189, v189
v_exp_f32 v190, v190
v_exp_f32 v191, v191
v_mfma_f32_32x32x4_2b_bf16 v[224:255], a[58:59], v[14:15], 0
v_exp_f32 v192, v192
v_exp_f32 v193, v193
v_exp_f32 v194, v194
v_exp_f32 v195, v195
v_exp_f32 v196, v196
v_exp_f32 v197, v197
v_exp_f32 v198, v198
v_exp_f32 v199, v199
v_smfmac_f32_32x32x32_bf16 v[144:159], a[20:23], v[184:191], v54
global_load_dwordx4 a[100:103], v41, s[98:99] offset:-2048 sc1
ds_read2st64_b64 a[52:55], v31 offset0:90 offset1:95
v_exp_f32 v200, v200
v_exp_f32 v201, v201
v_exp_f32 v202, v202
v_exp_f32 v203, v203
v_smfmac_f32_32x32x32_bf16 v[128:143], a[8:11], v[192:199], v54
s_waitcnt lgkmcnt(1)
ds_read_b64_tr_b16 a[16:17], v32 offset:55040
v_exp_f32 v204, v204
v_exp_f32 v205, v205
v_exp_f32 v206, v206
v_exp_f32 v207, v207
v_mfma_f32_32x32x16_bf16 v[224:239], a[44:47], a[0:3], v[224:239]
ds_read_b64_tr_b16 a[18:19], v33 offset:55040
v_exp_f32 v208, v208
v_exp_f32 v209, v209
v_exp_f32 v210, v210
v_exp_f32 v211, v211
v_smfmac_f32_32x32x32_bf16 v[128:143], a[12:15], v[200:207], v54
ds_read_b128 a[48:51], v30 offset:46080
v_exp_f32 v212, v212
v_exp_f32 v213, v213
v_exp_f32 v214, v214
v_exp_f32 v215, v215
v_mfma_f32_32x32x16_bf16 v[240:255], a[44:47], a[4:7], v[240:255]
global_load_dwordx4 a[104:107], v41, s[98:99] offset:-1024 sc1
ds_read_b64_tr_b16 a[20:21], v34 offset:55040
v_exp_f32 v216, v216
v_exp_f32 v217, v217
v_exp_f32 v218, v218
v_exp_f32 v219, v219
v_smfmac_f32_32x32x32_bf16 v[144:159], a[8:11], v[208:215], v54
s_waitcnt lgkmcnt(2)
ds_read_b64_tr_b16 a[22:23], v35 offset:55040
v_exp_f32 v220, v220
v_exp_f32 v221, v221
v_exp_f32 v222, v222
v_exp_f32 v223, v223
v_mfma_f32_32x32x4_2b_bf16 v[160:191], a[52:53], v[14:15], 0
v_exp_f32 v224, v224
v_exp_f32 v225, v225
v_exp_f32 v226, v226
v_exp_f32 v227, v227
v_exp_f32 v228, v228
v_exp_f32 v229, v229
v_exp_f32 v230, v230
v_exp_f32 v231, v231
v_smfmac_f32_32x32x32_bf16 v[144:159], a[12:15], v[216:223], v54
global_load_dwordx2 a[198:199], v42, s[100:101] offset:-1536 sc1
ds_read2st64_b64 a[56:59], v16 offset0:90 offset1:95
v_exp_f32 v232, v232
v_exp_f32 v233, v233
v_exp_f32 v234, v234
v_exp_f32 v235, v235
v_smfmac_f32_32x32x32_bf16 v[128:143], a[16:19], v[224:231], v54
s_waitcnt lgkmcnt(1)
ds_read_b64_tr_b16 a[8:9], v32 offset:56320
v_exp_f32 v236, v236
v_exp_f32 v237, v237
v_exp_f32 v238, v238
v_exp_f32 v239, v239
v_mfma_f32_32x32x16_bf16 v[160:175], a[48:51], a[0:3], v[160:175]
ds_read_b64_tr_b16 a[10:11], v33 offset:56320
v_exp_f32 v240, v240
v_exp_f32 v241, v241
v_exp_f32 v242, v242
v_exp_f32 v243, v243
v_smfmac_f32_32x32x32_bf16 v[128:143], a[20:23], v[232:239], v54
ds_read_b128 a[40:43], v30 offset:47360
v_exp_f32 v244, v244
v_exp_f32 v245, v245
v_exp_f32 v246, v246
v_exp_f32 v247, v247
v_mfma_f32_32x32x16_bf16 v[176:191], a[48:51], a[4:7], v[176:191]
global_load_dwordx4 a[108:111], v41, s[98:99] sc1
ds_read_b64_tr_b16 a[12:13], v34 offset:56320
v_exp_f32 v248, v248
v_exp_f32 v249, v249
v_exp_f32 v250, v250
v_exp_f32 v251, v251
v_smfmac_f32_32x32x32_bf16 v[144:159], a[16:19], v[240:247], v54
s_waitcnt lgkmcnt(2)
ds_read_b64_tr_b16 a[14:15], v35 offset:56320
v_exp_f32 v252, v252
v_exp_f32 v253, v253
v_exp_f32 v254, v254
v_exp_f32 v255, v255
v_mfma_f32_32x32x4_2b_bf16 v[192:223], a[56:57], v[14:15], 0
v_exp_f32 v160, v160
v_exp_f32 v161, v161
v_exp_f32 v162, v162
v_exp_f32 v163, v163
v_exp_f32 v164, v164
v_exp_f32 v165, v165
v_exp_f32 v166, v166
v_exp_f32 v167, v167
v_smfmac_f32_32x32x32_bf16 v[144:159], a[20:23], v[248:255], v54
global_load_dwordx4 a[112:115], v41, s[98:99] offset:1024 sc1
v_exp_f32 v168, v168
v_exp_f32 v169, v169
v_exp_f32 v170, v170
v_exp_f32 v171, v171
v_smfmac_f32_32x32x32_bf16 v[128:143], a[8:11], v[160:167], v54
s_waitcnt lgkmcnt(0)
ds_read_b64_tr_b16 a[16:17], v32 offset:57600
v_exp_f32 v172, v172
v_exp_f32 v173, v173
v_exp_f32 v174, v174
v_exp_f32 v175, v175
v_mfma_f32_32x32x16_bf16 v[192:207], a[40:43], a[0:3], v[192:207]
ds_read_b64_tr_b16 a[18:19], v33 offset:57600
v_exp_f32 v176, v176
v_exp_f32 v177, v177
v_exp_f32 v178, v178
v_exp_f32 v179, v179
v_smfmac_f32_32x32x32_bf16 v[128:143], a[12:15], v[168:175], v54
ds_read_b128 a[44:47], v30 offset:48640
v_exp_f32 v180, v180
v_exp_f32 v181, v181
v_exp_f32 v182, v182
v_exp_f32 v183, v183
v_mfma_f32_32x32x16_bf16 v[208:223], a[40:43], a[4:7], v[208:223]
global_load_dwordx2 a[200:201], v42, s[100:101] offset:-1024 sc1
ds_read_b64_tr_b16 a[20:21], v34 offset:57600
v_exp_f32 v184, v184
v_exp_f32 v185, v185
v_exp_f32 v186, v186
v_exp_f32 v187, v187
v_smfmac_f32_32x32x32_bf16 v[144:159], a[8:11], v[176:183], v54
s_waitcnt lgkmcnt(2)
ds_read_b64_tr_b16 a[22:23], v35 offset:57600
v_exp_f32 v188, v188
v_exp_f32 v189, v189
v_exp_f32 v190, v190
v_exp_f32 v191, v191
v_mfma_f32_32x32x4_2b_bf16 v[224:255], a[54:55], v[14:15], 0
v_exp_f32 v192, v192
v_exp_f32 v193, v193
v_exp_f32 v194, v194
v_exp_f32 v195, v195
v_exp_f32 v196, v196
v_exp_f32 v197, v197
v_exp_f32 v198, v198
v_exp_f32 v199, v199
v_smfmac_f32_32x32x32_bf16 v[144:159], a[12:15], v[184:191], v54
global_load_dwordx4 a[116:119], v41, s[98:99] offset:2048 sc1
v_exp_f32 v200, v200
v_exp_f32 v201, v201
v_exp_f32 v202, v202
v_exp_f32 v203, v203
v_smfmac_f32_32x32x32_bf16 v[128:143], a[16:19], v[192:199], v54
s_waitcnt lgkmcnt(0)
ds_read_b64_tr_b16 a[8:9], v32 offset:58880
v_exp_f32 v204, v204
v_exp_f32 v205, v205
v_exp_f32 v206, v206
v_exp_f32 v207, v207
v_mfma_f32_32x32x16_bf16 v[224:239], a[44:47], a[0:3], v[224:239]
ds_read_b64_tr_b16 a[10:11], v33 offset:58880
v_exp_f32 v208, v208
v_exp_f32 v209, v209
v_exp_f32 v210, v210
v_exp_f32 v211, v211
v_smfmac_f32_32x32x32_bf16 v[128:143], a[20:23], v[200:207], v54
s_waitcnt vmcnt(12)
s_barrier
ds_read_b128 a[48:51], v30 offset:49920
v_exp_f32 v212, v212
v_exp_f32 v213, v213
v_exp_f32 v214, v214
v_exp_f32 v215, v215
v_mfma_f32_32x32x16_bf16 v[240:255], a[44:47], a[4:7], v[240:255]
global_load_dwordx4 a[120:123], v41, s[98:99] offset:3072 sc1
ds_read_b64_tr_b16 a[12:13], v34 offset:58880
v_exp_f32 v216, v216
v_exp_f32 v217, v217
v_exp_f32 v218, v218
v_exp_f32 v219, v219
v_smfmac_f32_32x32x32_bf16 v[144:159], a[16:19], v[208:215], v54
s_waitcnt lgkmcnt(2)
s_add_u32 m0, s54, 0x5800
ds_read_b64_tr_b16 a[14:15], v35 offset:58880
v_exp_f32 v220, v220
v_exp_f32 v221, v221
v_exp_f32 v222, v222
v_exp_f32 v223, v223
v_mfma_f32_32x32x4_2b_bf16 v[160:191], a[58:59], v[14:15], 0
v_exp_f32 v224, v224
v_exp_f32 v225, v225
v_exp_f32 v226, v226
v_exp_f32 v227, v227
v_exp_f32 v228, v228
v_exp_f32 v229, v229
v_exp_f32 v230, v230
v_exp_f32 v231, v231
v_smfmac_f32_32x32x32_bf16 v[144:159], a[20:23], v[216:223], v54
global_load_dwordx2 a[202:203], v42, s[100:101] offset:-512 sc1
ds_read2st64_b64 a[52:55], v31 offset0:0 offset1:5
v_exp_f32 v232, v232
v_exp_f32 v233, v233
v_exp_f32 v234, v234
v_exp_f32 v235, v235
v_smfmac_f32_32x32x32_bf16 v[128:143], a[8:11], v[224:231], v54
s_waitcnt lgkmcnt(1)
s_add_u32 s98, s36, 0x805000
ds_read_b64_tr_b16 a[16:17], v32 offset:60160
v_exp_f32 v236, v236
v_exp_f32 v237, v237
v_exp_f32 v238, v238
v_exp_f32 v239, v239
v_mfma_f32_32x32x16_bf16 v[160:175], a[48:51], a[0:3], v[160:175]
s_addc_u32 s99, s37, 0
ds_read_b64_tr_b16 a[18:19], v33 offset:60160
v_exp_f32 v240, v240
v_exp_f32 v241, v241
v_exp_f32 v242, v242
v_exp_f32 v243, v243
v_smfmac_f32_32x32x32_bf16 v[128:143], a[12:15], v[232:239], v54
s_add_u32 s96, s36, 0x12000
s_addc_u32 s97, s37, 0
ds_read_b128 a[40:43], v30
v_exp_f32 v244, v244
v_exp_f32 v245, v245
v_exp_f32 v246, v246
v_exp_f32 v247, v247
v_mfma_f32_32x32x16_bf16 v[176:191], a[48:51], a[4:7], v[176:191]
global_load_lds_dwordx4 v36, s[96:97] offset:-2048 sc1
ds_read_b64_tr_b16 a[20:21], v34 offset:60160
v_exp_f32 v248, v248
v_exp_f32 v249, v249
v_exp_f32 v250, v250
v_exp_f32 v251, v251
v_smfmac_f32_32x32x32_bf16 v[144:159], a[8:11], v[240:247], v54
s_waitcnt lgkmcnt(2)
ds_read_b64_tr_b16 a[22:23], v35 offset:60160
v_exp_f32 v252, v252
v_exp_f32 v253, v253
v_exp_f32 v254, v254
v_exp_f32 v255, v255
v_mfma_f32_32x32x4_2b_bf16 v[192:223], a[52:53], v[14:15], 0
v_exp_f32 v160, v160
v_exp_f32 v161, v161
v_exp_f32 v162, v162
v_exp_f32 v163, v163
v_exp_f32 v164, v164
v_exp_f32 v165, v165
v_exp_f32 v166, v166
v_exp_f32 v167, v167
v_smfmac_f32_32x32x32_bf16 v[144:159], a[12:15], v[248:255], v54
global_load_lds_dwordx4 v36, s[96:97] offset:-1024 sc1
ds_read2st64_b64 a[56:59], v16 offset0:0 offset1:5
v_exp_f32 v168, v168
v_exp_f32 v169, v169
v_exp_f32 v170, v170
v_exp_f32 v171, v171
v_smfmac_f32_32x32x32_bf16 v[128:143], a[16:19], v[160:167], v54
s_waitcnt lgkmcnt(1)
ds_read_b64_tr_b16 a[8:9], v32 offset:10240
v_exp_f32 v172, v172
v_exp_f32 v173, v173
v_exp_f32 v174, v174
v_exp_f32 v175, v175
v_mfma_f32_32x32x16_bf16 v[192:207], a[40:43], a[0:3], v[192:207]
global_load_lds_dwordx4 v36, s[96:97] sc1
ds_read_b64_tr_b16 a[10:11], v33 offset:10240
v_exp_f32 v176, v176
v_exp_f32 v177, v177
v_exp_f32 v178, v178
v_exp_f32 v179, v179
v_smfmac_f32_32x32x32_bf16 v[128:143], a[20:23], v[168:175], v54
global_load_lds_dwordx4 v36, s[96:97] offset:1024 sc1
ds_read_b128 a[44:47], v30 offset:1280
v_exp_f32 v180, v180
v_exp_f32 v181, v181
v_exp_f32 v182, v182
v_exp_f32 v183, v183
v_mfma_f32_32x32x16_bf16 v[208:223], a[40:43], a[4:7], v[208:223]
global_load_lds_dwordx4 v36, s[96:97] offset:2048 sc1
ds_read_b64_tr_b16 a[12:13], v34 offset:10240
v_exp_f32 v184, v184
v_exp_f32 v185, v185
v_exp_f32 v186, v186
v_exp_f32 v187, v187
v_smfmac_f32_32x32x32_bf16 v[144:159], a[16:19], v[176:183], v54
s_waitcnt lgkmcnt(2)
ds_read_b64_tr_b16 a[14:15], v35 offset:10240
v_exp_f32 v188, v188
v_exp_f32 v189, v189
v_exp_f32 v190, v190
v_exp_f32 v191, v191
v_mfma_f32_32x32x4_2b_bf16 v[224:255], a[56:57], v[14:15], 0
v_exp_f32 v192, v192
v_exp_f32 v193, v193
v_exp_f32 v194, v194
v_exp_f32 v195, v195
v_exp_f32 v196, v196
v_exp_f32 v197, v197
v_exp_f32 v198, v198
v_exp_f32 v199, v199
v_smfmac_f32_32x32x32_bf16 v[144:159], a[20:23], v[184:191], v54
global_load_dwordx4 a[124:127], v41, s[98:99] offset:-4096 sc1
v_exp_f32 v200, v200
v_exp_f32 v201, v201
v_exp_f32 v202, v202
v_exp_f32 v203, v203
v_smfmac_f32_32x32x32_bf16 v[128:143], a[8:11], v[192:199], v54
s_waitcnt lgkmcnt(0)
ds_read_b64_tr_b16 a[16:17], v32 offset:11520
v_exp_f32 v204, v204
v_exp_f32 v205, v205
v_exp_f32 v206, v206
v_exp_f32 v207, v207
v_mfma_f32_32x32x16_bf16 v[224:239], a[44:47], a[0:3], v[224:239]
ds_read_b64_tr_b16 a[18:19], v33 offset:11520
v_exp_f32 v208, v208
v_exp_f32 v209, v209
v_exp_f32 v210, v210
v_exp_f32 v211, v211
v_smfmac_f32_32x32x32_bf16 v[128:143], a[12:15], v[200:207], v54
ds_read_b128 a[48:51], v30 offset:2560
v_exp_f32 v212, v212
v_exp_f32 v213, v213
v_exp_f32 v214, v214
v_exp_f32 v215, v215
v_mfma_f32_32x32x16_bf16 v[240:255], a[44:47], a[4:7], v[240:255]
global_load_dwordx4 a[128:131], v41, s[98:99] offset:-3072 sc1
ds_read_b64_tr_b16 a[20:21], v34 offset:11520
v_exp_f32 v216, v216
v_exp_f32 v217, v217
v_exp_f32 v218, v218
v_exp_f32 v219, v219
v_smfmac_f32_32x32x32_bf16 v[144:159], a[8:11], v[208:215], v54
s_waitcnt lgkmcnt(2)
ds_read_b64_tr_b16 a[22:23], v35 offset:11520
v_exp_f32 v220, v220
v_exp_f32 v221, v221
v_exp_f32 v222, v222
v_exp_f32 v223, v223
v_mfma_f32_32x32x4_2b_bf16 v[160:191], a[54:55], v[14:15], 0
v_exp_f32 v224, v224
v_exp_f32 v225, v225
v_exp_f32 v226, v226
v_exp_f32 v227, v227
v_exp_f32 v228, v228
v_exp_f32 v229, v229
v_exp_f32 v230, v230
v_exp_f32 v231, v231
v_smfmac_f32_32x32x32_bf16 v[144:159], a[12:15], v[216:223], v54
global_load_dwordx2 a[204:205], v42, s[100:101] sc1
v_exp_f32 v232, v232
v_exp_f32 v233, v233
v_exp_f32 v234, v234
v_exp_f32 v235, v235
v_smfmac_f32_32x32x32_bf16 v[128:143], a[16:19], v[224:231], v54
s_waitcnt lgkmcnt(0)
ds_read_b64_tr_b16 a[8:9], v32 offset:12800
v_exp_f32 v236, v236
v_exp_f32 v237, v237
v_exp_f32 v238, v238
v_exp_f32 v239, v239
v_mfma_f32_32x32x16_bf16 v[160:175], a[48:51], a[0:3], v[160:175]
ds_read_b64_tr_b16 a[10:11], v33 offset:12800
v_exp_f32 v240, v240
v_exp_f32 v241, v241
v_exp_f32 v242, v242
v_exp_f32 v243, v243
v_smfmac_f32_32x32x32_bf16 v[128:143], a[20:23], v[232:239], v54
ds_read_b128 a[40:43], v30 offset:3840
v_exp_f32 v244, v244
v_exp_f32 v245, v245
v_exp_f32 v246, v246
v_exp_f32 v247, v247
v_mfma_f32_32x32x16_bf16 v[176:191], a[48:51], a[4:7], v[176:191]
global_load_dwordx4 a[132:135], v41, s[98:99] offset:-2048 sc1
ds_read_b64_tr_b16 a[12:13], v34 offset:12800
v_exp_f32 v248, v248
v_exp_f32 v249, v249
v_exp_f32 v250, v250
v_exp_f32 v251, v251
v_smfmac_f32_32x32x32_bf16 v[144:159], a[16:19], v[240:247], v54
s_waitcnt lgkmcnt(2)
ds_read_b64_tr_b16 a[14:15], v35 offset:12800
v_exp_f32 v252, v252
v_exp_f32 v253, v253
v_exp_f32 v254, v254
v_exp_f32 v255, v255
v_mfma_f32_32x32x4_2b_bf16 v[192:223], a[58:59], v[14:15], 0
v_exp_f32 v160, v160
v_exp_f32 v161, v161
v_exp_f32 v162, v162
v_exp_f32 v163, v163
v_exp_f32 v164, v164
v_exp_f32 v165, v165
v_exp_f32 v166, v166
v_exp_f32 v167, v167
v_smfmac_f32_32x32x32_bf16 v[144:159], a[20:23], v[248:255], v54
global_load_dwordx4 a[136:139], v41, s[98:99] offset:-1024 sc1
ds_read2st64_b64 a[52:55], v31 offset0:10 offset1:15
v_exp_f32 v168, v168
v_exp_f32 v169, v169
v_exp_f32 v170, v170
v_exp_f32 v171, v171
v_smfmac_f32_32x32x32_bf16 v[128:143], a[8:11], v[160:167], v54
s_waitcnt lgkmcnt(1)
ds_read_b64_tr_b16 a[16:17], v32 offset:14080
v_exp_f32 v172, v172
v_exp_f32 v173, v173
v_exp_f32 v174, v174
v_exp_f32 v175, v175
v_mfma_f32_32x32x16_bf16 v[192:207], a[40:43], a[0:3], v[192:207]
ds_read_b64_tr_b16 a[18:19], v33 offset:14080
v_exp_f32 v176, v176
v_exp_f32 v177, v177
v_exp_f32 v178, v178
v_exp_f32 v179, v179
v_smfmac_f32_32x32x32_bf16 v[128:143], a[12:15], v[168:175], v54
ds_read_b128 a[44:47], v30 offset:5120
v_exp_f32 v180, v180
v_exp_f32 v181, v181
v_exp_f32 v182, v182
v_exp_f32 v183, v183
v_mfma_f32_32x32x16_bf16 v[208:223], a[40:43], a[4:7], v[208:223]
global_load_dwordx2 a[206:207], v42, s[100:101] offset:512 sc1
ds_read_b64_tr_b16 a[20:21], v34 offset:14080
v_exp_f32 v184, v184
v_exp_f32 v185, v185
v_exp_f32 v186, v186
v_exp_f32 v187, v187
v_smfmac_f32_32x32x32_bf16 v[144:159], a[8:11], v[176:183], v54
s_waitcnt lgkmcnt(2)
ds_read_b64_tr_b16 a[22:23], v35 offset:14080
v_exp_f32 v188, v188
v_exp_f32 v189, v189
v_exp_f32 v190, v190
v_exp_f32 v191, v191
v_mfma_f32_32x32x4_2b_bf16 v[224:255], a[52:53], v[14:15], 0
v_exp_f32 v192, v192
v_exp_f32 v193, v193
v_exp_f32 v194, v194
v_exp_f32 v195, v195
v_exp_f32 v196, v196
v_exp_f32 v197, v197
v_exp_f32 v198, v198
v_exp_f32 v199, v199
v_smfmac_f32_32x32x32_bf16 v[144:159], a[12:15], v[184:191], v54
global_load_dwordx4 a[140:143], v41, s[98:99] sc1
ds_read2st64_b64 a[56:59], v16 offset0:10 offset1:15
v_exp_f32 v200, v200
v_exp_f32 v201, v201
v_exp_f32 v202, v202
v_exp_f32 v203, v203
v_smfmac_f32_32x32x32_bf16 v[128:143], a[16:19], v[192:199], v54
s_waitcnt lgkmcnt(1)
ds_read_b64_tr_b16 a[8:9], v32 offset:15360
v_exp_f32 v204, v204
v_exp_f32 v205, v205
v_exp_f32 v206, v206
v_exp_f32 v207, v207
v_mfma_f32_32x32x16_bf16 v[224:239], a[44:47], a[0:3], v[224:239]
ds_read_b64_tr_b16 a[10:11], v33 offset:15360
v_exp_f32 v208, v208
v_exp_f32 v209, v209
v_exp_f32 v210, v210
v_exp_f32 v211, v211
v_smfmac_f32_32x32x32_bf16 v[128:143], a[20:23], v[200:207], v54
ds_read_b128 a[48:51], v30 offset:6400
v_exp_f32 v212, v212
v_exp_f32 v213, v213
v_exp_f32 v214, v214
v_exp_f32 v215, v215
v_mfma_f32_32x32x16_bf16 v[240:255], a[44:47], a[4:7], v[240:255]
global_load_dwordx4 a[144:147], v41, s[98:99] offset:1024 sc1
ds_read_b64_tr_b16 a[12:13], v34 offset:15360
v_exp_f32 v216, v216
v_exp_f32 v217, v217
v_exp_f32 v218, v218
v_exp_f32 v219, v219
v_smfmac_f32_32x32x32_bf16 v[144:159], a[16:19], v[208:215], v54
s_waitcnt lgkmcnt(2)
ds_read_b64_tr_b16 a[14:15], v35 offset:15360
v_exp_f32 v220, v220
v_exp_f32 v221, v221
v_exp_f32 v222, v222
v_exp_f32 v223, v223
v_mfma_f32_32x32x4_2b_bf16 v[160:191], a[56:57], v[14:15], 0
v_exp_f32 v224, v224
v_exp_f32 v225, v225
v_exp_f32 v226, v226
v_exp_f32 v227, v227
v_exp_f32 v228, v228
v_exp_f32 v229, v229
v_exp_f32 v230, v230
v_exp_f32 v231, v231
v_smfmac_f32_32x32x32_bf16 v[144:159], a[20:23], v[216:223], v54
global_load_dwordx2 a[24:25], v42, s[100:101] offset:1024 sc1
v_exp_f32 v232, v232
v_exp_f32 v233, v233
v_exp_f32 v234, v234
v_exp_f32 v235, v235
v_smfmac_f32_32x32x32_bf16 v[128:143], a[8:11], v[224:231], v54
s_waitcnt lgkmcnt(0)
ds_read_b64_tr_b16 a[16:17], v32 offset:16640
v_exp_f32 v236, v236
v_exp_f32 v237, v237
v_exp_f32 v238, v238
v_exp_f32 v239, v239
v_mfma_f32_32x32x16_bf16 v[160:175], a[48:51], a[0:3], v[160:175]
ds_read_b64_tr_b16 a[18:19], v33 offset:16640
v_exp_f32 v240, v240
v_exp_f32 v241, v241
v_exp_f32 v242, v242
v_exp_f32 v243, v243
v_smfmac_f32_32x32x32_bf16 v[128:143], a[12:15], v[232:239], v54
ds_read_b128 a[40:43], v30 offset:7680
v_exp_f32 v244, v244
v_exp_f32 v245, v245
v_exp_f32 v246, v246
v_exp_f32 v247, v247
v_mfma_f32_32x32x16_bf16 v[176:191], a[48:51], a[4:7], v[176:191]
global_load_dwordx4 a[148:151], v41, s[98:99] offset:2048 sc1
ds_read_b64_tr_b16 a[20:21], v34 offset:16640
v_exp_f32 v248, v248
v_exp_f32 v249, v249
v_exp_f32 v250, v250
v_exp_f32 v251, v251
v_smfmac_f32_32x32x32_bf16 v[144:159], a[8:11], v[240:247], v54
s_waitcnt lgkmcnt(2)
ds_read_b64_tr_b16 a[22:23], v35 offset:16640
v_exp_f32 v252, v252
v_exp_f32 v253, v253
v_exp_f32 v254, v254
v_exp_f32 v255, v255
v_mfma_f32_32x32x4_2b_bf16 v[192:223], a[54:55], v[14:15], 0
v_exp_f32 v160, v160
v_exp_f32 v161, v161
v_exp_f32 v162, v162
v_exp_f32 v163, v163
v_exp_f32 v164, v164
v_exp_f32 v165, v165
v_exp_f32 v166, v166
v_exp_f32 v167, v167
v_smfmac_f32_32x32x32_bf16 v[144:159], a[12:15], v[248:255], v54
global_load_dwordx4 a[152:155], v41, s[98:99] offset:3072 sc1
v_exp_f32 v168, v168
v_exp_f32 v169, v169
v_exp_f32 v170, v170
v_exp_f32 v171, v171
v_smfmac_f32_32x32x32_bf16 v[128:143], a[16:19], v[160:167], v54
s_waitcnt lgkmcnt(0)
ds_read_b64_tr_b16 a[8:9], v32 offset:17920
L_pg17:
s_cbranch_execz L_tr4
v_exp_f32 v172, v172
v_exp_f32 v173, v173
v_exp_f32 v174, v174
v_exp_f32 v175, v175
v_mfma_f32_32x32x16_bf16 v[192:207], a[40:43], a[0:3], v[192:207]
ds_read_b64_tr_b16 a[10:11], v33 offset:17920
v_exp_f32 v176, v176
v_exp_f32 v177, v177
v_exp_f32 v178, v178
v_exp_f32 v179, v179
v_smfmac_f32_32x32x32_bf16 v[128:143], a[20:23], v[168:175], v54
s_waitcnt vmcnt(11)
s_barrier
ds_read_b128 a[44:47], v30 offset:8960
v_exp_f32 v180, v180
v_exp_f32 v181, v181
v_exp_f32 v182, v182
v_exp_f32 v183, v183
v_mfma_f32_32x32x16_bf16 v[208:223], a[40:43], a[4:7], v[208:223]
global_load_dwordx2 a[26:27], v42, s[100:101] offset:1536 sc1
ds_read_b64_tr_b16 a[12:13], v34 offset:17920
v_exp_f32 v184, v184
v_exp_f32 v185, v185
v_exp_f32 v186, v186
v_exp_f32 v187, v187
v_smfmac_f32_32x32x32_bf16 v[144:159], a[16:19], v[176:183], v54
s_waitcnt lgkmcnt(2)
s_add_u32 s98, s36, 0x807000
ds_read_b64_tr_b16 a[14:15], v35 offset:17920
v_exp_f32 v188, v188
v_exp_f32 v189, v189
v_exp_f32 v190, v190
v_exp_f32 v191, v191
v_mfma_f32_32x32x4_2b_bf16 v[224:255], a[58:59], v[14:15], 0
v_exp_f32 v192, v192
v_exp_f32 v193, v193
v_exp_f32 v194, v194
v_exp_f32 v195, v195
v_exp_f32 v196, v196
v_exp_f32 v197, v197
v_exp_f32 v198, v198
v_exp_f32 v199, v199
v_smfmac_f32_32x32x32_bf16 v[144:159], a[20:23], v[184:191], v54
s_addc_u32 s99, s37, 0
ds_read2st64_b64 a[52:55], v31 offset0:40 offset1:45
v_exp_f32 v200, v200
v_exp_f32 v201, v201
v_exp_f32 v202, v202
v_exp_f32 v203, v203
v_smfmac_f32_32x32x32_bf16 v[128:143], a[8:11], v[192:199], v54
s_waitcnt lgkmcnt(1)
ds_read_b64_tr_b16 a[16:17], v32 offset:19200
v_exp_f32 v204, v204
v_exp_f32 v205, v205
v_exp_f32 v206, v206
v_exp_f32 v207, v207
v_mfma_f32_32x32x16_bf16 v[224:239], a[44:47], a[0:3], v[224:239]
global_load_dwordx4 a[156:159], v41, s[98:99] offset:-4096 sc1
ds_read_b64_tr_b16 a[18:19], v33 offset:19200
v_exp_f32 v208, v208
v_exp_f32 v209, v209
v_exp_f32 v210, v210
v_exp_f32 v211, v211
v_smfmac_f32_32x32x32_bf16 v[128:143], a[12:15], v[200:207], v54
ds_read_b128 a[48:51], v30 offset:20480
v_exp_f32 v212, v212
v_exp_f32 v213, v213
v_exp_f32 v214, v214
v_exp_f32 v215, v215
v_mfma_f32_32x32x16_bf16 v[240:255], a[44:47], a[4:7], v[240:255]
ds_read_b64_tr_b16 a[20:21], v34 offset:19200
v_exp_f32 v216, v216
v_exp_f32 v217, v217
v_exp_f32 v218, v218
v_exp_f32 v219, v219
v_smfmac_f32_32x32x32_bf16 v[144:159], a[8:11], v[208:215], v54
s_waitcnt lgkmcnt(2)
ds_read_b64_tr_b16 a[22:23], v35 offset:19200
v_exp_f32 v220, v220
v_exp_f32 v221, v221
v_exp_f32 v222, v222
v_exp_f32 v223, v223
v_mfma_f32_32x32x4_2b_bf16 v[160:191], a[52:53], v[14:15], 0
v_exp_f32 v224, v224
v_exp_f32 v225, v225
v_exp_f32 v226, v226
v_exp_f32 v227, v227
v_exp_f32 v228, v228
v_exp_f32 v229, v229
v_exp_f32 v230, v230
v_exp_f32 v231, v231
v_smfmac_f32_32x32x32_bf16 v[144:159], a[12:15], v[216:223], v54
global_load_dwordx4 a[160:163], v41, s[98:99] offset:-3072 sc1
ds_read2st64_b64 a[56:59], v16 offset0:40 offset1:45
v_exp_f32 v232, v232
v_exp_f32 v233, v233
v_exp_f32 v234, v234
v_exp_f32 v235, v235
v_smfmac_f32_32x32x32_bf16 v[128:143], a[16:19], v[224:231], v54
s_waitcnt lgkmcnt(1)
ds_read_b64_tr_b16 a[8:9], v32 offset:30720
v_exp_f32 v236, v236
v_exp_f32 v237, v237
v_exp_f32 v238, v238
v_exp_f32 v239, v239
v_mfma_f32_32x32x16_bf16 v[160:175], a[48:51], a[0:3], v[160:175]
ds_read_b64_tr_b16 a[10:11], v33 offset:30720
v_exp_f32 v240, v240
v_exp_f32 v241, v241
v_exp_f32 v242, v242
v_exp_f32 v243, v243
v_smfmac_f32_32x32x32_bf16 v[128:143], a[20:23], v[232:239], v54
ds_read_b128 a[40:43], v30 offset:21760
v_exp_f32 v244, v244
v_exp_f32 v245, v245
v_exp_f32 v246, v246
v_exp_f32 v247, v247
v_mfma_f32_32x32x16_bf16 v[176:191], a[48:51], a[4:7], v[176:191]
global_load_dwordx2 a[28:29], v42, s[100:101] offset:2048 sc1
ds_read_b64_tr_b16 a[12:13], v34 offset:30720
v_exp_f32 v248, v248
v_exp_f32 v249, v249
v_exp_f32 v250, v250
v_exp_f32 v251, v251
v_smfmac_f32_32x32x32_bf16 v[144:159], a[16:19], v[240:247], v54
s_waitcnt lgkmcnt(2)
ds_read_b64_tr_b16 a[14:15], v35 offset:30720
v_exp_f32 v252, v252
v_exp_f32 v253, v253
v_exp_f32 v254, v254
v_exp_f32 v255, v255
v_mfma_f32_32x32x4_2b_bf16 v[192:223], a[56:57], v[14:15], 0
v_exp_f32 v160, v160
v_exp_f32 v161, v161
v_exp_f32 v162, v162
v_exp_f32 v163, v163
v_exp_f32 v164, v164
v_exp_f32 v165, v165
v_exp_f32 v166, v166
v_exp_f32 v167, v167
v_smfmac_f32_32x32x32_bf16 v[144:159], a[20:23], v[248:255], v54
global_load_dwordx4 a[164:167], v41, s[98:99] offset:-2048 sc1
v_exp_f32 v168, v168
v_exp_f32 v169, v169
v_exp_f32 v170, v170
v_exp_f32 v171, v171
v_smfmac_f32_32x32x32_bf16 v[128:143], a[8:11], v[160:167], v54
s_waitcnt lgkmcnt(0)
ds_read_b64_tr_b16 a[16:17], v32 offset:32000
v_exp_f32 v172, v172
v_exp_f32 v173, v173
v_exp_f32 v174, v174
v_exp_f32 v175, v175
v_mfma_f32_32x32x16_bf16 v[192:207], a[40:43], a[0:3], v[192:207]
ds_read_b64_tr_b16 a[18:19], v33 offset:32000
v_exp_f32 v176, v176
v_exp_f32 v177, v177
v_exp_f32 v178, v178
v_exp_f32 v179, v179
v_smfmac_f32_32x32x32_bf16 v[128:143], a[12:15], v[168:175], v54
ds_read_b128 a[44:47], v30 offset:23040
v_exp_f32 v180, v180
v_exp_f32 v181, v181
v_exp_f32 v182, v182
v_exp_f32 v183, v183
v_mfma_f32_32x32x16_bf16 v[208:223], a[40:43], a[4:7], v[208:223]
global_load_dwordx4 a[168:171], v41, s[98:99] offset:-1024 sc1
ds_read_b64_tr_b16 a[20:21], v34 offset:32000
v_exp_f32 v184, v184
v_exp_f32 v185, v185
v_exp_f32 v186, v186
v_exp_f32 v187, v187
v_smfmac_f32_32x32x32_bf16 v[144:159], a[8:11], v[176:183], v54
s_waitcnt lgkmcnt(2)
ds_read_b64_tr_b16 a[22:23], v35 offset:32000
v_exp_f32 v188, v188
v_exp_f32 v189, v189
v_exp_f32 v190, v190
v_exp_f32 v191, v191
v_mfma_f32_32x32x4_2b_bf16 v[224:255], a[54:55], v[14:15], 0
v_exp_f32 v192, v192
v_exp_f32 v193, v193
v_exp_f32 v194, v194
v_exp_f32 v195, v195
v_exp_f32 v196, v196
v_exp_f32 v197, v197
v_exp_f32 v198, v198
v_exp_f32 v199, v199
v_smfmac_f32_32x32x32_bf16 v[144:159], a[12:15], v[184:191], v54
global_load_dwordx2 a[30:31], v42, s[100:101] offset:2560 sc1
v_exp_f32 v200, v200
v_exp_f32 v201, v201
v_exp_f32 v202, v202
v_exp_f32 v203, v203
v_smfmac_f32_32x32x32_bf16 v[128:143], a[16:19], v[192:199], v54
s_waitcnt lgkmcnt(0)
ds_read_b64_tr_b16 a[8:9], v32 offset:33280
v_exp_f32 v204, v204
v_exp_f32 v205, v205
v_exp_f32 v206, v206
v_exp_f32 v207, v207
v_mfma_f32_32x32x16_bf16 v[224:239], a[44:47], a[0:3], v[224:239]
ds_read_b64_tr_b16 a[10:11], v33 offset:33280
v_exp_f32 v208, v208
v_exp_f32 v209, v209
v_exp_f32 v210, v210
v_exp_f32 v211, v211
v_smfmac_f32_32x32x32_bf16 v[128:143], a[20:23], v[200:207], v54
ds_read_b128 a[48:51], v30 offset:24320
v_exp_f32 v212, v212
v_exp_f32 v213, v213
v_exp_f32 v214, v214
v_exp_f32 v215, v215
v_mfma_f32_32x32x16_bf16 v[240:255], a[44:47], a[4:7], v[240:255]
global_load_dwordx4 a[172:175], v41, s[98:99] sc1
ds_read_b64_tr_b16 a[12:13], v34 offset:33280
v_exp_f32 v216, v216
v_exp_f32 v217, v217
v_exp_f32 v218, v218
v_exp_f32 v219, v219
v_smfmac_f32_32x32x32_bf16 v[144:159], a[16:19], v[208:215], v54
s_waitcnt lgkmcnt(2)
ds_read_b64_tr_b16 a[14:15], v35 offset:33280
v_exp_f32 v220, v220
v_exp_f32 v221, v221
v_exp_f32 v222, v222
v_exp_f32 v223, v223
v_mfma_f32_32x32x4_2b_bf16 v[160:191], a[58:59], v[14:15], 0
v_exp_f32 v224, v224
v_exp_f32 v225, v225
v_exp_f32 v226, v226
v_exp_f32 v227, v227
v_exp_f32 v228, v228
v_exp_f32 v229, v229
v_exp_f32 v230, v230
v_exp_f32 v231, v231
v_smfmac_f32_32x32x32_bf16 v[144:159], a[20:23], v[216:223], v54
global_load_dwordx4 a[176:179], v41, s[98:99] offset:1024 sc1
ds_read2st64_b64 a[52:55], v31 offset0:50 offset1:55
v_exp_f32 v232, v232
v_exp_f32 v233, v233
v_exp_f32 v234, v234
v_exp_f32 v235, v235
v_smfmac_f32_32x32x32_bf16 v[128:143], a[8:11], v[224:231], v54
s_waitcnt lgkmcnt(1)
ds_read_b64_tr_b16 a[16:17], v32 offset:34560
v_exp_f32 v236, v236
v_exp_f32 v237, v237
v_exp_f32 v238, v238
v_exp_f32 v239, v239
v_mfma_f32_32x32x16_bf16 v[160:175], a[48:51], a[0:3], v[160:175]
ds_read_b64_tr_b16 a[18:19], v33 offset:34560
v_exp_f32 v240, v240
v_exp_f32 v241, v241
v_exp_f32 v242, v242
v_exp_f32 v243, v243
v_smfmac_f32_32x32x32_bf16 v[128:143], a[12:15], v[232:239], v54
ds_read_b128 a[40:43], v30 offset:25600
v_exp_f32 v244, v244
v_exp_f32 v245, v245
v_exp_f32 v246, v246
v_exp_f32 v247, v247
v_mfma_f32_32x32x16_bf16 v[176:191], a[48:51], a[4:7], v[176:191]
global_load_dwordx2 a[32:33], v42, s[100:101] offset:3072 sc1
ds_read_b64_tr_b16 a[20:21], v34 offset:34560
v_exp_f32 v248, v248
v_exp_f32 v249, v249
v_exp_f32 v250, v250
v_exp_f32 v251, v251
v_smfmac_f32_32x32x32_bf16 v[144:159], a[8:11], v[240:247], v54
s_waitcnt lgkmcnt(2)
ds_read_b64_tr_b16 a[22:23], v35 offset:34560
v_exp_f32 v252, v252
v_exp_f32 v253, v253
v_exp_f32 v254, v254
v_exp_f32 v255, v255
v_mfma_f32_32x32x4_2b_bf16 v[192:223], a[52:53], v[14:15], 0
v_exp_f32 v160, v160
v_exp_f32 v161, v161
v_exp_f32 v162, v162
v_exp_f32 v163, v163
v_exp_f32 v164, v164
v_exp_f32 v165, v165
v_exp_f32 v166, v166
v_exp_f32 v167, v167
v_smfmac_f32_32x32x32_bf16 v[144:159], a[12:15], v[248:255], v54
global_load_dwordx4 a[180:183], v41, s[98:99] offset:2048 sc1
ds_read2st64_b64 a[56:59], v16 offset0:50 offset1:55
v_exp_f32 v168, v168
v_exp_f32 v169, v169
v_exp_f32 v170, v170
v_exp_f32 v171, v171
v_smfmac_f32_32x32x32_bf16 v[128:143], a[16:19], v[160:167], v54
s_waitcnt lgkmcnt(1)
ds_read_b64_tr_b16 a[8:9], v32 offset:35840
v_exp_f32 v172, v172
v_exp_f32 v173, v173
v_exp_f32 v174, v174
v_exp_f32 v175, v175
v_mfma_f32_32x32x16_bf16 v[192:207], a[40:43], a[0:3], v[192:207]
ds_read_b64_tr_b16 a[10:11], v33 offset:35840
v_exp_f32 v176, v176
v_exp_f32 v177, v177
v_exp_f32 v178, v178
v_exp_f32 v179, v179
v_smfmac_f32_32x32x32_bf16 v[128:143], a[20:23], v[168:175], v54
ds_read_b128 a[44:47], v30 offset:26880
v_exp_f32 v180, v180
v_exp_f32 v181, v181
v_exp_f32 v182, v182
v_exp_f32 v183, v183
v_mfma_f32_32x32x16_bf16 v[208:223], a[40:43], a[4:7], v[208:223]
global_load_dwordx4 a[184:187], v41, s[98:99] offset:3072 sc1
ds_read_b64_tr_b16 a[12:13], v34 offset:35840
v_exp_f32 v184, v184
v_exp_f32 v185, v185
v_exp_f32 v186, v186
v_exp_f32 v187, v187
v_smfmac_f32_32x32x32_bf16 v[144:159], a[16:19], v[176:183], v54
s_waitcnt lgkmcnt(2)
ds_read_b64_tr_b16 a[14:15], v35 offset:35840
v_exp_f32 v188, v188
v_exp_f32 v189, v189
v_exp_f32 v190, v190
v_exp_f32 v191, v191
v_mfma_f32_32x32x4_2b_bf16 v[224:255], a[56:57], v[14:15], 0
v_exp_f32 v192, v192
v_exp_f32 v193, v193
v_exp_f32 v194, v194
v_exp_f32 v195, v195
v_exp_f32 v196, v196
v_exp_f32 v197, v197
v_exp_f32 v198, v198
v_exp_f32 v199, v199
v_smfmac_f32_32x32x32_bf16 v[144:159], a[20:23], v[184:191], v54
global_load_dwordx2 a[34:35], v42, s[100:101] offset:3584 sc1
v_exp_f32 v200, v200
v_exp_f32 v201, v201
v_exp_f32 v202, v202
v_exp_f32 v203, v203
v_smfmac_f32_32x32x32_bf16 v[128:143], a[8:11], v[192:199], v54
s_waitcnt lgkmcnt(0)
ds_read_b64_tr_b16 a[16:17], v32 offset:37120
v_exp_f32 v204, v204
v_exp_f32 v205, v205
v_exp_f32 v206, v206
v_exp_f32 v207, v207
v_mfma_f32_32x32x16_bf16 v[224:239], a[44:47], a[0:3], v[224:239]
ds_read_b64_tr_b16 a[18:19], v33 offset:37120
v_exp_f32 v208, v208
v_exp_f32 v209, v209
v_exp_f32 v210, v210
v_exp_f32 v211, v211
v_smfmac_f32_32x32x32_bf16 v[128:143], a[12:15], v[200:207], v54
ds_read_b128 a[48:51], v30 offset:28160
v_exp_f32 v212, v212
v_exp_f32 v213, v213
v_exp_f32 v214, v214
v_exp_f32 v215, v215
v_mfma_f32_32x32x16_bf16 v[240:255], a[44:47], a[4:7], v[240:255]
ds_read_b64_tr_b16 a[20:21], v34 offset:37120
v_exp_f32 v216, v216
v_exp_f32 v217, v217
v_exp_f32 v218, v218
v_exp_f32 v219, v219
v_smfmac_f32_32x32x32_bf16 v[144:159], a[8:11], v[208:215], v54
s_waitcnt lgkmcnt(2)
ds_read_b64_tr_b16 a[22:23], v35 offset:37120
v_exp_f32 v220, v220
v_exp_f32 v221, v221
v_exp_f32 v222, v222
v_exp_f32 v223, v223
v_mfma_f32_32x32x4_2b_bf16 v[160:191], a[54:55], v[14:15], 0
v_exp_f32 v224, v224
v_exp_f32 v225, v225
v_exp_f32 v226, v226
v_exp_f32 v227, v227
v_exp_f32 v228, v228
v_exp_f32 v229, v229
v_exp_f32 v230, v230
v_exp_f32 v231, v231
v_smfmac_f32_32x32x32_bf16 v[144:159], a[12:15], v[216:223], v54
v_exp_f32 v232, v232
v_exp_f32 v233, v233
v_exp_f32 v234, v234
v_exp_f32 v235, v235
v_smfmac_f32_32x32x32_bf16 v[128:143], a[16:19], v[224:231], v54
s_waitcnt lgkmcnt(0)
ds_read_b64_tr_b16 a[8:9], v32 offset:38400
v_exp_f32 v236, v236
v_exp_f32 v237, v237
v_exp_f32 v238, v238
v_exp_f32 v239, v239
v_mfma_f32_32x32x16_bf16 v[160:175], a[48:51], a[0:3], v[160:175]
ds_read_b64_tr_b16 a[10:11], v33 offset:38400
v_exp_f32 v240, v240
v_exp_f32 v241, v241
v_exp_f32 v242, v242
v_exp_f32 v243, v243
v_smfmac_f32_32x32x32_bf16 v[128:143], a[20:23], v[232:239], v54
ds_read_b128 a[40:43], v30 offset:29440
v_exp_f32 v244, v244
v_exp_f32 v245, v245
v_exp_f32 v246, v246
v_exp_f32 v247, v247
v_mfma_f32_32x32x16_bf16 v[176:191], a[48:51], a[4:7], v[176:191]
ds_read_b64_tr_b16 a[12:13], v34 offset:38400
v_exp_f32 v248, v248
v_exp_f32 v249, v249
v_exp_f32 v250, v250
v_exp_f32 v251, v251
v_smfmac_f32_32x32x32_bf16 v[144:159], a[16:19], v[240:247], v54
s_waitcnt lgkmcnt(2)
ds_read_b64_tr_b16 a[14:15], v35 offset:38400
v_exp_f32 v252, v252
v_exp_f32 v253, v253
v_exp_f32 v254, v254
v_exp_f32 v255, v255
v_mfma_f32_32x32x4_2b_bf16 v[192:223], a[58:59], v[14:15], 0
v_exp_f32 v160, v160
v_exp_f32 v161, v161
v_exp_f32 v162, v162
v_exp_f32 v163, v163
v_exp_f32 v164, v164
v_exp_f32 v165, v165
v_exp_f32 v166, v166
v_exp_f32 v167, v167
v_smfmac_f32_32x32x32_bf16 v[144:159], a[20:23], v[248:255], v54
v_exp_f32 v168, v168
v_exp_f32 v169, v169
v_exp_f32 v170, v170
v_exp_f32 v171, v171
v_smfmac_f32_32x32x32_bf16 v[128:143], a[8:11], v[160:167], v54
s_waitcnt lgkmcnt(0)
ds_read_b64_tr_b16 a[16:17], v32 offset:39680
v_exp_f32 v172, v172
v_exp_f32 v173, v173
v_exp_f32 v174, v174
v_exp_f32 v175, v175
v_mfma_f32_32x32x16_bf16 v[192:207], a[40:43], a[0:3], v[192:207]
ds_read_b64_tr_b16 a[18:19], v33 offset:39680
v_exp_f32 v176, v176
v_exp_f32 v177, v177
v_exp_f32 v178, v178
v_exp_f32 v179, v179
v_smfmac_f32_32x32x32_bf16 v[128:143], a[12:15], v[168:175], v54
v_exp_f32 v180, v180
v_exp_f32 v181, v181
v_exp_f32 v182, v182
v_exp_f32 v183, v183
v_mfma_f32_32x32x16_bf16 v[208:223], a[40:43], a[4:7], v[208:223]
ds_read_b64_tr_b16 a[20:21], v34 offset:39680
v_exp_f32 v184, v184
v_exp_f32 v185, v185
v_exp_f32 v186, v186
v_exp_f32 v187, v187
v_smfmac_f32_32x32x32_bf16 v[144:159], a[8:11], v[176:183], v54
s_waitcnt lgkmcnt(1)
ds_read_b64_tr_b16 a[22:23], v35 offset:39680
v_exp_f32 v188, v188
v_exp_f32 v189, v189
v_exp_f32 v190, v190
v_exp_f32 v191, v191
v_exp_f32 v192, v192
v_exp_f32 v193, v193
v_exp_f32 v194, v194
v_exp_f32 v195, v195
v_exp_f32 v196, v196
v_exp_f32 v197, v197
v_exp_f32 v198, v198
v_exp_f32 v199, v199
v_smfmac_f32_32x32x32_bf16 v[144:159], a[12:15], v[184:191], v54
v_exp_f32 v200, v200
v_exp_f32 v201, v201
v_exp_f32 v202, v202
v_exp_f32 v203, v203
v_smfmac_f32_32x32x32_bf16 v[128:143], a[16:19], v[192:199], v54
s_waitcnt lgkmcnt(0)
v_exp_f32 v204, v204
v_exp_f32 v205, v205
v_exp_f32 v206, v206
v_exp_f32 v207, v207
v_exp_f32 v208, v208
v_exp_f32 v209, v209
v_exp_f32 v210, v210
v_exp_f32 v211, v211
v_smfmac_f32_32x32x32_bf16 v[128:143], a[20:23], v[200:207], v54
v_exp_f32 v212, v212
v_exp_f32 v213, v213
v_exp_f32 v214, v214
v_exp_f32 v215, v215
v_exp_f32 v216, v216
v_exp_f32 v217, v217
v_exp_f32 v218, v218
v_exp_f32 v219, v219
v_smfmac_f32_32x32x32_bf16 v[144:159], a[16:19], v[208:215], v54
v_exp_f32 v220, v220
v_exp_f32 v221, v221
v_exp_f32 v222, v222
v_exp_f32 v223, v223
s_nop 1
v_smfmac_f32_32x32x32_bf16 v[144:159], a[20:23], v[216:223], v54
v_rcp_f32 v116, v138
s_nop 0
v_mov_b32 v117, v116
s_nop 1
v_permlane32_swap_b32 v116, v117
v_mul_f32 v224, v116, v128
v_mul_f32 v225, v116, v129
v_mul_f32 v226, v116, v130
v_mul_f32 v227, v116, v131
v_mul_f32 v228, v116, v132
v_mul_f32 v229, v116, v133
v_mul_f32 v230, v116, v134
v_mul_f32 v231, v116, v135
v_mul_f32 v232, v116, v136
v_mul_f32 v233, v116, v137
v_cvt_pk_bf16_f32 v224, v224, v225
v_cvt_pk_bf16_f32 v225, v226, v227
v_cvt_pk_bf16_f32 v226, v228, v229
v_cvt_pk_bf16_f32 v227, v230, v231
global_store_dwordx4 v45, v[224:227], s[88:89] sc1
v_cvt_pk_bf16_f32 v232, v232, v233
v_rcp_f32 v122, v154
s_nop 0
v_mov_b32 v123, v122
s_nop 1
v_permlane32_swap_b32 v122, v123
v_mul_f32 v240, v122, v144
v_mul_f32 v241, v122, v145
v_mul_f32 v242, v122, v146
v_mul_f32 v243, v122, v147
v_mul_f32 v244, v122, v148
v_mul_f32 v245, v122, v149
v_mul_f32 v246, v122, v150
v_mul_f32 v247, v122, v151
v_mul_f32 v248, v122, v152
v_mul_f32 v249, v122, v153
v_cvt_pk_bf16_f32 v240, v240, v241
v_cvt_pk_bf16_f32 v241, v242, v243
v_cvt_pk_bf16_f32 v242, v244, v245
v_cvt_pk_bf16_f32 v243, v246, v247
global_store_dwordx4 v45, v[240:243], s[90:91] sc1
v_cvt_pk_bf16_f32 v248, v248, v249
s_nop 1
v_permlane32_swap_b32 v232, v248
global_store_dword v46, v232, s[36:37] sc1
s_waitcnt vmcnt(3)
v_mfma_f32_4x4x4_16b_bf16 v[76:79], a[208:209], a[60:61], 0
v_add_f32_e64 v118, |v128|, |v129|
v_mfma_f32_4x4x4_16b_bf16 v[80:83], a[208:209], a[62:63], 0
v_add_f32_e64 v118, v118, |v130|
v_mfma_f32_4x4x4_16b_bf16 v[84:87], a[208:209], a[124:125], 0
v_add_f32_e64 v118, v118, |v131|
v_mfma_f32_4x4x4_16b_bf16 v[88:91], a[208:209], a[126:127], 0
v_add_f32_e64 v118, v118, |v132|
v_mfma_f32_4x4x4_16b_bf16 v[92:95], a[208:209], a[188:189], 0
v_add_f32_e64 v118, v118, |v133|
v_mfma_f32_4x4x4_16b_bf16 v[76:79], a[208:209], a[64:65], v[76:79]
v_add_f32_e64 v118, v118, |v134|
v_mfma_f32_4x4x4_16b_bf16 v[80:83], a[208:209], a[66:67], v[80:83]
v_add_f32_e64 v118, v118, |v135|
v_mfma_f32_4x4x4_16b_bf16 v[84:87], a[208:209], a[128:129], v[84:87]
v_add_f32_e64 v118, v118, |v136|
v_mfma_f32_4x4x4_16b_bf16 v[88:91], a[208:209], a[130:131], v[88:91]
v_add_f32_e64 v118, v118, |v137|
v_mfma_f32_4x4x4_16b_bf16 v[92:95], a[208:209], a[190:191], v[92:95]
v_add_f32_e64 v119, |v144|, |v145|
v_mfma_f32_4x4x4_16b_bf16 v[76:79], a[208:209], a[68:69], v[76:79]
s_atomic_umax s78, s[36:37], s79 glc
v_add_f32_e64 v119, v119, |v146|
v_mfma_f32_4x4x4_16b_bf16 v[80:83], a[208:209], a[70:71], v[80:83]
v_add_f32_e64 v119, v119, |v147|
v_mfma_f32_4x4x4_16b_bf16 v[84:87], a[208:209], a[132:133], v[84:87]
v_add_f32_e64 v119, v119, |v148|
v_mfma_f32_4x4x4_16b_bf16 v[88:91], a[208:209], a[134:135], v[88:91]
v_add_f32_e64 v119, v119, |v149|
v_mfma_f32_4x4x4_16b_bf16 v[92:95], a[208:209], a[192:193], v[92:95]
v_add_f32_e64 v119, v119, |v150|
v_mfma_f32_4x4x4_16b_bf16 v[76:79], a[208:209], a[72:73], v[76:79]
v_add_f32_e64 v119, v119, |v151|
v_mfma_f32_4x4x4_16b_bf16 v[80:83], a[208:209], a[74:75], v[80:83]
v_add_f32_e64 v119, v119, |v152|
v_mfma_f32_4x4x4_16b_bf16 v[84:87], a[208:209], a[136:137], v[84:87]
v_add_f32_e64 v119, v119, |v153|
v_mfma_f32_4x4x4_16b_bf16 v[88:91], a[208:209], a[138:139], v[88:91]
v_min_f32 v120, v118, v119
v_mfma_f32_4x4x4_16b_bf16 v[92:95], a[208:209], a[194:195], v[92:95]
v_add_f32 v118, v118, v119
v_mfma_f32_4x4x4_16b_bf16 v[76:79], a[208:209], a[76:77], v[76:79]
v_add_f32 v119, v138, v154
v_mfma_f32_4x4x4_16b_bf16 v[80:83], a[208:209], a[78:79], v[80:83]
v_add_f32 v118, v118, v119
v_mfma_f32_4x4x4_16b_bf16 v[84:87], a[208:209], a[140:141], v[84:87]
v_max_f32 v116, v116, v122
v_mfma_f32_4x4x4_16b_bf16 v[88:91], a[208:209], a[142:143], v[88:91]
v_fmac_f32 v118, 0x50800000, v116
v_cmp_nle_f32 vcc, 0xc000000, v120
s_nop 0
s_cbranch_vccnz L_fb
v_cmp_nge_f32 vcc, 0x7e800000, v118
s_nop 0
s_cbranch_vccnz L_fb
L_fb_ret:
s_add_u32 s98, s36, 0x2c00000
s_addc_u32 s99, s37, 0
v_mfma_f32_4x4x4_16b_bf16 v[92:95], a[208:209], a[196:197], v[92:95]
ds_read_b64_tr_b16 v[128:129], v20 offset:28672
v_mfma_f32_4x4x4_16b_bf16 v[76:79], a[208:209], a[80:81], v[76:79]
ds_read_b64_tr_b16 v[130:131], v20 offset:30720
v_mfma_f32_4x4x4_16b_bf16 v[80:83], a[208:209], a[82:83], v[80:83]
ds_read_b64_tr_b16 v[132:133], v23 offset:28672
v_mfma_f32_4x4x4_16b_bf16 v[84:87], a[208:209], a[144:145], v[84:87]
ds_read_b64_tr_b16 v[134:135], v23 offset:30720
v_mfma_f32_4x4x4_16b_bf16 v[88:91], a[208:209], a[146:147], v[88:91]
ds_read_b64_tr_b16 v[136:137], v26 offset:28672
v_mfma_f32_4x4x4_16b_bf16 v[92:95], a[208:209], a[198:199], v[92:95]
ds_read_b64_tr_b16 v[138:139], v26 offset:30720
v_mfma_f32_4x4x4_16b_bf16 v[76:79], a[208:209], a[84:85], v[76:79]
ds_read_b64_tr_b16 v[140:141], v29 offset:28672
v_mfma_f32_4x4x4_16b_bf16 v[80:83], a[208:209], a[86:87], v[80:83]
ds_read_b64_tr_b16 v[142:143], v29 offset:30720
v_mfma_f32_4x4x4_16b_bf16 v[84:87], a[208:209], a[148:149], v[84:87]
ds_read_b64_tr_b16 v[144:145], v20
v_mfma_f32_4x4x4_16b_bf16 v[88:91], a[208:209], a[150:151], v[88:91]
ds_read_b64_tr_b16 v[146:147], v20 offset:2048
v_mfma_f32_4x4x4_16b_bf16 v[92:95], a[208:209], a[200:201], v[92:95]
ds_read_b64_tr_b16 v[148:149], v18 offset:61440
v_mfma_f32_4x4x4_16b_bf16 v[76:79], a[208:209], a[88:89], v[76:79]
s_waitcnt lgkmcnt(9)
ds_read_b64_tr_b16 v[150:151], v18 offset:63488
v_mfma_f32_4x4x4_16b_bf16 v[80:83], a[208:209], a[90:91], v[80:83]
ds_read_b64_tr_b16 v[152:153], v21 offset:61440
v_mfma_f32_4x4x4_16b_bf16 v[84:87], a[208:209], a[152:153], v[84:87]
ds_read_b64_tr_b16 v[154:155], v21 offset:63488
v_mfma_f32_4x4x4_16b_bf16 v[88:91], a[208:209], a[154:155], v[88:91]
ds_read_b64_tr_b16 v[156:157], v24 offset:61440
v_mfma_f32_4x4x4_16b_bf16 v[92:95], a[208:209], a[202:203], v[92:95]
s_waitcnt lgkmcnt(9)
ds_read_b64_tr_b16 v[158:159], v24 offset:63488
v_mfma_f32_4x4x4_16b_bf16 v[76:79], a[208:209], a[92:93], v[76:79]
ds_read_b64_tr_b16 v[160:161], v27 offset:61440
v_mfma_f32_4x4x4_16b_bf16 v[80:83], a[208:209], a[94:95], v[80:83]
ds_read_b64_tr_b16 v[162:163], v27 offset:63488
v_mfma_f32_4x4x4_16b_bf16 v[84:87], a[208:209], a[156:157], v[84:87]
ds_read_b64_tr_b16 v[164:165], v23
v_mfma_f32_4x4x4_16b_bf16 v[88:91], a[208:209], a[158:159], v[88:91]
s_waitcnt lgkmcnt(9)
ds_read_b64_tr_b16 v[166:167], v23 offset:2048
v_mfma_f32_4x4x4_16b_bf16 v[92:95], a[208:209], a[204:205], v[92:95]
ds_read_b64_tr_b16 v[168:169], v19 offset:8192
v_mfma_f32_4x4x4_16b_bf16 v[76:79], a[208:209], a[96:97], v[76:79]
ds_read_b64_tr_b16 v[170:171], v19 offset:10240
v_mfma_f32_4x4x4_16b_bf16 v[80:83], a[208:209], a[98:99], v[80:83]
ds_read_b64_tr_b16 v[172:173], v22 offset:8192
v_mfma_f32_4x4x4_16b_bf16 v[84:87], a[208:209], a[160:161], v[84:87]
s_waitcnt lgkmcnt(9)
ds_read_b64_tr_b16 v[174:175], v22 offset:10240
v_mfma_f32_4x4x4_16b_bf16 v[88:91], a[208:209], a[162:163], v[88:91]
ds_read_b64_tr_b16 v[176:177], v25 offset:8192
v_mfma_f32_4x4x4_16b_bf16 v[92:95], a[208:209], a[206:207], v[92:95]
ds_read_b64_tr_b16 v[178:179], v25 offset:10240
v_mfma_f32_4x4x4_16b_bf16 v[76:79], a[208:209], a[100:101], v[76:79]
ds_read_b64_tr_b16 v[180:181], v28 offset:8192
v_mfma_f32_4x4x4_16b_bf16 v[80:83], a[208:209], a[102:103], v[80:83]
s_waitcnt lgkmcnt(9)
ds_read_b64_tr_b16 v[182:183], v28 offset:10240
v_mfma_f32_4x4x4_16b_bf16 v[84:87], a[208:209], a[164:165], v[84:87]
ds_read_b64_tr_b16 v[184:185], v20 offset:4096
v_mfma_f32_4x4x4_16b_bf16 v[88:91], a[208:209], a[166:167], v[88:91]
ds_read_b64_tr_b16 v[186:187], v20 offset:6144
v_mfma_f32_4x4x4_16b_bf16 v[92:95], a[208:209], a[24:25], v[92:95]
ds_read_b64_tr_b16 v[188:189], v19 offset:12288
v_mfma_f32_4x4x4_16b_bf16 v[76:79], a[208:209], a[104:105], v[76:79]
s_waitcnt lgkmcnt(9)
ds_read_b64_tr_b16 v[190:191], v19 offset:14336
v_mfma_f32_4x4x4_16b_bf16 v[80:83], a[208:209], a[106:107], v[80:83]
ds_read_b64_tr_b16 v[192:193], v22 offset:12288
v_mfma_f32_4x4x4_16b_bf16 v[84:87], a[208:209], a[168:169], v[84:87]
ds_read_b64_tr_b16 v[194:195], v22 offset:14336
v_mfma_f32_4x4x4_16b_bf16 v[88:91], a[208:209], a[170:171], v[88:91]
ds_read_b64_tr_b16 v[196:197], v25 offset:12288
v_mfma_f32_4x4x4_16b_bf16 v[92:95], a[208:209], a[26:27], v[92:95]
s_waitcnt lgkmcnt(9)
ds_read_b64_tr_b16 v[198:199], v25 offset:14336
v_mfma_f32_4x4x4_16b_bf16 v[76:79], a[208:209], a[108:109], v[76:79]
s_waitcnt vmcnt(0)
buffer_atomic_add v17, v52, s[36:39], 0 offen
v_mfma_f32_4x4x4_16b_bf16 v[80:83], a[208:209], a[110:111], v[80:83]
ds_read_b64_tr_b16 v[200:201], v28 offset:12288
v_mfma_f32_4x4x4_16b_bf16 v[84:87], a[208:209], a[172:173], v[84:87]
ds_read_b64_tr_b16 v[202:203], v28 offset:14336
v_mfma_f32_4x4x4_16b_bf16 v[88:91], a[208:209], a[174:175], v[88:91]
s_waitcnt lgkmcnt(8)
ds_read_b64_tr_b16 v[204:205], v23 offset:4096
v_mfma_f32_4x4x4_16b_bf16 v[92:95], a[208:209], a[28:29], v[92:95]
ds_read_b64_tr_b16 v[206:207], v23 offset:6144
v_mfma_f32_4x4x4_16b_bf16 v[76:79], a[208:209], a[112:113], v[76:79]
ds_read_b64_tr_b16 v[208:209], v19 offset:24576
v_mfma_f32_4x4x4_16b_bf16 v[80:83], a[208:209], a[114:115], v[80:83]
ds_read_b64_tr_b16 v[210:211], v19 offset:26624
v_mfma_f32_4x4x4_16b_bf16 v[84:87], a[208:209], a[176:177], v[84:87]
s_waitcnt lgkmcnt(8)
ds_read_b64_tr_b16 v[212:213], v22 offset:24576
v_mfma_f32_4x4x4_16b_bf16 v[88:91], a[208:209], a[178:179], v[88:91]
ds_read_b64_tr_b16 v[214:215], v22 offset:26624
v_mfma_f32_4x4x4_16b_bf16 v[92:95], a[208:209], a[30:31], v[92:95]
ds_read_b64_tr_b16 v[216:217], v25 offset:24576
v_mfma_f32_4x4x4_16b_bf16 v[76:79], a[208:209], a[116:117], v[76:79]
ds_read_b64_tr_b16 v[218:219], v25 offset:26624
v_mfma_f32_4x4x4_16b_bf16 v[80:83], a[208:209], a[118:119], v[80:83]
s_waitcnt lgkmcnt(8)
ds_read_b64_tr_b16 v[220:221], v28 offset:24576
v_mfma_f32_4x4x4_16b_bf16 v[84:87], a[208:209], a[180:181], v[84:87]
ds_read_b64_tr_b16 v[222:223], v28 offset:26624
v_mfma_f32_4x4x4_16b_bf16 v[88:91], a[208:209], a[182:183], v[88:91]
ds_read_b64_tr_b16 v[224:225], v20 offset:8192
v_mfma_f32_4x4x4_16b_bf16 v[92:95], a[208:209], a[32:33], v[92:95]
L_pg18:
s_cbranch_execz L_tr4
ds_read_b64_tr_b16 v[226:227], v20 offset:10240
v_mfma_f32_4x4x4_16b_bf16 v[76:79], a[208:209], a[120:121], v[76:79]
s_waitcnt lgkmcnt(8)
ds_read_b64_tr_b16 v[228:229], v19 offset:28672
v_mfma_f32_4x4x4_16b_bf16 v[80:83], a[208:209], a[122:123], v[80:83]
ds_read_b64_tr_b16 v[230:231], v19 offset:30720
v_mfma_f32_4x4x4_16b_bf16 v[84:87], a[208:209], a[184:185], v[84:87]
ds_read_b64_tr_b16 v[232:233], v22 offset:28672
v_mfma_f32_4x4x4_16b_bf16 v[88:91], a[208:209], a[186:187], v[88:91]
ds_read_b64_tr_b16 v[234:235], v22 offset:30720
v_mfma_f32_4x4x4_16b_bf16 v[92:95], a[208:209], a[34:35], v[92:95]
s_waitcnt lgkmcnt(8)
ds_read_b64_tr_b16 v[236:237], v25 offset:28672
v_mfma_f32_4x4x4_16b_bf16 v[96:99], a[208:209], a[240:241], 0
v_mul_f32 v125, 0xbfb8aa3b, v9
v_mfma_f32_4x4x4_16b_bf16 v[100:103], a[208:209], a[242:243], 0
v_rcp_f32 v126, v9
v_mfma_f32_4x4x4_16b_bf16 v[104:107], a[208:209], a[244:245], 0
v_mfma_f32_4x4x4_16b_bf16 v[108:111], a[208:209], a[246:247], 0
v_mfma_f32_4x4x4_16b_bf16 v[112:115], a[208:209], a[248:249], 0
s_mov_b32 s46, 0x80000
s_and_b32 s47, s78, 0x4040404
s_cmp_eq_u32 s47, 0x4040404
s_cbranch_scc0 L_we
L_ge:
global_load_dwordx4 a[0:3], v43, s[80:81] offset:-4096 sc1
global_load_dwordx4 a[4:7], v43, s[80:81] offset:-2048 sc1
global_load_dwordx4 a[8:11], v43, s[82:83] offset:-4096 sc1
global_load_dwordx4 a[12:15], v43, s[82:83] offset:-2048 sc1
global_load_dwordx4 a[16:19], v43, s[84:85] offset:-4096 sc1
global_load_dwordx4 a[20:23], v43, s[84:85] offset:-2048 sc1
s_atomic_umax s78, s[36:37], s79 glc
ds_read_b64_tr_b16 v[238:239], v25 offset:30720
s_waitcnt lgkmcnt(8)
ds_read_b64_tr_b16 v[240:241], v28 offset:28672
ds_read_b64_tr_b16 v[242:243], v28 offset:30720
ds_read_b64_tr_b16 v[244:245], v23 offset:8192
ds_read_b64_tr_b16 v[246:247], v23 offset:10240
s_waitcnt lgkmcnt(8)
ds_read_b64_tr_b16 v[248:249], v19 offset:40960
ds_read_b64_tr_b16 v[250:251], v19 offset:43008
ds_read_b64_tr_b16 v[252:253], v22 offset:40960
ds_read_b64_tr_b16 v[254:255], v22 offset:43008
s_waitcnt lgkmcnt(8)
ds_read_b64_tr_b16 a[212:213], v25 offset:40960
ds_read_b64_tr_b16 a[214:215], v25 offset:43008
ds_read_b64_tr_b16 a[216:217], v28 offset:40960
ds_read_b64_tr_b16 a[218:219], v28 offset:43008
s_waitcnt lgkmcnt(8)
ds_read_b64_tr_b16 a[220:221], v20 offset:12288
ds_read_b64_tr_b16 a[222:223], v20 offset:14336
ds_read_b64_tr_b16 a[224:225], v19 offset:45056
ds_read_b64_tr_b16 a[226:227], v19 offset:47104
s_waitcnt lgkmcnt(8)
ds_read_b64_tr_b16 a[228:229], v22 offset:45056
ds_read_b64_tr_b16 a[230:231], v22 offset:47104
ds_read_b64_tr_b16 a[232:233], v25 offset:45056
ds_read_b64_tr_b16 a[234:235], v25 offset:47104
s_waitcnt lgkmcnt(8)
ds_read_b64_tr_b16 a[236:237], v28 offset:45056
ds_read_b64_tr_b16 a[238:239], v28 offset:47104
ds_read_b64_tr_b16 a[72:73], v23 offset:12288
ds_read_b64_tr_b16 a[74:75], v23 offset:14336
s_waitcnt lgkmcnt(8)
ds_read_b64_tr_b16 a[76:77], v19 offset:57344
ds_read_b64_tr_b16 a[78:79], v19 offset:59392
ds_read_b64_tr_b16 a[80:81], v22 offset:57344
ds_read_b64_tr_b16 a[82:83], v22 offset:59392
s_waitcnt lgkmcnt(8)
ds_read_b64_tr_b16 a[84:85], v25 offset:57344
ds_read_b64_tr_b16 a[86:87], v25 offset:59392
ds_read_b64_tr_b16 a[88:89], v28 offset:57344
ds_read_b64_tr_b16 a[90:91], v28 offset:59392
s_waitcnt lgkmcnt(8)
ds_read_b64_tr_b16 a[92:93], v20 offset:16384
ds_read_b64_tr_b16 a[94:95], v20 offset:18432
ds_read_b64_tr_b16 a[96:97], v19
ds_read_b64_tr_b16 a[98:99], v19 offset:2048
s_waitcnt lgkmcnt(8)
ds_read_b64_tr_b16 a[100:101], v22
ds_read_b64_tr_b16 a[102:103], v22 offset:2048
ds_read_b64_tr_b16 a[104:105], v25
ds_read_b64_tr_b16 a[106:107], v25 offset:2048
s_waitcnt lgkmcnt(8)
ds_read_b64_tr_b16 a[108:109], v28
ds_read_b64_tr_b16 a[110:111], v28 offset:2048
ds_read_b64_tr_b16 a[112:113], v26
ds_read_b64_tr_b16 a[114:115], v26 offset:2048
v_mul_f32 v30, v125, v76
v_mul_f32 v31, v125, v77
v_mul_f32 v32, v125, v78
v_mul_f32 v33, v125, v79
v_mul_f32 v34, v125, v80
v_mul_f32 v35, v125, v81
v_mul_f32 v36, v125, v82
v_mul_f32 v37, v125, v83
v_mul_f32 v38, v125, v84
v_mul_f32 v39, v125, v85
v_mul_f32 v40, v125, v86
v_mul_f32 v41, v125, v87
v_mul_f32 v42, v125, v88
v_mul_f32 v45, v125, v89
v_mul_f32 v46, v125, v90
v_mul_f32 v47, v125, v91
v_mul_f32 v48, v125, v92
v_mul_f32 v49, v125, v93
v_mul_f32 v14, v125, v94
v_mul_f32 v15, v125, v95
v_exp_f32 v30, v30
v_exp_f32 v31, v31
v_exp_f32 v32, v32
v_exp_f32 v33, v33
v_exp_f32 v34, v34
v_exp_f32 v35, v35
v_exp_f32 v36, v36
v_exp_f32 v37, v37
v_exp_f32 v38, v38
v_exp_f32 v39, v39
v_exp_f32 v40, v40
v_exp_f32 v41, v41
v_exp_f32 v42, v42
v_exp_f32 v45, v45
v_exp_f32 v46, v46
v_exp_f32 v47, v47
global_load_dwordx4 a[24:27], v43, s[86:87] offset:-4096 sc1
global_load_dwordx4 a[28:31], v43, s[86:87] offset:-2048 sc1
global_load_dword a32, v44, s[98:99] sc1
s_atomic_umax s78, s[36:37], s79 glc
v_exp_f32 v48, v48
v_exp_f32 v49, v49
v_exp_f32 v14, v14
v_exp_f32 v15, v15
v_fma_f32 v30, v30, v126, v126
v_fma_f32 v31, v31, v126, v126
v_fma_f32 v32, v32, v126, v126
v_fma_f32 v33, v33, v126, v126
v_fma_f32 v34, v34, v126, v126
v_fma_f32 v35, v35, v126, v126
v_fma_f32 v36, v36, v126, v126
v_fma_f32 v37, v37, v126, v126
v_fma_f32 v38, v38, v126, v126
v_fma_f32 v39, v39, v126, v126
v_fma_f32 v40, v40, v126, v126
v_fma_f32 v41, v41, v126, v126
v_fma_f32 v42, v42, v126, v126
v_fma_f32 v45, v45, v126, v126
v_fma_f32 v46, v46, v126, v126
v_fma_f32 v47, v47, v126, v126
v_fma_f32 v48, v48, v126, v126
v_fma_f32 v49, v49, v126, v126
v_fma_f32 v14, v14, v126, v126
v_fma_f32 v15, v15, v126, v126
v_rcp_f32 v30, v30
v_rcp_f32 v31, v31
v_rcp_f32 v32, v32
v_rcp_f32 v33, v33
global_load_dword a33, v44, s[98:99] offset:128 sc1
global_load_dword a34, v44, s[98:99] offset:256 sc1
global_load_dword a35, v44, s[98:99] offset:384 sc1
s_atomic_umax s78, s[36:37], s79 glc
v_rcp_f32 v34, v34
v_rcp_f32 v35, v35
v_rcp_f32 v36, v36
v_rcp_f32 v37, v37
v_rcp_f32 v38, v38
v_rcp_f32 v39, v39
v_rcp_f32 v40, v40
v_rcp_f32 v41, v41
v_rcp_f32 v42, v42
v_rcp_f32 v45, v45
v_rcp_f32 v46, v46
v_rcp_f32 v47, v47
v_rcp_f32 v48, v48
v_rcp_f32 v49, v49
v_rcp_f32 v14, v14
v_rcp_f32 v15, v15
s_waitcnt vmcnt(11) lgkmcnt(6)
v_mfma_f32_16x16x32_bf16 v[56:59], v[128:131], a[0:3], 0
s_bitcmp1_b32 s78, 6
s_cbranch_scc0 L_w2
L_g2:
v_mfma_f32_16x16x32_bf16 v[60:63], v[132:135], a[0:3], 0
global_load_dwordx4 a[36:39], v43, s[80:81] sc1
v_mfma_f32_16x16x32_bf16 v[64:67], v[136:139], a[0:3], 0
ds_read_b64_tr_b16 a[116:117], v19 offset:4096
ds_read_b64_tr_b16 a[118:119], v19 offset:6144
v_mfma_f32_16x16x32_bf16 v[68:71], v[140:143], a[0:3], 0
ds_read_b64_tr_b16 a[120:121], v22 offset:4096
ds_read_b64_tr_b16 a[122:123], v22 offset:6144
v_mfma_f32_16x16x32_bf16 v[72:75], v[144:147], a[0:3], 0
ds_read_b64_tr_b16 a[124:125], v25 offset:4096
ds_read_b64_tr_b16 a[126:127], v25 offset:6144
s_waitcnt vmcnt(11) lgkmcnt(6)
v_mfma_f32_16x16x32_bf16 v[56:59], v[148:151], a[4:7], v[56:59]
ds_read_b64_tr_b16 a[128:129], v28 offset:4096
v_mul_f32 v76, v30, v76
v_mfma_f32_16x16x32_bf16 v[60:63], v[152:155], a[4:7], v[60:63]
global_load_dwordx4 a[40:43], v43, s[80:81] offset:2048 sc1
v_mfma_f32_16x16x32_bf16 v[64:67], v[156:159], a[4:7], v[64:67]
ds_read_b64_tr_b16 a[130:131], v28 offset:6144
ds_read_b64_tr_b16 a[132:133], v29
v_mfma_f32_16x16x32_bf16 v[68:71], v[160:163], a[4:7], v[68:71]
ds_read_b64_tr_b16 a[134:135], v29 offset:2048
v_mul_f32 v77, v31, v77
v_mfma_f32_16x16x32_bf16 v[72:75], v[164:167], a[4:7], v[72:75]
ds_read_b64_tr_b16 a[136:137], v19 offset:16384
ds_read_b64_tr_b16 a[138:139], v19 offset:18432
s_waitcnt vmcnt(11) lgkmcnt(6)
v_mfma_f32_16x16x32_bf16 v[56:59], v[168:171], a[8:11], v[56:59]
s_bitcmp1_b32 s78, 14
s_cbranch_scc0 L_w6
L_g6:
v_mfma_f32_16x16x32_bf16 v[60:63], v[172:175], a[8:11], v[60:63]
global_load_dwordx4 a[44:47], v43, s[82:83] sc1
v_mfma_f32_16x16x32_bf16 v[64:67], v[176:179], a[8:11], v[64:67]
ds_read_b64_tr_b16 a[140:141], v22 offset:16384
ds_read_b64_tr_b16 a[142:143], v22 offset:18432
v_mfma_f32_16x16x32_bf16 v[68:71], v[180:183], a[8:11], v[68:71]
ds_read_b64_tr_b16 a[144:145], v25 offset:16384
ds_read_b64_tr_b16 a[146:147], v25 offset:18432
v_mfma_f32_16x16x32_bf16 v[72:75], v[184:187], a[8:11], v[72:75]
ds_read_b64_tr_b16 a[148:149], v28 offset:16384
ds_read_b64_tr_b16 a[150:151], v28 offset:18432
s_waitcnt vmcnt(11) lgkmcnt(6)
v_mfma_f32_16x16x32_bf16 v[56:59], v[188:191], a[12:15], v[56:59]
ds_read_b64_tr_b16 a[152:153], v26 offset:4096
v_mul_f32 v78, v32, v78
v_mfma_f32_16x16x32_bf16 v[60:63], v[192:195], a[12:15], v[60:63]
global_load_dwordx4 a[48:51], v43, s[82:83] offset:2048 sc1
v_mfma_f32_16x16x32_bf16 v[64:67], v[196:199], a[12:15], v[64:67]
ds_read_b64_tr_b16 a[154:155], v26 offset:6144
ds_read_b64_tr_b16 a[156:157], v19 offset:20480
v_mfma_f32_16x16x32_bf16 v[68:71], v[200:203], a[12:15], v[68:71]
ds_read_b64_tr_b16 a[158:159], v19 offset:22528
v_mul_f32 v79, v33, v79
v_mfma_f32_16x16x32_bf16 v[72:75], v[204:207], a[12:15], v[72:75]
ds_read_b64_tr_b16 a[160:161], v22 offset:20480
ds_read_b64_tr_b16 a[162:163], v22 offset:22528
s_waitcnt vmcnt(11) lgkmcnt(6)
v_mfma_f32_16x16x32_bf16 v[56:59], v[208:211], a[16:19], v[56:59]
s_bitcmp1_b32 s78, 22
s_cbranch_scc0 L_w10
L_g10:
v_mfma_f32_16x16x32_bf16 v[60:63], v[212:215], a[16:19], v[60:63]
global_load_dwordx4 a[52:55], v43, s[84:85] sc1
v_mfma_f32_16x16x32_bf16 v[64:67], v[216:219], a[16:19], v[64:67]
ds_read_b64_tr_b16 a[164:165], v25 offset:20480
ds_read_b64_tr_b16 a[166:167], v25 offset:22528
v_mfma_f32_16x16x32_bf16 v[68:71], v[220:223], a[16:19], v[68:71]
ds_read_b64_tr_b16 a[168:169], v28 offset:20480
ds_read_b64_tr_b16 a[170:171], v28 offset:22528
v_mfma_f32_16x16x32_bf16 v[72:75], v[224:227], a[16:19], v[72:75]
ds_read_b64_tr_b16 a[172:173], v29 offset:4096
ds_read_b64_tr_b16 a[174:175], v29 offset:6144
s_waitcnt vmcnt(11) lgkmcnt(6)
v_mfma_f32_16x16x32_bf16 v[56:59], v[228:231], a[20:23], v[56:59]
ds_read_b64_tr_b16 a[176:177], v19 offset:32768
v_mul_f32 v80, v34, v80
v_mfma_f32_16x16x32_bf16 v[60:63], v[232:235], a[20:23], v[60:63]
global_load_dwordx4 a[56:59], v43, s[84:85] offset:2048 sc1
v_mfma_f32_16x16x32_bf16 v[64:67], v[236:239], a[20:23], v[64:67]
ds_read_b64_tr_b16 a[178:179], v19 offset:34816
ds_read_b64_tr_b16 a[180:181], v22 offset:32768
v_mfma_f32_16x16x32_bf16 v[68:71], v[240:243], a[20:23], v[68:71]
ds_read_b64_tr_b16 a[182:183], v22 offset:34816
v_mul_f32 v81, v35, v81
v_mfma_f32_16x16x32_bf16 v[72:75], v[244:247], a[20:23], v[72:75]
ds_read_b64_tr_b16 a[184:185], v25 offset:32768
ds_read_b64_tr_b16 a[186:187], v25 offset:34816
s_waitcnt vmcnt(11) lgkmcnt(6)
v_mfma_f32_16x16x32_bf16 v[56:59], v[248:251], a[24:27], v[56:59]
s_bitcmp1_b32 s78, 30
s_cbranch_scc0 L_w14
L_g14:
v_mfma_f32_16x16x32_bf16 v[60:63], v[252:255], a[24:27], v[60:63]
global_load_dwordx4 a[60:63], v43, s[86:87] sc1
v_mfma_f32_16x16x32_bf16 v[64:67], a[212:215], a[24:27], v[64:67]
ds_read_b64_tr_b16 a[188:189], v28 offset:32768
ds_read_b64_tr_b16 a[190:191], v28 offset:34816
v_mfma_f32_16x16x32_bf16 v[68:71], a[216:219], a[24:27], v[68:71]
ds_read_b64_tr_b16 a[192:193], v26 offset:8192
ds_read_b64_tr_b16 a[194:195], v26 offset:10240
v_mfma_f32_16x16x32_bf16 v[72:75], a[220:223], a[24:27], v[72:75]
ds_read_b64_tr_b16 a[196:197], v19 offset:36864
ds_read_b64_tr_b16 a[198:199], v19 offset:38912
s_waitcnt vmcnt(11) lgkmcnt(6)
v_mfma_f32_16x16x32_bf16 v[56:59], a[224:227], a[28:31], v[56:59]
ds_read_b64_tr_b16 a[200:201], v22 offset:36864
v_mul_f32 v82, v36, v82
v_mfma_f32_16x16x32_bf16 v[60:63], a[228:231], a[28:31], v[60:63]
global_load_dwordx4 a[64:67], v43, s[86:87] offset:2048 sc1
v_mfma_f32_16x16x32_bf16 v[64:67], a[232:235], a[28:31], v[64:67]
ds_read_b64_tr_b16 a[202:203], v22 offset:38912
ds_read_b64_tr_b16 a[204:205], v25 offset:36864
v_mfma_f32_16x16x32_bf16 v[68:71], a[236:239], a[28:31], v[68:71]
ds_read_b64_tr_b16 a[206:207], v25 offset:38912
v_mul_f32 v83, v37, v83
v_mfma_f32_16x16x32_bf16 v[72:75], a[72:75], a[28:31], v[72:75]
ds_read_b64_tr_b16 v[128:129], v28 offset:36864
ds_read_b64_tr_b16 v[130:131], v28 offset:38912
s_waitcnt vmcnt(8) lgkmcnt(6)
v_mfma_f32_16x16x32_bf16 v[56:59], a[76:79], a[32:35], v[56:59]
ds_read_b64_tr_b16 v[132:133], v29 offset:8192
v_mul_f32 v84, v38, v84
v_mfma_f32_16x16x32_bf16 v[60:63], a[80:83], a[32:35], v[60:63]
global_load_dword a68, v44, s[98:99] offset:512 sc1
v_mfma_f32_16x16x32_bf16 v[64:67], a[84:87], a[32:35], v[64:67]
ds_read_b64_tr_b16 v[134:135], v29 offset:10240
ds_read_b64_tr_b16 v[136:137], v19 offset:49152
v_mfma_f32_16x16x32_bf16 v[68:71], a[88:91], a[32:35], v[68:71]
ds_read_b64_tr_b16 v[138:139], v19 offset:51200
v_mul_f32 v85, v39, v85
v_mfma_f32_16x16x32_bf16 v[72:75], a[92:95], a[32:35], v[72:75]
ds_read_b64_tr_b16 v[140:141], v22 offset:49152
ds_read_b64_tr_b16 v[142:143], v22 offset:51200
s_waitcnt vmcnt(8) lgkmcnt(6)
v_mfma_f32_16x16x32_bf16 v[56:59], a[96:99], a[36:39], v[56:59]
ds_read_b64_tr_b16 v[144:145], v25 offset:49152
v_mul_f32 v86, v40, v86
v_mfma_f32_16x16x32_bf16 v[60:63], a[100:103], a[36:39], v[60:63]
global_load_dword a69, v44, s[98:99] offset:640 sc1
v_mfma_f32_16x16x32_bf16 v[64:67], a[104:107], a[36:39], v[64:67]
ds_read_b64_tr_b16 v[146:147], v25 offset:51200
ds_read_b64_tr_b16 v[148:149], v28 offset:49152
v_mfma_f32_16x16x32_bf16 v[68:71], a[108:111], a[36:39], v[68:71]
ds_read_b64_tr_b16 v[150:151], v28 offset:51200
v_mul_f32 v87, v41, v87
v_mfma_f32_16x16x32_bf16 v[72:75], a[112:115], a[36:39], v[72:75]
ds_read_b64_tr_b16 v[152:153], v26 offset:12288
ds_read_b64_tr_b16 v[154:155], v26 offset:14336
s_waitcnt vmcnt(8) lgkmcnt(6)
v_mfma_f32_16x16x32_bf16 v[56:59], a[116:119], a[40:43], v[56:59]
ds_read_b64_tr_b16 v[156:157], v19 offset:53248
v_mul_f32 v88, v42, v88
v_mfma_f32_16x16x32_bf16 v[60:63], a[120:123], a[40:43], v[60:63]
global_load_dword a70, v44, s[98:99] offset:768 sc1
v_mfma_f32_16x16x32_bf16 v[64:67], a[124:127], a[40:43], v[64:67]
ds_read_b64_tr_b16 v[158:159], v19 offset:55296
ds_read_b64_tr_b16 v[160:161], v22 offset:53248
v_mfma_f32_16x16x32_bf16 v[68:71], a[128:131], a[40:43], v[68:71]
ds_read_b64_tr_b16 v[162:163], v22 offset:55296
v_mul_f32 v89, v45, v89
v_mfma_f32_16x16x32_bf16 v[72:75], a[132:135], a[40:43], v[72:75]
ds_read_b64_tr_b16 v[164:165], v25 offset:53248
ds_read_b64_tr_b16 v[166:167], v25 offset:55296
s_waitcnt vmcnt(8) lgkmcnt(6)
v_mfma_f32_16x16x32_bf16 v[56:59], a[136:139], a[44:47], v[56:59]
ds_read_b64_tr_b16 v[168:169], v28 offset:53248
v_mul_f32 v90, v46, v90
v_mfma_f32_16x16x32_bf16 v[60:63], a[140:143], a[44:47], v[60:63]
global_load_dword a71, v44, s[98:99] offset:896 sc1
v_mfma_f32_16x16x32_bf16 v[64:67], a[144:147], a[44:47], v[64:67]
ds_read_b64_tr_b16 v[170:171], v28 offset:55296
ds_read_b64_tr_b16 v[172:173], v29 offset:12288
v_mfma_f32_16x16x32_bf16 v[68:71], a[148:151], a[44:47], v[68:71]
ds_read_b64_tr_b16 v[174:175], v29 offset:14336
v_mul_f32 v91, v47, v91
v_mfma_f32_16x16x32_bf16 v[72:75], a[152:155], a[44:47], v[72:75]
ds_read_b64_tr_b16 v[176:177], v19 offset:61440
ds_read_b64_tr_b16 v[178:179], v19 offset:63488
s_waitcnt vmcnt(8) lgkmcnt(6)
v_mfma_f32_16x16x32_bf16 v[56:59], a[156:159], a[48:51], v[56:59]
ds_read_b64_tr_b16 v[180:181], v22 offset:61440
v_mul_f32 v92, v48, v92
v_mfma_f32_16x16x32_bf16 v[60:63], a[160:163], a[48:51], v[60:63]
ds_read_b64_tr_b16 v[182:183], v22 offset:63488
v_mul_f32 v93, v49, v93
v_mfma_f32_16x16x32_bf16 v[64:67], a[164:167], a[48:51], v[64:67]
ds_read_b64_tr_b16 v[184:185], v25 offset:61440
v_mul_f32 v94, v14, v94
v_mfma_f32_16x16x32_bf16 v[68:71], a[168:171], a[48:51], v[68:71]
ds_read_b64_tr_b16 v[186:187], v25 offset:63488
v_mul_f32 v95, v15, v95
v_mfma_f32_16x16x32_bf16 v[72:75], a[172:175], a[48:51], v[72:75]
ds_read_b64_tr_b16 v[188:189], v28 offset:61440
ds_read_b64_tr_b16 v[190:191], v28 offset:63488
s_waitcnt vmcnt(7) lgkmcnt(6)
v_mfma_f32_16x16x32_bf16 v[56:59], a[176:179], a[52:55], v[56:59]
ds_read_b64_tr_b16 v[192:193], v23 offset:16384
v_mfma_f32_16x16x32_bf16 v[60:63], a[180:183], a[52:55], v[60:63]
ds_read_b64_tr_b16 v[194:195], v23 offset:18432
v_mfma_f32_16x16x32_bf16 v[64:67], a[184:187], a[52:55], v[64:67]
v_mfma_f32_16x16x32_bf16 v[68:71], a[188:191], a[52:55], v[68:71]
v_mfma_f32_16x16x32_bf16 v[72:75], a[192:195], a[52:55], v[72:75]
s_waitcnt vmcnt(6) lgkmcnt(6)
v_mfma_f32_16x16x32_bf16 v[56:59], a[196:199], a[56:59], v[56:59]
v_mfma_f32_16x16x32_bf16 v[60:63], a[200:203], a[56:59], v[60:63]
v_mfma_f32_16x16x32_bf16 v[64:67], a[204:207], a[56:59], v[64:67]
v_mfma_f32_16x16x32_bf16 v[68:71], v[128:131], a[56:59], v[68:71]
v_mfma_f32_16x16x32_bf16 v[72:75], v[132:135], a[56:59], v[72:75]
s_waitcnt vmcnt(5)
v_mfma_f32_16x16x32_bf16 v[72:75], v[152:155], a[60:63], v[72:75]
s_waitcnt vmcnt(4)
v_mfma_f32_16x16x32_bf16 v[72:75], v[172:175], a[64:67], v[72:75]
s_waitcnt vmcnt(0) lgkmcnt(0)
v_mfma_f32_16x16x32_bf16 v[72:75], v[192:195], a[68:71], v[72:75]
v_mfma_f32_16x16x32_bf16 v[56:59], v[136:139], a[60:63], v[56:59]
v_mfma_f32_16x16x32_bf16 v[56:59], v[156:159], a[64:67], v[56:59]
v_mfma_f32_16x16x32_bf16 v[56:59], v[176:179], a[68:71], v[56:59]
s_nop 4
v_fmac_f32 v112, v72, v92
v_fmac_f32 v113, v73, v93
v_mfma_f32_16x16x32_bf16 v[60:63], v[140:143], a[60:63], v[60:63]
v_fmac_f32 v114, v74, v94
v_fmac_f32 v115, v75, v95
v_mfma_f32_16x16x32_bf16 v[60:63], v[160:163], a[64:67], v[60:63]
v_cvt_pk_bf16_f32 v124, v112, v113
v_cvt_pk_bf16_f32 v125, v114, v115
v_mfma_f32_16x16x32_bf16 v[60:63], v[180:183], a[68:71], v[60:63]
buffer_store_dwordx2 v[124:125], v12, s[28:31], 0 offen
v_mfma_f32_16x16x32_bf16 v[64:67], v[144:147], a[60:63], v[64:67]
v_fmac_f32 v96, v56, v76
v_fmac_f32 v97, v57, v77
v_mfma_f32_16x16x32_bf16 v[64:67], v[164:167], a[64:67], v[64:67]
v_fmac_f32 v98, v58, v78
v_fmac_f32 v99, v59, v79
v_mfma_f32_16x16x32_bf16 v[64:67], v[184:187], a[68:71], v[64:67]
v_cvt_pk_bf16_f32 v116, v96, v97
v_cvt_pk_bf16_f32 v117, v98, v99
v_mfma_f32_16x16x32_bf16 v[68:71], v[148:151], a[60:63], v[68:71]
ds_write_b64 v55, v[116:117]
v_mfma_f32_16x16x32_bf16 v[68:71], v[168:171], a[64:67], v[68:71]
v_fmac_f32 v100, v60, v80
v_fmac_f32 v101, v61, v81
v_mfma_f32_16x16x32_bf16 v[68:71], v[188:191], a[68:71], v[68:71]
v_fmac_f32 v102, v62, v82
v_fmac_f32 v103, v63, v83
v_cvt_pk_bf16_f32 v118, v100, v101
v_cvt_pk_bf16_f32 v119, v102, v103
ds_write_b64 v55, v[118:119] offset:32
v_fmac_f32 v104, v64, v84
v_fmac_f32 v105, v65, v85
v_fmac_f32 v106, v66, v86
v_fmac_f32 v107, v67, v87
v_cvt_pk_bf16_f32 v120, v104, v105
v_cvt_pk_bf16_f32 v121, v106, v107
ds_write_b64 v55, v[120:121] offset:64
v_fmac_f32 v108, v68, v88
v_fmac_f32 v109, v69, v89
v_fmac_f32 v110, v70, v90
v_fmac_f32 v111, v71, v91
v_cvt_pk_bf16_f32 v122, v108, v109
v_cvt_pk_bf16_f32 v123, v110, v111
ds_write_b64 v55, v[122:123] offset:96
ds_read_b128 v[96:99], v10
ds_read_b128 v[100:103], v10 offset:1152
s_mov_b32 s47, 0x2400
s_waitcnt lgkmcnt(1)
buffer_store_dwordx4 v[96:99], v3, s[28:31], 0 offen sc1
s_waitcnt lgkmcnt(0)
buffer_store_dwordx4 v[100:103], v3, s[28:31], s47 offen sc1
s_endpgm
.p2align 12
L_pg19:
s_cbranch_execz L_tr4
L_we:
L_wle:
s_waitcnt lgkmcnt(0)
s_and_b32 s47, s78, 0x4040404
s_cmp_eq_u32 s47, 0x4040404
s_cbranch_scc1 L_ge
s_atomic_umax s78, s[36:37], s79 glc
s_addk_i32 s46, -1
s_cmp_gt_i32 s46, 0
s_cbranch_scc1 L_wle
s_branch L_ge
L_w2:
L_wl2:
s_waitcnt lgkmcnt(0)
s_bitcmp1_b32 s78, 6
s_cbranch_scc1 L_g2
s_atomic_umax s78, s[36:37], s79 glc
s_addk_i32 s46, -1
s_cmp_gt_i32 s46, 0
s_cbranch_scc1 L_wl2
s_branch L_g2
L_w6:
L_wl6:
s_waitcnt lgkmcnt(0)
s_bitcmp1_b32 s78, 14
s_cbranch_scc1 L_g6
s_atomic_umax s78, s[36:37], s79 glc
s_addk_i32 s46, -1
s_cmp_gt_i32 s46, 0
s_cbranch_scc1 L_wl6
s_branch L_g6
L_w10:
L_wl10:
s_waitcnt lgkmcnt(0)
s_bitcmp1_b32 s78, 22
s_cbranch_scc1 L_g10
s_atomic_umax s78, s[36:37], s79 glc
s_addk_i32 s46, -1
s_cmp_gt_i32 s46, 0
s_cbranch_scc1 L_wl10
s_branch L_g10
L_w14:
L_wl14:
s_waitcnt lgkmcnt(0)
s_bitcmp1_b32 s78, 30
s_cbranch_scc1 L_g14
s_atomic_umax s78, s[36:37], s79 glc
s_addk_i32 s46, -1
s_cmp_gt_i32 s46, 0
s_cbranch_scc1 L_wl14
s_branch L_g14
L_spin_f1:
v_mov_b32 v7, 0x40000
L_spinl_f1:
buffer_load_dword v53, v10, s[32:35], 0 offen sc1
s_waitcnt vmcnt(0)
v_cmp_gt_u32 vcc, 0x80, v53
s_nop 1
s_cbranch_vccz L_back_f1
v_subrev_u32 v7, 1, v7
v_cmp_ne_u32 vcc, 0, v7
s_sleep 40
s_cbranch_vccnz L_spinl_f1
s_branch L_back_f1
L_spin_f2:
v_mov_b32 v7, 0x40000
L_spinl_f2:
v_mov_b32 v53, 0
buffer_atomic_add v53, v51, s[36:39], 0 offen sc0
s_waitcnt vmcnt(0)
v_cmp_ne_u32 vcc, 0, v53
s_nop 1
s_cbranch_vccz L_back_f2
v_subrev_u32 v7, 1, v7
v_cmp_ne_u32 vcc, 0, v7
s_sleep 2
s_cbranch_vccnz L_spinl_f2
s_branch L_back_f2
L_fb:
s_waitcnt vmcnt(0) lgkmcnt(0)
s_nop 15
v_add_u32 v192, s54, v30
v_add_u32 v193, s54, v31
v_add_u32 v194, s54, v32
v_add_u32 v195, s54, v33
v_add_u32 v196, s54, v34
v_add_u32 v197, s54, v35
v_lshlrev_b32 v198, 4, v0
v_mov_b32 v15, 0
v_mov_b32 v199, 0xff800000
v_mov_b32 v200, 0xff800000
s_add_u32 s46, s44, 32
s_mul_i32 s46, s46, 0x14000
s_add_u32 s47, s46, 0x280000
s_mov_b32 s62, 64
L_fbl0:
s_add_u32 m0, s54, 0xa000
s_nop 0
buffer_load_dwordx4 v198, s[36:39], s46 offen sc1 lds
buffer_load_dwordx4 v198, s[36:39], s46 offen offset:1024 sc1 lds
s_waitcnt vmcnt(0)
ds_read_b128 a[40:43], v192 offset:40960
ds_read_b64 a[52:53], v193 offset:40960
s_waitcnt lgkmcnt(0)
v_mfma_f32_32x32x4_2b_bf16 v[160:191], a[52:53], v[14:15], 0
s_nop 15
s_nop 1
v_mfma_f32_32x32x16_bf16 v[160:175], a[40:43], a[0:3], v[160:175]
v_mfma_f32_32x32x16_bf16 v[176:191], a[40:43], a[4:7], v[176:191]
s_nop 10
v_max3_f32 v199, v199, v160, v161
v_max3_f32 v199, v199, v162, v163
v_max3_f32 v199, v199, v164, v165
v_max3_f32 v199, v199, v166, v167
v_max3_f32 v199, v199, v168, v169
v_max3_f32 v199, v199, v170, v171
v_max3_f32 v199, v199, v172, v173
v_max3_f32 v199, v199, v174, v175
v_max3_f32 v200, v200, v176, v177
v_max3_f32 v200, v200, v178, v179
v_max3_f32 v200, v200, v180, v181
v_max3_f32 v200, v200, v182, v183
v_max3_f32 v200, v200, v184, v185
v_max3_f32 v200, v200, v186, v187
v_max3_f32 v200, v200, v188, v189
v_max3_f32 v200, v200, v190, v191
s_nop 15
s_add_u32 s46, s46, 0x500
s_add_u32 s47, s47, 0x500
s_sub_u32 s62, s62, 1
s_cmp_lg_u32 s62, 0
s_cbranch_scc1 L_fbl0
v_permlane32_swap_b32 v199, v200
v_max_f32 v199, v199, v200
v_sub_f32 v199, 0, v199
v_cvt_pk_bf16_f32 v200, v199, v199
v_lshlrev_b32 v200, 16, v200
v_sub_f32 v200, v199, v200
v_cvt_pk_bf16_f32 v15, v199, v200
v_mov_b32 v128, 0
v_mov_b32 v129, 0
v_mov_b32 v130, 0
v_mov_b32 v131, 0
v_mov_b32 v132, 0
v_mov_b32 v133, 0
v_mov_b32 v134, 0
v_mov_b32 v135, 0
v_mov_b32 v136, 0
v_mov_b32 v137, 0
v_mov_b32 v138, 0
v_mov_b32 v139, 0
v_mov_b32 v140, 0
v_mov_b32 v141, 0
v_mov_b32 v142, 0
v_mov_b32 v143, 0
v_mov_b32 v144, 0
v_mov_b32 v145, 0
v_mov_b32 v146, 0
v_mov_b32 v147, 0
v_mov_b32 v148, 0
v_mov_b32 v149, 0
v_mov_b32 v150, 0
v_mov_b32 v151, 0
v_mov_b32 v152, 0
v_mov_b32 v153, 0
v_mov_b32 v154, 0
v_mov_b32 v155, 0
v_mov_b32 v156, 0
v_mov_b32 v157, 0
v_mov_b32 v158, 0
v_mov_b32 v159, 0
s_add_u32 s46, s44, 32
s_mul_i32 s46, s46, 0x14000
s_add_u32 s47, s46, 0x280000
s_mov_b32 s62, 64
L_fbl1:
s_add_u32 m0, s54, 0xa000
s_nop 0
buffer_load_dwordx4 v198, s[36:39], s46 offen sc1 lds
buffer_load_dwordx4 v198, s[36:39], s46 offen offset:1024 sc1 lds
s_add_u32 m0, s54, 0xaa00
s_nop 0
buffer_load_dwordx4 v198, s[36:39], s47 offen sc1 lds
buffer_load_dwordx4 v198, s[36:39], s47 offen offset:1024 sc1 lds
s_waitcnt vmcnt(0)
ds_read_b128 a[40:43], v192 offset:40960
ds_read_b64 a[52:53], v193 offset:40960
ds_read_b64_tr_b16 a[8:9], v194 offset:43520
ds_read_b64_tr_b16 a[10:11], v195 offset:43520
ds_read_b64_tr_b16 a[12:13], v196 offset:43520
ds_read_b64_tr_b16 a[14:15], v197 offset:43520
s_waitcnt lgkmcnt(0)
v_mfma_f32_32x32x4_2b_bf16 v[160:191], a[52:53], v[14:15], 0
s_nop 15
s_nop 1
v_mfma_f32_32x32x16_bf16 v[160:175], a[40:43], a[0:3], v[160:175]
v_mfma_f32_32x32x16_bf16 v[176:191], a[40:43], a[4:7], v[176:191]
s_nop 10
v_exp_f32 v160, v160
v_exp_f32 v161, v161
v_exp_f32 v162, v162
v_exp_f32 v163, v163
v_exp_f32 v164, v164
v_exp_f32 v165, v165
v_exp_f32 v166, v166
v_exp_f32 v167, v167
v_exp_f32 v168, v168
v_exp_f32 v169, v169
v_exp_f32 v170, v170
v_exp_f32 v171, v171
v_exp_f32 v172, v172
v_exp_f32 v173, v173
v_exp_f32 v174, v174
v_exp_f32 v175, v175
v_smfmac_f32_32x32x32_bf16 v[128:143], a[8:11], v[160:167], v54
s_nop 0
v_smfmac_f32_32x32x32_bf16 v[128:143], a[12:15], v[168:175], v54
v_exp_f32 v176, v176
v_exp_f32 v177, v177
v_exp_f32 v178, v178
v_exp_f32 v179, v179
v_exp_f32 v180, v180
v_exp_f32 v181, v181
v_exp_f32 v182, v182
v_exp_f32 v183, v183
v_exp_f32 v184, v184
v_exp_f32 v185, v185
v_exp_f32 v186, v186
v_exp_f32 v187, v187
v_exp_f32 v188, v188
v_exp_f32 v189, v189
v_exp_f32 v190, v190
v_exp_f32 v191, v191
v_smfmac_f32_32x32x32_bf16 v[144:159], a[8:11], v[176:183], v54
s_nop 0
v_smfmac_f32_32x32x32_bf16 v[144:159], a[12:15], v[184:191], v54
s_nop 15
s_add_u32 s46, s46, 0x500
s_add_u32 s47, s47, 0x500
s_sub_u32 s62, s62, 1
s_cmp_lg_u32 s62, 0
s_cbranch_scc1 L_fbl1
v_rcp_f32 v116, v138
s_nop 0
v_mov_b32 v117, v116
s_nop 1
v_permlane32_swap_b32 v116, v117
v_mul_f32 v224, v116, v128
v_mul_f32 v225, v116, v129
v_mul_f32 v226, v116, v130
v_mul_f32 v227, v116, v131
v_mul_f32 v228, v116, v132
v_mul_f32 v229, v116, v133
v_mul_f32 v230, v116, v134
v_mul_f32 v231, v116, v135
v_mul_f32 v232, v116, v136
v_mul_f32 v233, v116, v137
v_cvt_pk_bf16_f32 v224, v224, v225
v_cvt_pk_bf16_f32 v225, v226, v227
v_cvt_pk_bf16_f32 v226, v228, v229
v_cvt_pk_bf16_f32 v227, v230, v231
global_store_dwordx4 v45, v[224:227], s[88:89] sc1
v_cvt_pk_bf16_f32 v232, v232, v233
v_rcp_f32 v116, v154
s_nop 0
v_mov_b32 v117, v116
s_nop 1
v_permlane32_swap_b32 v116, v117
v_mul_f32 v240, v116, v144
v_mul_f32 v241, v116, v145
v_mul_f32 v242, v116, v146
v_mul_f32 v243, v116, v147
v_mul_f32 v244, v116, v148
v_mul_f32 v245, v116, v149
v_mul_f32 v246, v116, v150
v_mul_f32 v247, v116, v151
v_mul_f32 v248, v116, v152
v_mul_f32 v249, v116, v153
v_cvt_pk_bf16_f32 v240, v240, v241
v_cvt_pk_bf16_f32 v241, v242, v243
v_cvt_pk_bf16_f32 v242, v244, v245
v_cvt_pk_bf16_f32 v243, v246, v247
global_store_dwordx4 v45, v[240:243], s[90:91] sc1
v_cvt_pk_bf16_f32 v248, v248, v249
s_nop 1
v_permlane32_swap_b32 v232, v248
global_store_dword v46, v232, s[36:37] sc1
s_waitcnt vmcnt(0)
s_nop 3
s_branch L_fb_ret
s_endpgm
L_codeend:
.section .rodata,"a"
.p2align 6
.amdhsa_kernel recurrent_scan__mha_block__glu_gated_reglu__prompt_kernel
  .amdhsa_next_free_vgpr 512
  .amdhsa_next_free_sgpr 102
  .amdhsa_accum_offset 256
  .amdhsa_group_segment_fixed_size 0
  .amdhsa_kernarg_size 80
  .amdhsa_user_sgpr_count 2
  .amdhsa_user_sgpr_kernarg_segment_ptr 1
  .amdhsa_system_sgpr_workgroup_id_x 1
  .amdhsa_float_denorm_mode_32 3
.end_amdhsa_kernel
```
